```python
import torch

def _softmax(x, axis=-1):
    return torch.softmax(x, dim=axis)
def _gelu(x):
    return torch.nn.functional.gelu(x, approximate="tanh")
def _silu(x):
    return torch.nn.functional.silu(x)
def _sigmoid(x):
    return torch.sigmoid(x)
def _layernorm(x, axis=-1, eps=1e-5):
    m = x.mean(dim=axis, keepdim=True)
    v = x.var(dim=axis, keepdim=True, unbiased=False)
    return (x - m) / torch.sqrt(v + eps)
def _scatter_add(tgt, idx, src, axis=0):
    return tgt.clone().index_add_(axis, idx, src)
def _segment_sum(src, seg, n):
    out = torch.zeros((n,) + src.shape[1:], dtype=src.dtype)
    return out.index_add_(0, seg, src)
def _pad(x, pw):
    flat = tuple(v for pair in reversed(pw) for v in pair)
    return torch.nn.functional.pad(x, flat)

kernel_name = 'standalone__standard_2d_1d_3d_conv__vision'

def setup_inputs():

    _w = (lambda a: (lambda t: t.to(torch.bfloat16) if t.is_floating_point() else t)(torch.as_tensor(a)))
    H = W = 224
    C = 192
    K = 3
    return {
        "x": _w((lambda *s: torch.randn(*s, dtype=torch.bfloat16) * 0.05)(1, H, W, C)),
        "w": _w((lambda *s: torch.randn(*s, dtype=torch.bfloat16) * 0.05)(K, K, C, C)),
        "b": _w((lambda *s: torch.randn(*s, dtype=torch.bfloat16) * 0.05)(C)),
    }

def reference(x, w, b):
    B, H, W, Cin = x.shape
    K = w.shape[0]
    pl = (K - 1) // 2
    pr = K // 2
    xp = _pad(x, ((0, 0), (pl, pr), (pl, pr), (0, 0)))
    out = sum(
        torch.einsum('bhwc,cd->bhwd', xp[:, i:i+H, j:j+W, :], w[i, j])
        for i in range(K) for j in range(K)
    )
    return out + b[None, None, None, :]
```

```asm
; @launch grid=(256,1,1) block=(512,1,1) lds=149504
.amdgcn_target "amdgcn-amd-amdhsa--gfx950"
.text
.globl standalone__standard_2d_1d_3d_conv__vision_kernel
.p2align 8
.type standalone__standard_2d_1d_3d_conv__vision_kernel,@function
standalone__standard_2d_1d_3d_conv__vision_kernel:
    s_load_dwordx8 s[28:35], s[0:1], 0
    s_load_dwordx4 s[24:27], s[0:1], 32
    v_lshrrev_b32 v1, 6, v0
    s_cmp_ge_u32 s2, 256
    s_cbranch_scc1 L_END
    v_readfirstlane_b32 s36, v1
    v_and_b32 v0, 63, v0
    s_getpc_b64 s[56:57]
    s_bfe_u32 s47, s2, 65539
    v_min_u32 v2, 11, v0
    v_lshl_add_u32 v2, v2, 1, s47
    v_mul_u32_u24 v1, 12800, v1
    v_lshl_add_u32 v2, v2, 7, v1
    v_min_u32 v2, L_END-standalone__standard_2d_1d_3d_conv__vision_kernel-256, v2
    global_load_dword v255, v2, s[56:57]
    s_mov_b32 s51, 0xffff0000
    s_mov_b32 s59, 0x80000000
    s_lshr_b32 s46, s2, 3
    s_sub_u32 s47, s46, 7
    s_cmp_lt_u32 s47, 12
    s_cselect_b32 s40, 1, 0
    s_cmp_lt_u32 s36, 4
    s_cbranch_scc1 L_CONS
    s_sub_u32 s55, s36, 4
    s_cmp_lt_u32 s46, 7
    s_cbranch_scc1 L_PW
    s_and_b32 s47, s2, 7
    s_lshl_b32 s47, s47, 5
    s_add_u32 s47, s47, s46
    s_mul_i32 s47, s47, 7
    s_lshr_b32 s38, s47, 8
    s_and_b32 s47, s47, 255
    s_mul_i32 s47, s47, 293
    s_lshr_b32 s47, s47, 11
    s_mul_i32 s39, s47, 6
    v_and_b32 v13, 3, v0
    v_bfe_u32 v14, v0, 2, 2
    v_bfe_u32 v15, v0, 4, 1
    v_lshrrev_b32 v7, 5, v0
    s_lshl_b32 s47, s55, 1
    s_add_u32 s47, s47, s39
    s_mul_i32 s47, s47, 86016
    s_mul_i32 s48, s38, 12288
    s_add_u32 s47, s47, s48
    s_sub_u32 s47, s47, 86016
    v_mul_u32_u24 v16, 86016, v15
    v_lshl_add_u32 v16, v13, 4, v16
    v_lshl_add_u32 v16, v7, 6, v16
    v_mul_u32_u24 v2, 3072, v14
    v_add3_u32 v2, v2, v16, s47
    v_cmp_gt_i32 vcc, 0, v2
    v_lshl_add_u32 v16, s38, 2, v14
    v_mov_b32 v3, s59
    v_cndmask_b32 v2, v2, v3, vcc
    v_cmp_ne_u32 vcc, 0, v16
    v_subrev_u32 v1, 384, v2
    v_add_u32 v8, 3072, v2
    v_cndmask_b32 v1, v3, v1, vcc
    v_cmp_ne_u32 vcc, 27, v16
    s_waitcnt lgkmcnt(0)
    s_mov_b32 s4, s28
    s_mov_b32 s5, s29
    s_mov_b32 s6, 19267584
    s_mov_b32 s7, 0x20000
    v_cndmask_b32 v3, v3, v8, vcc
    buffer_load_dwordx4 v[58:61], v1, s[4:7], 0 offen offset:0
    buffer_load_dwordx4 v[66:69], v2, s[4:7], 0 offen offset:384
    buffer_load_dwordx4 v[74:77], v2, s[4:7], 0 offen offset:1152
    buffer_load_dwordx4 v[82:85], v2, s[4:7], 0 offen offset:1920
    buffer_load_dwordx4 v[90:93], v2, s[4:7], 0 offen offset:2688
    s_cmp_eq_u32 s40, 0
    s_cbranch_scc1 L_PN
    s_cmp_eq_u32 s55, 3
    s_cbranch_scc1 L_PN
    s_lshl_b32 s47, s55, 1
    v_add_u32 v15, s47, v15
    v_mul_u32_u24 v7, 11264, v7
    v_lshl_add_u32 v7, v15, 10, v7
    v_lshlrev_b32 v16, 2, v14
    v_lshl_add_u32 v16, v13, 4, v16
    v_add_u32 v16, v16, v13
    v_lshl_add_u32 v7, v16, 4, v7
    v_xor_b32 v8, 16, v7
    v_xor_b32 v9, 32, v7
    v_xor_b32 v10, 48, v7
    s_and_b32 s47, s2, 7
    s_mul_i32 s47, s47, 12
    s_add_u32 s47, s47, s46
    s_sub_u32 s47, s47, 7
    s_mul_i32 s48, s47, 21846
    s_lshr_b32 s48, s48, 16
    s_mul_i32 s49, s48, 3
    s_sub_u32 s43, s47, s49
    s_cmp_eq_u32 s40, 1
    s_cselect_b32 s43, s43, 0
    s_cselect_b32 s48, s48, 0
    s_lshl_b32 s41, s48, 1
    s_and_b32 s41, s41, 12
    s_lshr_b32 s41, 0x5310, s41
    s_and_b32 s41, s41, 15
    s_and_b32 s42, s48, 1
    s_add_u32 s42, s42, 222
    s_lshr_b32 s50, s48, 3
    s_lshl_b32 s50, s50, 1
    s_and_b32 s49, s48, 7
    s_add_u32 s49, s49, 216
    s_cmp_lt_u32 s48, 8
    s_cselect_b32 s41, s41, s50
    s_cselect_b32 s42, s42, s49
    s_mov_b32 s12, s34
    s_mov_b32 s13, s35
    s_mov_b32 s14, 19267584
    s_mov_b32 s15, 0x20000
    v_bfe_u32 v14, v0, 2, 1
    v_lshlrev_b32 v14, 1, v14
    v_bfe_u32 v15, v0, 3, 1
    v_bfe_u32 v16, v0, 4, 1
    v_lshlrev_b32 v16, 2, v16
    v_or3_b32 v14, v14, v15, v16
    s_add_u32 s47, s42, s55
    s_sub_u32 s47, s47, 1
    s_mul_i32 s48, s47, 86016
    s_cmp_lt_u32 s47, 224
    s_cselect_b32 s48, s48, s59
    s_lshl_b32 s47, s41, 5
    v_lshl_add_u32 v17, v14, 2, s47
    v_mul_u32_u24 v15, 384, v17
    v_lshl_add_u32 v15, v13, 4, v15
    v_lshrrev_b32 v16, 5, v0
    v_lshl_add_u32 v15, v16, 6, v15
    v_add_u32 v5, s48, v15
    v_cmp_ne_u32 vcc, 0, v17
    v_subrev_u32 v15, 384, v5
    v_mov_b32 v4, s59
    v_cndmask_b32 v4, v4, v15, vcc
    v_cmp_ne_u32 vcc, 220, v17
    v_add_u32 v15, 1536, v5
    v_mov_b32 v6, s59
    v_cndmask_b32 v6, v6, v15, vcc
    buffer_load_dwordx4 v[178:181], v4, s[4:7], 0 offen offset:0
    buffer_load_dwordx4 v[186:189], v5, s[4:7], 0 offen offset:384
    buffer_load_dwordx4 v[194:197], v5, s[4:7], 0 offen offset:1152
    buffer_load_dwordx4 v[62:65], v2, s[4:7], 0 offen offset:0
    buffer_load_dwordx4 v[70:73], v2, s[4:7], 0 offen offset:768
    buffer_load_dwordx4 v[78:81], v2, s[4:7], 0 offen offset:1536
    buffer_load_dwordx4 v[86:89], v2, s[4:7], 0 offen offset:2304
    buffer_load_dwordx4 v[94:97], v3, s[4:7], 0 offen offset:0
    buffer_load_dwordx4 v[182:185], v5, s[4:7], 0 offen offset:0
    buffer_load_dwordx4 v[190:193], v5, s[4:7], 0 offen offset:768
    buffer_load_dwordx4 v[198:201], v6, s[4:7], 0 offen offset:0
    v_lshlrev_b32 v14, 1, v14
    v_xor_b32 v14, v14, v13
    v_lshl_add_u32 v14, v13, 4, v14
    v_lshlrev_b32 v14, 4, v14
    v_mul_u32_u24 v16, 11264, v16
    s_add_u32 s47, s55, 8
    s_lshl_b32 s47, s47, 10
    v_add3_u32 v11, v14, v16, s47
    v_xor_b32 v12, 16, v11
    v_mov_b32 v251, 1
    v_mov_b32 v252, 67584
    s_waitcnt lgkmcnt(0)
    s_barrier
    s_waitcnt vmcnt(11)
    v_lshlrev_b32 v13, 16, v58
    v_and_b32 v14, s51, v58
    v_lshlrev_b32 v15, 16, v59
    v_and_b32 v16, s51, v59
    v_lshlrev_b32 v17, 16, v60
    v_and_b32 v18, s51, v60
    v_lshlrev_b32 v19, 16, v61
    v_and_b32 v20, s51, v61
    v_lshlrev_b32 v21, 16, v66
    v_and_b32 v22, s51, v66
    v_lshlrev_b32 v23, 16, v67
    v_and_b32 v24, s51, v67
    v_lshlrev_b32 v25, 16, v68
    v_and_b32 v54, s51, v68
    v_lshlrev_b32 v55, 16, v69
    v_and_b32 v56, s51, v69
    v_sub_f32 v13, v13, v21
    v_sub_f32 v14, v14, v22
    v_sub_f32 v15, v15, v23
    v_sub_f32 v16, v16, v24
    v_sub_f32 v17, v17, v25
    v_sub_f32 v18, v18, v54
    v_sub_f32 v19, v19, v55
    v_sub_f32 v20, v20, v56
    v_cvt_pk_bf16_f32 v26, v13, v14
    v_cvt_pk_bf16_f32 v27, v15, v16
    v_cvt_pk_bf16_f32 v28, v17, v18
    v_cvt_pk_bf16_f32 v29, v19, v20
    ds_write_b128 v7, v[26:29] offset:0
    v_lshlrev_b32 v13, 16, v74
    v_and_b32 v14, s51, v74
    v_lshlrev_b32 v15, 16, v75
    v_and_b32 v16, s51, v75
    v_lshlrev_b32 v17, 16, v76
    v_and_b32 v18, s51, v76
    v_lshlrev_b32 v19, 16, v77
    v_and_b32 v20, s51, v77
    v_sub_f32 v21, v21, v13
    v_sub_f32 v22, v22, v14
    v_sub_f32 v23, v23, v15
    v_sub_f32 v24, v24, v16
    v_sub_f32 v25, v25, v17
    v_sub_f32 v54, v54, v18
    v_sub_f32 v55, v55, v19
    v_sub_f32 v56, v56, v20
    v_cvt_pk_bf16_f32 v30, v21, v22
    v_cvt_pk_bf16_f32 v31, v23, v24
    v_cvt_pk_bf16_f32 v32, v25, v54
    v_cvt_pk_bf16_f32 v33, v55, v56
    ds_write_b128 v8, v[30:33] offset:0
    v_lshlrev_b32 v21, 16, v82
    v_and_b32 v22, s51, v82
    v_lshlrev_b32 v23, 16, v83
    v_and_b32 v24, s51, v83
    v_lshlrev_b32 v25, 16, v84
    v_and_b32 v54, s51, v84
    v_lshlrev_b32 v55, 16, v85
    v_and_b32 v56, s51, v85
    v_sub_f32 v13, v13, v21
    v_sub_f32 v14, v14, v22
    v_sub_f32 v15, v15, v23
    v_sub_f32 v16, v16, v24
    v_sub_f32 v17, v17, v25
    v_sub_f32 v18, v18, v54
    v_sub_f32 v19, v19, v55
    v_sub_f32 v20, v20, v56
    v_cvt_pk_bf16_f32 v26, v13, v14
    v_cvt_pk_bf16_f32 v27, v15, v16
    v_cvt_pk_bf16_f32 v28, v17, v18
    v_cvt_pk_bf16_f32 v29, v19, v20
    ds_write_b128 v9, v[26:29] offset:0
    v_lshlrev_b32 v13, 16, v90
    v_and_b32 v14, s51, v90
    v_lshlrev_b32 v15, 16, v91
    v_and_b32 v16, s51, v91
    v_lshlrev_b32 v17, 16, v92
    v_and_b32 v18, s51, v92
    v_lshlrev_b32 v19, 16, v93
    v_and_b32 v20, s51, v93
    v_sub_f32 v21, v21, v13
    v_sub_f32 v22, v22, v14
    v_sub_f32 v23, v23, v15
    v_sub_f32 v24, v24, v16
    v_sub_f32 v25, v25, v17
    v_sub_f32 v54, v54, v18
    v_sub_f32 v55, v55, v19
    v_sub_f32 v56, v56, v20
    v_cvt_pk_bf16_f32 v30, v21, v22
    v_cvt_pk_bf16_f32 v31, v23, v24
    v_cvt_pk_bf16_f32 v32, v25, v54
    v_cvt_pk_bf16_f32 v33, v55, v56
    ds_write_b128 v10, v[30:33] offset:0
    s_waitcnt vmcnt(8)
    v_lshlrev_b32 v13, 16, v178
    v_and_b32 v14, s51, v178
    v_lshlrev_b32 v15, 16, v179
    v_and_b32 v16, s51, v179
    v_lshlrev_b32 v17, 16, v180
    v_and_b32 v18, s51, v180
    v_lshlrev_b32 v19, 16, v181
    v_and_b32 v20, s51, v181
    v_lshlrev_b32 v21, 16, v186
    v_and_b32 v22, s51, v186
    v_lshlrev_b32 v23, 16, v187
    v_and_b32 v24, s51, v187
    v_lshlrev_b32 v25, 16, v188
    v_and_b32 v54, s51, v188
    v_lshlrev_b32 v55, 16, v189
    v_and_b32 v56, s51, v189
    v_sub_f32 v13, v13, v21
    v_sub_f32 v14, v14, v22
    v_sub_f32 v15, v15, v23
    v_sub_f32 v16, v16, v24
    v_sub_f32 v17, v17, v25
    v_sub_f32 v18, v18, v54
    v_sub_f32 v19, v19, v55
    v_sub_f32 v20, v20, v56
    v_cvt_pk_bf16_f32 v34, v13, v14
    v_cvt_pk_bf16_f32 v35, v15, v16
    v_cvt_pk_bf16_f32 v36, v17, v18
    v_cvt_pk_bf16_f32 v37, v19, v20
    ds_write_b128 v11, v[34:37] offset:0
    v_lshlrev_b32 v13, 16, v194
    v_and_b32 v14, s51, v194
    v_lshlrev_b32 v15, 16, v195
    v_and_b32 v16, s51, v195
    v_lshlrev_b32 v17, 16, v196
    v_and_b32 v18, s51, v196
    v_lshlrev_b32 v19, 16, v197
    v_and_b32 v20, s51, v197
    v_sub_f32 v21, v21, v13
    v_sub_f32 v22, v22, v14
    v_sub_f32 v23, v23, v15
    v_sub_f32 v24, v24, v16
    v_sub_f32 v25, v25, v17
    v_sub_f32 v54, v54, v18
    v_sub_f32 v55, v55, v19
    v_sub_f32 v56, v56, v20
    v_cvt_pk_bf16_f32 v38, v21, v22
    v_cvt_pk_bf16_f32 v39, v23, v24
    v_cvt_pk_bf16_f32 v40, v25, v54
    v_cvt_pk_bf16_f32 v41, v55, v56
    ds_write_b128 v12, v[38:41] offset:0
    s_mov_b64 exec, 1
    ds_add_u32 v252, v251 offset:448
    s_mov_b64 exec, -1
    s_waitcnt vmcnt(3)
    v_lshlrev_b32 v13, 16, v62
    v_and_b32 v14, s51, v62
    v_lshlrev_b32 v15, 16, v63
    v_and_b32 v16, s51, v63
    v_lshlrev_b32 v17, 16, v64
    v_and_b32 v18, s51, v64
    v_lshlrev_b32 v19, 16, v65
    v_and_b32 v20, s51, v65
    v_lshlrev_b32 v21, 16, v70
    v_and_b32 v22, s51, v70
    v_lshlrev_b32 v23, 16, v71
    v_and_b32 v24, s51, v71
    v_lshlrev_b32 v25, 16, v72
    v_and_b32 v54, s51, v72
    v_lshlrev_b32 v55, 16, v73
    v_and_b32 v56, s51, v73
    v_sub_f32 v13, v13, v21
    v_sub_f32 v14, v14, v22
    v_sub_f32 v15, v15, v23
    v_sub_f32 v16, v16, v24
    v_sub_f32 v17, v17, v25
    v_sub_f32 v18, v18, v54
    v_sub_f32 v19, v19, v55
    v_sub_f32 v20, v20, v56
    v_cvt_pk_bf16_f32 v26, v13, v14
    v_cvt_pk_bf16_f32 v27, v15, v16
    v_cvt_pk_bf16_f32 v28, v17, v18
    v_cvt_pk_bf16_f32 v29, v19, v20
    ds_write_b128 v7, v[26:29] offset:22528
    v_lshlrev_b32 v13, 16, v78
    v_and_b32 v14, s51, v78
    v_lshlrev_b32 v15, 16, v79
    v_and_b32 v16, s51, v79
    v_lshlrev_b32 v17, 16, v80
    v_and_b32 v18, s51, v80
    v_lshlrev_b32 v19, 16, v81
    v_and_b32 v20, s51, v81
    v_sub_f32 v21, v21, v13
    v_sub_f32 v22, v22, v14
    v_sub_f32 v23, v23, v15
    v_sub_f32 v24, v24, v16
    v_sub_f32 v25, v25, v17
    v_sub_f32 v54, v54, v18
    v_sub_f32 v55, v55, v19
    v_sub_f32 v56, v56, v20
    v_cvt_pk_bf16_f32 v30, v21, v22
    v_cvt_pk_bf16_f32 v31, v23, v24
    v_cvt_pk_bf16_f32 v32, v25, v54
    v_cvt_pk_bf16_f32 v33, v55, v56
    ds_write_b128 v8, v[30:33] offset:22528
    v_lshlrev_b32 v21, 16, v86
    v_and_b32 v22, s51, v86
    v_lshlrev_b32 v23, 16, v87
    v_and_b32 v24, s51, v87
    v_lshlrev_b32 v25, 16, v88
    v_and_b32 v54, s51, v88
    v_lshlrev_b32 v55, 16, v89
    v_and_b32 v56, s51, v89
    v_sub_f32 v13, v13, v21
    v_sub_f32 v14, v14, v22
    v_sub_f32 v15, v15, v23
    v_sub_f32 v16, v16, v24
    v_sub_f32 v17, v17, v25
    v_sub_f32 v18, v18, v54
    v_sub_f32 v19, v19, v55
    v_sub_f32 v20, v20, v56
    v_cvt_pk_bf16_f32 v26, v13, v14
    v_cvt_pk_bf16_f32 v27, v15, v16
    v_cvt_pk_bf16_f32 v28, v17, v18
    v_cvt_pk_bf16_f32 v29, v19, v20
    ds_write_b128 v9, v[26:29] offset:22528
    v_lshlrev_b32 v13, 16, v94
    v_and_b32 v14, s51, v94
    v_lshlrev_b32 v15, 16, v95
    v_and_b32 v16, s51, v95
    v_lshlrev_b32 v17, 16, v96
    v_and_b32 v18, s51, v96
    v_lshlrev_b32 v19, 16, v97
    v_and_b32 v20, s51, v97
    v_sub_f32 v21, v21, v13
    v_sub_f32 v22, v22, v14
    v_sub_f32 v23, v23, v15
    v_sub_f32 v24, v24, v16
    v_sub_f32 v25, v25, v17
    v_sub_f32 v54, v54, v18
    v_sub_f32 v55, v55, v19
    v_sub_f32 v56, v56, v20
    v_cvt_pk_bf16_f32 v30, v21, v22
    v_cvt_pk_bf16_f32 v31, v23, v24
    v_cvt_pk_bf16_f32 v32, v25, v54
    v_cvt_pk_bf16_f32 v33, v55, v56
    ds_write_b128 v10, v[30:33] offset:22528
    s_waitcnt vmcnt(0)
    v_lshlrev_b32 v13, 16, v182
    v_and_b32 v14, s51, v182
    v_lshlrev_b32 v15, 16, v183
    v_and_b32 v16, s51, v183
    v_lshlrev_b32 v17, 16, v184
    v_and_b32 v18, s51, v184
    v_lshlrev_b32 v19, 16, v185
    v_and_b32 v20, s51, v185
    v_lshlrev_b32 v21, 16, v190
    v_and_b32 v22, s51, v190
    v_lshlrev_b32 v23, 16, v191
    v_and_b32 v24, s51, v191
    v_lshlrev_b32 v25, 16, v192
    v_and_b32 v54, s51, v192
    v_lshlrev_b32 v55, 16, v193
    v_and_b32 v56, s51, v193
    v_sub_f32 v13, v13, v21
    v_sub_f32 v14, v14, v22
    v_sub_f32 v15, v15, v23
    v_sub_f32 v16, v16, v24
    v_sub_f32 v17, v17, v25
    v_sub_f32 v18, v18, v54
    v_sub_f32 v19, v19, v55
    v_sub_f32 v20, v20, v56
    v_cvt_pk_bf16_f32 v34, v13, v14
    v_cvt_pk_bf16_f32 v35, v15, v16
    v_cvt_pk_bf16_f32 v36, v17, v18
    v_cvt_pk_bf16_f32 v37, v19, v20
    ds_write_b128 v11, v[34:37] offset:22528
    v_lshlrev_b32 v13, 16, v198
    v_and_b32 v14, s51, v198
    v_lshlrev_b32 v15, 16, v199
    v_and_b32 v16, s51, v199
    v_lshlrev_b32 v17, 16, v200
    v_and_b32 v18, s51, v200
    v_lshlrev_b32 v19, 16, v201
    v_and_b32 v20, s51, v201
    v_sub_f32 v21, v21, v13
    v_sub_f32 v22, v22, v14
    v_sub_f32 v23, v23, v15
    v_sub_f32 v24, v24, v16
    v_sub_f32 v25, v25, v17
    v_sub_f32 v54, v54, v18
    v_sub_f32 v55, v55, v19
    v_sub_f32 v56, v56, v20
    v_cvt_pk_bf16_f32 v38, v21, v22
    v_cvt_pk_bf16_f32 v39, v23, v24
    v_cvt_pk_bf16_f32 v40, v25, v54
    v_cvt_pk_bf16_f32 v41, v55, v56
    ds_write_b128 v12, v[38:41] offset:22528
    s_mov_b64 exec, 1
    ds_add_u32 v252, v251 offset:452
    s_mov_b64 exec, -1
    v_lshlrev_b32 v13, 16, v62
    v_and_b32 v14, s51, v62
    v_lshlrev_b32 v15, 16, v66
    v_and_b32 v16, s51, v66
    v_lshlrev_b32 v19, 16, v63
    v_and_b32 v20, s51, v63
    v_lshlrev_b32 v21, 16, v67
    v_and_b32 v22, s51, v67
    v_add_f32 v17, v13, v15
    v_add_f32 v18, v14, v16
    v_sub_f32 v13, v15, v13
    v_sub_f32 v14, v16, v14
    v_add_f32 v23, v19, v21
    v_add_f32 v24, v20, v22
    v_sub_f32 v19, v21, v19
    v_sub_f32 v20, v22, v20
    v_cvt_pk_bf16_f32 v26, v17, v18
    v_cvt_pk_bf16_f32 v34, v13, v14
    v_cvt_pk_bf16_f32 v27, v23, v24
    v_cvt_pk_bf16_f32 v35, v19, v20
    v_lshlrev_b32 v13, 16, v64
    v_and_b32 v14, s51, v64
    v_lshlrev_b32 v15, 16, v68
    v_and_b32 v16, s51, v68
    v_lshlrev_b32 v19, 16, v65
    v_and_b32 v20, s51, v65
    v_lshlrev_b32 v21, 16, v69
    v_and_b32 v22, s51, v69
    v_add_f32 v17, v13, v15
    v_add_f32 v18, v14, v16
    v_sub_f32 v13, v15, v13
    v_sub_f32 v14, v16, v14
    v_add_f32 v23, v19, v21
    v_add_f32 v24, v20, v22
    v_sub_f32 v19, v21, v19
    v_sub_f32 v20, v22, v20
    v_cvt_pk_bf16_f32 v28, v17, v18
    v_cvt_pk_bf16_f32 v36, v13, v14
    v_cvt_pk_bf16_f32 v29, v23, v24
    v_cvt_pk_bf16_f32 v37, v19, v20
    ds_write_b128 v7, v[26:29] offset:45056
    v_lshlrev_b32 v13, 16, v70
    v_and_b32 v14, s51, v70
    v_lshlrev_b32 v15, 16, v74
    v_and_b32 v16, s51, v74
    v_lshlrev_b32 v19, 16, v71
    v_and_b32 v20, s51, v71
    v_lshlrev_b32 v21, 16, v75
    v_and_b32 v22, s51, v75
    v_add_f32 v17, v13, v15
    v_add_f32 v18, v14, v16
    v_sub_f32 v13, v15, v13
    v_sub_f32 v14, v16, v14
    v_add_f32 v23, v19, v21
    v_add_f32 v24, v20, v22
    v_sub_f32 v19, v21, v19
    v_sub_f32 v20, v22, v20
    v_cvt_pk_bf16_f32 v30, v17, v18
    v_cvt_pk_bf16_f32 v38, v13, v14
    v_cvt_pk_bf16_f32 v31, v23, v24
    v_cvt_pk_bf16_f32 v39, v19, v20
    v_lshlrev_b32 v13, 16, v72
    v_and_b32 v14, s51, v72
    v_lshlrev_b32 v15, 16, v76
    v_and_b32 v16, s51, v76
    v_lshlrev_b32 v19, 16, v73
    v_and_b32 v20, s51, v73
    v_lshlrev_b32 v21, 16, v77
    v_and_b32 v22, s51, v77
    v_add_f32 v17, v13, v15
    v_add_f32 v18, v14, v16
    v_sub_f32 v13, v15, v13
    v_sub_f32 v14, v16, v14
    v_add_f32 v23, v19, v21
    v_add_f32 v24, v20, v22
    v_sub_f32 v19, v21, v19
    v_sub_f32 v20, v22, v20
    v_cvt_pk_bf16_f32 v32, v17, v18
    v_cvt_pk_bf16_f32 v40, v13, v14
    v_cvt_pk_bf16_f32 v33, v23, v24
    v_cvt_pk_bf16_f32 v41, v19, v20
    ds_write_b128 v8, v[30:33] offset:45056
L_WIx:
    ds_read_b128 v[20:23], v252 offset:496
    s_waitcnt lgkmcnt(0)
    v_and_b32 v20, v20, v21
    v_and_b32 v22, v22, v23
    v_and_b32 v20, v20, v22
    s_nop 0
    v_readfirstlane_b32 s47, v20
    s_cmp_eq_u32 s47, 1
    s_cbranch_scc1 L_WIx_ok
    s_sleep 2
    s_branch L_WIx
L_WIx_ok:
    buffer_load_dwordx4 v[98:101], v1, s[4:7], 0 offen offset:128
    buffer_load_dwordx4 v[106:109], v2, s[4:7], 0 offen offset:512
    buffer_load_dwordx4 v[114:117], v2, s[4:7], 0 offen offset:1280
    buffer_load_dwordx4 v[122:125], v2, s[4:7], 0 offen offset:2048
    buffer_load_dwordx4 v[130:133], v2, s[4:7], 0 offen offset:2816
    buffer_load_dwordx4 v[202:205], v4, s[4:7], 0 offen offset:128
    buffer_load_dwordx4 v[210:213], v5, s[4:7], 0 offen offset:512
    buffer_load_dwordx4 v[218:221], v5, s[4:7], 0 offen offset:1280
    buffer_load_dwordx4 v[102:105], v2, s[4:7], 0 offen offset:128
    buffer_load_dwordx4 v[110:113], v2, s[4:7], 0 offen offset:896
    buffer_load_dwordx4 v[118:121], v2, s[4:7], 0 offen offset:1664
    buffer_load_dwordx4 v[126:129], v2, s[4:7], 0 offen offset:2432
    buffer_load_dwordx4 v[134:137], v3, s[4:7], 0 offen offset:128
    buffer_load_dwordx4 v[206:209], v5, s[4:7], 0 offen offset:128
    buffer_load_dwordx4 v[214:217], v5, s[4:7], 0 offen offset:896
    buffer_load_dwordx4 v[222:225], v6, s[4:7], 0 offen offset:128
    v_lshlrev_b32 v13, 16, v78
    v_and_b32 v14, s51, v78
    v_lshlrev_b32 v15, 16, v82
    v_and_b32 v16, s51, v82
    v_lshlrev_b32 v19, 16, v79
    v_and_b32 v20, s51, v79
    v_lshlrev_b32 v21, 16, v83
    v_and_b32 v22, s51, v83
    v_add_f32 v17, v13, v15
    v_add_f32 v18, v14, v16
    v_sub_f32 v13, v15, v13
    v_sub_f32 v14, v16, v14
    v_add_f32 v23, v19, v21
    v_add_f32 v24, v20, v22
    v_sub_f32 v19, v21, v19
    v_sub_f32 v20, v22, v20
    v_cvt_pk_bf16_f32 v26, v17, v18
    v_cvt_pk_bf16_f32 v42, v13, v14
    v_cvt_pk_bf16_f32 v27, v23, v24
    v_cvt_pk_bf16_f32 v43, v19, v20
    v_lshlrev_b32 v13, 16, v80
    v_and_b32 v14, s51, v80
    v_lshlrev_b32 v15, 16, v84
    v_and_b32 v16, s51, v84
    v_lshlrev_b32 v19, 16, v81
    v_and_b32 v20, s51, v81
    v_lshlrev_b32 v21, 16, v85
    v_and_b32 v22, s51, v85
    v_add_f32 v17, v13, v15
    v_add_f32 v18, v14, v16
    v_sub_f32 v13, v15, v13
    v_sub_f32 v14, v16, v14
    v_add_f32 v23, v19, v21
    v_add_f32 v24, v20, v22
    v_sub_f32 v19, v21, v19
    v_sub_f32 v20, v22, v20
    v_cvt_pk_bf16_f32 v28, v17, v18
    v_cvt_pk_bf16_f32 v44, v13, v14
    v_cvt_pk_bf16_f32 v29, v23, v24
    v_cvt_pk_bf16_f32 v45, v19, v20
    ds_write_b128 v9, v[26:29] offset:45056
    v_lshlrev_b32 v13, 16, v86
    v_and_b32 v14, s51, v86
    v_lshlrev_b32 v15, 16, v90
    v_and_b32 v16, s51, v90
    v_lshlrev_b32 v19, 16, v87
    v_and_b32 v20, s51, v87
    v_lshlrev_b32 v21, 16, v91
    v_and_b32 v22, s51, v91
    v_add_f32 v17, v13, v15
    v_add_f32 v18, v14, v16
    v_sub_f32 v13, v15, v13
    v_sub_f32 v14, v16, v14
    v_add_f32 v23, v19, v21
    v_add_f32 v24, v20, v22
    v_sub_f32 v19, v21, v19
    v_sub_f32 v20, v22, v20
    v_cvt_pk_bf16_f32 v30, v17, v18
    v_cvt_pk_bf16_f32 v46, v13, v14
    v_cvt_pk_bf16_f32 v31, v23, v24
    v_cvt_pk_bf16_f32 v47, v19, v20
    v_lshlrev_b32 v13, 16, v88
    v_and_b32 v14, s51, v88
    v_lshlrev_b32 v15, 16, v92
    v_and_b32 v16, s51, v92
    v_lshlrev_b32 v19, 16, v89
    v_and_b32 v20, s51, v89
    v_lshlrev_b32 v21, 16, v93
    v_and_b32 v22, s51, v93
    v_add_f32 v17, v13, v15
    v_add_f32 v18, v14, v16
    v_sub_f32 v13, v15, v13
    v_sub_f32 v14, v16, v14
    v_add_f32 v23, v19, v21
    v_add_f32 v24, v20, v22
    v_sub_f32 v19, v21, v19
    v_sub_f32 v20, v22, v20
    v_cvt_pk_bf16_f32 v32, v17, v18
    v_cvt_pk_bf16_f32 v48, v13, v14
    v_cvt_pk_bf16_f32 v33, v23, v24
    v_cvt_pk_bf16_f32 v49, v19, v20
    ds_write_b128 v10, v[30:33] offset:45056
    v_lshlrev_b32 v13, 16, v182
    v_and_b32 v14, s51, v182
    v_lshlrev_b32 v15, 16, v186
    v_and_b32 v16, s51, v186
    v_lshlrev_b32 v19, 16, v183
    v_and_b32 v20, s51, v183
    v_lshlrev_b32 v21, 16, v187
    v_and_b32 v22, s51, v187
    v_add_f32 v17, v13, v15
    v_add_f32 v18, v14, v16
    v_sub_f32 v13, v15, v13
    v_sub_f32 v14, v16, v14
    v_add_f32 v23, v19, v21
    v_add_f32 v24, v20, v22
    v_sub_f32 v19, v21, v19
    v_sub_f32 v20, v22, v20
    v_cvt_pk_bf16_f32 v26, v17, v18
    v_cvt_pk_bf16_f32 v50, v13, v14
    v_cvt_pk_bf16_f32 v27, v23, v24
    v_cvt_pk_bf16_f32 v51, v19, v20
    v_lshlrev_b32 v13, 16, v184
    v_and_b32 v14, s51, v184
    v_lshlrev_b32 v15, 16, v188
    v_and_b32 v16, s51, v188
    v_lshlrev_b32 v19, 16, v185
    v_and_b32 v20, s51, v185
    v_lshlrev_b32 v21, 16, v189
    v_and_b32 v22, s51, v189
    v_add_f32 v17, v13, v15
    v_add_f32 v18, v14, v16
    v_sub_f32 v13, v15, v13
    v_sub_f32 v14, v16, v14
    v_add_f32 v23, v19, v21
    v_add_f32 v24, v20, v22
    v_sub_f32 v19, v21, v19
    v_sub_f32 v20, v22, v20
    v_cvt_pk_bf16_f32 v28, v17, v18
    v_cvt_pk_bf16_f32 v52, v13, v14
    v_cvt_pk_bf16_f32 v29, v23, v24
    v_cvt_pk_bf16_f32 v53, v19, v20
    ds_write_b128 v11, v[26:29] offset:45056
    v_lshlrev_b32 v13, 16, v190
    v_and_b32 v14, s51, v190
    v_lshlrev_b32 v15, 16, v194
    v_and_b32 v16, s51, v194
    v_lshlrev_b32 v19, 16, v191
    v_and_b32 v20, s51, v191
    v_lshlrev_b32 v21, 16, v195
    v_and_b32 v22, s51, v195
    v_add_f32 v17, v13, v15
    v_add_f32 v18, v14, v16
    v_sub_f32 v13, v15, v13
    v_sub_f32 v14, v16, v14
    v_add_f32 v23, v19, v21
    v_add_f32 v24, v20, v22
    v_sub_f32 v19, v21, v19
    v_sub_f32 v20, v22, v20
    v_cvt_pk_bf16_f32 v30, v17, v18
    v_cvt_pk_bf16_f32 v54, v13, v14
    v_cvt_pk_bf16_f32 v31, v23, v24
    v_cvt_pk_bf16_f32 v55, v19, v20
    v_lshlrev_b32 v13, 16, v192
    v_and_b32 v14, s51, v192
    v_lshlrev_b32 v15, 16, v196
    v_and_b32 v16, s51, v196
    v_lshlrev_b32 v19, 16, v193
    v_and_b32 v20, s51, v193
    v_lshlrev_b32 v21, 16, v197
    v_and_b32 v22, s51, v197
    v_add_f32 v17, v13, v15
    v_add_f32 v18, v14, v16
    v_sub_f32 v13, v15, v13
    v_sub_f32 v14, v16, v14
    v_add_f32 v23, v19, v21
    v_add_f32 v24, v20, v22
    v_sub_f32 v19, v21, v19
    v_sub_f32 v20, v22, v20
    v_cvt_pk_bf16_f32 v32, v17, v18
    v_cvt_pk_bf16_f32 v56, v13, v14
    v_cvt_pk_bf16_f32 v33, v23, v24
    v_cvt_pk_bf16_f32 v57, v19, v20
    ds_write_b128 v12, v[30:33] offset:45056
    s_mov_b64 exec, 1
    ds_add_u32 v252, v251 offset:456
    s_mov_b64 exec, -1
L_FRx3:
    ds_read_b128 v[16:19], v252 offset:256
    s_waitcnt lgkmcnt(0)
    v_and_b32 v16, v16, v17
    v_and_b32 v18, v18, v19
    v_and_b32 v16, v16, v18
    s_nop 0
    v_readfirstlane_b32 s47, v16
    s_cmp_eq_u32 s47, 1
    s_cbranch_scc1 L_FRx3_ok
    s_sleep 2
    s_branch L_FRx3
L_FRx3_ok:
    ds_write_b128 v7, v[34:37] offset:0
    ds_write_b128 v8, v[38:41] offset:0
    ds_write_b128 v9, v[42:45] offset:0
    ds_write_b128 v10, v[46:49] offset:0
    ds_write_b128 v11, v[50:53] offset:0
    ds_write_b128 v12, v[54:57] offset:0
    s_mov_b64 exec, 1
    ds_add_u32 v252, v251 offset:460
    s_mov_b64 exec, -1
    s_waitcnt vmcnt(0)
    v_lshlrev_b32 v13, 16, v102
    v_and_b32 v14, s51, v102
    v_lshlrev_b32 v15, 16, v106
    v_and_b32 v16, s51, v106
    v_lshlrev_b32 v19, 16, v103
    v_and_b32 v20, s51, v103
    v_lshlrev_b32 v21, 16, v107
    v_and_b32 v22, s51, v107
    v_add_f32 v17, v13, v15
    v_add_f32 v18, v14, v16
    v_sub_f32 v13, v15, v13
    v_sub_f32 v14, v16, v14
    v_add_f32 v23, v19, v21
    v_add_f32 v24, v20, v22
    v_sub_f32 v19, v21, v19
    v_sub_f32 v20, v22, v20
    v_cvt_pk_bf16_f32 v26, v17, v18
    v_cvt_pk_bf16_f32 v34, v13, v14
    v_cvt_pk_bf16_f32 v27, v23, v24
    v_cvt_pk_bf16_f32 v35, v19, v20
    v_lshlrev_b32 v13, 16, v104
    v_and_b32 v14, s51, v104
    v_lshlrev_b32 v15, 16, v108
    v_and_b32 v16, s51, v108
    v_lshlrev_b32 v19, 16, v105
    v_and_b32 v20, s51, v105
    v_lshlrev_b32 v21, 16, v109
    v_and_b32 v22, s51, v109
    v_add_f32 v17, v13, v15
    v_add_f32 v18, v14, v16
    v_sub_f32 v13, v15, v13
    v_sub_f32 v14, v16, v14
    v_add_f32 v23, v19, v21
    v_add_f32 v24, v20, v22
    v_sub_f32 v19, v21, v19
    v_sub_f32 v20, v22, v20
    v_cvt_pk_bf16_f32 v28, v17, v18
    v_cvt_pk_bf16_f32 v36, v13, v14
    v_cvt_pk_bf16_f32 v29, v23, v24
    v_cvt_pk_bf16_f32 v37, v19, v20
L_FRx4:
    ds_read_b128 v[16:19], v252 offset:272
    s_waitcnt lgkmcnt(0)
    v_and_b32 v16, v16, v17
    v_and_b32 v18, v18, v19
    v_and_b32 v16, v16, v18
    s_nop 0
    v_readfirstlane_b32 s47, v16
    s_cmp_eq_u32 s47, 1
    s_cbranch_scc1 L_FRx4_ok
    s_sleep 2
    s_branch L_FRx4
L_FRx4_ok:
    ds_write_b128 v7, v[26:29] offset:22528
    v_lshlrev_b32 v13, 16, v110
    v_and_b32 v14, s51, v110
    v_lshlrev_b32 v15, 16, v114
    v_and_b32 v16, s51, v114
    v_lshlrev_b32 v19, 16, v111
    v_and_b32 v20, s51, v111
    v_lshlrev_b32 v21, 16, v115
    v_and_b32 v22, s51, v115
    v_add_f32 v17, v13, v15
    v_add_f32 v18, v14, v16
    v_sub_f32 v13, v15, v13
    v_sub_f32 v14, v16, v14
    v_add_f32 v23, v19, v21
    v_add_f32 v24, v20, v22
    v_sub_f32 v19, v21, v19
    v_sub_f32 v20, v22, v20
    v_cvt_pk_bf16_f32 v30, v17, v18
    v_cvt_pk_bf16_f32 v38, v13, v14
    v_cvt_pk_bf16_f32 v31, v23, v24
    v_cvt_pk_bf16_f32 v39, v19, v20
    v_lshlrev_b32 v13, 16, v112
    v_and_b32 v14, s51, v112
    v_lshlrev_b32 v15, 16, v116
    v_and_b32 v16, s51, v116
    v_lshlrev_b32 v19, 16, v113
    buffer_load_dwordx4 v[138:141], v1, s[4:7], 0 offen offset:256
    v_and_b32 v20, s51, v113
    v_lshlrev_b32 v21, 16, v117
    v_and_b32 v22, s51, v117
    v_add_f32 v17, v13, v15
    v_add_f32 v18, v14, v16
    v_sub_f32 v13, v15, v13
    v_sub_f32 v14, v16, v14
    v_add_f32 v23, v19, v21
    v_add_f32 v24, v20, v22
    v_sub_f32 v19, v21, v19
    v_sub_f32 v20, v22, v20
    v_cvt_pk_bf16_f32 v32, v17, v18
    v_cvt_pk_bf16_f32 v40, v13, v14
    v_cvt_pk_bf16_f32 v33, v23, v24
    v_cvt_pk_bf16_f32 v41, v19, v20
    ds_write_b128 v8, v[30:33] offset:22528
    v_lshlrev_b32 v13, 16, v118
    v_and_b32 v14, s51, v118
    v_lshlrev_b32 v15, 16, v122
    v_and_b32 v16, s51, v122
    v_lshlrev_b32 v19, 16, v119
    v_and_b32 v20, s51, v119
    v_lshlrev_b32 v21, 16, v123
    v_and_b32 v22, s51, v123
    v_add_f32 v17, v13, v15
    v_add_f32 v18, v14, v16
    buffer_load_dwordx4 v[146:149], v2, s[4:7], 0 offen offset:640
    v_sub_f32 v13, v15, v13
    v_sub_f32 v14, v16, v14
    v_add_f32 v23, v19, v21
    v_add_f32 v24, v20, v22
    v_sub_f32 v19, v21, v19
    v_sub_f32 v20, v22, v20
    v_cvt_pk_bf16_f32 v26, v17, v18
    v_cvt_pk_bf16_f32 v42, v13, v14
    v_cvt_pk_bf16_f32 v27, v23, v24
    v_cvt_pk_bf16_f32 v43, v19, v20
    v_lshlrev_b32 v13, 16, v120
    v_and_b32 v14, s51, v120
    v_lshlrev_b32 v15, 16, v124
    v_and_b32 v16, s51, v124
    v_lshlrev_b32 v19, 16, v121
    v_and_b32 v20, s51, v121
    v_lshlrev_b32 v21, 16, v125
    v_and_b32 v22, s51, v125
    v_add_f32 v17, v13, v15
    v_add_f32 v18, v14, v16
    v_sub_f32 v13, v15, v13
    v_sub_f32 v14, v16, v14
    v_add_f32 v23, v19, v21
    v_add_f32 v24, v20, v22
    v_sub_f32 v19, v21, v19
    buffer_load_dwordx4 v[154:157], v2, s[4:7], 0 offen offset:1408
    v_sub_f32 v20, v22, v20
    v_cvt_pk_bf16_f32 v28, v17, v18
    v_cvt_pk_bf16_f32 v44, v13, v14
    v_cvt_pk_bf16_f32 v29, v23, v24
    v_cvt_pk_bf16_f32 v45, v19, v20
    ds_write_b128 v9, v[26:29] offset:22528
    v_lshlrev_b32 v13, 16, v126
    v_and_b32 v14, s51, v126
    v_lshlrev_b32 v15, 16, v130
    v_and_b32 v16, s51, v130
    v_lshlrev_b32 v19, 16, v127
    v_and_b32 v20, s51, v127
    v_lshlrev_b32 v21, 16, v131
    v_and_b32 v22, s51, v131
    v_add_f32 v17, v13, v15
    v_add_f32 v18, v14, v16
    v_sub_f32 v13, v15, v13
    v_sub_f32 v14, v16, v14
    v_add_f32 v23, v19, v21
    v_add_f32 v24, v20, v22
    v_sub_f32 v19, v21, v19
    v_sub_f32 v20, v22, v20
    v_cvt_pk_bf16_f32 v30, v17, v18
    v_cvt_pk_bf16_f32 v46, v13, v14
    v_cvt_pk_bf16_f32 v31, v23, v24
    v_cvt_pk_bf16_f32 v47, v19, v20
    buffer_load_dwordx4 v[162:165], v2, s[4:7], 0 offen offset:2176
    v_lshlrev_b32 v13, 16, v128
    v_and_b32 v14, s51, v128
    v_lshlrev_b32 v15, 16, v132
    v_and_b32 v16, s51, v132
    v_lshlrev_b32 v19, 16, v129
    v_and_b32 v20, s51, v129
    v_lshlrev_b32 v21, 16, v133
    v_and_b32 v22, s51, v133
    v_add_f32 v17, v13, v15
    v_add_f32 v18, v14, v16
    v_sub_f32 v13, v15, v13
    v_sub_f32 v14, v16, v14
    v_add_f32 v23, v19, v21
    v_add_f32 v24, v20, v22
    v_sub_f32 v19, v21, v19
    v_sub_f32 v20, v22, v20
    v_cvt_pk_bf16_f32 v32, v17, v18
    v_cvt_pk_bf16_f32 v48, v13, v14
    v_cvt_pk_bf16_f32 v33, v23, v24
    v_cvt_pk_bf16_f32 v49, v19, v20
    ds_write_b128 v10, v[30:33] offset:22528
    v_lshlrev_b32 v13, 16, v206
    v_and_b32 v14, s51, v206
    v_lshlrev_b32 v15, 16, v210
    v_and_b32 v16, s51, v210
    v_lshlrev_b32 v19, 16, v207
    buffer_load_dwordx4 v[170:173], v2, s[4:7], 0 offen offset:2944
    v_and_b32 v20, s51, v207
    v_lshlrev_b32 v21, 16, v211
    v_and_b32 v22, s51, v211
    v_add_f32 v17, v13, v15
    v_add_f32 v18, v14, v16
    v_sub_f32 v13, v15, v13
    v_sub_f32 v14, v16, v14
    v_add_f32 v23, v19, v21
    v_add_f32 v24, v20, v22
    v_sub_f32 v19, v21, v19
    v_sub_f32 v20, v22, v20
    v_cvt_pk_bf16_f32 v26, v17, v18
    v_cvt_pk_bf16_f32 v50, v13, v14
    v_cvt_pk_bf16_f32 v27, v23, v24
    v_cvt_pk_bf16_f32 v51, v19, v20
    v_lshlrev_b32 v13, 16, v208
    v_and_b32 v14, s51, v208
    v_lshlrev_b32 v15, 16, v212
    v_and_b32 v16, s51, v212
    v_lshlrev_b32 v19, 16, v209
    v_and_b32 v20, s51, v209
    v_lshlrev_b32 v21, 16, v213
    v_and_b32 v22, s51, v213
    v_add_f32 v17, v13, v15
    v_add_f32 v18, v14, v16
    buffer_load_dwordx4 v[226:229], v4, s[4:7], 0 offen offset:256
    v_sub_f32 v13, v15, v13
    v_sub_f32 v14, v16, v14
    v_add_f32 v23, v19, v21
    v_add_f32 v24, v20, v22
    v_sub_f32 v19, v21, v19
    v_sub_f32 v20, v22, v20
    v_cvt_pk_bf16_f32 v28, v17, v18
    v_cvt_pk_bf16_f32 v52, v13, v14
    v_cvt_pk_bf16_f32 v29, v23, v24
    v_cvt_pk_bf16_f32 v53, v19, v20
    ds_write_b128 v11, v[26:29] offset:22528
    v_lshlrev_b32 v13, 16, v214
    v_and_b32 v14, s51, v214
    v_lshlrev_b32 v15, 16, v218
    v_and_b32 v16, s51, v218
    v_lshlrev_b32 v19, 16, v215
    v_and_b32 v20, s51, v215
    v_lshlrev_b32 v21, 16, v219
    v_and_b32 v22, s51, v219
    v_add_f32 v17, v13, v15
    v_add_f32 v18, v14, v16
    v_sub_f32 v13, v15, v13
    v_sub_f32 v14, v16, v14
    v_add_f32 v23, v19, v21
    v_add_f32 v24, v20, v22
    v_sub_f32 v19, v21, v19
    buffer_load_dwordx4 v[234:237], v5, s[4:7], 0 offen offset:640
    v_sub_f32 v20, v22, v20
    v_cvt_pk_bf16_f32 v30, v17, v18
    v_cvt_pk_bf16_f32 v54, v13, v14
    v_cvt_pk_bf16_f32 v31, v23, v24
    v_cvt_pk_bf16_f32 v55, v19, v20
    v_lshlrev_b32 v13, 16, v216
    v_and_b32 v14, s51, v216
    v_lshlrev_b32 v15, 16, v220
    v_and_b32 v16, s51, v220
    v_lshlrev_b32 v19, 16, v217
    v_and_b32 v20, s51, v217
    v_lshlrev_b32 v21, 16, v221
    v_and_b32 v22, s51, v221
    v_add_f32 v17, v13, v15
    v_add_f32 v18, v14, v16
    v_sub_f32 v13, v15, v13
    v_sub_f32 v14, v16, v14
    v_add_f32 v23, v19, v21
    v_add_f32 v24, v20, v22
    v_sub_f32 v19, v21, v19
    v_sub_f32 v20, v22, v20
    v_cvt_pk_bf16_f32 v32, v17, v18
    v_cvt_pk_bf16_f32 v56, v13, v14
    v_cvt_pk_bf16_f32 v33, v23, v24
    v_cvt_pk_bf16_f32 v57, v19, v20
    buffer_load_dwordx4 v[242:245], v5, s[4:7], 0 offen offset:1408
    ds_write_b128 v12, v[30:33] offset:22528
    s_mov_b64 exec, 1
    ds_add_u32 v252, v251 offset:464
    s_mov_b64 exec, -1
L_FRx5:
    ds_read_b128 v[16:19], v252 offset:288
    s_waitcnt lgkmcnt(0)
    v_and_b32 v16, v16, v17
    v_and_b32 v18, v18, v19
    v_and_b32 v16, v16, v18
    s_nop 0
    v_readfirstlane_b32 s47, v16
    s_cmp_eq_u32 s47, 1
    s_cbranch_scc1 L_FRx5_ok
    s_sleep 2
    s_branch L_FRx5
L_FRx5_ok:
    ds_write_b128 v7, v[34:37] offset:45056
    ds_write_b128 v8, v[38:41] offset:45056
    ds_write_b128 v9, v[42:45] offset:45056
    ds_write_b128 v10, v[46:49] offset:45056
    ds_write_b128 v11, v[50:53] offset:45056
    ds_write_b128 v12, v[54:57] offset:45056
    s_mov_b64 exec, 1
    ds_add_u32 v252, v251 offset:468
    s_mov_b64 exec, -1
    buffer_load_dwordx4 v[142:145], v2, s[4:7], 0 offen offset:256
    buffer_load_dwordx4 v[150:153], v2, s[4:7], 0 offen offset:1024
    buffer_load_dwordx4 v[158:161], v2, s[4:7], 0 offen offset:1792
    buffer_load_dwordx4 v[166:169], v2, s[4:7], 0 offen offset:2560
    buffer_load_dwordx4 v[174:177], v3, s[4:7], 0 offen offset:256
    buffer_load_dwordx4 v[230:233], v5, s[4:7], 0 offen offset:256
    buffer_load_dwordx4 v[238:241], v5, s[4:7], 0 offen offset:1024
    buffer_load_dwordx4 v[246:249], v6, s[4:7], 0 offen offset:256
    s_waitcnt vmcnt(0)
    v_lshlrev_b32 v13, 16, v142
    v_and_b32 v14, s51, v142
    v_lshlrev_b32 v15, 16, v146
    v_and_b32 v16, s51, v146
    v_lshlrev_b32 v19, 16, v143
    v_and_b32 v20, s51, v143
    v_lshlrev_b32 v21, 16, v147
    v_and_b32 v22, s51, v147
    v_add_f32 v17, v13, v15
    v_add_f32 v18, v14, v16
    v_sub_f32 v13, v15, v13
    v_sub_f32 v14, v16, v14
    v_add_f32 v23, v19, v21
    v_add_f32 v24, v20, v22
    v_sub_f32 v19, v21, v19
    v_sub_f32 v20, v22, v20
    v_cvt_pk_bf16_f32 v26, v17, v18
    v_cvt_pk_bf16_f32 v34, v13, v14
    v_cvt_pk_bf16_f32 v27, v23, v24
    v_cvt_pk_bf16_f32 v35, v19, v20
    v_lshlrev_b32 v13, 16, v144
    v_and_b32 v14, s51, v144
    v_lshlrev_b32 v15, 16, v148
    v_and_b32 v16, s51, v148
    v_lshlrev_b32 v19, 16, v145
    v_and_b32 v20, s51, v145
    v_lshlrev_b32 v21, 16, v149
    v_and_b32 v22, s51, v149
    v_add_f32 v17, v13, v15
    v_add_f32 v18, v14, v16
    v_sub_f32 v13, v15, v13
    v_sub_f32 v14, v16, v14
    v_add_f32 v23, v19, v21
    v_add_f32 v24, v20, v22
    v_sub_f32 v19, v21, v19
    v_sub_f32 v20, v22, v20
    v_cvt_pk_bf16_f32 v28, v17, v18
    v_cvt_pk_bf16_f32 v36, v13, v14
    v_cvt_pk_bf16_f32 v29, v23, v24
    v_cvt_pk_bf16_f32 v37, v19, v20
L_FRx6:
    ds_read_b128 v[16:19], v252 offset:304
    s_waitcnt lgkmcnt(0)
    v_and_b32 v16, v16, v17
    v_and_b32 v18, v18, v19
    v_and_b32 v16, v16, v18
    s_nop 0
    v_readfirstlane_b32 s47, v16
    s_cmp_eq_u32 s47, 1
    s_cbranch_scc1 L_FRx6_ok
    s_sleep 2
    s_branch L_FRx6
L_FRx6_ok:
    ds_write_b128 v7, v[26:29] offset:0
    v_lshlrev_b32 v13, 16, v150
    v_and_b32 v14, s51, v150
    v_lshlrev_b32 v15, 16, v154
    v_and_b32 v16, s51, v154
    v_lshlrev_b32 v19, 16, v151
    v_and_b32 v20, s51, v151
    v_lshlrev_b32 v21, 16, v155
    v_and_b32 v22, s51, v155
    v_add_f32 v17, v13, v15
    v_add_f32 v18, v14, v16
    v_sub_f32 v13, v15, v13
    v_sub_f32 v14, v16, v14
    v_add_f32 v23, v19, v21
    v_add_f32 v24, v20, v22
    v_sub_f32 v19, v21, v19
    v_sub_f32 v20, v22, v20
    v_cvt_pk_bf16_f32 v30, v17, v18
    v_cvt_pk_bf16_f32 v38, v13, v14
    v_cvt_pk_bf16_f32 v31, v23, v24
    v_cvt_pk_bf16_f32 v39, v19, v20
    v_lshlrev_b32 v13, 16, v152
    v_and_b32 v14, s51, v152
    v_lshlrev_b32 v15, 16, v156
    v_and_b32 v16, s51, v156
    v_lshlrev_b32 v19, 16, v153
    v_and_b32 v20, s51, v153
    v_lshlrev_b32 v21, 16, v157
    v_and_b32 v22, s51, v157
    v_add_f32 v17, v13, v15
    v_add_f32 v18, v14, v16
    v_sub_f32 v13, v15, v13
    v_sub_f32 v14, v16, v14
    v_add_f32 v23, v19, v21
    v_add_f32 v24, v20, v22
    v_sub_f32 v19, v21, v19
    v_sub_f32 v20, v22, v20
    v_cvt_pk_bf16_f32 v32, v17, v18
    v_cvt_pk_bf16_f32 v40, v13, v14
    v_cvt_pk_bf16_f32 v33, v23, v24
    v_cvt_pk_bf16_f32 v41, v19, v20
    ds_write_b128 v8, v[30:33] offset:0
    v_lshlrev_b32 v13, 16, v158
    v_and_b32 v14, s51, v158
    v_lshlrev_b32 v15, 16, v162
    v_and_b32 v16, s51, v162
    v_lshlrev_b32 v19, 16, v159
    v_and_b32 v20, s51, v159
    v_lshlrev_b32 v21, 16, v163
    v_and_b32 v22, s51, v163
    v_add_f32 v17, v13, v15
    v_add_f32 v18, v14, v16
    v_sub_f32 v13, v15, v13
    v_sub_f32 v14, v16, v14
    v_add_f32 v23, v19, v21
    v_add_f32 v24, v20, v22
    v_sub_f32 v19, v21, v19
    v_sub_f32 v20, v22, v20
    v_cvt_pk_bf16_f32 v26, v17, v18
    v_cvt_pk_bf16_f32 v42, v13, v14
    v_cvt_pk_bf16_f32 v27, v23, v24
    v_cvt_pk_bf16_f32 v43, v19, v20
    v_lshlrev_b32 v13, 16, v160
    v_and_b32 v14, s51, v160
    v_lshlrev_b32 v15, 16, v164
    v_and_b32 v16, s51, v164
    v_lshlrev_b32 v19, 16, v161
    v_and_b32 v20, s51, v161
    v_lshlrev_b32 v21, 16, v165
    v_and_b32 v22, s51, v165
    v_add_f32 v17, v13, v15
    v_add_f32 v18, v14, v16
    v_sub_f32 v13, v15, v13
    v_sub_f32 v14, v16, v14
    v_add_f32 v23, v19, v21
    v_add_f32 v24, v20, v22
    v_sub_f32 v19, v21, v19
    v_sub_f32 v20, v22, v20
    v_cvt_pk_bf16_f32 v28, v17, v18
    v_cvt_pk_bf16_f32 v44, v13, v14
    v_cvt_pk_bf16_f32 v29, v23, v24
    v_cvt_pk_bf16_f32 v45, v19, v20
    ds_write_b128 v9, v[26:29] offset:0
    v_lshlrev_b32 v13, 16, v166
    v_and_b32 v14, s51, v166
    v_lshlrev_b32 v15, 16, v170
    v_and_b32 v16, s51, v170
    v_lshlrev_b32 v19, 16, v167
    v_and_b32 v20, s51, v167
    v_lshlrev_b32 v21, 16, v171
    v_and_b32 v22, s51, v171
    v_add_f32 v17, v13, v15
    v_add_f32 v18, v14, v16
    v_sub_f32 v13, v15, v13
    v_sub_f32 v14, v16, v14
    v_add_f32 v23, v19, v21
    v_add_f32 v24, v20, v22
    v_sub_f32 v19, v21, v19
    v_sub_f32 v20, v22, v20
    v_cvt_pk_bf16_f32 v30, v17, v18
    v_cvt_pk_bf16_f32 v46, v13, v14
    v_cvt_pk_bf16_f32 v31, v23, v24
    v_cvt_pk_bf16_f32 v47, v19, v20
    v_lshlrev_b32 v13, 16, v168
    v_and_b32 v14, s51, v168
    v_lshlrev_b32 v15, 16, v172
    v_and_b32 v16, s51, v172
    v_lshlrev_b32 v19, 16, v169
    v_and_b32 v20, s51, v169
    v_lshlrev_b32 v21, 16, v173
    v_and_b32 v22, s51, v173
    v_add_f32 v17, v13, v15
    v_add_f32 v18, v14, v16
    v_sub_f32 v13, v15, v13
    v_sub_f32 v14, v16, v14
    v_add_f32 v23, v19, v21
    v_add_f32 v24, v20, v22
    v_sub_f32 v19, v21, v19
    v_sub_f32 v20, v22, v20
    v_cvt_pk_bf16_f32 v32, v17, v18
    v_cvt_pk_bf16_f32 v48, v13, v14
    v_cvt_pk_bf16_f32 v33, v23, v24
    v_cvt_pk_bf16_f32 v49, v19, v20
    ds_write_b128 v10, v[30:33] offset:0
    v_lshlrev_b32 v13, 16, v230
    v_and_b32 v14, s51, v230
    v_lshlrev_b32 v15, 16, v234
    v_and_b32 v16, s51, v234
    v_lshlrev_b32 v19, 16, v231
    v_and_b32 v20, s51, v231
    v_lshlrev_b32 v21, 16, v235
    v_and_b32 v22, s51, v235
    v_add_f32 v17, v13, v15
    v_add_f32 v18, v14, v16
    v_sub_f32 v13, v15, v13
    v_sub_f32 v14, v16, v14
    v_add_f32 v23, v19, v21
    v_add_f32 v24, v20, v22
    v_sub_f32 v19, v21, v19
    v_sub_f32 v20, v22, v20
    v_cvt_pk_bf16_f32 v26, v17, v18
    v_cvt_pk_bf16_f32 v50, v13, v14
    v_cvt_pk_bf16_f32 v27, v23, v24
    v_cvt_pk_bf16_f32 v51, v19, v20
    v_lshlrev_b32 v13, 16, v232
    v_and_b32 v14, s51, v232
    v_lshlrev_b32 v15, 16, v236
    v_and_b32 v16, s51, v236
    v_lshlrev_b32 v19, 16, v233
    v_and_b32 v20, s51, v233
    v_lshlrev_b32 v21, 16, v237
    v_and_b32 v22, s51, v237
    v_add_f32 v17, v13, v15
    v_add_f32 v18, v14, v16
    v_sub_f32 v13, v15, v13
    v_sub_f32 v14, v16, v14
    v_add_f32 v23, v19, v21
    v_add_f32 v24, v20, v22
    v_sub_f32 v19, v21, v19
    v_sub_f32 v20, v22, v20
    v_cvt_pk_bf16_f32 v28, v17, v18
    v_cvt_pk_bf16_f32 v52, v13, v14
    v_cvt_pk_bf16_f32 v29, v23, v24
    v_cvt_pk_bf16_f32 v53, v19, v20
    ds_write_b128 v11, v[26:29] offset:0
    v_lshlrev_b32 v13, 16, v238
    v_and_b32 v14, s51, v238
    v_lshlrev_b32 v15, 16, v242
    v_and_b32 v16, s51, v242
    v_lshlrev_b32 v19, 16, v239
    v_and_b32 v20, s51, v239
    v_lshlrev_b32 v21, 16, v243
    v_and_b32 v22, s51, v243
    v_add_f32 v17, v13, v15
    v_add_f32 v18, v14, v16
    v_sub_f32 v13, v15, v13
    v_sub_f32 v14, v16, v14
    v_add_f32 v23, v19, v21
    v_add_f32 v24, v20, v22
    v_sub_f32 v19, v21, v19
    v_sub_f32 v20, v22, v20
    v_cvt_pk_bf16_f32 v30, v17, v18
    v_cvt_pk_bf16_f32 v54, v13, v14
    v_cvt_pk_bf16_f32 v31, v23, v24
    v_cvt_pk_bf16_f32 v55, v19, v20
    v_lshlrev_b32 v13, 16, v240
    v_and_b32 v14, s51, v240
    v_lshlrev_b32 v15, 16, v244
    v_and_b32 v16, s51, v244
    v_lshlrev_b32 v19, 16, v241
    v_and_b32 v20, s51, v241
    v_lshlrev_b32 v21, 16, v245
    v_and_b32 v22, s51, v245
    v_add_f32 v17, v13, v15
    v_add_f32 v18, v14, v16
    v_sub_f32 v13, v15, v13
    v_sub_f32 v14, v16, v14
    v_add_f32 v23, v19, v21
    v_add_f32 v24, v20, v22
    v_sub_f32 v19, v21, v19
    v_sub_f32 v20, v22, v20
    v_cvt_pk_bf16_f32 v32, v17, v18
    v_cvt_pk_bf16_f32 v56, v13, v14
    v_cvt_pk_bf16_f32 v33, v23, v24
    v_cvt_pk_bf16_f32 v57, v19, v20
    ds_write_b128 v12, v[30:33] offset:0
    s_mov_b64 exec, 1
    ds_add_u32 v252, v251 offset:472
    s_mov_b64 exec, -1
L_FRx7:
    ds_read_b128 v[16:19], v252 offset:320
    s_waitcnt lgkmcnt(0)
    v_and_b32 v16, v16, v17
    v_and_b32 v18, v18, v19
    v_and_b32 v16, v16, v18
    s_nop 0
    v_readfirstlane_b32 s47, v16
    s_cmp_eq_u32 s47, 1
    s_cbranch_scc1 L_FRx7_ok
    s_sleep 2
    s_branch L_FRx7
L_FRx7_ok:
    ds_write_b128 v7, v[34:37] offset:22528
    ds_write_b128 v8, v[38:41] offset:22528
    ds_write_b128 v9, v[42:45] offset:22528
    ds_write_b128 v10, v[46:49] offset:22528
    ds_write_b128 v11, v[50:53] offset:22528
    ds_write_b128 v12, v[54:57] offset:22528
    s_mov_b64 exec, 1
    ds_add_u32 v252, v251 offset:476
    s_mov_b64 exec, -1
    v_lshlrev_b32 v13, 16, v98
    v_and_b32 v14, s51, v98
    v_lshlrev_b32 v15, 16, v99
    v_and_b32 v16, s51, v99
    v_lshlrev_b32 v17, 16, v100
    v_and_b32 v18, s51, v100
    v_lshlrev_b32 v19, 16, v101
    v_and_b32 v20, s51, v101
    v_lshlrev_b32 v21, 16, v106
    v_and_b32 v22, s51, v106
    v_lshlrev_b32 v23, 16, v107
    v_and_b32 v24, s51, v107
    v_lshlrev_b32 v25, 16, v108
    v_and_b32 v54, s51, v108
    v_lshlrev_b32 v55, 16, v109
    v_and_b32 v56, s51, v109
    v_sub_f32 v13, v13, v21
    v_sub_f32 v14, v14, v22
    v_sub_f32 v15, v15, v23
    v_sub_f32 v16, v16, v24
    v_sub_f32 v17, v17, v25
    v_sub_f32 v18, v18, v54
    v_sub_f32 v19, v19, v55
    v_sub_f32 v20, v20, v56
    v_cvt_pk_bf16_f32 v26, v13, v14
    v_cvt_pk_bf16_f32 v27, v15, v16
    v_cvt_pk_bf16_f32 v28, v17, v18
    v_cvt_pk_bf16_f32 v29, v19, v20
L_FRx8:
    ds_read_b128 v[44:47], v252 offset:336
    s_waitcnt lgkmcnt(0)
    v_and_b32 v44, v44, v45
    v_and_b32 v46, v46, v47
    v_and_b32 v44, v44, v46
    s_nop 0
    v_readfirstlane_b32 s47, v44
    s_cmp_eq_u32 s47, 1
    s_cbranch_scc1 L_FRx8_ok
    s_sleep 2
    s_branch L_FRx8
L_FRx8_ok:
    ds_write_b128 v7, v[26:29] offset:45056
    v_lshlrev_b32 v13, 16, v114
    v_and_b32 v14, s51, v114
    v_lshlrev_b32 v15, 16, v115
    v_and_b32 v16, s51, v115
    v_lshlrev_b32 v17, 16, v116
    v_and_b32 v18, s51, v116
    v_lshlrev_b32 v19, 16, v117
    v_and_b32 v20, s51, v117
    v_sub_f32 v21, v21, v13
    v_sub_f32 v22, v22, v14
    v_sub_f32 v23, v23, v15
    v_sub_f32 v24, v24, v16
    v_sub_f32 v25, v25, v17
    v_sub_f32 v54, v54, v18
    v_sub_f32 v55, v55, v19
    v_sub_f32 v56, v56, v20
    v_cvt_pk_bf16_f32 v30, v21, v22
    v_cvt_pk_bf16_f32 v31, v23, v24
    v_cvt_pk_bf16_f32 v32, v25, v54
    v_cvt_pk_bf16_f32 v33, v55, v56
    ds_write_b128 v8, v[30:33] offset:45056
    v_lshlrev_b32 v21, 16, v122
    v_and_b32 v22, s51, v122
    v_lshlrev_b32 v23, 16, v123
    v_and_b32 v24, s51, v123
    v_lshlrev_b32 v25, 16, v124
    v_and_b32 v54, s51, v124
    v_lshlrev_b32 v55, 16, v125
    v_and_b32 v56, s51, v125
    v_sub_f32 v13, v13, v21
    v_sub_f32 v14, v14, v22
    v_sub_f32 v15, v15, v23
    v_sub_f32 v16, v16, v24
    v_sub_f32 v17, v17, v25
    v_sub_f32 v18, v18, v54
    v_sub_f32 v19, v19, v55
    v_sub_f32 v20, v20, v56
    v_cvt_pk_bf16_f32 v26, v13, v14
    v_cvt_pk_bf16_f32 v27, v15, v16
    v_cvt_pk_bf16_f32 v28, v17, v18
    v_cvt_pk_bf16_f32 v29, v19, v20
    ds_write_b128 v9, v[26:29] offset:45056
    v_lshlrev_b32 v13, 16, v130
    v_and_b32 v14, s51, v130
    v_lshlrev_b32 v15, 16, v131
    v_and_b32 v16, s51, v131
    v_lshlrev_b32 v17, 16, v132
    v_and_b32 v18, s51, v132
    v_lshlrev_b32 v19, 16, v133
    v_and_b32 v20, s51, v133
    v_sub_f32 v21, v21, v13
    v_sub_f32 v22, v22, v14
    v_sub_f32 v23, v23, v15
    v_sub_f32 v24, v24, v16
    v_sub_f32 v25, v25, v17
    v_sub_f32 v54, v54, v18
    v_sub_f32 v55, v55, v19
    v_sub_f32 v56, v56, v20
    v_cvt_pk_bf16_f32 v30, v21, v22
    v_cvt_pk_bf16_f32 v31, v23, v24
    v_cvt_pk_bf16_f32 v32, v25, v54
    v_cvt_pk_bf16_f32 v33, v55, v56
    ds_write_b128 v10, v[30:33] offset:45056
    v_lshlrev_b32 v13, 16, v202
    v_and_b32 v14, s51, v202
    v_lshlrev_b32 v15, 16, v203
    v_and_b32 v16, s51, v203
    v_lshlrev_b32 v17, 16, v204
    v_and_b32 v18, s51, v204
    v_lshlrev_b32 v19, 16, v205
    v_and_b32 v20, s51, v205
    v_lshlrev_b32 v21, 16, v210
    v_and_b32 v22, s51, v210
    v_lshlrev_b32 v23, 16, v211
    v_and_b32 v24, s51, v211
    v_lshlrev_b32 v25, 16, v212
    v_and_b32 v54, s51, v212
    v_lshlrev_b32 v55, 16, v213
    v_and_b32 v56, s51, v213
    v_sub_f32 v13, v13, v21
    v_sub_f32 v14, v14, v22
    v_sub_f32 v15, v15, v23
    v_sub_f32 v16, v16, v24
    v_sub_f32 v17, v17, v25
    v_sub_f32 v18, v18, v54
    v_sub_f32 v19, v19, v55
    v_sub_f32 v20, v20, v56
    v_cvt_pk_bf16_f32 v34, v13, v14
    v_cvt_pk_bf16_f32 v35, v15, v16
    v_cvt_pk_bf16_f32 v36, v17, v18
    v_cvt_pk_bf16_f32 v37, v19, v20
    ds_write_b128 v11, v[34:37] offset:45056
    v_lshlrev_b32 v13, 16, v218
    v_and_b32 v14, s51, v218
    v_lshlrev_b32 v15, 16, v219
    v_and_b32 v16, s51, v219
    v_lshlrev_b32 v17, 16, v220
    v_and_b32 v18, s51, v220
    v_lshlrev_b32 v19, 16, v221
    v_and_b32 v20, s51, v221
    v_sub_f32 v21, v21, v13
    v_sub_f32 v22, v22, v14
    v_sub_f32 v23, v23, v15
    v_sub_f32 v24, v24, v16
    v_sub_f32 v25, v25, v17
    v_sub_f32 v54, v54, v18
    v_sub_f32 v55, v55, v19
    v_sub_f32 v56, v56, v20
    v_cvt_pk_bf16_f32 v38, v21, v22
    v_cvt_pk_bf16_f32 v39, v23, v24
    v_cvt_pk_bf16_f32 v40, v25, v54
    v_cvt_pk_bf16_f32 v41, v55, v56
    ds_write_b128 v12, v[38:41] offset:45056
    s_mov_b64 exec, 1
    ds_add_u32 v252, v251 offset:480
    s_mov_b64 exec, -1
    v_lshlrev_b32 v13, 16, v138
    v_and_b32 v14, s51, v138
    v_lshlrev_b32 v15, 16, v139
    v_and_b32 v16, s51, v139
    v_lshlrev_b32 v17, 16, v140
    v_and_b32 v18, s51, v140
    v_lshlrev_b32 v19, 16, v141
    v_and_b32 v20, s51, v141
    v_lshlrev_b32 v21, 16, v146
    v_and_b32 v22, s51, v146
    v_lshlrev_b32 v23, 16, v147
    v_and_b32 v24, s51, v147
    v_lshlrev_b32 v25, 16, v148
    v_and_b32 v54, s51, v148
    v_lshlrev_b32 v55, 16, v149
    v_and_b32 v56, s51, v149
    v_sub_f32 v13, v13, v21
    v_sub_f32 v14, v14, v22
    v_sub_f32 v15, v15, v23
    v_sub_f32 v16, v16, v24
    v_sub_f32 v17, v17, v25
    v_sub_f32 v18, v18, v54
    v_sub_f32 v19, v19, v55
    v_sub_f32 v20, v20, v56
    v_cvt_pk_bf16_f32 v26, v13, v14
    v_cvt_pk_bf16_f32 v27, v15, v16
    v_cvt_pk_bf16_f32 v28, v17, v18
    v_cvt_pk_bf16_f32 v29, v19, v20
L_FRx9:
    ds_read_b128 v[44:47], v252 offset:352
    s_waitcnt lgkmcnt(0)
    v_and_b32 v44, v44, v45
    v_and_b32 v46, v46, v47
    v_and_b32 v44, v44, v46
    s_nop 0
    v_readfirstlane_b32 s47, v44
    s_cmp_eq_u32 s47, 1
    s_cbranch_scc1 L_FRx9_ok
    s_sleep 2
    s_branch L_FRx9
L_FRx9_ok:
    ds_write_b128 v7, v[26:29] offset:0
    v_lshlrev_b32 v13, 16, v154
    v_and_b32 v14, s51, v154
    v_lshlrev_b32 v15, 16, v155
    v_and_b32 v16, s51, v155
    v_lshlrev_b32 v17, 16, v156
    v_and_b32 v18, s51, v156
    v_lshlrev_b32 v19, 16, v157
    v_and_b32 v20, s51, v157
    v_sub_f32 v21, v21, v13
    v_sub_f32 v22, v22, v14
    v_sub_f32 v23, v23, v15
    v_sub_f32 v24, v24, v16
    v_sub_f32 v25, v25, v17
    v_sub_f32 v54, v54, v18
    v_sub_f32 v55, v55, v19
    v_sub_f32 v56, v56, v20
    v_cvt_pk_bf16_f32 v30, v21, v22
    v_cvt_pk_bf16_f32 v31, v23, v24
    v_cvt_pk_bf16_f32 v32, v25, v54
    v_cvt_pk_bf16_f32 v33, v55, v56
    ds_write_b128 v8, v[30:33] offset:0
    v_lshlrev_b32 v21, 16, v162
    v_and_b32 v22, s51, v162
    v_lshlrev_b32 v23, 16, v163
    v_and_b32 v24, s51, v163
    v_lshlrev_b32 v25, 16, v164
    v_and_b32 v54, s51, v164
    v_lshlrev_b32 v55, 16, v165
    v_and_b32 v56, s51, v165
    v_sub_f32 v13, v13, v21
    v_sub_f32 v14, v14, v22
    v_sub_f32 v15, v15, v23
    v_sub_f32 v16, v16, v24
    v_sub_f32 v17, v17, v25
    v_sub_f32 v18, v18, v54
    v_sub_f32 v19, v19, v55
    v_sub_f32 v20, v20, v56
    v_cvt_pk_bf16_f32 v26, v13, v14
    v_cvt_pk_bf16_f32 v27, v15, v16
    v_cvt_pk_bf16_f32 v28, v17, v18
    v_cvt_pk_bf16_f32 v29, v19, v20
    ds_write_b128 v9, v[26:29] offset:0
    v_lshlrev_b32 v13, 16, v170
    v_and_b32 v14, s51, v170
    v_lshlrev_b32 v15, 16, v171
    v_and_b32 v16, s51, v171
    v_lshlrev_b32 v17, 16, v172
    v_and_b32 v18, s51, v172
    v_lshlrev_b32 v19, 16, v173
    v_and_b32 v20, s51, v173
    v_sub_f32 v21, v21, v13
    v_sub_f32 v22, v22, v14
    v_sub_f32 v23, v23, v15
    v_sub_f32 v24, v24, v16
    v_sub_f32 v25, v25, v17
    v_sub_f32 v54, v54, v18
    v_sub_f32 v55, v55, v19
    v_sub_f32 v56, v56, v20
    v_cvt_pk_bf16_f32 v30, v21, v22
    v_cvt_pk_bf16_f32 v31, v23, v24
    v_cvt_pk_bf16_f32 v32, v25, v54
    v_cvt_pk_bf16_f32 v33, v55, v56
    ds_write_b128 v10, v[30:33] offset:0
    v_lshlrev_b32 v13, 16, v226
    v_and_b32 v14, s51, v226
    v_lshlrev_b32 v15, 16, v227
    v_and_b32 v16, s51, v227
    v_lshlrev_b32 v17, 16, v228
    v_and_b32 v18, s51, v228
    v_lshlrev_b32 v19, 16, v229
    v_and_b32 v20, s51, v229
    v_lshlrev_b32 v21, 16, v234
    v_and_b32 v22, s51, v234
    v_lshlrev_b32 v23, 16, v235
    v_and_b32 v24, s51, v235
    v_lshlrev_b32 v25, 16, v236
    v_and_b32 v54, s51, v236
    v_lshlrev_b32 v55, 16, v237
    v_and_b32 v56, s51, v237
    v_sub_f32 v13, v13, v21
    v_sub_f32 v14, v14, v22
    v_sub_f32 v15, v15, v23
    v_sub_f32 v16, v16, v24
    v_sub_f32 v17, v17, v25
    v_sub_f32 v18, v18, v54
    v_sub_f32 v19, v19, v55
    v_sub_f32 v20, v20, v56
    v_cvt_pk_bf16_f32 v34, v13, v14
    v_cvt_pk_bf16_f32 v35, v15, v16
    v_cvt_pk_bf16_f32 v36, v17, v18
    v_cvt_pk_bf16_f32 v37, v19, v20
    ds_write_b128 v11, v[34:37] offset:0
    v_lshlrev_b32 v13, 16, v242
    v_and_b32 v14, s51, v242
    v_lshlrev_b32 v15, 16, v243
    v_and_b32 v16, s51, v243
    v_lshlrev_b32 v17, 16, v244
    v_and_b32 v18, s51, v244
    v_lshlrev_b32 v19, 16, v245
    v_and_b32 v20, s51, v245
    v_sub_f32 v21, v21, v13
    v_sub_f32 v22, v22, v14
    v_sub_f32 v23, v23, v15
    v_sub_f32 v24, v24, v16
    v_sub_f32 v25, v25, v17
    v_sub_f32 v54, v54, v18
    v_sub_f32 v55, v55, v19
    v_sub_f32 v56, v56, v20
    v_cvt_pk_bf16_f32 v38, v21, v22
    v_cvt_pk_bf16_f32 v39, v23, v24
    v_cvt_pk_bf16_f32 v40, v25, v54
    v_cvt_pk_bf16_f32 v41, v55, v56
    ds_write_b128 v12, v[38:41] offset:0
    s_mov_b64 exec, 1
    ds_add_u32 v252, v251 offset:484
    s_mov_b64 exec, -1
    v_lshlrev_b32 v13, 16, v102
    v_and_b32 v14, s51, v102
    v_lshlrev_b32 v15, 16, v103
    v_and_b32 v16, s51, v103
    v_lshlrev_b32 v17, 16, v104
    v_and_b32 v18, s51, v104
    v_lshlrev_b32 v19, 16, v105
    v_and_b32 v20, s51, v105
    v_lshlrev_b32 v21, 16, v110
    v_and_b32 v22, s51, v110
    v_lshlrev_b32 v23, 16, v111
    v_and_b32 v24, s51, v111
    v_lshlrev_b32 v25, 16, v112
    v_and_b32 v54, s51, v112
    v_lshlrev_b32 v55, 16, v113
    v_and_b32 v56, s51, v113
    v_subrev_f32 v13, v13, v21
    v_subrev_f32 v14, v14, v22
    v_subrev_f32 v15, v15, v23
    v_subrev_f32 v16, v16, v24
    v_subrev_f32 v17, v17, v25
    v_subrev_f32 v18, v18, v54
    v_subrev_f32 v19, v19, v55
    v_subrev_f32 v20, v20, v56
    v_cvt_pk_bf16_f32 v26, v13, v14
    v_cvt_pk_bf16_f32 v27, v15, v16
    v_cvt_pk_bf16_f32 v28, v17, v18
    v_cvt_pk_bf16_f32 v29, v19, v20
L_FRx10:
    ds_read_b128 v[44:47], v252 offset:368
    s_waitcnt lgkmcnt(0)
    v_and_b32 v44, v44, v45
    v_and_b32 v46, v46, v47
    v_and_b32 v44, v44, v46
    s_nop 0
    v_readfirstlane_b32 s47, v44
    s_cmp_eq_u32 s47, 1
    s_cbranch_scc1 L_FRx10_ok
    s_sleep 2
    s_branch L_FRx10
L_FRx10_ok:
    ds_write_b128 v7, v[26:29] offset:22528
    v_lshlrev_b32 v13, 16, v118
    v_and_b32 v14, s51, v118
    v_lshlrev_b32 v15, 16, v119
    v_and_b32 v16, s51, v119
    v_lshlrev_b32 v17, 16, v120
    v_and_b32 v18, s51, v120
    v_lshlrev_b32 v19, 16, v121
    v_and_b32 v20, s51, v121
    v_subrev_f32 v21, v21, v13
    v_subrev_f32 v22, v22, v14
    v_subrev_f32 v23, v23, v15
    v_subrev_f32 v24, v24, v16
    v_subrev_f32 v25, v25, v17
    v_subrev_f32 v54, v54, v18
    v_subrev_f32 v55, v55, v19
    v_subrev_f32 v56, v56, v20
    v_cvt_pk_bf16_f32 v30, v21, v22
    v_cvt_pk_bf16_f32 v31, v23, v24
    v_cvt_pk_bf16_f32 v32, v25, v54
    v_cvt_pk_bf16_f32 v33, v55, v56
    ds_write_b128 v8, v[30:33] offset:22528
    v_lshlrev_b32 v21, 16, v126
    v_and_b32 v22, s51, v126
    v_lshlrev_b32 v23, 16, v127
    v_and_b32 v24, s51, v127
    v_lshlrev_b32 v25, 16, v128
    v_and_b32 v54, s51, v128
    v_lshlrev_b32 v55, 16, v129
    v_and_b32 v56, s51, v129
    v_subrev_f32 v13, v13, v21
    v_subrev_f32 v14, v14, v22
    v_subrev_f32 v15, v15, v23
    v_subrev_f32 v16, v16, v24
    v_subrev_f32 v17, v17, v25
    v_subrev_f32 v18, v18, v54
    v_subrev_f32 v19, v19, v55
    v_subrev_f32 v20, v20, v56
    v_cvt_pk_bf16_f32 v26, v13, v14
    v_cvt_pk_bf16_f32 v27, v15, v16
    v_cvt_pk_bf16_f32 v28, v17, v18
    v_cvt_pk_bf16_f32 v29, v19, v20
    ds_write_b128 v9, v[26:29] offset:22528
    v_lshlrev_b32 v13, 16, v134
    v_and_b32 v14, s51, v134
    v_lshlrev_b32 v15, 16, v135
    v_and_b32 v16, s51, v135
    v_lshlrev_b32 v17, 16, v136
    v_and_b32 v18, s51, v136
    v_lshlrev_b32 v19, 16, v137
    v_and_b32 v20, s51, v137
    v_subrev_f32 v21, v21, v13
    v_subrev_f32 v22, v22, v14
    v_subrev_f32 v23, v23, v15
    v_subrev_f32 v24, v24, v16
    v_subrev_f32 v25, v25, v17
    v_subrev_f32 v54, v54, v18
    v_subrev_f32 v55, v55, v19
    v_subrev_f32 v56, v56, v20
    v_cvt_pk_bf16_f32 v30, v21, v22
    v_cvt_pk_bf16_f32 v31, v23, v24
    v_cvt_pk_bf16_f32 v32, v25, v54
    v_cvt_pk_bf16_f32 v33, v55, v56
    ds_write_b128 v10, v[30:33] offset:22528
    v_lshlrev_b32 v13, 16, v206
    v_and_b32 v14, s51, v206
    v_lshlrev_b32 v15, 16, v207
    v_and_b32 v16, s51, v207
    v_lshlrev_b32 v17, 16, v208
    v_and_b32 v18, s51, v208
    v_lshlrev_b32 v19, 16, v209
    v_and_b32 v20, s51, v209
    v_lshlrev_b32 v21, 16, v214
    v_and_b32 v22, s51, v214
    v_lshlrev_b32 v23, 16, v215
    v_and_b32 v24, s51, v215
    v_lshlrev_b32 v25, 16, v216
    v_and_b32 v54, s51, v216
    v_lshlrev_b32 v55, 16, v217
    v_and_b32 v56, s51, v217
    v_subrev_f32 v13, v13, v21
    v_subrev_f32 v14, v14, v22
    v_subrev_f32 v15, v15, v23
    v_subrev_f32 v16, v16, v24
    v_subrev_f32 v17, v17, v25
    v_subrev_f32 v18, v18, v54
    v_subrev_f32 v19, v19, v55
    v_subrev_f32 v20, v20, v56
    v_cvt_pk_bf16_f32 v34, v13, v14
    v_cvt_pk_bf16_f32 v35, v15, v16
    v_cvt_pk_bf16_f32 v36, v17, v18
    v_cvt_pk_bf16_f32 v37, v19, v20
    ds_write_b128 v11, v[34:37] offset:22528
    v_lshlrev_b32 v13, 16, v222
    v_and_b32 v14, s51, v222
    v_lshlrev_b32 v15, 16, v223
    v_and_b32 v16, s51, v223
    v_lshlrev_b32 v17, 16, v224
    v_and_b32 v18, s51, v224
    v_lshlrev_b32 v19, 16, v225
    v_and_b32 v20, s51, v225
    v_subrev_f32 v21, v21, v13
    v_subrev_f32 v22, v22, v14
    v_subrev_f32 v23, v23, v15
    v_subrev_f32 v24, v24, v16
    v_subrev_f32 v25, v25, v17
    v_subrev_f32 v54, v54, v18
    v_subrev_f32 v55, v55, v19
    v_subrev_f32 v56, v56, v20
    v_cvt_pk_bf16_f32 v38, v21, v22
    v_cvt_pk_bf16_f32 v39, v23, v24
    v_cvt_pk_bf16_f32 v40, v25, v54
    v_cvt_pk_bf16_f32 v41, v55, v56
    ds_write_b128 v12, v[38:41] offset:22528
    s_mov_b64 exec, 1
    ds_add_u32 v252, v251 offset:488
    s_mov_b64 exec, -1
    v_lshlrev_b32 v13, 16, v142
    v_and_b32 v14, s51, v142
    v_lshlrev_b32 v15, 16, v143
    v_and_b32 v16, s51, v143
    v_lshlrev_b32 v17, 16, v144
    v_and_b32 v18, s51, v144
    v_lshlrev_b32 v19, 16, v145
    v_and_b32 v20, s51, v145
    v_lshlrev_b32 v21, 16, v150
    v_and_b32 v22, s51, v150
    v_lshlrev_b32 v23, 16, v151
    v_and_b32 v24, s51, v151
    v_lshlrev_b32 v25, 16, v152
    v_and_b32 v54, s51, v152
    v_lshlrev_b32 v55, 16, v153
    v_and_b32 v56, s51, v153
    v_subrev_f32 v13, v13, v21
    v_subrev_f32 v14, v14, v22
    v_subrev_f32 v15, v15, v23
    v_subrev_f32 v16, v16, v24
    v_subrev_f32 v17, v17, v25
    v_subrev_f32 v18, v18, v54
    v_subrev_f32 v19, v19, v55
    v_subrev_f32 v20, v20, v56
    v_cvt_pk_bf16_f32 v26, v13, v14
    v_cvt_pk_bf16_f32 v27, v15, v16
    v_cvt_pk_bf16_f32 v28, v17, v18
    v_cvt_pk_bf16_f32 v29, v19, v20
L_FRx11:
    ds_read_b128 v[44:47], v252 offset:384
    s_waitcnt lgkmcnt(0)
    v_and_b32 v44, v44, v45
    v_and_b32 v46, v46, v47
    v_and_b32 v44, v44, v46
    s_nop 0
    v_readfirstlane_b32 s47, v44
    s_cmp_eq_u32 s47, 1
    s_cbranch_scc1 L_FRx11_ok
    s_sleep 2
    s_branch L_FRx11
L_FRx11_ok:
    ds_write_b128 v7, v[26:29] offset:45056
    v_lshlrev_b32 v13, 16, v158
    v_and_b32 v14, s51, v158
    v_lshlrev_b32 v15, 16, v159
    v_and_b32 v16, s51, v159
    v_lshlrev_b32 v17, 16, v160
    v_and_b32 v18, s51, v160
    v_lshlrev_b32 v19, 16, v161
    v_and_b32 v20, s51, v161
    v_subrev_f32 v21, v21, v13
    v_subrev_f32 v22, v22, v14
    v_subrev_f32 v23, v23, v15
    v_subrev_f32 v24, v24, v16
    v_subrev_f32 v25, v25, v17
    v_subrev_f32 v54, v54, v18
    v_subrev_f32 v55, v55, v19
    v_subrev_f32 v56, v56, v20
    v_cvt_pk_bf16_f32 v30, v21, v22
    v_cvt_pk_bf16_f32 v31, v23, v24
    v_cvt_pk_bf16_f32 v32, v25, v54
    v_cvt_pk_bf16_f32 v33, v55, v56
    ds_write_b128 v8, v[30:33] offset:45056
    v_lshlrev_b32 v21, 16, v166
    v_and_b32 v22, s51, v166
    v_lshlrev_b32 v23, 16, v167
    v_and_b32 v24, s51, v167
    v_lshlrev_b32 v25, 16, v168
    v_and_b32 v54, s51, v168
    v_lshlrev_b32 v55, 16, v169
    v_and_b32 v56, s51, v169
    v_subrev_f32 v13, v13, v21
    v_subrev_f32 v14, v14, v22
    v_subrev_f32 v15, v15, v23
    v_subrev_f32 v16, v16, v24
    v_subrev_f32 v17, v17, v25
    v_subrev_f32 v18, v18, v54
    v_subrev_f32 v19, v19, v55
    v_subrev_f32 v20, v20, v56
    v_cvt_pk_bf16_f32 v26, v13, v14
    v_cvt_pk_bf16_f32 v27, v15, v16
    v_cvt_pk_bf16_f32 v28, v17, v18
    v_cvt_pk_bf16_f32 v29, v19, v20
    ds_write_b128 v9, v[26:29] offset:45056
    v_lshlrev_b32 v13, 16, v174
    v_and_b32 v14, s51, v174
    v_lshlrev_b32 v15, 16, v175
    v_and_b32 v16, s51, v175
    v_lshlrev_b32 v17, 16, v176
    v_and_b32 v18, s51, v176
    v_lshlrev_b32 v19, 16, v177
    v_and_b32 v20, s51, v177
    v_subrev_f32 v21, v21, v13
    v_subrev_f32 v22, v22, v14
    v_subrev_f32 v23, v23, v15
    v_subrev_f32 v24, v24, v16
    v_subrev_f32 v25, v25, v17
    v_subrev_f32 v54, v54, v18
    v_subrev_f32 v55, v55, v19
    v_subrev_f32 v56, v56, v20
    v_cvt_pk_bf16_f32 v30, v21, v22
    v_cvt_pk_bf16_f32 v31, v23, v24
    v_cvt_pk_bf16_f32 v32, v25, v54
    v_cvt_pk_bf16_f32 v33, v55, v56
    ds_write_b128 v10, v[30:33] offset:45056
    v_lshlrev_b32 v13, 16, v230
    v_and_b32 v14, s51, v230
    v_lshlrev_b32 v15, 16, v231
    v_and_b32 v16, s51, v231
    v_lshlrev_b32 v17, 16, v232
    v_and_b32 v18, s51, v232
    v_lshlrev_b32 v19, 16, v233
    v_and_b32 v20, s51, v233
    v_lshlrev_b32 v21, 16, v238
    v_and_b32 v22, s51, v238
    v_lshlrev_b32 v23, 16, v239
    v_and_b32 v24, s51, v239
    v_lshlrev_b32 v25, 16, v240
    v_and_b32 v54, s51, v240
    v_lshlrev_b32 v55, 16, v241
    v_and_b32 v56, s51, v241
    v_subrev_f32 v13, v13, v21
    v_subrev_f32 v14, v14, v22
    v_subrev_f32 v15, v15, v23
    v_subrev_f32 v16, v16, v24
    v_subrev_f32 v17, v17, v25
    v_subrev_f32 v18, v18, v54
    v_subrev_f32 v19, v19, v55
    v_subrev_f32 v20, v20, v56
    v_cvt_pk_bf16_f32 v34, v13, v14
    v_cvt_pk_bf16_f32 v35, v15, v16
    v_cvt_pk_bf16_f32 v36, v17, v18
    v_cvt_pk_bf16_f32 v37, v19, v20
    ds_write_b128 v11, v[34:37] offset:45056
    v_lshlrev_b32 v13, 16, v246
    v_and_b32 v14, s51, v246
    v_lshlrev_b32 v15, 16, v247
    v_and_b32 v16, s51, v247
    v_lshlrev_b32 v17, 16, v248
    v_and_b32 v18, s51, v248
    v_lshlrev_b32 v19, 16, v249
    v_and_b32 v20, s51, v249
    v_subrev_f32 v21, v21, v13
    v_subrev_f32 v22, v22, v14
    v_subrev_f32 v23, v23, v15
    v_subrev_f32 v24, v24, v16
    v_subrev_f32 v25, v25, v17
    v_subrev_f32 v54, v54, v18
    v_subrev_f32 v55, v55, v19
    v_subrev_f32 v56, v56, v20
    v_cvt_pk_bf16_f32 v38, v21, v22
    v_cvt_pk_bf16_f32 v39, v23, v24
    v_cvt_pk_bf16_f32 v40, v25, v54
    v_cvt_pk_bf16_f32 v41, v55, v56
    ds_write_b128 v12, v[38:41] offset:45056
    s_mov_b64 exec, 1
    ds_add_u32 v252, v251 offset:492
    s_mov_b64 exec, -1
    s_mul_i32 s47, s39, 86016
    s_mul_i32 s48, s38, 12288
    s_add_u32 s47, s47, s48
    s_mul_i32 s48, s55, 3072
    s_add_u32 s47, s47, s48
    s_mul_i32 s48, s55, 1600
    s_add_u32 s48, s48, 68096
    v_add_u32 v13, 0, v0
    v_mul_u32_u24 v14, 1366, v13
    v_lshrrev_b32 v14, 16, v14
    v_mul_u32_u24 v15, 48, v14
    v_sub_u32 v15, v13, v15
    v_lshlrev_b32 v15, 3, v15
    v_mul_u32_u24 v16, 400, v14
    v_add3_u32 v7, v16, v15, s48
    v_mul_u32_u24 v16, 768, v14
    v_add3_u32 v10, v16, v15, s47
    v_add_u32 v20, 38400, v7
    v_add_u32 v13, 64, v0
    v_mul_u32_u24 v14, 1366, v13
    v_lshrrev_b32 v14, 16, v14
    v_mul_u32_u24 v15, 48, v14
    v_sub_u32 v15, v13, v15
    v_lshlrev_b32 v15, 3, v15
    v_mul_u32_u24 v16, 400, v14
    v_add3_u32 v8, v16, v15, s48
    v_mul_u32_u24 v16, 768, v14
    v_add3_u32 v11, v16, v15, s47
    v_add_u32 v21, 38400, v8
    v_add_u32 v13, 128, v0
    v_mul_u32_u24 v14, 1366, v13
    v_lshrrev_b32 v14, 16, v14
    v_mul_u32_u24 v15, 48, v14
    v_sub_u32 v15, v13, v15
    v_lshlrev_b32 v15, 3, v15
    v_mul_u32_u24 v16, 400, v14
    v_add3_u32 v9, v16, v15, s48
    v_mul_u32_u24 v16, 768, v14
    v_add3_u32 v12, v16, v15, s47
    v_add_u32 v22, 38400, v9
    v_add_u32 v13, 0, v0
    v_min_u32 v13, 95, v13
    v_mul_u32_u24 v14, 10923, v13
    v_lshrrev_b32 v14, 18, v14
    v_mul_u32_u24 v15, 24, v14
    v_sub_u32 v15, v13, v15
    v_lshlrev_b32 v15, 4, v15
    v_mul_u32_u24 v16, 400, v14
    v_add3_u32 v1, v16, v15, s48
    v_mul_u32_u24 v16, 768, v14
    v_add3_u32 v3, v16, v15, s47
    v_add_u32 v13, 64, v0
    v_min_u32 v13, 95, v13
    v_mul_u32_u24 v14, 10923, v13
    v_lshrrev_b32 v14, 18, v14
    v_mul_u32_u24 v15, 24, v14
    v_sub_u32 v15, v13, v15
    v_lshlrev_b32 v15, 4, v15
    v_mul_u32_u24 v16, 400, v14
    v_add3_u32 v2, v16, v15, s48
    v_mul_u32_u24 v16, 768, v14
    v_add3_u32 v4, v16, v15, s47
    v_cmp_gt_u32 vcc, 32, v0
    v_mov_b32 v17, s59
    v_add_u32 v250, 38400, v1
    v_cndmask_b32 v4, v17, v4, vcc
    v_add_u32 v251, 38400, v2
    s_lshl_b32 s47, s55, 2
    v_bfe_u32 v13, v0, 3, 2
    v_add_u32 v13, s47, v13
    v_and_b32 v14, 7, v0
    v_mul_u32_u24 v15, 144, v13
    v_lshl_add_u32 v15, v14, 4, v15
    v_add_u32 v5, 144896, v15
    v_mul_u32_u24 v13, 768, v13
    v_lshrrev_b32 v15, 1, v14
    v_mul_u32_u24 v15, 96, v15
    v_and_b32 v14, 1, v14
    v_lshl_add_u32 v15, v14, 4, v15
    s_mul_i32 s47, s42, 86016
    s_mul_i32 s48, s41, 12288
    s_add_u32 s47, s47, s48
    s_lshl_b32 s48, s43, 5
    s_add_u32 s47, s47, s48
    v_add3_u32 v6, v13, v15, s47
    v_cndmask_b32 v6, v17, v6, vcc
L_Fx0_5:
    ds_read_b128 v[16:19], v252 offset:80
    s_waitcnt lgkmcnt(0)
    v_and_b32 v16, v16, v17
    v_and_b32 v18, v18, v19
    v_and_b32 v16, v16, v18
    s_nop 0
    v_readfirstlane_b32 s47, v16
    s_cmp_eq_u32 s47, 1
    s_cbranch_scc1 L_Fx0_5_ok
    s_sleep 2
    s_branch L_Fx0_5
L_Fx0_5_ok:
    ds_read_b64 v[28:29], v7 offset:0
    ds_read_b64 v[30:31], v8 offset:0
    ds_read_b64 v[32:33], v9 offset:0
    ds_read_b64 v[36:37], v7 offset:6400
    ds_read_b64 v[38:39], v8 offset:6400
    ds_read_b64 v[40:41], v9 offset:6400
    ds_read_b64 v[44:45], v7 offset:12800
    ds_read_b64 v[46:47], v8 offset:12800
    ds_read_b64 v[48:49], v9 offset:12800
    ds_read_b64 v[52:53], v7 offset:19200
    ds_read_b64 v[54:55], v8 offset:19200
    ds_read_b64 v[56:57], v9 offset:19200
    ds_read_b64 v[60:61], v7 offset:25600
    ds_read_b64 v[62:63], v8 offset:25600
    ds_read_b64 v[64:65], v9 offset:25600
    ds_read_b64 v[68:69], v7 offset:32000
    ds_read_b64 v[70:71], v8 offset:32000
    ds_read_b64 v[72:73], v9 offset:32000
L_FxGO14:
    ds_read_b128 v[16:19], v252 offset:224
    s_waitcnt lgkmcnt(0)
    v_and_b32 v16, v16, v17
    v_and_b32 v18, v18, v19
    v_and_b32 v16, v16, v18
    s_nop 0
    v_readfirstlane_b32 s47, v16
    s_cmp_eq_u32 s47, 1
    s_cbranch_scc1 L_FxGO14_ok
    s_sleep 1
    s_branch L_FxGO14
L_FxGO14_ok:
    s_mov_b32 s53, 0
    buffer_store_dwordx2 v[28:29], v10, s[12:15], s53 offen offset:0 nt
    buffer_store_dwordx2 v[30:31], v11, s[12:15], s53 offen offset:0 nt
    buffer_store_dwordx2 v[32:33], v12, s[12:15], s53 offen offset:0 nt
    s_mov_b32 s53, 86016
    buffer_store_dwordx2 v[36:37], v10, s[12:15], s53 offen offset:0 nt
    buffer_store_dwordx2 v[38:39], v11, s[12:15], s53 offen offset:0 nt
    buffer_store_dwordx2 v[40:41], v12, s[12:15], s53 offen offset:0 nt
    s_mov_b32 s53, 172032
    buffer_store_dwordx2 v[44:45], v10, s[12:15], s53 offen offset:0 nt
    buffer_store_dwordx2 v[46:47], v11, s[12:15], s53 offen offset:0 nt
    buffer_store_dwordx2 v[48:49], v12, s[12:15], s53 offen offset:0 nt
    s_mov_b32 s53, 258048
    buffer_store_dwordx2 v[52:53], v10, s[12:15], s53 offen offset:0 nt
    buffer_store_dwordx2 v[54:55], v11, s[12:15], s53 offen offset:0 nt
    buffer_store_dwordx2 v[56:57], v12, s[12:15], s53 offen offset:0 nt
    s_mov_b32 s53, 344064
    buffer_store_dwordx2 v[60:61], v10, s[12:15], s53 offen offset:0 nt
    buffer_store_dwordx2 v[62:63], v11, s[12:15], s53 offen offset:0 nt
    buffer_store_dwordx2 v[64:65], v12, s[12:15], s53 offen offset:0 nt
    s_mov_b32 s53, 430080
    buffer_store_dwordx2 v[68:69], v10, s[12:15], s53 offen offset:0 nt
    buffer_store_dwordx2 v[70:71], v11, s[12:15], s53 offen offset:0 nt
    buffer_store_dwordx2 v[72:73], v12, s[12:15], s53 offen offset:0 nt
L_FxX0:
    ds_read_b128 v[16:19], v252 offset:192
    s_waitcnt lgkmcnt(0)
    v_and_b32 v16, v16, v17
    v_and_b32 v18, v18, v19
    v_and_b32 v16, v16, v18
    s_nop 0
    v_readfirstlane_b32 s47, v16
    s_cmp_eq_u32 s47, 1
    s_cbranch_scc1 L_FxX0_ok
    s_sleep 1
    s_branch L_FxX0
L_FxX0_ok:
    ds_read_b128 v[76:79], v5 offset:0
    s_waitcnt lgkmcnt(0)
    buffer_store_dwordx4 v[76:79], v6, s[12:15], 0 offen offset:0
L_Fx1_0:
    ds_read_b128 v[16:19], v252 offset:96
    s_waitcnt lgkmcnt(0)
    v_and_b32 v16, v16, v17
    v_and_b32 v18, v18, v19
    v_and_b32 v16, v16, v18
    s_nop 0
    v_readfirstlane_b32 s47, v16
    s_cmp_eq_u32 s47, 1
    s_cbranch_scc1 L_Fx1_0_ok
    s_sleep 1
    s_branch L_Fx1_0
L_Fx1_0_ok:
    ds_read_b64 v[84:85], v20 offset:0
    ds_read_b64 v[86:87], v21 offset:0
    ds_read_b64 v[88:89], v22 offset:0
    s_mov_b32 s53, 0
    s_waitcnt lgkmcnt(2)
    buffer_store_dwordx2 v[84:85], v10, s[12:15], s53 offen offset:384 nt
    s_waitcnt lgkmcnt(1)
    buffer_store_dwordx2 v[86:87], v11, s[12:15], s53 offen offset:384 nt
    s_waitcnt lgkmcnt(0)
    buffer_store_dwordx2 v[88:89], v12, s[12:15], s53 offen offset:384 nt
L_Fx1_1:
    ds_read_b128 v[16:19], v252 offset:112
    s_waitcnt lgkmcnt(0)
    v_and_b32 v16, v16, v17
    v_and_b32 v18, v18, v19
    v_and_b32 v16, v16, v18
    s_nop 0
    v_readfirstlane_b32 s47, v16
    s_cmp_eq_u32 s47, 1
    s_cbranch_scc1 L_Fx1_1_ok
    s_sleep 1
    s_branch L_Fx1_1
L_Fx1_1_ok:
    ds_read_b64 v[92:93], v20 offset:6400
    ds_read_b64 v[94:95], v21 offset:6400
    ds_read_b64 v[96:97], v22 offset:6400
    s_mov_b32 s53, 86016
    s_waitcnt lgkmcnt(2)
    buffer_store_dwordx2 v[92:93], v10, s[12:15], s53 offen offset:384 nt
    s_waitcnt lgkmcnt(1)
    buffer_store_dwordx2 v[94:95], v11, s[12:15], s53 offen offset:384 nt
    s_waitcnt lgkmcnt(0)
    buffer_store_dwordx2 v[96:97], v12, s[12:15], s53 offen offset:384 nt
L_FxX1:
    ds_read_b128 v[16:19], v252 offset:208
    s_waitcnt lgkmcnt(0)
    v_and_b32 v16, v16, v17
    v_and_b32 v18, v18, v19
    v_and_b32 v16, v16, v18
    s_nop 0
    v_readfirstlane_b32 s47, v16
    s_cmp_eq_u32 s47, 1
    s_cbranch_scc1 L_FxX1_ok
    s_sleep 1
    s_branch L_FxX1
L_FxX1_ok:
    ds_read_b128 v[80:83], v5 offset:2304
    s_waitcnt lgkmcnt(0)
    buffer_store_dwordx4 v[80:83], v6, s[12:15], 0 offen offset:384
L_Fx1_2:
    ds_read_b128 v[16:19], v252 offset:128
    s_waitcnt lgkmcnt(0)
    v_and_b32 v16, v16, v17
    v_and_b32 v18, v18, v19
    v_and_b32 v16, v16, v18
    s_nop 0
    v_readfirstlane_b32 s47, v16
    s_cmp_eq_u32 s47, 1
    s_cbranch_scc1 L_Fx1_2_ok
    s_sleep 1
    s_branch L_Fx1_2
L_Fx1_2_ok:
    ds_read_b64 v[100:101], v20 offset:12800
    ds_read_b64 v[102:103], v21 offset:12800
    ds_read_b64 v[104:105], v22 offset:12800
    s_mov_b32 s53, 172032
    s_waitcnt lgkmcnt(2)
    buffer_store_dwordx2 v[100:101], v10, s[12:15], s53 offen offset:384 nt
    s_waitcnt lgkmcnt(1)
    buffer_store_dwordx2 v[102:103], v11, s[12:15], s53 offen offset:384 nt
    s_waitcnt lgkmcnt(0)
    buffer_store_dwordx2 v[104:105], v12, s[12:15], s53 offen offset:384 nt
L_Fx1_3:
    ds_read_b128 v[16:19], v252 offset:144
    s_waitcnt lgkmcnt(0)
    v_and_b32 v16, v16, v17
    v_and_b32 v18, v18, v19
    v_and_b32 v16, v16, v18
    s_nop 0
    v_readfirstlane_b32 s47, v16
    s_cmp_eq_u32 s47, 1
    s_cbranch_scc1 L_Fx1_3_ok
    s_sleep 1
    s_branch L_Fx1_3
L_Fx1_3_ok:
    ds_read_b64 v[108:109], v20 offset:19200
    ds_read_b64 v[110:111], v21 offset:19200
    ds_read_b64 v[112:113], v22 offset:19200
    s_mov_b32 s53, 258048
    s_waitcnt lgkmcnt(2)
    buffer_store_dwordx2 v[108:109], v10, s[12:15], s53 offen offset:384 nt
    s_waitcnt lgkmcnt(1)
    buffer_store_dwordx2 v[110:111], v11, s[12:15], s53 offen offset:384 nt
    s_waitcnt lgkmcnt(0)
    buffer_store_dwordx2 v[112:113], v12, s[12:15], s53 offen offset:384 nt
L_Fx1_4:
    ds_read_b128 v[16:19], v252 offset:160
    s_waitcnt lgkmcnt(0)
    v_and_b32 v16, v16, v17
    v_and_b32 v18, v18, v19
    v_and_b32 v16, v16, v18
    s_nop 0
    v_readfirstlane_b32 s47, v16
    s_cmp_eq_u32 s47, 1
    s_cbranch_scc1 L_Fx1_4_ok
    s_branch L_Fx1_4
L_Fx1_4_ok:
    ds_read_b64 v[116:117], v20 offset:25600
    ds_read_b64 v[118:119], v21 offset:25600
    ds_read_b64 v[120:121], v22 offset:25600
    s_mov_b32 s53, 344064
    s_waitcnt lgkmcnt(2)
    buffer_store_dwordx2 v[116:117], v10, s[12:15], s53 offen offset:384 nt
    s_waitcnt lgkmcnt(1)
    buffer_store_dwordx2 v[118:119], v11, s[12:15], s53 offen offset:384 nt
    s_waitcnt lgkmcnt(0)
    buffer_store_dwordx2 v[120:121], v12, s[12:15], s53 offen offset:384 nt
L_Fx1_5:
    ds_read_b128 v[16:19], v252 offset:176
    s_waitcnt lgkmcnt(0)
    v_and_b32 v16, v16, v17
    v_and_b32 v18, v18, v19
    v_and_b32 v16, v16, v18
    s_nop 0
    v_readfirstlane_b32 s47, v16
    s_cmp_eq_u32 s47, 1
    s_cbranch_scc1 L_Fx1_5_ok
    s_branch L_Fx1_5
L_Fx1_5_ok:
    ds_read_b64 v[124:125], v20 offset:32000
    ds_read_b64 v[126:127], v21 offset:32000
    ds_read_b64 v[128:129], v22 offset:32000
    s_mov_b32 s53, 430080
    s_waitcnt lgkmcnt(2)
    buffer_store_dwordx2 v[124:125], v10, s[12:15], s53 offen offset:384 nt
    s_waitcnt lgkmcnt(1)
    buffer_store_dwordx2 v[126:127], v11, s[12:15], s53 offen offset:384 nt
    s_waitcnt lgkmcnt(0)
    buffer_store_dwordx2 v[128:129], v12, s[12:15], s53 offen offset:384 nt
    s_endpgm
.org standalone__standard_2d_1d_3d_conv__vision_kernel + 12800, 0
L_PN:
    buffer_load_dwordx4 v[62:65], v2, s[4:7], 0 offen offset:0
    buffer_load_dwordx4 v[70:73], v2, s[4:7], 0 offen offset:768
    buffer_load_dwordx4 v[78:81], v2, s[4:7], 0 offen offset:1536
    buffer_load_dwordx4 v[86:89], v2, s[4:7], 0 offen offset:2304
    buffer_load_dwordx4 v[94:97], v3, s[4:7], 0 offen offset:0
    s_lshl_b32 s47, s55, 1
    v_add_u32 v15, s47, v15
    v_mul_u32_u24 v7, 11264, v7
    v_lshl_add_u32 v7, v15, 10, v7
    v_lshlrev_b32 v16, 2, v14
    v_lshl_add_u32 v16, v13, 4, v16
    v_add_u32 v16, v16, v13
    v_lshl_add_u32 v7, v16, 4, v7
    v_xor_b32 v8, 16, v7
    v_xor_b32 v9, 32, v7
    v_xor_b32 v10, 48, v7
    s_and_b32 s47, s2, 7
    s_mul_i32 s47, s47, 12
    s_add_u32 s47, s47, s46
    s_sub_u32 s47, s47, 7
    s_mul_i32 s48, s47, 21846
    s_lshr_b32 s48, s48, 16
    s_mul_i32 s49, s48, 3
    s_sub_u32 s43, s47, s49
    s_cmp_eq_u32 s40, 1
    s_cselect_b32 s43, s43, 0
    s_cselect_b32 s48, s48, 0
    s_lshl_b32 s41, s48, 1
    s_and_b32 s41, s41, 12
    s_lshr_b32 s41, 0x5310, s41
    s_and_b32 s41, s41, 15
    s_and_b32 s42, s48, 1
    s_add_u32 s42, s42, 222
    s_lshr_b32 s50, s48, 3
    s_lshl_b32 s50, s50, 1
    s_and_b32 s49, s48, 7
    s_add_u32 s49, s49, 216
    s_cmp_lt_u32 s48, 8
    s_cselect_b32 s41, s41, s50
    s_cselect_b32 s42, s42, s49
    s_mov_b32 s12, s34
    s_mov_b32 s13, s35
    s_mov_b32 s14, 19267584
    s_mov_b32 s15, 0x20000
    s_cmp_eq_u32 s55, 3
    s_cselect_b32 s56, 1, 0
    s_mul_i32 s47, s46, 2304
    v_min_u32 v253, 17, v0
    v_lshl_add_u32 v253, v253, 7, s47
    v_mov_b32 v250, 67824
    s_mov_b32 s16, s26
    s_mov_b32 s17, s27
    s_mov_b32 s18, 884736
    s_mov_b32 s19, 0x20000
    v_mov_b32 v251, 1
    v_mov_b32 v252, 67584
    s_waitcnt lgkmcnt(0)
    s_barrier
    s_waitcnt vmcnt(5)
    v_lshlrev_b32 v13, 16, v58
    v_and_b32 v14, s51, v58
    v_lshlrev_b32 v15, 16, v59
    v_and_b32 v16, s51, v59
    v_lshlrev_b32 v17, 16, v60
    v_and_b32 v18, s51, v60
    v_lshlrev_b32 v19, 16, v61
    v_and_b32 v20, s51, v61
    v_lshlrev_b32 v21, 16, v66
    v_and_b32 v22, s51, v66
    v_lshlrev_b32 v23, 16, v67
    v_and_b32 v24, s51, v67
    v_lshlrev_b32 v25, 16, v68
    v_and_b32 v54, s51, v68
    v_lshlrev_b32 v55, 16, v69
    v_and_b32 v56, s51, v69
    v_sub_f32 v13, v13, v21
    v_sub_f32 v14, v14, v22
    v_sub_f32 v15, v15, v23
    v_sub_f32 v16, v16, v24
    v_sub_f32 v17, v17, v25
    v_sub_f32 v18, v18, v54
    v_sub_f32 v19, v19, v55
    v_sub_f32 v20, v20, v56
    v_cvt_pk_bf16_f32 v26, v13, v14
    v_cvt_pk_bf16_f32 v27, v15, v16
    v_cvt_pk_bf16_f32 v28, v17, v18
    v_cvt_pk_bf16_f32 v29, v19, v20
    ds_write_b128 v7, v[26:29] offset:0
    v_lshlrev_b32 v13, 16, v74
    v_and_b32 v14, s51, v74
    v_lshlrev_b32 v15, 16, v75
    v_and_b32 v16, s51, v75
    v_lshlrev_b32 v17, 16, v76
    v_and_b32 v18, s51, v76
    v_lshlrev_b32 v19, 16, v77
    v_and_b32 v20, s51, v77
    v_sub_f32 v21, v21, v13
    v_sub_f32 v22, v22, v14
    v_sub_f32 v23, v23, v15
    v_sub_f32 v24, v24, v16
    v_sub_f32 v25, v25, v17
    v_sub_f32 v54, v54, v18
    v_sub_f32 v55, v55, v19
    v_sub_f32 v56, v56, v20
    v_cvt_pk_bf16_f32 v30, v21, v22
    v_cvt_pk_bf16_f32 v31, v23, v24
    v_cvt_pk_bf16_f32 v32, v25, v54
    v_cvt_pk_bf16_f32 v33, v55, v56
    ds_write_b128 v8, v[30:33] offset:0
    v_lshlrev_b32 v21, 16, v82
    v_and_b32 v22, s51, v82
    v_lshlrev_b32 v23, 16, v83
    v_and_b32 v24, s51, v83
    v_lshlrev_b32 v25, 16, v84
    v_and_b32 v54, s51, v84
    v_lshlrev_b32 v55, 16, v85
    v_and_b32 v56, s51, v85
    v_sub_f32 v13, v13, v21
    v_sub_f32 v14, v14, v22
    v_sub_f32 v15, v15, v23
    v_sub_f32 v16, v16, v24
    v_sub_f32 v17, v17, v25
    v_sub_f32 v18, v18, v54
    v_sub_f32 v19, v19, v55
    v_sub_f32 v20, v20, v56
    v_cvt_pk_bf16_f32 v26, v13, v14
    v_cvt_pk_bf16_f32 v27, v15, v16
    v_cvt_pk_bf16_f32 v28, v17, v18
    v_cvt_pk_bf16_f32 v29, v19, v20
    ds_write_b128 v9, v[26:29] offset:0
    v_lshlrev_b32 v13, 16, v90
    v_and_b32 v14, s51, v90
    v_lshlrev_b32 v15, 16, v91
    v_and_b32 v16, s51, v91
    v_lshlrev_b32 v17, 16, v92
    v_and_b32 v18, s51, v92
    v_lshlrev_b32 v19, 16, v93
    v_and_b32 v20, s51, v93
    v_sub_f32 v21, v21, v13
    v_sub_f32 v22, v22, v14
    v_sub_f32 v23, v23, v15
    v_sub_f32 v24, v24, v16
    v_sub_f32 v25, v25, v17
    v_sub_f32 v54, v54, v18
    v_sub_f32 v55, v55, v19
    v_sub_f32 v56, v56, v20
    v_cvt_pk_bf16_f32 v30, v21, v22
    v_cvt_pk_bf16_f32 v31, v23, v24
    v_cvt_pk_bf16_f32 v32, v25, v54
    v_cvt_pk_bf16_f32 v33, v55, v56
    ds_write_b128 v10, v[30:33] offset:0
    s_mov_b64 exec, 1
    ds_add_u32 v252, v251 offset:448
    s_mov_b64 exec, -1
    s_waitcnt vmcnt(0)
    v_lshlrev_b32 v13, 16, v62
    v_and_b32 v14, s51, v62
    v_lshlrev_b32 v15, 16, v63
    v_and_b32 v16, s51, v63
    v_lshlrev_b32 v17, 16, v64
    v_and_b32 v18, s51, v64
    v_lshlrev_b32 v19, 16, v65
    v_and_b32 v20, s51, v65
    v_lshlrev_b32 v21, 16, v70
    v_and_b32 v22, s51, v70
    v_lshlrev_b32 v23, 16, v71
    v_and_b32 v24, s51, v71
    v_lshlrev_b32 v25, 16, v72
    v_and_b32 v54, s51, v72
    v_lshlrev_b32 v55, 16, v73
    v_and_b32 v56, s51, v73
    v_sub_f32 v13, v13, v21
    v_sub_f32 v14, v14, v22
    v_sub_f32 v15, v15, v23
    v_sub_f32 v16, v16, v24
    v_sub_f32 v17, v17, v25
    v_sub_f32 v18, v18, v54
    v_sub_f32 v19, v19, v55
    v_sub_f32 v20, v20, v56
    v_cvt_pk_bf16_f32 v26, v13, v14
    v_cvt_pk_bf16_f32 v27, v15, v16
    v_cvt_pk_bf16_f32 v28, v17, v18
    v_cvt_pk_bf16_f32 v29, v19, v20
    ds_write_b128 v7, v[26:29] offset:22528
    v_lshlrev_b32 v13, 16, v78
    v_and_b32 v14, s51, v78
    v_lshlrev_b32 v15, 16, v79
    v_and_b32 v16, s51, v79
    v_lshlrev_b32 v17, 16, v80
    v_and_b32 v18, s51, v80
    v_lshlrev_b32 v19, 16, v81
    v_and_b32 v20, s51, v81
    v_sub_f32 v21, v21, v13
    v_sub_f32 v22, v22, v14
    v_sub_f32 v23, v23, v15
    v_sub_f32 v24, v24, v16
    v_sub_f32 v25, v25, v17
    v_sub_f32 v54, v54, v18
    v_sub_f32 v55, v55, v19
    v_sub_f32 v56, v56, v20
    v_cvt_pk_bf16_f32 v30, v21, v22
    v_cvt_pk_bf16_f32 v31, v23, v24
    v_cvt_pk_bf16_f32 v32, v25, v54
    v_cvt_pk_bf16_f32 v33, v55, v56
    ds_write_b128 v8, v[30:33] offset:22528
    v_lshlrev_b32 v21, 16, v86
    v_and_b32 v22, s51, v86
    v_lshlrev_b32 v23, 16, v87
    v_and_b32 v24, s51, v87
    v_lshlrev_b32 v25, 16, v88
    v_and_b32 v54, s51, v88
    v_lshlrev_b32 v55, 16, v89
    v_and_b32 v56, s51, v89
    v_sub_f32 v13, v13, v21
    v_sub_f32 v14, v14, v22
    v_sub_f32 v15, v15, v23
    v_sub_f32 v16, v16, v24
    v_sub_f32 v17, v17, v25
    v_sub_f32 v18, v18, v54
    v_sub_f32 v19, v19, v55
    v_sub_f32 v20, v20, v56
    v_cvt_pk_bf16_f32 v26, v13, v14
    v_cvt_pk_bf16_f32 v27, v15, v16
    v_cvt_pk_bf16_f32 v28, v17, v18
    v_cvt_pk_bf16_f32 v29, v19, v20
    ds_write_b128 v9, v[26:29] offset:22528
    v_lshlrev_b32 v13, 16, v94
    v_and_b32 v14, s51, v94
    v_lshlrev_b32 v15, 16, v95
    v_and_b32 v16, s51, v95
    v_lshlrev_b32 v17, 16, v96
    v_and_b32 v18, s51, v96
    v_lshlrev_b32 v19, 16, v97
    v_and_b32 v20, s51, v97
    v_sub_f32 v21, v21, v13
    v_sub_f32 v22, v22, v14
    v_sub_f32 v23, v23, v15
    v_sub_f32 v24, v24, v16
    v_sub_f32 v25, v25, v17
    v_sub_f32 v54, v54, v18
    v_sub_f32 v55, v55, v19
    v_sub_f32 v56, v56, v20
    v_cvt_pk_bf16_f32 v30, v21, v22
    v_cvt_pk_bf16_f32 v31, v23, v24
    v_cvt_pk_bf16_f32 v32, v25, v54
    v_cvt_pk_bf16_f32 v33, v55, v56
    ds_write_b128 v10, v[30:33] offset:22528
    s_mov_b64 exec, 1
    ds_add_u32 v252, v251 offset:452
    s_mov_b64 exec, -1
    v_lshlrev_b32 v13, 16, v62
    v_and_b32 v14, s51, v62
    v_lshlrev_b32 v15, 16, v66
    v_and_b32 v16, s51, v66
    v_lshlrev_b32 v19, 16, v63
    v_and_b32 v20, s51, v63
    v_lshlrev_b32 v21, 16, v67
    v_and_b32 v22, s51, v67
    v_add_f32 v17, v13, v15
    v_add_f32 v18, v14, v16
    v_sub_f32 v13, v15, v13
    v_sub_f32 v14, v16, v14
    v_add_f32 v23, v19, v21
    v_add_f32 v24, v20, v22
    v_sub_f32 v19, v21, v19
    v_sub_f32 v20, v22, v20
    v_cvt_pk_bf16_f32 v26, v17, v18
    v_cvt_pk_bf16_f32 v34, v13, v14
    v_cvt_pk_bf16_f32 v27, v23, v24
    v_cvt_pk_bf16_f32 v35, v19, v20
    v_lshlrev_b32 v13, 16, v64
    v_and_b32 v14, s51, v64
    v_lshlrev_b32 v15, 16, v68
    v_and_b32 v16, s51, v68
    v_lshlrev_b32 v19, 16, v65
    v_and_b32 v20, s51, v65
    v_lshlrev_b32 v21, 16, v69
    v_and_b32 v22, s51, v69
    v_add_f32 v17, v13, v15
    v_add_f32 v18, v14, v16
    v_sub_f32 v13, v15, v13
    v_sub_f32 v14, v16, v14
    v_add_f32 v23, v19, v21
    v_add_f32 v24, v20, v22
    v_sub_f32 v19, v21, v19
    v_sub_f32 v20, v22, v20
    v_cvt_pk_bf16_f32 v28, v17, v18
    v_cvt_pk_bf16_f32 v36, v13, v14
    v_cvt_pk_bf16_f32 v29, v23, v24
    v_cvt_pk_bf16_f32 v37, v19, v20
    ds_write_b128 v7, v[26:29] offset:45056
    v_lshlrev_b32 v13, 16, v70
    v_and_b32 v14, s51, v70
    v_lshlrev_b32 v15, 16, v74
    v_and_b32 v16, s51, v74
    v_lshlrev_b32 v19, 16, v71
    v_and_b32 v20, s51, v71
    v_lshlrev_b32 v21, 16, v75
    v_and_b32 v22, s51, v75
    v_add_f32 v17, v13, v15
    v_add_f32 v18, v14, v16
    v_sub_f32 v13, v15, v13
    v_sub_f32 v14, v16, v14
    v_add_f32 v23, v19, v21
    v_add_f32 v24, v20, v22
    v_sub_f32 v19, v21, v19
    v_sub_f32 v20, v22, v20
    v_cvt_pk_bf16_f32 v30, v17, v18
    v_cvt_pk_bf16_f32 v38, v13, v14
    v_cvt_pk_bf16_f32 v31, v23, v24
    v_cvt_pk_bf16_f32 v39, v19, v20
    v_lshlrev_b32 v13, 16, v72
    v_and_b32 v14, s51, v72
    v_lshlrev_b32 v15, 16, v76
    v_and_b32 v16, s51, v76
    v_lshlrev_b32 v19, 16, v73
    v_and_b32 v20, s51, v73
    v_lshlrev_b32 v21, 16, v77
    v_and_b32 v22, s51, v77
    v_add_f32 v17, v13, v15
    v_add_f32 v18, v14, v16
    v_sub_f32 v13, v15, v13
    v_sub_f32 v14, v16, v14
    v_add_f32 v23, v19, v21
    v_add_f32 v24, v20, v22
    v_sub_f32 v19, v21, v19
    v_sub_f32 v20, v22, v20
    v_cvt_pk_bf16_f32 v32, v17, v18
    v_cvt_pk_bf16_f32 v40, v13, v14
    v_cvt_pk_bf16_f32 v33, v23, v24
    v_cvt_pk_bf16_f32 v41, v19, v20
    ds_write_b128 v8, v[30:33] offset:45056
L_WIn:
    ds_read_b128 v[20:23], v252 offset:496
    s_waitcnt lgkmcnt(0)
    v_and_b32 v20, v20, v21
    v_and_b32 v22, v22, v23
    v_and_b32 v20, v20, v22
    s_nop 0
    v_readfirstlane_b32 s47, v20
    s_cmp_eq_u32 s47, 1
    s_cbranch_scc1 L_WIn_ok
    s_sleep 2
    s_branch L_WIn
L_WIn_ok:
    buffer_load_dwordx4 v[98:101], v1, s[4:7], 0 offen offset:128
    buffer_load_dwordx4 v[106:109], v2, s[4:7], 0 offen offset:512
    buffer_load_dwordx4 v[114:117], v2, s[4:7], 0 offen offset:1280
    buffer_load_dwordx4 v[122:125], v2, s[4:7], 0 offen offset:2048
    buffer_load_dwordx4 v[130:133], v2, s[4:7], 0 offen offset:2816
    buffer_load_dwordx4 v[102:105], v2, s[4:7], 0 offen offset:128
    buffer_load_dwordx4 v[110:113], v2, s[4:7], 0 offen offset:896
    buffer_load_dwordx4 v[118:121], v2, s[4:7], 0 offen offset:1664
    buffer_load_dwordx4 v[126:129], v2, s[4:7], 0 offen offset:2432
    buffer_load_dwordx4 v[134:137], v3, s[4:7], 0 offen offset:128
    v_lshlrev_b32 v13, 16, v78
    v_and_b32 v14, s51, v78
    v_lshlrev_b32 v15, 16, v82
    v_and_b32 v16, s51, v82
    v_lshlrev_b32 v19, 16, v79
    v_and_b32 v20, s51, v79
    v_lshlrev_b32 v21, 16, v83
    v_and_b32 v22, s51, v83
    v_add_f32 v17, v13, v15
    v_add_f32 v18, v14, v16
    v_sub_f32 v13, v15, v13
    v_sub_f32 v14, v16, v14
    v_add_f32 v23, v19, v21
    v_add_f32 v24, v20, v22
    v_sub_f32 v19, v21, v19
    v_sub_f32 v20, v22, v20
    v_cvt_pk_bf16_f32 v26, v17, v18
    v_cvt_pk_bf16_f32 v42, v13, v14
    v_cvt_pk_bf16_f32 v27, v23, v24
    v_cvt_pk_bf16_f32 v43, v19, v20
    v_lshlrev_b32 v13, 16, v80
    v_and_b32 v14, s51, v80
    v_lshlrev_b32 v15, 16, v84
    v_and_b32 v16, s51, v84
    v_lshlrev_b32 v19, 16, v81
    v_and_b32 v20, s51, v81
    v_lshlrev_b32 v21, 16, v85
    v_and_b32 v22, s51, v85
    v_add_f32 v17, v13, v15
    v_add_f32 v18, v14, v16
    v_sub_f32 v13, v15, v13
    v_sub_f32 v14, v16, v14
    v_add_f32 v23, v19, v21
    v_add_f32 v24, v20, v22
    v_sub_f32 v19, v21, v19
    v_sub_f32 v20, v22, v20
    v_cvt_pk_bf16_f32 v28, v17, v18
    v_cvt_pk_bf16_f32 v44, v13, v14
    v_cvt_pk_bf16_f32 v29, v23, v24
    v_cvt_pk_bf16_f32 v45, v19, v20
    ds_write_b128 v9, v[26:29] offset:45056
    v_lshlrev_b32 v13, 16, v86
    v_and_b32 v14, s51, v86
    v_lshlrev_b32 v15, 16, v90
    v_and_b32 v16, s51, v90
    v_lshlrev_b32 v19, 16, v87
    v_and_b32 v20, s51, v87
    v_lshlrev_b32 v21, 16, v91
    v_and_b32 v22, s51, v91
    v_add_f32 v17, v13, v15
    v_add_f32 v18, v14, v16
    v_sub_f32 v13, v15, v13
    v_sub_f32 v14, v16, v14
    v_add_f32 v23, v19, v21
    v_add_f32 v24, v20, v22
    v_sub_f32 v19, v21, v19
    v_sub_f32 v20, v22, v20
    v_cvt_pk_bf16_f32 v30, v17, v18
    v_cvt_pk_bf16_f32 v46, v13, v14
    v_cvt_pk_bf16_f32 v31, v23, v24
    v_cvt_pk_bf16_f32 v47, v19, v20
    v_lshlrev_b32 v13, 16, v88
    v_and_b32 v14, s51, v88
    v_lshlrev_b32 v15, 16, v92
    v_and_b32 v16, s51, v92
    v_lshlrev_b32 v19, 16, v89
    v_and_b32 v20, s51, v89
    v_lshlrev_b32 v21, 16, v93
    v_and_b32 v22, s51, v93
    v_add_f32 v17, v13, v15
    v_add_f32 v18, v14, v16
    v_sub_f32 v13, v15, v13
    v_sub_f32 v14, v16, v14
    v_add_f32 v23, v19, v21
    v_add_f32 v24, v20, v22
    v_sub_f32 v19, v21, v19
    v_sub_f32 v20, v22, v20
    v_cvt_pk_bf16_f32 v32, v17, v18
    v_cvt_pk_bf16_f32 v48, v13, v14
    v_cvt_pk_bf16_f32 v33, v23, v24
    v_cvt_pk_bf16_f32 v49, v19, v20
    ds_write_b128 v10, v[30:33] offset:45056
    s_cmp_eq_u32 s56, 0
    s_cbranch_scc1 L_PLn0_skip
    s_getreg_b32 s47, hwreg(HW_REG_HW_ID, 8, 1)
    s_cmp_eq_u32 s47, 0
    s_mov_b32 s57, 0x004080c0
    s_cselect_b32 s57, 0x0040c080, s57
    s_and_b32 s47, s57, 255
    s_load_dword s3, s[24:25], s47
L_PLn0_skip:
    s_cmp_eq_u32 s56, 0
    s_cbranch_scc1 L_PLn1_skip
    s_waitcnt lgkmcnt(0)
    s_mov_b32 s58, 1
    v_mov_b32 v255, 0
L_PLn1:
    s_cmp_ge_u32 s3, 56
    s_cbranch_scc1 L_PLn1_ok
    s_sleep 4
    s_cmp_ge_u32 s58, 4
    s_cbranch_scc1 L_PLn1_v
    s_lshr_b32 s57, s57, 8
    s_and_b32 s47, s57, 255
    s_load_dword s3, s[24:25], s47
    s_add_u32 s58, s58, 1
    s_waitcnt lgkmcnt(0)
    s_branch L_PLn1
L_PLn1_v:
    global_load_dword v254, v255, s[24:25] offset:128 sc1
    s_add_u32 s58, s58, 1
    s_waitcnt vmcnt(0)
    v_readfirstlane_b32 s3, v254
    s_cmp_lt_u32 s58, 20000
    s_cbranch_scc1 L_PLn1
L_PLn1_ok:
    ds_write_b32 v250, v251
    s_mov_b32 s56, 0
    s_cmp_eq_u32 s55, 3
    s_cbranch_scc0 L_UPn2_1
    s_mov_b32 s48, 0
    buffer_load_dword v254, v253, s[16:19], s48 offen sc1
L_UPn2_1:
L_PLn1_skip:
    s_mov_b64 exec, 1
    ds_add_u32 v252, v251 offset:456
    s_mov_b64 exec, -1
L_FRn3:
    ds_read_b128 v[16:19], v252 offset:256
    s_waitcnt lgkmcnt(0)
    v_and_b32 v16, v16, v17
    v_and_b32 v18, v18, v19
    v_and_b32 v16, v16, v18
    s_nop 0
    v_readfirstlane_b32 s47, v16
    s_cmp_eq_u32 s47, 1
    s_cbranch_scc1 L_FRn3_ok
    s_sleep 2
    s_branch L_FRn3
L_FRn3_ok:
    s_cmp_eq_u32 s55, 3
    s_cbranch_scc0 L_UPn3
    s_mov_b32 s48, 221184
    buffer_load_dword v254, v253, s[16:19], s48 offen sc1
L_UPn3:
    ds_write_b128 v7, v[34:37] offset:0
    ds_write_b128 v8, v[38:41] offset:0
    ds_write_b128 v9, v[42:45] offset:0
    ds_write_b128 v10, v[46:49] offset:0
    s_mov_b64 exec, 1
    ds_add_u32 v252, v251 offset:460
    s_mov_b64 exec, -1
    s_waitcnt vmcnt(0)
    v_lshlrev_b32 v13, 16, v102
    v_and_b32 v14, s51, v102
    v_lshlrev_b32 v15, 16, v106
    v_and_b32 v16, s51, v106
    v_lshlrev_b32 v19, 16, v103
    v_and_b32 v20, s51, v103
    v_lshlrev_b32 v21, 16, v107
    v_and_b32 v22, s51, v107
    v_add_f32 v17, v13, v15
    v_add_f32 v18, v14, v16
    v_sub_f32 v13, v15, v13
    v_sub_f32 v14, v16, v14
    v_add_f32 v23, v19, v21
    v_add_f32 v24, v20, v22
    v_sub_f32 v19, v21, v19
    v_sub_f32 v20, v22, v20
    v_cvt_pk_bf16_f32 v26, v17, v18
    v_cvt_pk_bf16_f32 v34, v13, v14
    v_cvt_pk_bf16_f32 v27, v23, v24
    v_cvt_pk_bf16_f32 v35, v19, v20
    v_lshlrev_b32 v13, 16, v104
    v_and_b32 v14, s51, v104
    v_lshlrev_b32 v15, 16, v108
    v_and_b32 v16, s51, v108
    v_lshlrev_b32 v19, 16, v105
    v_and_b32 v20, s51, v105
    v_lshlrev_b32 v21, 16, v109
    v_and_b32 v22, s51, v109
    v_add_f32 v17, v13, v15
    v_add_f32 v18, v14, v16
    v_sub_f32 v13, v15, v13
    v_sub_f32 v14, v16, v14
    v_add_f32 v23, v19, v21
    v_add_f32 v24, v20, v22
    v_sub_f32 v19, v21, v19
    v_sub_f32 v20, v22, v20
    v_cvt_pk_bf16_f32 v28, v17, v18
    v_cvt_pk_bf16_f32 v36, v13, v14
    v_cvt_pk_bf16_f32 v29, v23, v24
    v_cvt_pk_bf16_f32 v37, v19, v20
L_FRn4:
    ds_read_b128 v[16:19], v252 offset:272
    s_waitcnt lgkmcnt(0)
    v_and_b32 v16, v16, v17
    v_and_b32 v18, v18, v19
    v_and_b32 v16, v16, v18
    s_nop 0
    v_readfirstlane_b32 s47, v16
    s_cmp_eq_u32 s47, 1
    s_cbranch_scc1 L_FRn4_ok
    s_sleep 2
    s_branch L_FRn4
L_FRn4_ok:
    s_cmp_eq_u32 s55, 3
    s_cbranch_scc0 L_UPn4
    s_mov_b32 s48, 73728
    buffer_load_dword v254, v253, s[16:19], s48 offen sc1
L_UPn4:
    ds_write_b128 v7, v[26:29] offset:22528
    v_lshlrev_b32 v13, 16, v110
    v_and_b32 v14, s51, v110
    v_lshlrev_b32 v15, 16, v114
    v_and_b32 v16, s51, v114
    v_lshlrev_b32 v19, 16, v111
    v_and_b32 v20, s51, v111
    v_lshlrev_b32 v21, 16, v115
    v_and_b32 v22, s51, v115
    v_add_f32 v17, v13, v15
    v_add_f32 v18, v14, v16
    v_sub_f32 v13, v15, v13
    v_sub_f32 v14, v16, v14
    v_add_f32 v23, v19, v21
    v_add_f32 v24, v20, v22
    v_sub_f32 v19, v21, v19
    v_sub_f32 v20, v22, v20
    v_cvt_pk_bf16_f32 v30, v17, v18
    v_cvt_pk_bf16_f32 v38, v13, v14
    v_cvt_pk_bf16_f32 v31, v23, v24
    v_cvt_pk_bf16_f32 v39, v19, v20
    v_lshlrev_b32 v13, 16, v112
    v_and_b32 v14, s51, v112
    v_lshlrev_b32 v15, 16, v116
    v_and_b32 v16, s51, v116
    buffer_load_dwordx4 v[138:141], v1, s[4:7], 0 offen offset:256
    v_lshlrev_b32 v19, 16, v113
    v_and_b32 v20, s51, v113
    v_lshlrev_b32 v21, 16, v117
    v_and_b32 v22, s51, v117
    v_add_f32 v17, v13, v15
    v_add_f32 v18, v14, v16
    v_sub_f32 v13, v15, v13
    v_sub_f32 v14, v16, v14
    v_add_f32 v23, v19, v21
    v_add_f32 v24, v20, v22
    v_sub_f32 v19, v21, v19
    v_sub_f32 v20, v22, v20
    v_cvt_pk_bf16_f32 v32, v17, v18
    v_cvt_pk_bf16_f32 v40, v13, v14
    v_cvt_pk_bf16_f32 v33, v23, v24
    v_cvt_pk_bf16_f32 v41, v19, v20
    ds_write_b128 v8, v[30:33] offset:22528
    v_lshlrev_b32 v13, 16, v118
    v_and_b32 v14, s51, v118
    v_lshlrev_b32 v15, 16, v122
    v_and_b32 v16, s51, v122
    v_lshlrev_b32 v19, 16, v119
    v_and_b32 v20, s51, v119
    v_lshlrev_b32 v21, 16, v123
    v_and_b32 v22, s51, v123
    buffer_load_dwordx4 v[146:149], v2, s[4:7], 0 offen offset:640
    v_add_f32 v17, v13, v15
    v_add_f32 v18, v14, v16
    v_sub_f32 v13, v15, v13
    v_sub_f32 v14, v16, v14
    v_add_f32 v23, v19, v21
    v_add_f32 v24, v20, v22
    v_sub_f32 v19, v21, v19
    v_sub_f32 v20, v22, v20
    v_cvt_pk_bf16_f32 v26, v17, v18
    v_cvt_pk_bf16_f32 v42, v13, v14
    v_cvt_pk_bf16_f32 v27, v23, v24
    v_cvt_pk_bf16_f32 v43, v19, v20
    v_lshlrev_b32 v13, 16, v120
    v_and_b32 v14, s51, v120
    v_lshlrev_b32 v15, 16, v124
    v_and_b32 v16, s51, v124
    v_lshlrev_b32 v19, 16, v121
    v_and_b32 v20, s51, v121
    v_lshlrev_b32 v21, 16, v125
    v_and_b32 v22, s51, v125
    v_add_f32 v17, v13, v15
    v_add_f32 v18, v14, v16
    v_sub_f32 v13, v15, v13
    v_sub_f32 v14, v16, v14
    buffer_load_dwordx4 v[154:157], v2, s[4:7], 0 offen offset:1408
    v_add_f32 v23, v19, v21
    v_add_f32 v24, v20, v22
    v_sub_f32 v19, v21, v19
    v_sub_f32 v20, v22, v20
    v_cvt_pk_bf16_f32 v28, v17, v18
    v_cvt_pk_bf16_f32 v44, v13, v14
    v_cvt_pk_bf16_f32 v29, v23, v24
    v_cvt_pk_bf16_f32 v45, v19, v20
    ds_write_b128 v9, v[26:29] offset:22528
    v_lshlrev_b32 v13, 16, v126
    v_and_b32 v14, s51, v126
    v_lshlrev_b32 v15, 16, v130
    v_and_b32 v16, s51, v130
    v_lshlrev_b32 v19, 16, v127
    v_and_b32 v20, s51, v127
    v_lshlrev_b32 v21, 16, v131
    v_and_b32 v22, s51, v131
    v_add_f32 v17, v13, v15
    v_add_f32 v18, v14, v16
    v_sub_f32 v13, v15, v13
    v_sub_f32 v14, v16, v14
    v_add_f32 v23, v19, v21
    v_add_f32 v24, v20, v22
    v_sub_f32 v19, v21, v19
    v_sub_f32 v20, v22, v20
    buffer_load_dwordx4 v[162:165], v2, s[4:7], 0 offen offset:2176
    v_cvt_pk_bf16_f32 v30, v17, v18
    v_cvt_pk_bf16_f32 v46, v13, v14
    v_cvt_pk_bf16_f32 v31, v23, v24
    v_cvt_pk_bf16_f32 v47, v19, v20
    v_lshlrev_b32 v13, 16, v128
    v_and_b32 v14, s51, v128
    v_lshlrev_b32 v15, 16, v132
    v_and_b32 v16, s51, v132
    v_lshlrev_b32 v19, 16, v129
    v_and_b32 v20, s51, v129
    v_lshlrev_b32 v21, 16, v133
    v_and_b32 v22, s51, v133
    v_add_f32 v17, v13, v15
    v_add_f32 v18, v14, v16
    v_sub_f32 v13, v15, v13
    v_sub_f32 v14, v16, v14
    v_add_f32 v23, v19, v21
    v_add_f32 v24, v20, v22
    v_sub_f32 v19, v21, v19
    v_sub_f32 v20, v22, v20
    v_cvt_pk_bf16_f32 v32, v17, v18
    v_cvt_pk_bf16_f32 v48, v13, v14
    v_cvt_pk_bf16_f32 v33, v23, v24
    v_cvt_pk_bf16_f32 v49, v19, v20
    buffer_load_dwordx4 v[170:173], v2, s[4:7], 0 offen offset:2944
    ds_write_b128 v10, v[30:33] offset:22528
    s_mov_b64 exec, 1
    ds_add_u32 v252, v251 offset:464
    s_mov_b64 exec, -1
L_FRn5:
    ds_read_b128 v[16:19], v252 offset:288
    s_waitcnt lgkmcnt(0)
    v_and_b32 v16, v16, v17
    v_and_b32 v18, v18, v19
    v_and_b32 v16, v16, v18
    s_nop 0
    v_readfirstlane_b32 s47, v16
    s_cmp_eq_u32 s47, 1
    s_cbranch_scc1 L_FRn5_ok
    s_sleep 2
    s_branch L_FRn5
L_FRn5_ok:
    s_cmp_eq_u32 s55, 3
    s_cbranch_scc0 L_UPn5
    s_mov_b32 s48, 294912
    buffer_load_dword v254, v253, s[16:19], s48 offen sc1
L_UPn5:
    ds_write_b128 v7, v[34:37] offset:45056
    ds_write_b128 v8, v[38:41] offset:45056
    ds_write_b128 v9, v[42:45] offset:45056
    ds_write_b128 v10, v[46:49] offset:45056
    s_mov_b64 exec, 1
    ds_add_u32 v252, v251 offset:468
    s_mov_b64 exec, -1
    buffer_load_dwordx4 v[142:145], v2, s[4:7], 0 offen offset:256
    buffer_load_dwordx4 v[150:153], v2, s[4:7], 0 offen offset:1024
    buffer_load_dwordx4 v[158:161], v2, s[4:7], 0 offen offset:1792
    buffer_load_dwordx4 v[166:169], v2, s[4:7], 0 offen offset:2560
    buffer_load_dwordx4 v[174:177], v3, s[4:7], 0 offen offset:256
    s_waitcnt vmcnt(0)
    v_lshlrev_b32 v13, 16, v142
    v_and_b32 v14, s51, v142
    v_lshlrev_b32 v15, 16, v146
    v_and_b32 v16, s51, v146
    v_lshlrev_b32 v19, 16, v143
    v_and_b32 v20, s51, v143
    v_lshlrev_b32 v21, 16, v147
    v_and_b32 v22, s51, v147
    v_add_f32 v17, v13, v15
    v_add_f32 v18, v14, v16
    v_sub_f32 v13, v15, v13
    v_sub_f32 v14, v16, v14
    v_add_f32 v23, v19, v21
    v_add_f32 v24, v20, v22
    v_sub_f32 v19, v21, v19
    v_sub_f32 v20, v22, v20
    v_cvt_pk_bf16_f32 v26, v17, v18
    v_cvt_pk_bf16_f32 v34, v13, v14
    v_cvt_pk_bf16_f32 v27, v23, v24
    v_cvt_pk_bf16_f32 v35, v19, v20
    v_lshlrev_b32 v13, 16, v144
    v_and_b32 v14, s51, v144
    v_lshlrev_b32 v15, 16, v148
    v_and_b32 v16, s51, v148
    v_lshlrev_b32 v19, 16, v145
    v_and_b32 v20, s51, v145
    v_lshlrev_b32 v21, 16, v149
    v_and_b32 v22, s51, v149
    v_add_f32 v17, v13, v15
    v_add_f32 v18, v14, v16
    v_sub_f32 v13, v15, v13
    v_sub_f32 v14, v16, v14
    v_add_f32 v23, v19, v21
    v_add_f32 v24, v20, v22
    v_sub_f32 v19, v21, v19
    v_sub_f32 v20, v22, v20
    v_cvt_pk_bf16_f32 v28, v17, v18
    v_cvt_pk_bf16_f32 v36, v13, v14
    v_cvt_pk_bf16_f32 v29, v23, v24
    v_cvt_pk_bf16_f32 v37, v19, v20
L_FRn6:
    ds_read_b128 v[16:19], v252 offset:304
    s_waitcnt lgkmcnt(0)
    v_and_b32 v16, v16, v17
    v_and_b32 v18, v18, v19
    v_and_b32 v16, v16, v18
    s_nop 0
    v_readfirstlane_b32 s47, v16
    s_cmp_eq_u32 s47, 1
    s_cbranch_scc1 L_FRn6_ok
    s_sleep 2
    s_branch L_FRn6
L_FRn6_ok:
    s_cmp_eq_u32 s55, 3
    s_cbranch_scc0 L_UPn6
    s_mov_b32 s48, 147456
    buffer_load_dword v254, v253, s[16:19], s48 offen sc1
L_UPn6:
    ds_write_b128 v7, v[26:29] offset:0
    v_lshlrev_b32 v13, 16, v150
    v_and_b32 v14, s51, v150
    v_lshlrev_b32 v15, 16, v154
    v_and_b32 v16, s51, v154
    v_lshlrev_b32 v19, 16, v151
    v_and_b32 v20, s51, v151
    v_lshlrev_b32 v21, 16, v155
    v_and_b32 v22, s51, v155
    v_add_f32 v17, v13, v15
    v_add_f32 v18, v14, v16
    v_sub_f32 v13, v15, v13
    v_sub_f32 v14, v16, v14
    v_add_f32 v23, v19, v21
    v_add_f32 v24, v20, v22
    v_sub_f32 v19, v21, v19
    v_sub_f32 v20, v22, v20
    v_cvt_pk_bf16_f32 v30, v17, v18
    v_cvt_pk_bf16_f32 v38, v13, v14
    v_cvt_pk_bf16_f32 v31, v23, v24
    v_cvt_pk_bf16_f32 v39, v19, v20
    v_lshlrev_b32 v13, 16, v152
    v_and_b32 v14, s51, v152
    v_lshlrev_b32 v15, 16, v156
    v_and_b32 v16, s51, v156
    v_lshlrev_b32 v19, 16, v153
    v_and_b32 v20, s51, v153
    v_lshlrev_b32 v21, 16, v157
    v_and_b32 v22, s51, v157
    v_add_f32 v17, v13, v15
    v_add_f32 v18, v14, v16
    v_sub_f32 v13, v15, v13
    v_sub_f32 v14, v16, v14
    v_add_f32 v23, v19, v21
    v_add_f32 v24, v20, v22
    v_sub_f32 v19, v21, v19
    v_sub_f32 v20, v22, v20
    v_cvt_pk_bf16_f32 v32, v17, v18
    v_cvt_pk_bf16_f32 v40, v13, v14
    v_cvt_pk_bf16_f32 v33, v23, v24
    v_cvt_pk_bf16_f32 v41, v19, v20
    ds_write_b128 v8, v[30:33] offset:0
    v_lshlrev_b32 v13, 16, v158
    v_and_b32 v14, s51, v158
    v_lshlrev_b32 v15, 16, v162
    v_and_b32 v16, s51, v162
    v_lshlrev_b32 v19, 16, v159
    v_and_b32 v20, s51, v159
    v_lshlrev_b32 v21, 16, v163
    v_and_b32 v22, s51, v163
    v_add_f32 v17, v13, v15
    v_add_f32 v18, v14, v16
    v_sub_f32 v13, v15, v13
    v_sub_f32 v14, v16, v14
    v_add_f32 v23, v19, v21
    v_add_f32 v24, v20, v22
    v_sub_f32 v19, v21, v19
    v_sub_f32 v20, v22, v20
    v_cvt_pk_bf16_f32 v26, v17, v18
    v_cvt_pk_bf16_f32 v42, v13, v14
    v_cvt_pk_bf16_f32 v27, v23, v24
    v_cvt_pk_bf16_f32 v43, v19, v20
    v_lshlrev_b32 v13, 16, v160
    v_and_b32 v14, s51, v160
    v_lshlrev_b32 v15, 16, v164
    v_and_b32 v16, s51, v164
    v_lshlrev_b32 v19, 16, v161
    v_and_b32 v20, s51, v161
    v_lshlrev_b32 v21, 16, v165
    v_and_b32 v22, s51, v165
    v_add_f32 v17, v13, v15
    v_add_f32 v18, v14, v16
    v_sub_f32 v13, v15, v13
    v_sub_f32 v14, v16, v14
    v_add_f32 v23, v19, v21
    v_add_f32 v24, v20, v22
    v_sub_f32 v19, v21, v19
    v_sub_f32 v20, v22, v20
    v_cvt_pk_bf16_f32 v28, v17, v18
    v_cvt_pk_bf16_f32 v44, v13, v14
    v_cvt_pk_bf16_f32 v29, v23, v24
    v_cvt_pk_bf16_f32 v45, v19, v20
    ds_write_b128 v9, v[26:29] offset:0
    v_lshlrev_b32 v13, 16, v166
    v_and_b32 v14, s51, v166
    v_lshlrev_b32 v15, 16, v170
    v_and_b32 v16, s51, v170
    v_lshlrev_b32 v19, 16, v167
    v_and_b32 v20, s51, v167
    v_lshlrev_b32 v21, 16, v171
    v_and_b32 v22, s51, v171
    v_add_f32 v17, v13, v15
    v_add_f32 v18, v14, v16
    v_sub_f32 v13, v15, v13
    v_sub_f32 v14, v16, v14
    v_add_f32 v23, v19, v21
    v_add_f32 v24, v20, v22
    v_sub_f32 v19, v21, v19
    v_sub_f32 v20, v22, v20
    v_cvt_pk_bf16_f32 v30, v17, v18
    v_cvt_pk_bf16_f32 v46, v13, v14
    v_cvt_pk_bf16_f32 v31, v23, v24
    v_cvt_pk_bf16_f32 v47, v19, v20
    v_lshlrev_b32 v13, 16, v168
    v_and_b32 v14, s51, v168
    v_lshlrev_b32 v15, 16, v172
    v_and_b32 v16, s51, v172
    v_lshlrev_b32 v19, 16, v169
    v_and_b32 v20, s51, v169
    v_lshlrev_b32 v21, 16, v173
    v_and_b32 v22, s51, v173
    v_add_f32 v17, v13, v15
    v_add_f32 v18, v14, v16
    v_sub_f32 v13, v15, v13
    v_sub_f32 v14, v16, v14
    v_add_f32 v23, v19, v21
    v_add_f32 v24, v20, v22
    v_sub_f32 v19, v21, v19
    v_sub_f32 v20, v22, v20
    v_cvt_pk_bf16_f32 v32, v17, v18
    v_cvt_pk_bf16_f32 v48, v13, v14
    v_cvt_pk_bf16_f32 v33, v23, v24
    v_cvt_pk_bf16_f32 v49, v19, v20
    ds_write_b128 v10, v[30:33] offset:0
    s_mov_b64 exec, 1
    ds_add_u32 v252, v251 offset:472
    s_mov_b64 exec, -1
L_FRn7:
    ds_read_b128 v[16:19], v252 offset:320
    s_waitcnt lgkmcnt(0)
    v_and_b32 v16, v16, v17
    v_and_b32 v18, v18, v19
    v_and_b32 v16, v16, v18
    s_nop 0
    v_readfirstlane_b32 s47, v16
    s_cmp_eq_u32 s47, 1
    s_cbranch_scc1 L_FRn7_ok
    s_sleep 2
    s_branch L_FRn7
L_FRn7_ok:
    s_cmp_eq_u32 s55, 3
    s_cbranch_scc0 L_UPn7
    s_mov_b32 s48, 368640
    buffer_load_dword v254, v253, s[16:19], s48 offen sc1
L_UPn7:
    ds_write_b128 v7, v[34:37] offset:22528
    ds_write_b128 v8, v[38:41] offset:22528
    ds_write_b128 v9, v[42:45] offset:22528
    ds_write_b128 v10, v[46:49] offset:22528
    s_mov_b64 exec, 1
    ds_add_u32 v252, v251 offset:476
    s_mov_b64 exec, -1
    v_lshlrev_b32 v13, 16, v98
    v_and_b32 v14, s51, v98
    v_lshlrev_b32 v15, 16, v99
    v_and_b32 v16, s51, v99
    v_lshlrev_b32 v17, 16, v100
    v_and_b32 v18, s51, v100
    v_lshlrev_b32 v19, 16, v101
    v_and_b32 v20, s51, v101
    v_lshlrev_b32 v21, 16, v106
    v_and_b32 v22, s51, v106
    v_lshlrev_b32 v23, 16, v107
    v_and_b32 v24, s51, v107
    v_lshlrev_b32 v25, 16, v108
    v_and_b32 v54, s51, v108
    v_lshlrev_b32 v55, 16, v109
    v_and_b32 v56, s51, v109
    v_sub_f32 v13, v13, v21
    v_sub_f32 v14, v14, v22
    v_sub_f32 v15, v15, v23
    v_sub_f32 v16, v16, v24
    v_sub_f32 v17, v17, v25
    v_sub_f32 v18, v18, v54
    v_sub_f32 v19, v19, v55
    v_sub_f32 v20, v20, v56
    v_cvt_pk_bf16_f32 v26, v13, v14
    v_cvt_pk_bf16_f32 v27, v15, v16
    v_cvt_pk_bf16_f32 v28, v17, v18
    v_cvt_pk_bf16_f32 v29, v19, v20
L_FRn8:
    ds_read_b128 v[44:47], v252 offset:336
    s_waitcnt lgkmcnt(0)
    v_and_b32 v44, v44, v45
    v_and_b32 v46, v46, v47
    v_and_b32 v44, v44, v46
    s_nop 0
    v_readfirstlane_b32 s47, v44
    s_cmp_eq_u32 s47, 1
    s_cbranch_scc1 L_FRn8_ok
    s_sleep 2
    s_branch L_FRn8
L_FRn8_ok:
    s_cmp_eq_u32 s55, 3
    s_cbranch_scc0 L_UPn8
    s_mov_b32 s48, 516096
    buffer_load_dword v254, v253, s[16:19], s48 offen sc1
L_UPn8:
    ds_write_b128 v7, v[26:29] offset:45056
    v_lshlrev_b32 v13, 16, v114
    v_and_b32 v14, s51, v114
    v_lshlrev_b32 v15, 16, v115
    v_and_b32 v16, s51, v115
    v_lshlrev_b32 v17, 16, v116
    v_and_b32 v18, s51, v116
    v_lshlrev_b32 v19, 16, v117
    v_and_b32 v20, s51, v117
    v_sub_f32 v21, v21, v13
    v_sub_f32 v22, v22, v14
    v_sub_f32 v23, v23, v15
    v_sub_f32 v24, v24, v16
    v_sub_f32 v25, v25, v17
    v_sub_f32 v54, v54, v18
    v_sub_f32 v55, v55, v19
    v_sub_f32 v56, v56, v20
    v_cvt_pk_bf16_f32 v30, v21, v22
    v_cvt_pk_bf16_f32 v31, v23, v24
    v_cvt_pk_bf16_f32 v32, v25, v54
    v_cvt_pk_bf16_f32 v33, v55, v56
    ds_write_b128 v8, v[30:33] offset:45056
    v_lshlrev_b32 v21, 16, v122
    v_and_b32 v22, s51, v122
    v_lshlrev_b32 v23, 16, v123
    v_and_b32 v24, s51, v123
    v_lshlrev_b32 v25, 16, v124
    v_and_b32 v54, s51, v124
    v_lshlrev_b32 v55, 16, v125
    v_and_b32 v56, s51, v125
    v_sub_f32 v13, v13, v21
    v_sub_f32 v14, v14, v22
    v_sub_f32 v15, v15, v23
    v_sub_f32 v16, v16, v24
    v_sub_f32 v17, v17, v25
    v_sub_f32 v18, v18, v54
    v_sub_f32 v19, v19, v55
    v_sub_f32 v20, v20, v56
    v_cvt_pk_bf16_f32 v26, v13, v14
    v_cvt_pk_bf16_f32 v27, v15, v16
    v_cvt_pk_bf16_f32 v28, v17, v18
    v_cvt_pk_bf16_f32 v29, v19, v20
    ds_write_b128 v9, v[26:29] offset:45056
    v_lshlrev_b32 v13, 16, v130
    v_and_b32 v14, s51, v130
    v_lshlrev_b32 v15, 16, v131
    v_and_b32 v16, s51, v131
    v_lshlrev_b32 v17, 16, v132
    v_and_b32 v18, s51, v132
    v_lshlrev_b32 v19, 16, v133
    v_and_b32 v20, s51, v133
    v_sub_f32 v21, v21, v13
    v_sub_f32 v22, v22, v14
    v_sub_f32 v23, v23, v15
    v_sub_f32 v24, v24, v16
    v_sub_f32 v25, v25, v17
    v_sub_f32 v54, v54, v18
    v_sub_f32 v55, v55, v19
    v_sub_f32 v56, v56, v20
    v_cvt_pk_bf16_f32 v30, v21, v22
    v_cvt_pk_bf16_f32 v31, v23, v24
    v_cvt_pk_bf16_f32 v32, v25, v54
    v_cvt_pk_bf16_f32 v33, v55, v56
    ds_write_b128 v10, v[30:33] offset:45056
    s_mov_b64 exec, 1
    ds_add_u32 v252, v251 offset:480
    s_mov_b64 exec, -1
    v_lshlrev_b32 v13, 16, v138
    v_and_b32 v14, s51, v138
    v_lshlrev_b32 v15, 16, v139
    v_and_b32 v16, s51, v139
    v_lshlrev_b32 v17, 16, v140
    v_and_b32 v18, s51, v140
    v_lshlrev_b32 v19, 16, v141
    v_and_b32 v20, s51, v141
    v_lshlrev_b32 v21, 16, v146
    v_and_b32 v22, s51, v146
    v_lshlrev_b32 v23, 16, v147
    v_and_b32 v24, s51, v147
    v_lshlrev_b32 v25, 16, v148
    v_and_b32 v54, s51, v148
    v_lshlrev_b32 v55, 16, v149
    v_and_b32 v56, s51, v149
    v_sub_f32 v13, v13, v21
    v_sub_f32 v14, v14, v22
    v_sub_f32 v15, v15, v23
    v_sub_f32 v16, v16, v24
    v_sub_f32 v17, v17, v25
    v_sub_f32 v18, v18, v54
    v_sub_f32 v19, v19, v55
    v_sub_f32 v20, v20, v56
    v_cvt_pk_bf16_f32 v26, v13, v14
    v_cvt_pk_bf16_f32 v27, v15, v16
    v_cvt_pk_bf16_f32 v28, v17, v18
    v_cvt_pk_bf16_f32 v29, v19, v20
L_FRn9:
    ds_read_b128 v[44:47], v252 offset:352
    s_waitcnt lgkmcnt(0)
    v_and_b32 v44, v44, v45
    v_and_b32 v46, v46, v47
    v_and_b32 v44, v44, v46
    s_nop 0
    v_readfirstlane_b32 s47, v44
    s_cmp_eq_u32 s47, 1
    s_cbranch_scc1 L_FRn9_ok
    s_sleep 2
    s_branch L_FRn9
L_FRn9_ok:
    s_cmp_eq_u32 s55, 3
    s_cbranch_scc0 L_UPn9
    s_mov_b32 s48, 589824
    buffer_load_dword v254, v253, s[16:19], s48 offen sc1
L_UPn9:
    ds_write_b128 v7, v[26:29] offset:0
    v_lshlrev_b32 v13, 16, v154
    v_and_b32 v14, s51, v154
    v_lshlrev_b32 v15, 16, v155
    v_and_b32 v16, s51, v155
    v_lshlrev_b32 v17, 16, v156
    v_and_b32 v18, s51, v156
    v_lshlrev_b32 v19, 16, v157
    v_and_b32 v20, s51, v157
    v_sub_f32 v21, v21, v13
    v_sub_f32 v22, v22, v14
    v_sub_f32 v23, v23, v15
    v_sub_f32 v24, v24, v16
    v_sub_f32 v25, v25, v17
    v_sub_f32 v54, v54, v18
    v_sub_f32 v55, v55, v19
    v_sub_f32 v56, v56, v20
    v_cvt_pk_bf16_f32 v30, v21, v22
    v_cvt_pk_bf16_f32 v31, v23, v24
    v_cvt_pk_bf16_f32 v32, v25, v54
    v_cvt_pk_bf16_f32 v33, v55, v56
    ds_write_b128 v8, v[30:33] offset:0
    v_lshlrev_b32 v21, 16, v162
    v_and_b32 v22, s51, v162
    v_lshlrev_b32 v23, 16, v163
    v_and_b32 v24, s51, v163
    v_lshlrev_b32 v25, 16, v164
    v_and_b32 v54, s51, v164
    v_lshlrev_b32 v55, 16, v165
    v_and_b32 v56, s51, v165
    v_sub_f32 v13, v13, v21
    v_sub_f32 v14, v14, v22
    v_sub_f32 v15, v15, v23
    v_sub_f32 v16, v16, v24
    v_sub_f32 v17, v17, v25
    v_sub_f32 v18, v18, v54
    v_sub_f32 v19, v19, v55
    v_sub_f32 v20, v20, v56
    v_cvt_pk_bf16_f32 v26, v13, v14
    v_cvt_pk_bf16_f32 v27, v15, v16
    v_cvt_pk_bf16_f32 v28, v17, v18
    v_cvt_pk_bf16_f32 v29, v19, v20
    ds_write_b128 v9, v[26:29] offset:0
    v_lshlrev_b32 v13, 16, v170
    v_and_b32 v14, s51, v170
    v_lshlrev_b32 v15, 16, v171
    v_and_b32 v16, s51, v171
    v_lshlrev_b32 v17, 16, v172
    v_and_b32 v18, s51, v172
    v_lshlrev_b32 v19, 16, v173
    v_and_b32 v20, s51, v173
    v_sub_f32 v21, v21, v13
    v_sub_f32 v22, v22, v14
    v_sub_f32 v23, v23, v15
    v_sub_f32 v24, v24, v16
    v_sub_f32 v25, v25, v17
    v_sub_f32 v54, v54, v18
    v_sub_f32 v55, v55, v19
    v_sub_f32 v56, v56, v20
    v_cvt_pk_bf16_f32 v30, v21, v22
    v_cvt_pk_bf16_f32 v31, v23, v24
    v_cvt_pk_bf16_f32 v32, v25, v54
    v_cvt_pk_bf16_f32 v33, v55, v56
    ds_write_b128 v10, v[30:33] offset:0
    s_mov_b64 exec, 1
    ds_add_u32 v252, v251 offset:484
    s_mov_b64 exec, -1
    v_lshlrev_b32 v13, 16, v102
    v_and_b32 v14, s51, v102
    v_lshlrev_b32 v15, 16, v103
    v_and_b32 v16, s51, v103
    v_lshlrev_b32 v17, 16, v104
    v_and_b32 v18, s51, v104
    v_lshlrev_b32 v19, 16, v105
    v_and_b32 v20, s51, v105
    v_lshlrev_b32 v21, 16, v110
    v_and_b32 v22, s51, v110
    v_lshlrev_b32 v23, 16, v111
    v_and_b32 v24, s51, v111
    v_lshlrev_b32 v25, 16, v112
    v_and_b32 v54, s51, v112
    v_lshlrev_b32 v55, 16, v113
    v_and_b32 v56, s51, v113
    v_subrev_f32 v13, v13, v21
    v_subrev_f32 v14, v14, v22
    v_subrev_f32 v15, v15, v23
    v_subrev_f32 v16, v16, v24
    v_subrev_f32 v17, v17, v25
    v_subrev_f32 v18, v18, v54
    v_subrev_f32 v19, v19, v55
    v_subrev_f32 v20, v20, v56
    v_cvt_pk_bf16_f32 v26, v13, v14
    v_cvt_pk_bf16_f32 v27, v15, v16
    v_cvt_pk_bf16_f32 v28, v17, v18
    v_cvt_pk_bf16_f32 v29, v19, v20
L_FRn10:
    ds_read_b128 v[44:47], v252 offset:368
    s_waitcnt lgkmcnt(0)
    v_and_b32 v44, v44, v45
    v_and_b32 v46, v46, v47
    v_and_b32 v44, v44, v46
    s_nop 0
    v_readfirstlane_b32 s47, v44
    s_cmp_eq_u32 s47, 1
    s_cbranch_scc1 L_FRn10_ok
    s_sleep 2
    s_branch L_FRn10
L_FRn10_ok:
    s_cmp_eq_u32 s55, 3
    s_cbranch_scc0 L_UPn10
    s_mov_b32 s48, 737280
    buffer_load_dword v254, v253, s[16:19], s48 offen sc1
L_UPn10:
    ds_write_b128 v7, v[26:29] offset:22528
    v_lshlrev_b32 v13, 16, v118
    v_and_b32 v14, s51, v118
    v_lshlrev_b32 v15, 16, v119
    v_and_b32 v16, s51, v119
    v_lshlrev_b32 v17, 16, v120
    v_and_b32 v18, s51, v120
    v_lshlrev_b32 v19, 16, v121
    v_and_b32 v20, s51, v121
    v_subrev_f32 v21, v21, v13
    v_subrev_f32 v22, v22, v14
    v_subrev_f32 v23, v23, v15
    v_subrev_f32 v24, v24, v16
    v_subrev_f32 v25, v25, v17
    v_subrev_f32 v54, v54, v18
    v_subrev_f32 v55, v55, v19
    v_subrev_f32 v56, v56, v20
    v_cvt_pk_bf16_f32 v30, v21, v22
    v_cvt_pk_bf16_f32 v31, v23, v24
    v_cvt_pk_bf16_f32 v32, v25, v54
    v_cvt_pk_bf16_f32 v33, v55, v56
    ds_write_b128 v8, v[30:33] offset:22528
    v_lshlrev_b32 v21, 16, v126
    v_and_b32 v22, s51, v126
    v_lshlrev_b32 v23, 16, v127
    v_and_b32 v24, s51, v127
    v_lshlrev_b32 v25, 16, v128
    v_and_b32 v54, s51, v128
    v_lshlrev_b32 v55, 16, v129
    v_and_b32 v56, s51, v129
    v_subrev_f32 v13, v13, v21
    v_subrev_f32 v14, v14, v22
    v_subrev_f32 v15, v15, v23
    v_subrev_f32 v16, v16, v24
    v_subrev_f32 v17, v17, v25
    v_subrev_f32 v18, v18, v54
    v_subrev_f32 v19, v19, v55
    v_subrev_f32 v20, v20, v56
    v_cvt_pk_bf16_f32 v26, v13, v14
    v_cvt_pk_bf16_f32 v27, v15, v16
    v_cvt_pk_bf16_f32 v28, v17, v18
    v_cvt_pk_bf16_f32 v29, v19, v20
    ds_write_b128 v9, v[26:29] offset:22528
    v_lshlrev_b32 v13, 16, v134
    v_and_b32 v14, s51, v134
    v_lshlrev_b32 v15, 16, v135
    v_and_b32 v16, s51, v135
    v_lshlrev_b32 v17, 16, v136
    v_and_b32 v18, s51, v136
    v_lshlrev_b32 v19, 16, v137
    v_and_b32 v20, s51, v137
    v_subrev_f32 v21, v21, v13
    v_subrev_f32 v22, v22, v14
    v_subrev_f32 v23, v23, v15
    v_subrev_f32 v24, v24, v16
    v_subrev_f32 v25, v25, v17
    v_subrev_f32 v54, v54, v18
    v_subrev_f32 v55, v55, v19
    v_subrev_f32 v56, v56, v20
    v_cvt_pk_bf16_f32 v30, v21, v22
    v_cvt_pk_bf16_f32 v31, v23, v24
    v_cvt_pk_bf16_f32 v32, v25, v54
    v_cvt_pk_bf16_f32 v33, v55, v56
    ds_write_b128 v10, v[30:33] offset:22528
    s_mov_b64 exec, 1
    ds_add_u32 v252, v251 offset:488
    s_mov_b64 exec, -1
    v_lshlrev_b32 v13, 16, v142
    v_and_b32 v14, s51, v142
    v_lshlrev_b32 v15, 16, v143
    v_and_b32 v16, s51, v143
    v_lshlrev_b32 v17, 16, v144
    v_and_b32 v18, s51, v144
    v_lshlrev_b32 v19, 16, v145
    v_and_b32 v20, s51, v145
    v_lshlrev_b32 v21, 16, v150
    v_and_b32 v22, s51, v150
    v_lshlrev_b32 v23, 16, v151
    v_and_b32 v24, s51, v151
    v_lshlrev_b32 v25, 16, v152
    v_and_b32 v54, s51, v152
    v_lshlrev_b32 v55, 16, v153
    v_and_b32 v56, s51, v153
    v_subrev_f32 v13, v13, v21
    v_subrev_f32 v14, v14, v22
    v_subrev_f32 v15, v15, v23
    v_subrev_f32 v16, v16, v24
    v_subrev_f32 v17, v17, v25
    v_subrev_f32 v18, v18, v54
    v_subrev_f32 v19, v19, v55
    v_subrev_f32 v20, v20, v56
    v_cvt_pk_bf16_f32 v26, v13, v14
    v_cvt_pk_bf16_f32 v27, v15, v16
    v_cvt_pk_bf16_f32 v28, v17, v18
    v_cvt_pk_bf16_f32 v29, v19, v20
L_FRn11:
    ds_read_b128 v[44:47], v252 offset:384
    s_waitcnt lgkmcnt(0)
    v_and_b32 v44, v44, v45
    v_and_b32 v46, v46, v47
    v_and_b32 v44, v44, v46
    s_nop 0
    v_readfirstlane_b32 s47, v44
    s_cmp_eq_u32 s47, 1
    s_cbranch_scc1 L_FRn11_ok
    s_sleep 2
    s_branch L_FRn11
L_FRn11_ok:
    s_cmp_eq_u32 s55, 3
    s_cbranch_scc0 L_UPn11
    s_mov_b32 s48, 811008
    buffer_load_dword v254, v253, s[16:19], s48 offen sc1
L_UPn11:
    ds_write_b128 v7, v[26:29] offset:45056
    v_lshlrev_b32 v13, 16, v158
    v_and_b32 v14, s51, v158
    v_lshlrev_b32 v15, 16, v159
    v_and_b32 v16, s51, v159
    v_lshlrev_b32 v17, 16, v160
    v_and_b32 v18, s51, v160
    v_lshlrev_b32 v19, 16, v161
    v_and_b32 v20, s51, v161
    v_subrev_f32 v21, v21, v13
    v_subrev_f32 v22, v22, v14
    v_subrev_f32 v23, v23, v15
    v_subrev_f32 v24, v24, v16
    v_subrev_f32 v25, v25, v17
    v_subrev_f32 v54, v54, v18
    v_subrev_f32 v55, v55, v19
    v_subrev_f32 v56, v56, v20
    v_cvt_pk_bf16_f32 v30, v21, v22
    v_cvt_pk_bf16_f32 v31, v23, v24
    v_cvt_pk_bf16_f32 v32, v25, v54
    v_cvt_pk_bf16_f32 v33, v55, v56
    ds_write_b128 v8, v[30:33] offset:45056
    v_lshlrev_b32 v21, 16, v166
    v_and_b32 v22, s51, v166
    v_lshlrev_b32 v23, 16, v167
    v_and_b32 v24, s51, v167
    v_lshlrev_b32 v25, 16, v168
    v_and_b32 v54, s51, v168
    v_lshlrev_b32 v55, 16, v169
    v_and_b32 v56, s51, v169
    v_subrev_f32 v13, v13, v21
    v_subrev_f32 v14, v14, v22
    v_subrev_f32 v15, v15, v23
    v_subrev_f32 v16, v16, v24
    v_subrev_f32 v17, v17, v25
    v_subrev_f32 v18, v18, v54
    v_subrev_f32 v19, v19, v55
    v_subrev_f32 v20, v20, v56
    v_cvt_pk_bf16_f32 v26, v13, v14
    v_cvt_pk_bf16_f32 v27, v15, v16
    v_cvt_pk_bf16_f32 v28, v17, v18
    v_cvt_pk_bf16_f32 v29, v19, v20
    ds_write_b128 v9, v[26:29] offset:45056
    v_lshlrev_b32 v13, 16, v174
    v_and_b32 v14, s51, v174
    v_lshlrev_b32 v15, 16, v175
    v_and_b32 v16, s51, v175
    v_lshlrev_b32 v17, 16, v176
    v_and_b32 v18, s51, v176
    v_lshlrev_b32 v19, 16, v177
    v_and_b32 v20, s51, v177
    v_subrev_f32 v21, v21, v13
    v_subrev_f32 v22, v22, v14
    v_subrev_f32 v23, v23, v15
    v_subrev_f32 v24, v24, v16
    v_subrev_f32 v25, v25, v17
    v_subrev_f32 v54, v54, v18
    v_subrev_f32 v55, v55, v19
    v_subrev_f32 v56, v56, v20
    v_cvt_pk_bf16_f32 v30, v21, v22
    v_cvt_pk_bf16_f32 v31, v23, v24
    v_cvt_pk_bf16_f32 v32, v25, v54
    v_cvt_pk_bf16_f32 v33, v55, v56
    ds_write_b128 v10, v[30:33] offset:45056
    s_mov_b64 exec, 1
    ds_add_u32 v252, v251 offset:492
    s_mov_b64 exec, -1
    s_mul_i32 s47, s39, 86016
    s_mul_i32 s48, s38, 12288
    s_add_u32 s47, s47, s48
    s_mul_i32 s48, s55, 3072
    s_add_u32 s47, s47, s48
    s_mul_i32 s48, s55, 1600
    s_add_u32 s48, s48, 68096
    v_add_u32 v13, 0, v0
    v_mul_u32_u24 v14, 1366, v13
    v_lshrrev_b32 v14, 16, v14
    v_mul_u32_u24 v15, 48, v14
    v_sub_u32 v15, v13, v15
    v_lshlrev_b32 v15, 3, v15
    v_mul_u32_u24 v16, 400, v14
    v_add3_u32 v7, v16, v15, s48
    v_mul_u32_u24 v16, 768, v14
    v_add3_u32 v10, v16, v15, s47
    v_add_u32 v20, 38400, v7
    v_add_u32 v13, 64, v0
    v_mul_u32_u24 v14, 1366, v13
    v_lshrrev_b32 v14, 16, v14
    v_mul_u32_u24 v15, 48, v14
    v_sub_u32 v15, v13, v15
    v_lshlrev_b32 v15, 3, v15
    v_mul_u32_u24 v16, 400, v14
    v_add3_u32 v8, v16, v15, s48
    v_mul_u32_u24 v16, 768, v14
    v_add3_u32 v11, v16, v15, s47
    v_add_u32 v21, 38400, v8
    v_add_u32 v13, 128, v0
    v_mul_u32_u24 v14, 1366, v13
    v_lshrrev_b32 v14, 16, v14
    v_mul_u32_u24 v15, 48, v14
    v_sub_u32 v15, v13, v15
    v_lshlrev_b32 v15, 3, v15
    v_mul_u32_u24 v16, 400, v14
    v_add3_u32 v9, v16, v15, s48
    v_mul_u32_u24 v16, 768, v14
    v_add3_u32 v12, v16, v15, s47
    v_add_u32 v22, 38400, v9
    v_add_u32 v13, 0, v0
    v_min_u32 v13, 95, v13
    v_mul_u32_u24 v14, 10923, v13
    v_lshrrev_b32 v14, 18, v14
    v_mul_u32_u24 v15, 24, v14
    v_sub_u32 v15, v13, v15
    v_lshlrev_b32 v15, 4, v15
    v_mul_u32_u24 v16, 400, v14
    v_add3_u32 v1, v16, v15, s48
    v_mul_u32_u24 v16, 768, v14
    v_add3_u32 v3, v16, v15, s47
    v_add_u32 v13, 64, v0
    v_min_u32 v13, 95, v13
    v_mul_u32_u24 v14, 10923, v13
    v_lshrrev_b32 v14, 18, v14
    v_mul_u32_u24 v15, 24, v14
    v_sub_u32 v15, v13, v15
    v_lshlrev_b32 v15, 4, v15
    v_mul_u32_u24 v16, 400, v14
    v_add3_u32 v2, v16, v15, s48
    v_mul_u32_u24 v16, 768, v14
    v_add3_u32 v4, v16, v15, s47
    v_cmp_gt_u32 vcc, 32, v0
    v_mov_b32 v17, s59
    v_add_u32 v250, 38400, v1
    v_cndmask_b32 v4, v17, v4, vcc
    v_add_u32 v251, 38400, v2
    s_lshl_b32 s47, s55, 2
    v_bfe_u32 v13, v0, 3, 2
    v_add_u32 v13, s47, v13
    v_and_b32 v14, 7, v0
    v_mul_u32_u24 v15, 144, v13
    v_lshl_add_u32 v15, v14, 4, v15
    v_add_u32 v5, 144896, v15
    v_mul_u32_u24 v13, 768, v13
    v_lshrrev_b32 v15, 1, v14
    v_mul_u32_u24 v15, 96, v15
    v_and_b32 v14, 1, v14
    v_lshl_add_u32 v15, v14, 4, v15
    s_mul_i32 s47, s42, 86016
    s_mul_i32 s48, s41, 12288
    s_add_u32 s47, s47, s48
    s_lshl_b32 s48, s43, 5
    s_add_u32 s47, s47, s48
    v_add3_u32 v6, v13, v15, s47
    v_cndmask_b32 v6, v17, v6, vcc
L_Fn0_5:
    ds_read_b128 v[16:19], v252 offset:80
    s_waitcnt lgkmcnt(0)
    v_and_b32 v16, v16, v17
    v_and_b32 v18, v18, v19
    v_and_b32 v16, v16, v18
    s_nop 0
    v_readfirstlane_b32 s47, v16
    s_cmp_eq_u32 s47, 1
    s_cbranch_scc1 L_Fn0_5_ok
    s_sleep 2
    s_branch L_Fn0_5
L_Fn0_5_ok:
    ds_read_b64 v[28:29], v7 offset:0
    ds_read_b64 v[30:31], v8 offset:0
    ds_read_b64 v[32:33], v9 offset:0
    ds_read_b64 v[36:37], v7 offset:6400
    ds_read_b64 v[38:39], v8 offset:6400
    ds_read_b64 v[40:41], v9 offset:6400
    ds_read_b64 v[44:45], v7 offset:12800
    ds_read_b64 v[46:47], v8 offset:12800
    ds_read_b64 v[48:49], v9 offset:12800
    ds_read_b64 v[52:53], v7 offset:19200
    ds_read_b64 v[54:55], v8 offset:19200
    ds_read_b64 v[56:57], v9 offset:19200
    ds_read_b64 v[60:61], v7 offset:25600
    ds_read_b64 v[62:63], v8 offset:25600
    ds_read_b64 v[64:65], v9 offset:25600
    ds_read_b64 v[68:69], v7 offset:32000
    ds_read_b64 v[70:71], v8 offset:32000
    ds_read_b64 v[72:73], v9 offset:32000
L_FnGO14:
    ds_read_b128 v[16:19], v252 offset:224
    s_waitcnt lgkmcnt(0)
    v_and_b32 v16, v16, v17
    v_and_b32 v18, v18, v19
    v_and_b32 v16, v16, v18
    s_nop 0
    v_readfirstlane_b32 s47, v16
    s_cmp_eq_u32 s47, 1
    s_cbranch_scc1 L_FnGO14_ok
    s_sleep 1
    s_branch L_FnGO14
L_FnGO14_ok:
    s_mov_b32 s53, 0
    buffer_store_dwordx2 v[28:29], v10, s[12:15], s53 offen offset:0 nt
    buffer_store_dwordx2 v[30:31], v11, s[12:15], s53 offen offset:0 nt
    buffer_store_dwordx2 v[32:33], v12, s[12:15], s53 offen offset:0 nt
    s_mov_b32 s53, 86016
    buffer_store_dwordx2 v[36:37], v10, s[12:15], s53 offen offset:0 nt
    buffer_store_dwordx2 v[38:39], v11, s[12:15], s53 offen offset:0 nt
    buffer_store_dwordx2 v[40:41], v12, s[12:15], s53 offen offset:0 nt
    s_mov_b32 s53, 172032
    buffer_store_dwordx2 v[44:45], v10, s[12:15], s53 offen offset:0 nt
    buffer_store_dwordx2 v[46:47], v11, s[12:15], s53 offen offset:0 nt
    buffer_store_dwordx2 v[48:49], v12, s[12:15], s53 offen offset:0 nt
    s_mov_b32 s53, 258048
    buffer_store_dwordx2 v[52:53], v10, s[12:15], s53 offen offset:0 nt
    buffer_store_dwordx2 v[54:55], v11, s[12:15], s53 offen offset:0 nt
    buffer_store_dwordx2 v[56:57], v12, s[12:15], s53 offen offset:0 nt
    s_mov_b32 s53, 344064
    buffer_store_dwordx2 v[60:61], v10, s[12:15], s53 offen offset:0 nt
    buffer_store_dwordx2 v[62:63], v11, s[12:15], s53 offen offset:0 nt
    buffer_store_dwordx2 v[64:65], v12, s[12:15], s53 offen offset:0 nt
    s_mov_b32 s53, 430080
    buffer_store_dwordx2 v[68:69], v10, s[12:15], s53 offen offset:0 nt
    buffer_store_dwordx2 v[70:71], v11, s[12:15], s53 offen offset:0 nt
    buffer_store_dwordx2 v[72:73], v12, s[12:15], s53 offen offset:0 nt
    s_cmp_eq_u32 s40, 0
    s_cbranch_scc1 L_NOX0
L_FnX0:
    ds_read_b128 v[16:19], v252 offset:192
    s_waitcnt lgkmcnt(0)
    v_and_b32 v16, v16, v17
    v_and_b32 v18, v18, v19
    v_and_b32 v16, v16, v18
    s_nop 0
    v_readfirstlane_b32 s47, v16
    s_cmp_eq_u32 s47, 1
    s_cbranch_scc1 L_FnX0_ok
    s_sleep 1
    s_branch L_FnX0
L_FnX0_ok:
    ds_read_b128 v[76:79], v5 offset:0
    s_waitcnt lgkmcnt(0)
    buffer_store_dwordx4 v[76:79], v6, s[12:15], 0 offen offset:0
L_NOX0:
L_Fn1_0:
    ds_read_b128 v[16:19], v252 offset:96
    s_waitcnt lgkmcnt(0)
    v_and_b32 v16, v16, v17
    v_and_b32 v18, v18, v19
    v_and_b32 v16, v16, v18
    s_nop 0
    v_readfirstlane_b32 s47, v16
    s_cmp_eq_u32 s47, 1
    s_cbranch_scc1 L_Fn1_0_ok
    s_sleep 1
    s_branch L_Fn1_0
L_Fn1_0_ok:
    ds_read_b64 v[84:85], v20 offset:0
    ds_read_b64 v[86:87], v21 offset:0
    ds_read_b64 v[88:89], v22 offset:0
    s_mov_b32 s53, 0
    s_waitcnt lgkmcnt(2)
    buffer_store_dwordx2 v[84:85], v10, s[12:15], s53 offen offset:384 nt
    s_waitcnt lgkmcnt(1)
    buffer_store_dwordx2 v[86:87], v11, s[12:15], s53 offen offset:384 nt
    s_waitcnt lgkmcnt(0)
    buffer_store_dwordx2 v[88:89], v12, s[12:15], s53 offen offset:384 nt
L_Fn1_1:
    ds_read_b128 v[16:19], v252 offset:112
    s_waitcnt lgkmcnt(0)
    v_and_b32 v16, v16, v17
    v_and_b32 v18, v18, v19
    v_and_b32 v16, v16, v18
    s_nop 0
    v_readfirstlane_b32 s47, v16
    s_cmp_eq_u32 s47, 1
    s_cbranch_scc1 L_Fn1_1_ok
    s_sleep 1
    s_branch L_Fn1_1
L_Fn1_1_ok:
    ds_read_b64 v[92:93], v20 offset:6400
    ds_read_b64 v[94:95], v21 offset:6400
    ds_read_b64 v[96:97], v22 offset:6400
    s_mov_b32 s53, 86016
    s_waitcnt lgkmcnt(2)
    buffer_store_dwordx2 v[92:93], v10, s[12:15], s53 offen offset:384 nt
    s_waitcnt lgkmcnt(1)
    buffer_store_dwordx2 v[94:95], v11, s[12:15], s53 offen offset:384 nt
    s_waitcnt lgkmcnt(0)
    buffer_store_dwordx2 v[96:97], v12, s[12:15], s53 offen offset:384 nt
    s_cmp_eq_u32 s40, 0
    s_cbranch_scc1 L_NOX1
L_FnX1:
    ds_read_b128 v[16:19], v252 offset:208
    s_waitcnt lgkmcnt(0)
    v_and_b32 v16, v16, v17
    v_and_b32 v18, v18, v19
    v_and_b32 v16, v16, v18
    s_nop 0
    v_readfirstlane_b32 s47, v16
    s_cmp_eq_u32 s47, 1
    s_cbranch_scc1 L_FnX1_ok
    s_sleep 1
    s_branch L_FnX1
L_FnX1_ok:
    ds_read_b128 v[80:83], v5 offset:2304
    s_waitcnt lgkmcnt(0)
    buffer_store_dwordx4 v[80:83], v6, s[12:15], 0 offen offset:384
L_NOX1:
L_Fn1_2:
    ds_read_b128 v[16:19], v252 offset:128
    s_waitcnt lgkmcnt(0)
    v_and_b32 v16, v16, v17
    v_and_b32 v18, v18, v19
    v_and_b32 v16, v16, v18
    s_nop 0
    v_readfirstlane_b32 s47, v16
    s_cmp_eq_u32 s47, 1
    s_cbranch_scc1 L_Fn1_2_ok
    s_sleep 1
    s_branch L_Fn1_2
L_Fn1_2_ok:
    ds_read_b64 v[100:101], v20 offset:12800
    ds_read_b64 v[102:103], v21 offset:12800
    ds_read_b64 v[104:105], v22 offset:12800
    s_mov_b32 s53, 172032
    s_waitcnt lgkmcnt(2)
    buffer_store_dwordx2 v[100:101], v10, s[12:15], s53 offen offset:384 nt
    s_waitcnt lgkmcnt(1)
    buffer_store_dwordx2 v[102:103], v11, s[12:15], s53 offen offset:384 nt
    s_waitcnt lgkmcnt(0)
    buffer_store_dwordx2 v[104:105], v12, s[12:15], s53 offen offset:384 nt
L_Fn1_3:
    ds_read_b128 v[16:19], v252 offset:144
    s_waitcnt lgkmcnt(0)
    v_and_b32 v16, v16, v17
    v_and_b32 v18, v18, v19
    v_and_b32 v16, v16, v18
    s_nop 0
    v_readfirstlane_b32 s47, v16
    s_cmp_eq_u32 s47, 1
    s_cbranch_scc1 L_Fn1_3_ok
    s_sleep 1
    s_branch L_Fn1_3
L_Fn1_3_ok:
    ds_read_b64 v[108:109], v20 offset:19200
    ds_read_b64 v[110:111], v21 offset:19200
    ds_read_b64 v[112:113], v22 offset:19200
    s_mov_b32 s53, 258048
    s_waitcnt lgkmcnt(2)
    buffer_store_dwordx2 v[108:109], v10, s[12:15], s53 offen offset:384 nt
    s_waitcnt lgkmcnt(1)
    buffer_store_dwordx2 v[110:111], v11, s[12:15], s53 offen offset:384 nt
    s_waitcnt lgkmcnt(0)
    buffer_store_dwordx2 v[112:113], v12, s[12:15], s53 offen offset:384 nt
L_Fn1_4:
    ds_read_b128 v[16:19], v252 offset:160
    s_waitcnt lgkmcnt(0)
    v_and_b32 v16, v16, v17
    v_and_b32 v18, v18, v19
    v_and_b32 v16, v16, v18
    s_nop 0
    v_readfirstlane_b32 s47, v16
    s_cmp_eq_u32 s47, 1
    s_cbranch_scc1 L_Fn1_4_ok
    s_branch L_Fn1_4
L_Fn1_4_ok:
    ds_read_b64 v[116:117], v20 offset:25600
    ds_read_b64 v[118:119], v21 offset:25600
    ds_read_b64 v[120:121], v22 offset:25600
    s_mov_b32 s53, 344064
    s_waitcnt lgkmcnt(2)
    buffer_store_dwordx2 v[116:117], v10, s[12:15], s53 offen offset:384 nt
    s_waitcnt lgkmcnt(1)
    buffer_store_dwordx2 v[118:119], v11, s[12:15], s53 offen offset:384 nt
    s_waitcnt lgkmcnt(0)
    buffer_store_dwordx2 v[120:121], v12, s[12:15], s53 offen offset:384 nt
L_Fn1_5:
    ds_read_b128 v[16:19], v252 offset:176
    s_waitcnt lgkmcnt(0)
    v_and_b32 v16, v16, v17
    v_and_b32 v18, v18, v19
    v_and_b32 v16, v16, v18
    s_nop 0
    v_readfirstlane_b32 s47, v16
    s_cmp_eq_u32 s47, 1
    s_cbranch_scc1 L_Fn1_5_ok
    s_branch L_Fn1_5
L_Fn1_5_ok:
    ds_read_b64 v[124:125], v20 offset:32000
    ds_read_b64 v[126:127], v21 offset:32000
    ds_read_b64 v[128:129], v22 offset:32000
    s_mov_b32 s53, 430080
    s_waitcnt lgkmcnt(2)
    buffer_store_dwordx2 v[124:125], v10, s[12:15], s53 offen offset:384 nt
    s_waitcnt lgkmcnt(1)
    buffer_store_dwordx2 v[126:127], v11, s[12:15], s53 offen offset:384 nt
    s_waitcnt lgkmcnt(0)
    buffer_store_dwordx2 v[128:129], v12, s[12:15], s53 offen offset:384 nt
    s_endpgm
.org standalone__standard_2d_1d_3d_conv__vision_kernel + 25600, 0
L_PW:
    s_and_b32 s41, s2, 7
    s_cmp_lt_u32 s46, 6
    s_cselect_b32 s43, s46, s41
    s_cselect_b32 s41, s41, 8
    s_cmp_lt_u32 s43, 6
    s_cselect_b32 s58, 0, s59
    s_mul_i32 s42, s41, 11
    s_lshr_b32 s42, s42, 5
    s_mul_i32 s44, s42, 3
    s_sub_u32 s41, s41, s44
    s_lshl_b32 s41, s41, 2
    s_add_u32 s41, s41, s55
    s_mul_i32 s53, s42, 221184
    s_mul_i32 s54, s43, 12288
    s_add_u32 s53, s53, s54
    s_lshl_b32 s54, s41, 5
    s_add_u32 s53, s53, s54
    v_bfe_u32 v18, v0, 3, 2
    v_lshlrev_b32 v18, 3, v18
    v_lshrrev_b32 v19, 5, v0
    v_lshl_add_u32 v18, v19, 2, v18
    v_bfe_u32 v19, v0, 1, 2
    v_add_u32 v18, v18, v19
    v_mul_u32_u24 v18, 384, v18
    v_and_b32 v19, 1, v0
    v_lshl_add_u32 v4, v19, 4, v18
    s_mul_i32 s52, s55, 6144
    s_add_u32 s52, s52, 22528
    s_mov_b32 m0, s52
    s_waitcnt lgkmcnt(0)
    s_mov_b32 s8, s30
    s_mov_b32 s9, s31
    s_mov_b32 s10, 663552
    s_mov_b32 s11, 0x20000
    buffer_load_dwordx4 v4, s[8:11], s53 offen lds
    s_add_u32 m0, s52, 1024
    s_add_u32 s53, s53, 73728
    buffer_load_dwordx4 v4, s[8:11], s53 offen lds
    s_add_u32 m0, s52, 2048
    s_add_u32 s53, s53, 73728
    buffer_load_dwordx4 v4, s[8:11], s53 offen lds
    s_mul_i32 s53, s43, 36864
    s_mul_i32 s41, s41, 3
    s_add_u32 s41, s41, s42
    s_lshl_b32 s41, s41, 10
    s_add_u32 s53, s53, s41
    s_or_b32 s53, s53, s58
    v_lshl_add_u32 v5, v0, 4, s53
    s_and_b32 s47, s2, 7
    s_lshl_b32 s47, s47, 5
    s_add_u32 s47, s47, s46
    s_mul_i32 s47, s47, 7
    s_lshr_b32 s38, s47, 8
    s_and_b32 s47, s47, 255
    s_mul_i32 s47, s47, 293
    s_lshr_b32 s47, s47, 11
    s_mul_i32 s39, s47, 6
    v_and_b32 v13, 3, v0
    v_bfe_u32 v14, v0, 2, 2
    v_bfe_u32 v15, v0, 4, 1
    v_lshrrev_b32 v7, 5, v0
    s_lshl_b32 s47, s55, 1
    s_add_u32 s47, s47, s39
    s_mul_i32 s47, s47, 86016
    s_mul_i32 s48, s38, 12288
    s_add_u32 s47, s47, s48
    s_sub_u32 s47, s47, 86016
    v_mul_u32_u24 v16, 86016, v15
    v_lshl_add_u32 v16, v13, 4, v16
    v_lshl_add_u32 v16, v7, 6, v16
    v_mul_u32_u24 v2, 3072, v14
    v_add3_u32 v2, v2, v16, s47
    v_cmp_gt_i32 vcc, 0, v2
    v_lshl_add_u32 v16, s38, 2, v14
    v_mov_b32 v3, s59
    v_cndmask_b32 v2, v2, v3, vcc
    v_cmp_ne_u32 vcc, 0, v16
    v_subrev_u32 v1, 384, v2
    v_add_u32 v8, 3072, v2
    v_cndmask_b32 v1, v3, v1, vcc
    v_cmp_ne_u32 vcc, 27, v16
    s_waitcnt lgkmcnt(0)
    s_mov_b32 s4, s28
    s_mov_b32 s5, s29
    s_mov_b32 s6, 19267584
    s_mov_b32 s7, 0x20000
    v_cndmask_b32 v3, v3, v8, vcc
    buffer_load_dwordx4 v[58:61], v1, s[4:7], 0 offen offset:0
    buffer_load_dwordx4 v[66:69], v2, s[4:7], 0 offen offset:384
    buffer_load_dwordx4 v[74:77], v2, s[4:7], 0 offen offset:1152
    buffer_load_dwordx4 v[82:85], v2, s[4:7], 0 offen offset:1920
    buffer_load_dwordx4 v[90:93], v2, s[4:7], 0 offen offset:2688
    s_mov_b32 s16, s26
    s_mov_b32 s17, s27
    s_mov_b32 s18, 884736
    s_mov_b32 s19, 0x20000
    v_lshrrev_b32 v6, 2, v0
    v_lshlrev_b32 v6, 5, v6
    v_lshl_add_u32 v6, v13, 3, v6
    v_add_u32 v6, s52, v6
    s_waitcnt vmcnt(5)
    ds_read_b64_tr_b16 v[178:179], v6 offset:0
    ds_read_b64_tr_b16 v[180:181], v6 offset:512
    ds_read_b64_tr_b16 v[182:183], v6 offset:1024
    ds_read_b64_tr_b16 v[184:185], v6 offset:1536
    ds_read_b64_tr_b16 v[186:187], v6 offset:2048
    ds_read_b64_tr_b16 v[188:189], v6 offset:2560
    s_waitcnt lgkmcnt(4)
    v_lshlrev_b32 v218, 16, v178
    v_and_b32 v219, s51, v178
    v_lshlrev_b32 v220, 16, v179
    v_and_b32 v221, s51, v179
    v_lshlrev_b32 v222, 16, v180
    v_and_b32 v223, s51, v180
    v_lshlrev_b32 v224, 16, v181
    v_and_b32 v225, s51, v181
    s_waitcnt lgkmcnt(0)
    v_lshlrev_b32 v234, 16, v186
    v_and_b32 v235, s51, v186
    v_lshlrev_b32 v236, 16, v187
    v_and_b32 v237, s51, v187
    v_lshlrev_b32 v238, 16, v188
    v_and_b32 v239, s51, v188
    v_lshlrev_b32 v240, 16, v189
    v_and_b32 v241, s51, v189
    v_add_f32 v218, v218, v234
    v_add_f32 v219, v219, v235
    v_add_f32 v220, v220, v236
    v_add_f32 v221, v221, v237
    v_add_f32 v222, v222, v238
    v_add_f32 v223, v223, v239
    v_add_f32 v224, v224, v240
    v_add_f32 v225, v225, v241
    v_lshlrev_b32 v226, 16, v182
    v_and_b32 v227, s51, v182
    v_lshlrev_b32 v228, 16, v183
    v_and_b32 v229, s51, v183
    v_lshlrev_b32 v230, 16, v184
    v_and_b32 v231, s51, v184
    v_lshlrev_b32 v232, 16, v185
    v_and_b32 v233, s51, v185
    v_sub_f32_e64 v234, v218, v226 div:2
    v_add_f32_e64 v218, v218, v226 div:2
    v_sub_f32_e64 v235, v219, v227 div:2
    v_add_f32_e64 v219, v219, v227 div:2
    v_sub_f32_e64 v236, v220, v228 div:2
    v_add_f32_e64 v220, v220, v228 div:2
    v_sub_f32_e64 v237, v221, v229 div:2
    v_add_f32_e64 v221, v221, v229 div:2
    v_sub_f32_e64 v238, v222, v230 div:2
    v_add_f32_e64 v222, v222, v230 div:2
    v_sub_f32_e64 v239, v223, v231 div:2
    v_add_f32_e64 v223, v223, v231 div:2
    v_sub_f32_e64 v240, v224, v232 div:2
    v_add_f32_e64 v224, v224, v232 div:2
    v_sub_f32_e64 v241, v225, v233 div:2
    v_add_f32_e64 v225, v225, v233 div:2
    v_cvt_pk_bf16_f32 v190, v218, v219
    v_cvt_pk_bf16_f32 v194, v234, v235
    v_cvt_pk_bf16_f32 v191, v220, v221
    v_cvt_pk_bf16_f32 v195, v236, v237
    v_cvt_pk_bf16_f32 v192, v222, v223
    v_cvt_pk_bf16_f32 v196, v238, v239
    v_cvt_pk_bf16_f32 v193, v224, v225
    v_cvt_pk_bf16_f32 v197, v240, v241
    s_mov_b32 s53, 0
    buffer_store_dwordx4 v[190:193], v5, s[16:19], s53 offen sc1
    s_mov_b32 s53, 221184
    buffer_store_dwordx4 v[194:197], v5, s[16:19], s53 offen sc1
    s_mov_b32 s53, 442368
    buffer_store_dwordx4 v[178:181], v5, s[16:19], s53 offen sc1
    s_mov_b32 s53, 663552
    buffer_store_dwordx4 v[186:189], v5, s[16:19], s53 offen sc1
    s_lshl_b32 s47, s55, 1
    v_add_u32 v15, s47, v15
    v_mul_u32_u24 v7, 11264, v7
    v_lshl_add_u32 v7, v15, 10, v7
    v_lshlrev_b32 v16, 2, v14
    v_lshl_add_u32 v16, v13, 4, v16
    v_add_u32 v16, v16, v13
    v_lshl_add_u32 v7, v16, 4, v7
    v_xor_b32 v8, 16, v7
    v_xor_b32 v9, 32, v7
    v_xor_b32 v10, 48, v7
    s_and_b32 s47, s2, 7
    s_mul_i32 s47, s47, 12
    s_add_u32 s47, s47, s46
    s_sub_u32 s47, s47, 7
    s_mul_i32 s48, s47, 21846
    s_lshr_b32 s48, s48, 16
    s_mul_i32 s49, s48, 3
    s_sub_u32 s43, s47, s49
    s_cmp_eq_u32 s40, 1
    s_cselect_b32 s43, s43, 0
    s_cselect_b32 s48, s48, 0
    s_lshl_b32 s41, s48, 1
    s_and_b32 s41, s41, 12
    s_lshr_b32 s41, 0x5310, s41
    s_and_b32 s41, s41, 15
    s_and_b32 s42, s48, 1
    s_add_u32 s42, s42, 222
    s_lshr_b32 s50, s48, 3
    s_lshl_b32 s50, s50, 1
    s_and_b32 s49, s48, 7
    s_add_u32 s49, s49, 216
    s_cmp_lt_u32 s48, 8
    s_cselect_b32 s41, s41, s50
    s_cselect_b32 s42, s42, s49
    s_mov_b32 s12, s34
    s_mov_b32 s13, s35
    s_mov_b32 s14, 19267584
    s_mov_b32 s15, 0x20000
    s_cmp_eq_u32 s55, 3
    s_cselect_b32 s56, 1, 0
    s_mul_i32 s47, s46, 2304
    v_min_u32 v253, 17, v0
    v_lshl_add_u32 v253, v253, 7, s47
    v_mov_b32 v250, 67824
    v_mov_b32 v251, 1
    v_mov_b32 v252, 67584
    s_waitcnt lgkmcnt(0)
    s_barrier
    s_waitcnt vmcnt(0)
    v_mov_b32 v4, 67828
    s_mov_b64 exec, 1
    ds_add_rtn_u32 v6, v4, v251
    s_waitcnt lgkmcnt(0)
    v_readfirstlane_b32 s47, v6
    v_mov_b32 v6, 0
    s_cmp_eq_u32 s47, 3
    s_cbranch_scc0 L_NOATOM
    v_lshlrev_b32 v4, 6, v0
    v_mov_b32 v6, 1
    global_atomic_add v6, v4, v6, s[24:25] sc0 sc1
L_NOATOM:
    s_mov_b64 exec, -1
    buffer_load_dwordx4 v[62:65], v2, s[4:7], 0 offen offset:0
    buffer_load_dwordx4 v[70:73], v2, s[4:7], 0 offen offset:768
    buffer_load_dwordx4 v[78:81], v2, s[4:7], 0 offen offset:1536
    buffer_load_dwordx4 v[86:89], v2, s[4:7], 0 offen offset:2304
    buffer_load_dwordx4 v[94:97], v3, s[4:7], 0 offen offset:0
    v_lshlrev_b32 v13, 16, v58
    v_and_b32 v14, s51, v58
    v_lshlrev_b32 v15, 16, v59
    v_and_b32 v16, s51, v59
    v_lshlrev_b32 v17, 16, v60
    v_and_b32 v18, s51, v60
    v_lshlrev_b32 v19, 16, v61
    v_and_b32 v20, s51, v61
    v_lshlrev_b32 v21, 16, v66
    v_and_b32 v22, s51, v66
    v_lshlrev_b32 v23, 16, v67
    v_and_b32 v24, s51, v67
    v_lshlrev_b32 v25, 16, v68
    v_and_b32 v54, s51, v68
    v_lshlrev_b32 v55, 16, v69
    v_and_b32 v56, s51, v69
    v_sub_f32 v13, v13, v21
    v_sub_f32 v14, v14, v22
    v_sub_f32 v15, v15, v23
    v_sub_f32 v16, v16, v24
    v_sub_f32 v17, v17, v25
    v_sub_f32 v18, v18, v54
    v_sub_f32 v19, v19, v55
    v_sub_f32 v20, v20, v56
    v_cvt_pk_bf16_f32 v26, v13, v14
    v_cvt_pk_bf16_f32 v27, v15, v16
    v_cvt_pk_bf16_f32 v28, v17, v18
    v_cvt_pk_bf16_f32 v29, v19, v20
    ds_write_b128 v7, v[26:29] offset:0
    v_lshlrev_b32 v13, 16, v74
    v_and_b32 v14, s51, v74
    v_lshlrev_b32 v15, 16, v75
    v_and_b32 v16, s51, v75
    v_lshlrev_b32 v17, 16, v76
    v_and_b32 v18, s51, v76
    v_lshlrev_b32 v19, 16, v77
    v_and_b32 v20, s51, v77
    v_sub_f32 v21, v21, v13
    v_sub_f32 v22, v22, v14
    v_sub_f32 v23, v23, v15
    v_sub_f32 v24, v24, v16
    v_sub_f32 v25, v25, v17
    v_sub_f32 v54, v54, v18
    v_sub_f32 v55, v55, v19
    v_sub_f32 v56, v56, v20
    v_cvt_pk_bf16_f32 v30, v21, v22
    v_cvt_pk_bf16_f32 v31, v23, v24
    v_cvt_pk_bf16_f32 v32, v25, v54
    v_cvt_pk_bf16_f32 v33, v55, v56
    ds_write_b128 v8, v[30:33] offset:0
    v_lshlrev_b32 v21, 16, v82
    v_and_b32 v22, s51, v82
    v_lshlrev_b32 v23, 16, v83
    v_and_b32 v24, s51, v83
    v_lshlrev_b32 v25, 16, v84
    v_and_b32 v54, s51, v84
    v_lshlrev_b32 v55, 16, v85
    v_and_b32 v56, s51, v85
    v_sub_f32 v13, v13, v21
    v_sub_f32 v14, v14, v22
    v_sub_f32 v15, v15, v23
    v_sub_f32 v16, v16, v24
    v_sub_f32 v17, v17, v25
    v_sub_f32 v18, v18, v54
    v_sub_f32 v19, v19, v55
    v_sub_f32 v20, v20, v56
    v_cvt_pk_bf16_f32 v26, v13, v14
    v_cvt_pk_bf16_f32 v27, v15, v16
    v_cvt_pk_bf16_f32 v28, v17, v18
    v_cvt_pk_bf16_f32 v29, v19, v20
    ds_write_b128 v9, v[26:29] offset:0
    v_lshlrev_b32 v13, 16, v90
    v_and_b32 v14, s51, v90
    v_lshlrev_b32 v15, 16, v91
    v_and_b32 v16, s51, v91
    v_lshlrev_b32 v17, 16, v92
    v_and_b32 v18, s51, v92
    v_lshlrev_b32 v19, 16, v93
    v_and_b32 v20, s51, v93
    v_sub_f32 v21, v21, v13
    v_sub_f32 v22, v22, v14
    v_sub_f32 v23, v23, v15
    v_sub_f32 v24, v24, v16
    v_sub_f32 v25, v25, v17
    v_sub_f32 v54, v54, v18
    v_sub_f32 v55, v55, v19
    v_sub_f32 v56, v56, v20
    v_cvt_pk_bf16_f32 v30, v21, v22
    v_cvt_pk_bf16_f32 v31, v23, v24
    v_cvt_pk_bf16_f32 v32, v25, v54
    v_cvt_pk_bf16_f32 v33, v55, v56
    ds_write_b128 v10, v[30:33] offset:0
    s_mov_b64 exec, 1
    ds_add_u32 v252, v251 offset:448
    s_mov_b64 exec, -1
    s_waitcnt vmcnt(5)
    v_readfirstlane_b32 s47, v6
    s_cmp_eq_u32 s47, 55
    s_cbranch_scc0 L_NOPUB
    s_mov_b64 exec, 7
    v_lshlrev_b32 v4, 6, v0
    v_mov_b32 v6, 56
    global_store_dword v4, v6, s[24:25] offset:64 sc1
    s_mov_b64 exec, -1
L_NOPUB:
    s_waitcnt vmcnt(0)
    v_lshlrev_b32 v13, 16, v62
    v_and_b32 v14, s51, v62
    v_lshlrev_b32 v15, 16, v63
    v_and_b32 v16, s51, v63
    v_lshlrev_b32 v17, 16, v64
    v_and_b32 v18, s51, v64
    v_lshlrev_b32 v19, 16, v65
    v_and_b32 v20, s51, v65
    v_lshlrev_b32 v21, 16, v70
    v_and_b32 v22, s51, v70
    v_lshlrev_b32 v23, 16, v71
    v_and_b32 v24, s51, v71
    v_lshlrev_b32 v25, 16, v72
    v_and_b32 v54, s51, v72
    v_lshlrev_b32 v55, 16, v73
    v_and_b32 v56, s51, v73
    v_sub_f32 v13, v13, v21
    v_sub_f32 v14, v14, v22
    v_sub_f32 v15, v15, v23
    v_sub_f32 v16, v16, v24
    v_sub_f32 v17, v17, v25
    v_sub_f32 v18, v18, v54
    v_sub_f32 v19, v19, v55
    v_sub_f32 v20, v20, v56
    v_cvt_pk_bf16_f32 v26, v13, v14
    v_cvt_pk_bf16_f32 v27, v15, v16
    v_cvt_pk_bf16_f32 v28, v17, v18
    v_cvt_pk_bf16_f32 v29, v19, v20
    ds_write_b128 v7, v[26:29] offset:22528
    v_lshlrev_b32 v13, 16, v78
    v_and_b32 v14, s51, v78
    v_lshlrev_b32 v15, 16, v79
    v_and_b32 v16, s51, v79
    v_lshlrev_b32 v17, 16, v80
    v_and_b32 v18, s51, v80
    v_lshlrev_b32 v19, 16, v81
    v_and_b32 v20, s51, v81
    v_sub_f32 v21, v21, v13
    v_sub_f32 v22, v22, v14
    v_sub_f32 v23, v23, v15
    v_sub_f32 v24, v24, v16
    v_sub_f32 v25, v25, v17
    v_sub_f32 v54, v54, v18
    v_sub_f32 v55, v55, v19
    v_sub_f32 v56, v56, v20
    v_cvt_pk_bf16_f32 v30, v21, v22
    v_cvt_pk_bf16_f32 v31, v23, v24
    v_cvt_pk_bf16_f32 v32, v25, v54
    v_cvt_pk_bf16_f32 v33, v55, v56
    ds_write_b128 v8, v[30:33] offset:22528
    v_lshlrev_b32 v21, 16, v86
    v_and_b32 v22, s51, v86
    v_lshlrev_b32 v23, 16, v87
    v_and_b32 v24, s51, v87
    v_lshlrev_b32 v25, 16, v88
    v_and_b32 v54, s51, v88
    v_lshlrev_b32 v55, 16, v89
    v_and_b32 v56, s51, v89
    v_sub_f32 v13, v13, v21
    v_sub_f32 v14, v14, v22
    v_sub_f32 v15, v15, v23
    v_sub_f32 v16, v16, v24
    v_sub_f32 v17, v17, v25
    v_sub_f32 v18, v18, v54
    v_sub_f32 v19, v19, v55
    v_sub_f32 v20, v20, v56
    v_cvt_pk_bf16_f32 v26, v13, v14
    v_cvt_pk_bf16_f32 v27, v15, v16
    v_cvt_pk_bf16_f32 v28, v17, v18
    v_cvt_pk_bf16_f32 v29, v19, v20
    ds_write_b128 v9, v[26:29] offset:22528
    v_lshlrev_b32 v13, 16, v94
    v_and_b32 v14, s51, v94
    v_lshlrev_b32 v15, 16, v95
    v_and_b32 v16, s51, v95
    v_lshlrev_b32 v17, 16, v96
    v_and_b32 v18, s51, v96
    v_lshlrev_b32 v19, 16, v97
    v_and_b32 v20, s51, v97
    v_sub_f32 v21, v21, v13
    v_sub_f32 v22, v22, v14
    v_sub_f32 v23, v23, v15
    v_sub_f32 v24, v24, v16
    v_sub_f32 v25, v25, v17
    v_sub_f32 v54, v54, v18
    v_sub_f32 v55, v55, v19
    v_sub_f32 v56, v56, v20
    v_cvt_pk_bf16_f32 v30, v21, v22
    v_cvt_pk_bf16_f32 v31, v23, v24
    v_cvt_pk_bf16_f32 v32, v25, v54
    v_cvt_pk_bf16_f32 v33, v55, v56
    ds_write_b128 v10, v[30:33] offset:22528
    s_mov_b64 exec, 1
    ds_add_u32 v252, v251 offset:452
    s_mov_b64 exec, -1
    v_lshlrev_b32 v13, 16, v62
    v_and_b32 v14, s51, v62
    v_lshlrev_b32 v15, 16, v66
    v_and_b32 v16, s51, v66
    v_lshlrev_b32 v19, 16, v63
    v_and_b32 v20, s51, v63
    v_lshlrev_b32 v21, 16, v67
    v_and_b32 v22, s51, v67
    v_add_f32 v17, v13, v15
    v_add_f32 v18, v14, v16
    v_sub_f32 v13, v15, v13
    v_sub_f32 v14, v16, v14
    v_add_f32 v23, v19, v21
    v_add_f32 v24, v20, v22
    v_sub_f32 v19, v21, v19
    v_sub_f32 v20, v22, v20
    v_cvt_pk_bf16_f32 v26, v17, v18
    v_cvt_pk_bf16_f32 v34, v13, v14
    v_cvt_pk_bf16_f32 v27, v23, v24
    v_cvt_pk_bf16_f32 v35, v19, v20
    v_lshlrev_b32 v13, 16, v64
    v_and_b32 v14, s51, v64
    v_lshlrev_b32 v15, 16, v68
    v_and_b32 v16, s51, v68
    v_lshlrev_b32 v19, 16, v65
    v_and_b32 v20, s51, v65
    v_lshlrev_b32 v21, 16, v69
    v_and_b32 v22, s51, v69
    v_add_f32 v17, v13, v15
    v_add_f32 v18, v14, v16
    v_sub_f32 v13, v15, v13
    v_sub_f32 v14, v16, v14
    v_add_f32 v23, v19, v21
    v_add_f32 v24, v20, v22
    v_sub_f32 v19, v21, v19
    v_sub_f32 v20, v22, v20
    v_cvt_pk_bf16_f32 v28, v17, v18
    v_cvt_pk_bf16_f32 v36, v13, v14
    v_cvt_pk_bf16_f32 v29, v23, v24
    v_cvt_pk_bf16_f32 v37, v19, v20
    ds_write_b128 v7, v[26:29] offset:45056
    v_lshlrev_b32 v13, 16, v70
    v_and_b32 v14, s51, v70
    v_lshlrev_b32 v15, 16, v74
    v_and_b32 v16, s51, v74
    v_lshlrev_b32 v19, 16, v71
    v_and_b32 v20, s51, v71
    v_lshlrev_b32 v21, 16, v75
    v_and_b32 v22, s51, v75
    v_add_f32 v17, v13, v15
    v_add_f32 v18, v14, v16
    v_sub_f32 v13, v15, v13
    v_sub_f32 v14, v16, v14
    v_add_f32 v23, v19, v21
    v_add_f32 v24, v20, v22
    v_sub_f32 v19, v21, v19
    v_sub_f32 v20, v22, v20
    v_cvt_pk_bf16_f32 v30, v17, v18
    v_cvt_pk_bf16_f32 v38, v13, v14
    v_cvt_pk_bf16_f32 v31, v23, v24
    v_cvt_pk_bf16_f32 v39, v19, v20
    v_lshlrev_b32 v13, 16, v72
    v_and_b32 v14, s51, v72
    v_lshlrev_b32 v15, 16, v76
    v_and_b32 v16, s51, v76
    v_lshlrev_b32 v19, 16, v73
    v_and_b32 v20, s51, v73
    v_lshlrev_b32 v21, 16, v77
    v_and_b32 v22, s51, v77
    v_add_f32 v17, v13, v15
    v_add_f32 v18, v14, v16
    v_sub_f32 v13, v15, v13
    v_sub_f32 v14, v16, v14
    v_add_f32 v23, v19, v21
    v_add_f32 v24, v20, v22
    v_sub_f32 v19, v21, v19
    v_sub_f32 v20, v22, v20
    v_cvt_pk_bf16_f32 v32, v17, v18
    v_cvt_pk_bf16_f32 v40, v13, v14
    v_cvt_pk_bf16_f32 v33, v23, v24
    v_cvt_pk_bf16_f32 v41, v19, v20
    ds_write_b128 v8, v[30:33] offset:45056
L_WIw:
    ds_read_b128 v[20:23], v252 offset:496
    s_waitcnt lgkmcnt(0)
    v_and_b32 v20, v20, v21
    v_and_b32 v22, v22, v23
    v_and_b32 v20, v20, v22
    s_nop 0
    v_readfirstlane_b32 s47, v20
    s_cmp_eq_u32 s47, 1
    s_cbranch_scc1 L_WIw_ok
    s_sleep 2
    s_branch L_WIw
L_WIw_ok:
    buffer_load_dwordx4 v[98:101], v1, s[4:7], 0 offen offset:128
    buffer_load_dwordx4 v[106:109], v2, s[4:7], 0 offen offset:512
    buffer_load_dwordx4 v[114:117], v2, s[4:7], 0 offen offset:1280
    buffer_load_dwordx4 v[122:125], v2, s[4:7], 0 offen offset:2048
    buffer_load_dwordx4 v[130:133], v2, s[4:7], 0 offen offset:2816
    buffer_load_dwordx4 v[102:105], v2, s[4:7], 0 offen offset:128
    buffer_load_dwordx4 v[110:113], v2, s[4:7], 0 offen offset:896
    buffer_load_dwordx4 v[118:121], v2, s[4:7], 0 offen offset:1664
    buffer_load_dwordx4 v[126:129], v2, s[4:7], 0 offen offset:2432
    buffer_load_dwordx4 v[134:137], v3, s[4:7], 0 offen offset:128
    v_lshlrev_b32 v13, 16, v78
    v_and_b32 v14, s51, v78
    v_lshlrev_b32 v15, 16, v82
    v_and_b32 v16, s51, v82
    v_lshlrev_b32 v19, 16, v79
    v_and_b32 v20, s51, v79
    v_lshlrev_b32 v21, 16, v83
    v_and_b32 v22, s51, v83
    v_add_f32 v17, v13, v15
    v_add_f32 v18, v14, v16
    v_sub_f32 v13, v15, v13
    v_sub_f32 v14, v16, v14
    v_add_f32 v23, v19, v21
    v_add_f32 v24, v20, v22
    v_sub_f32 v19, v21, v19
    v_sub_f32 v20, v22, v20
    v_cvt_pk_bf16_f32 v26, v17, v18
    v_cvt_pk_bf16_f32 v42, v13, v14
    v_cvt_pk_bf16_f32 v27, v23, v24
    v_cvt_pk_bf16_f32 v43, v19, v20
    v_lshlrev_b32 v13, 16, v80
    v_and_b32 v14, s51, v80
    v_lshlrev_b32 v15, 16, v84
    v_and_b32 v16, s51, v84
    v_lshlrev_b32 v19, 16, v81
    v_and_b32 v20, s51, v81
    v_lshlrev_b32 v21, 16, v85
    v_and_b32 v22, s51, v85
    v_add_f32 v17, v13, v15
    v_add_f32 v18, v14, v16
    v_sub_f32 v13, v15, v13
    v_sub_f32 v14, v16, v14
    v_add_f32 v23, v19, v21
    v_add_f32 v24, v20, v22
    v_sub_f32 v19, v21, v19
    v_sub_f32 v20, v22, v20
    v_cvt_pk_bf16_f32 v28, v17, v18
    v_cvt_pk_bf16_f32 v44, v13, v14
    v_cvt_pk_bf16_f32 v29, v23, v24
    v_cvt_pk_bf16_f32 v45, v19, v20
    ds_write_b128 v9, v[26:29] offset:45056
    v_lshlrev_b32 v13, 16, v86
    v_and_b32 v14, s51, v86
    v_lshlrev_b32 v15, 16, v90
    v_and_b32 v16, s51, v90
    v_lshlrev_b32 v19, 16, v87
    v_and_b32 v20, s51, v87
    v_lshlrev_b32 v21, 16, v91
    v_and_b32 v22, s51, v91
    v_add_f32 v17, v13, v15
    v_add_f32 v18, v14, v16
    v_sub_f32 v13, v15, v13
    v_sub_f32 v14, v16, v14
    v_add_f32 v23, v19, v21
    v_add_f32 v24, v20, v22
    v_sub_f32 v19, v21, v19
    v_sub_f32 v20, v22, v20
    v_cvt_pk_bf16_f32 v30, v17, v18
    v_cvt_pk_bf16_f32 v46, v13, v14
    v_cvt_pk_bf16_f32 v31, v23, v24
    v_cvt_pk_bf16_f32 v47, v19, v20
    v_lshlrev_b32 v13, 16, v88
    v_and_b32 v14, s51, v88
    v_lshlrev_b32 v15, 16, v92
    v_and_b32 v16, s51, v92
    v_lshlrev_b32 v19, 16, v89
    v_and_b32 v20, s51, v89
    v_lshlrev_b32 v21, 16, v93
    v_and_b32 v22, s51, v93
    v_add_f32 v17, v13, v15
    v_add_f32 v18, v14, v16
    v_sub_f32 v13, v15, v13
    v_sub_f32 v14, v16, v14
    v_add_f32 v23, v19, v21
    v_add_f32 v24, v20, v22
    v_sub_f32 v19, v21, v19
    v_sub_f32 v20, v22, v20
    v_cvt_pk_bf16_f32 v32, v17, v18
    v_cvt_pk_bf16_f32 v48, v13, v14
    v_cvt_pk_bf16_f32 v33, v23, v24
    v_cvt_pk_bf16_f32 v49, v19, v20
    ds_write_b128 v10, v[30:33] offset:45056
    s_cmp_eq_u32 s56, 0
    s_cbranch_scc1 L_PLw0_skip
    s_getreg_b32 s47, hwreg(HW_REG_HW_ID, 8, 1)
    s_cmp_eq_u32 s47, 0
    s_mov_b32 s57, 0x004080c0
    s_cselect_b32 s57, 0x0040c080, s57
    s_and_b32 s47, s57, 255
    s_load_dword s3, s[24:25], s47
L_PLw0_skip:
    s_cmp_eq_u32 s56, 0
    s_cbranch_scc1 L_PLw1_skip
    s_waitcnt lgkmcnt(0)
    s_mov_b32 s58, 1
    v_mov_b32 v255, 0
L_PLw1:
    s_cmp_ge_u32 s3, 56
    s_cbranch_scc1 L_PLw1_ok
    s_sleep 4
    s_cmp_ge_u32 s58, 4
    s_cbranch_scc1 L_PLw1_v
    s_lshr_b32 s57, s57, 8
    s_and_b32 s47, s57, 255
    s_load_dword s3, s[24:25], s47
    s_add_u32 s58, s58, 1
    s_waitcnt lgkmcnt(0)
    s_branch L_PLw1
L_PLw1_v:
    global_load_dword v254, v255, s[24:25] offset:128 sc1
    s_add_u32 s58, s58, 1
    s_waitcnt vmcnt(0)
    v_readfirstlane_b32 s3, v254
    s_cmp_lt_u32 s58, 20000
    s_cbranch_scc1 L_PLw1
L_PLw1_ok:
    ds_write_b32 v250, v251
    s_mov_b32 s56, 0
    s_cmp_eq_u32 s55, 3
    s_cbranch_scc0 L_UPw2_1
    s_mov_b32 s48, 0
    buffer_load_dword v254, v253, s[16:19], s48 offen sc1
L_UPw2_1:
L_PLw1_skip:
    s_mov_b64 exec, 1
    ds_add_u32 v252, v251 offset:456
    s_mov_b64 exec, -1
L_FRw3:
    ds_read_b128 v[16:19], v252 offset:256
    s_waitcnt lgkmcnt(0)
    v_and_b32 v16, v16, v17
    v_and_b32 v18, v18, v19
    v_and_b32 v16, v16, v18
    s_nop 0
    v_readfirstlane_b32 s47, v16
    s_cmp_eq_u32 s47, 1
    s_cbranch_scc1 L_FRw3_ok
    s_sleep 2
    s_branch L_FRw3
L_FRw3_ok:
    s_cmp_eq_u32 s55, 3
    s_cbranch_scc0 L_UPw3
    s_mov_b32 s48, 221184
    buffer_load_dword v254, v253, s[16:19], s48 offen sc1
L_UPw3:
    ds_write_b128 v7, v[34:37] offset:0
    ds_write_b128 v8, v[38:41] offset:0
    ds_write_b128 v9, v[42:45] offset:0
    ds_write_b128 v10, v[46:49] offset:0
    s_mov_b64 exec, 1
    ds_add_u32 v252, v251 offset:460
    s_mov_b64 exec, -1
    s_waitcnt vmcnt(0)
    v_lshlrev_b32 v13, 16, v102
    v_and_b32 v14, s51, v102
    v_lshlrev_b32 v15, 16, v106
    v_and_b32 v16, s51, v106
    v_lshlrev_b32 v19, 16, v103
    v_and_b32 v20, s51, v103
    v_lshlrev_b32 v21, 16, v107
    v_and_b32 v22, s51, v107
    v_add_f32 v17, v13, v15
    v_add_f32 v18, v14, v16
    v_sub_f32 v13, v15, v13
    v_sub_f32 v14, v16, v14
    v_add_f32 v23, v19, v21
    v_add_f32 v24, v20, v22
    v_sub_f32 v19, v21, v19
    v_sub_f32 v20, v22, v20
    v_cvt_pk_bf16_f32 v26, v17, v18
    v_cvt_pk_bf16_f32 v34, v13, v14
    v_cvt_pk_bf16_f32 v27, v23, v24
    v_cvt_pk_bf16_f32 v35, v19, v20
    v_lshlrev_b32 v13, 16, v104
    v_and_b32 v14, s51, v104
    v_lshlrev_b32 v15, 16, v108
    v_and_b32 v16, s51, v108
    v_lshlrev_b32 v19, 16, v105
    v_and_b32 v20, s51, v105
    v_lshlrev_b32 v21, 16, v109
    v_and_b32 v22, s51, v109
    v_add_f32 v17, v13, v15
    v_add_f32 v18, v14, v16
    v_sub_f32 v13, v15, v13
    v_sub_f32 v14, v16, v14
    v_add_f32 v23, v19, v21
    v_add_f32 v24, v20, v22
    v_sub_f32 v19, v21, v19
    v_sub_f32 v20, v22, v20
    v_cvt_pk_bf16_f32 v28, v17, v18
    v_cvt_pk_bf16_f32 v36, v13, v14
    v_cvt_pk_bf16_f32 v29, v23, v24
    v_cvt_pk_bf16_f32 v37, v19, v20
L_FRw4:
    ds_read_b128 v[16:19], v252 offset:272
    s_waitcnt lgkmcnt(0)
    v_and_b32 v16, v16, v17
    v_and_b32 v18, v18, v19
    v_and_b32 v16, v16, v18
    s_nop 0
    v_readfirstlane_b32 s47, v16
    s_cmp_eq_u32 s47, 1
    s_cbranch_scc1 L_FRw4_ok
    s_sleep 2
    s_branch L_FRw4
L_FRw4_ok:
    s_cmp_eq_u32 s55, 3
    s_cbranch_scc0 L_UPw4
    s_mov_b32 s48, 73728
    buffer_load_dword v254, v253, s[16:19], s48 offen sc1
L_UPw4:
    ds_write_b128 v7, v[26:29] offset:22528
    v_lshlrev_b32 v13, 16, v110
    v_and_b32 v14, s51, v110
    v_lshlrev_b32 v15, 16, v114
    v_and_b32 v16, s51, v114
    v_lshlrev_b32 v19, 16, v111
    v_and_b32 v20, s51, v111
    v_lshlrev_b32 v21, 16, v115
    v_and_b32 v22, s51, v115
    v_add_f32 v17, v13, v15
    v_add_f32 v18, v14, v16
    v_sub_f32 v13, v15, v13
    v_sub_f32 v14, v16, v14
    v_add_f32 v23, v19, v21
    v_add_f32 v24, v20, v22
    v_sub_f32 v19, v21, v19
    v_sub_f32 v20, v22, v20
    v_cvt_pk_bf16_f32 v30, v17, v18
    v_cvt_pk_bf16_f32 v38, v13, v14
    v_cvt_pk_bf16_f32 v31, v23, v24
    v_cvt_pk_bf16_f32 v39, v19, v20
    v_lshlrev_b32 v13, 16, v112
    v_and_b32 v14, s51, v112
    v_lshlrev_b32 v15, 16, v116
    v_and_b32 v16, s51, v116
    buffer_load_dwordx4 v[138:141], v1, s[4:7], 0 offen offset:256
    v_lshlrev_b32 v19, 16, v113
    v_and_b32 v20, s51, v113
    v_lshlrev_b32 v21, 16, v117
    v_and_b32 v22, s51, v117
    v_add_f32 v17, v13, v15
    v_add_f32 v18, v14, v16
    v_sub_f32 v13, v15, v13
    v_sub_f32 v14, v16, v14
    v_add_f32 v23, v19, v21
    v_add_f32 v24, v20, v22
    v_sub_f32 v19, v21, v19
    v_sub_f32 v20, v22, v20
    v_cvt_pk_bf16_f32 v32, v17, v18
    v_cvt_pk_bf16_f32 v40, v13, v14
    v_cvt_pk_bf16_f32 v33, v23, v24
    v_cvt_pk_bf16_f32 v41, v19, v20
    ds_write_b128 v8, v[30:33] offset:22528
    v_lshlrev_b32 v13, 16, v118
    v_and_b32 v14, s51, v118
    v_lshlrev_b32 v15, 16, v122
    v_and_b32 v16, s51, v122
    v_lshlrev_b32 v19, 16, v119
    v_and_b32 v20, s51, v119
    v_lshlrev_b32 v21, 16, v123
    v_and_b32 v22, s51, v123
    buffer_load_dwordx4 v[146:149], v2, s[4:7], 0 offen offset:640
    v_add_f32 v17, v13, v15
    v_add_f32 v18, v14, v16
    v_sub_f32 v13, v15, v13
    v_sub_f32 v14, v16, v14
    v_add_f32 v23, v19, v21
    v_add_f32 v24, v20, v22
    v_sub_f32 v19, v21, v19
    v_sub_f32 v20, v22, v20
    v_cvt_pk_bf16_f32 v26, v17, v18
    v_cvt_pk_bf16_f32 v42, v13, v14
    v_cvt_pk_bf16_f32 v27, v23, v24
    v_cvt_pk_bf16_f32 v43, v19, v20
    v_lshlrev_b32 v13, 16, v120
    v_and_b32 v14, s51, v120
    v_lshlrev_b32 v15, 16, v124
    v_and_b32 v16, s51, v124
    v_lshlrev_b32 v19, 16, v121
    v_and_b32 v20, s51, v121
    v_lshlrev_b32 v21, 16, v125
    v_and_b32 v22, s51, v125
    v_add_f32 v17, v13, v15
    v_add_f32 v18, v14, v16
    v_sub_f32 v13, v15, v13
    v_sub_f32 v14, v16, v14
    buffer_load_dwordx4 v[154:157], v2, s[4:7], 0 offen offset:1408
    v_add_f32 v23, v19, v21
    v_add_f32 v24, v20, v22
    v_sub_f32 v19, v21, v19
    v_sub_f32 v20, v22, v20
    v_cvt_pk_bf16_f32 v28, v17, v18
    v_cvt_pk_bf16_f32 v44, v13, v14
    v_cvt_pk_bf16_f32 v29, v23, v24
    v_cvt_pk_bf16_f32 v45, v19, v20
    ds_write_b128 v9, v[26:29] offset:22528
    v_lshlrev_b32 v13, 16, v126
    v_and_b32 v14, s51, v126
    v_lshlrev_b32 v15, 16, v130
    v_and_b32 v16, s51, v130
    v_lshlrev_b32 v19, 16, v127
    v_and_b32 v20, s51, v127
    v_lshlrev_b32 v21, 16, v131
    v_and_b32 v22, s51, v131
    v_add_f32 v17, v13, v15
    v_add_f32 v18, v14, v16
    v_sub_f32 v13, v15, v13
    v_sub_f32 v14, v16, v14
    v_add_f32 v23, v19, v21
    v_add_f32 v24, v20, v22
    v_sub_f32 v19, v21, v19
    v_sub_f32 v20, v22, v20
    buffer_load_dwordx4 v[162:165], v2, s[4:7], 0 offen offset:2176
    v_cvt_pk_bf16_f32 v30, v17, v18
    v_cvt_pk_bf16_f32 v46, v13, v14
    v_cvt_pk_bf16_f32 v31, v23, v24
    v_cvt_pk_bf16_f32 v47, v19, v20
    v_lshlrev_b32 v13, 16, v128
    v_and_b32 v14, s51, v128
    v_lshlrev_b32 v15, 16, v132
    v_and_b32 v16, s51, v132
    v_lshlrev_b32 v19, 16, v129
    v_and_b32 v20, s51, v129
    v_lshlrev_b32 v21, 16, v133
    v_and_b32 v22, s51, v133
    v_add_f32 v17, v13, v15
    v_add_f32 v18, v14, v16
    v_sub_f32 v13, v15, v13
    v_sub_f32 v14, v16, v14
    v_add_f32 v23, v19, v21
    v_add_f32 v24, v20, v22
    v_sub_f32 v19, v21, v19
    v_sub_f32 v20, v22, v20
    v_cvt_pk_bf16_f32 v32, v17, v18
    v_cvt_pk_bf16_f32 v48, v13, v14
    v_cvt_pk_bf16_f32 v33, v23, v24
    v_cvt_pk_bf16_f32 v49, v19, v20
    buffer_load_dwordx4 v[170:173], v2, s[4:7], 0 offen offset:2944
    ds_write_b128 v10, v[30:33] offset:22528
    s_mov_b64 exec, 1
    ds_add_u32 v252, v251 offset:464
    s_mov_b64 exec, -1
L_FRw5:
    ds_read_b128 v[16:19], v252 offset:288
    s_waitcnt lgkmcnt(0)
    v_and_b32 v16, v16, v17
    v_and_b32 v18, v18, v19
    v_and_b32 v16, v16, v18
    s_nop 0
    v_readfirstlane_b32 s47, v16
    s_cmp_eq_u32 s47, 1
    s_cbranch_scc1 L_FRw5_ok
    s_sleep 2
    s_branch L_FRw5
L_FRw5_ok:
    s_cmp_eq_u32 s55, 3
    s_cbranch_scc0 L_UPw5
    s_mov_b32 s48, 294912
    buffer_load_dword v254, v253, s[16:19], s48 offen sc1
L_UPw5:
    ds_write_b128 v7, v[34:37] offset:45056
    ds_write_b128 v8, v[38:41] offset:45056
    ds_write_b128 v9, v[42:45] offset:45056
    ds_write_b128 v10, v[46:49] offset:45056
    s_mov_b64 exec, 1
    ds_add_u32 v252, v251 offset:468
    s_mov_b64 exec, -1
    buffer_load_dwordx4 v[142:145], v2, s[4:7], 0 offen offset:256
    buffer_load_dwordx4 v[150:153], v2, s[4:7], 0 offen offset:1024
    buffer_load_dwordx4 v[158:161], v2, s[4:7], 0 offen offset:1792
    buffer_load_dwordx4 v[166:169], v2, s[4:7], 0 offen offset:2560
    buffer_load_dwordx4 v[174:177], v3, s[4:7], 0 offen offset:256
    s_waitcnt vmcnt(0)
    v_lshlrev_b32 v13, 16, v142
    v_and_b32 v14, s51, v142
    v_lshlrev_b32 v15, 16, v146
    v_and_b32 v16, s51, v146
    v_lshlrev_b32 v19, 16, v143
    v_and_b32 v20, s51, v143
    v_lshlrev_b32 v21, 16, v147
    v_and_b32 v22, s51, v147
    v_add_f32 v17, v13, v15
    v_add_f32 v18, v14, v16
    v_sub_f32 v13, v15, v13
    v_sub_f32 v14, v16, v14
    v_add_f32 v23, v19, v21
    v_add_f32 v24, v20, v22
    v_sub_f32 v19, v21, v19
    v_sub_f32 v20, v22, v20
    v_cvt_pk_bf16_f32 v26, v17, v18
    v_cvt_pk_bf16_f32 v34, v13, v14
    v_cvt_pk_bf16_f32 v27, v23, v24
    v_cvt_pk_bf16_f32 v35, v19, v20
    v_lshlrev_b32 v13, 16, v144
    v_and_b32 v14, s51, v144
    v_lshlrev_b32 v15, 16, v148
    v_and_b32 v16, s51, v148
    v_lshlrev_b32 v19, 16, v145
    v_and_b32 v20, s51, v145
    v_lshlrev_b32 v21, 16, v149
    v_and_b32 v22, s51, v149
    v_add_f32 v17, v13, v15
    v_add_f32 v18, v14, v16
    v_sub_f32 v13, v15, v13
    v_sub_f32 v14, v16, v14
    v_add_f32 v23, v19, v21
    v_add_f32 v24, v20, v22
    v_sub_f32 v19, v21, v19
    v_sub_f32 v20, v22, v20
    v_cvt_pk_bf16_f32 v28, v17, v18
    v_cvt_pk_bf16_f32 v36, v13, v14
    v_cvt_pk_bf16_f32 v29, v23, v24
    v_cvt_pk_bf16_f32 v37, v19, v20
L_FRw6:
    ds_read_b128 v[16:19], v252 offset:304
    s_waitcnt lgkmcnt(0)
    v_and_b32 v16, v16, v17
    v_and_b32 v18, v18, v19
    v_and_b32 v16, v16, v18
    s_nop 0
    v_readfirstlane_b32 s47, v16
    s_cmp_eq_u32 s47, 1
    s_cbranch_scc1 L_FRw6_ok
    s_sleep 2
    s_branch L_FRw6
L_FRw6_ok:
    s_cmp_eq_u32 s55, 3
    s_cbranch_scc0 L_UPw6
    s_mov_b32 s48, 147456
    buffer_load_dword v254, v253, s[16:19], s48 offen sc1
L_UPw6:
    ds_write_b128 v7, v[26:29] offset:0
    v_lshlrev_b32 v13, 16, v150
    v_and_b32 v14, s51, v150
    v_lshlrev_b32 v15, 16, v154
    v_and_b32 v16, s51, v154
    v_lshlrev_b32 v19, 16, v151
    v_and_b32 v20, s51, v151
    v_lshlrev_b32 v21, 16, v155
    v_and_b32 v22, s51, v155
    v_add_f32 v17, v13, v15
    v_add_f32 v18, v14, v16
    v_sub_f32 v13, v15, v13
    v_sub_f32 v14, v16, v14
    v_add_f32 v23, v19, v21
    v_add_f32 v24, v20, v22
    v_sub_f32 v19, v21, v19
    v_sub_f32 v20, v22, v20
    v_cvt_pk_bf16_f32 v30, v17, v18
    v_cvt_pk_bf16_f32 v38, v13, v14
    v_cvt_pk_bf16_f32 v31, v23, v24
    v_cvt_pk_bf16_f32 v39, v19, v20
    v_lshlrev_b32 v13, 16, v152
    v_and_b32 v14, s51, v152
    v_lshlrev_b32 v15, 16, v156
    v_and_b32 v16, s51, v156
    v_lshlrev_b32 v19, 16, v153
    v_and_b32 v20, s51, v153
    v_lshlrev_b32 v21, 16, v157
    v_and_b32 v22, s51, v157
    v_add_f32 v17, v13, v15
    v_add_f32 v18, v14, v16
    v_sub_f32 v13, v15, v13
    v_sub_f32 v14, v16, v14
    v_add_f32 v23, v19, v21
    v_add_f32 v24, v20, v22
    v_sub_f32 v19, v21, v19
    v_sub_f32 v20, v22, v20
    v_cvt_pk_bf16_f32 v32, v17, v18
    v_cvt_pk_bf16_f32 v40, v13, v14
    v_cvt_pk_bf16_f32 v33, v23, v24
    v_cvt_pk_bf16_f32 v41, v19, v20
    ds_write_b128 v8, v[30:33] offset:0
    v_lshlrev_b32 v13, 16, v158
    v_and_b32 v14, s51, v158
    v_lshlrev_b32 v15, 16, v162
    v_and_b32 v16, s51, v162
    v_lshlrev_b32 v19, 16, v159
    v_and_b32 v20, s51, v159
    v_lshlrev_b32 v21, 16, v163
    v_and_b32 v22, s51, v163
    v_add_f32 v17, v13, v15
    v_add_f32 v18, v14, v16
    v_sub_f32 v13, v15, v13
    v_sub_f32 v14, v16, v14
    v_add_f32 v23, v19, v21
    v_add_f32 v24, v20, v22
    v_sub_f32 v19, v21, v19
    v_sub_f32 v20, v22, v20
    v_cvt_pk_bf16_f32 v26, v17, v18
    v_cvt_pk_bf16_f32 v42, v13, v14
    v_cvt_pk_bf16_f32 v27, v23, v24
    v_cvt_pk_bf16_f32 v43, v19, v20
    v_lshlrev_b32 v13, 16, v160
    v_and_b32 v14, s51, v160
    v_lshlrev_b32 v15, 16, v164
    v_and_b32 v16, s51, v164
    v_lshlrev_b32 v19, 16, v161
    v_and_b32 v20, s51, v161
    v_lshlrev_b32 v21, 16, v165
    v_and_b32 v22, s51, v165
    v_add_f32 v17, v13, v15
    v_add_f32 v18, v14, v16
    v_sub_f32 v13, v15, v13
    v_sub_f32 v14, v16, v14
    v_add_f32 v23, v19, v21
    v_add_f32 v24, v20, v22
    v_sub_f32 v19, v21, v19
    v_sub_f32 v20, v22, v20
    v_cvt_pk_bf16_f32 v28, v17, v18
    v_cvt_pk_bf16_f32 v44, v13, v14
    v_cvt_pk_bf16_f32 v29, v23, v24
    v_cvt_pk_bf16_f32 v45, v19, v20
    ds_write_b128 v9, v[26:29] offset:0
    v_lshlrev_b32 v13, 16, v166
    v_and_b32 v14, s51, v166
    v_lshlrev_b32 v15, 16, v170
    v_and_b32 v16, s51, v170
    v_lshlrev_b32 v19, 16, v167
    v_and_b32 v20, s51, v167
    v_lshlrev_b32 v21, 16, v171
    v_and_b32 v22, s51, v171
    v_add_f32 v17, v13, v15
    v_add_f32 v18, v14, v16
    v_sub_f32 v13, v15, v13
    v_sub_f32 v14, v16, v14
    v_add_f32 v23, v19, v21
    v_add_f32 v24, v20, v22
    v_sub_f32 v19, v21, v19
    v_sub_f32 v20, v22, v20
    v_cvt_pk_bf16_f32 v30, v17, v18
    v_cvt_pk_bf16_f32 v46, v13, v14
    v_cvt_pk_bf16_f32 v31, v23, v24
    v_cvt_pk_bf16_f32 v47, v19, v20
    v_lshlrev_b32 v13, 16, v168
    v_and_b32 v14, s51, v168
    v_lshlrev_b32 v15, 16, v172
    v_and_b32 v16, s51, v172
    v_lshlrev_b32 v19, 16, v169
    v_and_b32 v20, s51, v169
    v_lshlrev_b32 v21, 16, v173
    v_and_b32 v22, s51, v173
    v_add_f32 v17, v13, v15
    v_add_f32 v18, v14, v16
    v_sub_f32 v13, v15, v13
    v_sub_f32 v14, v16, v14
    v_add_f32 v23, v19, v21
    v_add_f32 v24, v20, v22
    v_sub_f32 v19, v21, v19
    v_sub_f32 v20, v22, v20
    v_cvt_pk_bf16_f32 v32, v17, v18
    v_cvt_pk_bf16_f32 v48, v13, v14
    v_cvt_pk_bf16_f32 v33, v23, v24
    v_cvt_pk_bf16_f32 v49, v19, v20
    ds_write_b128 v10, v[30:33] offset:0
    s_mov_b64 exec, 1
    ds_add_u32 v252, v251 offset:472
    s_mov_b64 exec, -1
L_FRw7:
    ds_read_b128 v[16:19], v252 offset:320
    s_waitcnt lgkmcnt(0)
    v_and_b32 v16, v16, v17
    v_and_b32 v18, v18, v19
    v_and_b32 v16, v16, v18
    s_nop 0
    v_readfirstlane_b32 s47, v16
    s_cmp_eq_u32 s47, 1
    s_cbranch_scc1 L_FRw7_ok
    s_sleep 2
    s_branch L_FRw7
L_FRw7_ok:
    s_cmp_eq_u32 s55, 3
    s_cbranch_scc0 L_UPw7
    s_mov_b32 s48, 368640
    buffer_load_dword v254, v253, s[16:19], s48 offen sc1
L_UPw7:
    ds_write_b128 v7, v[34:37] offset:22528
    ds_write_b128 v8, v[38:41] offset:22528
    ds_write_b128 v9, v[42:45] offset:22528
    ds_write_b128 v10, v[46:49] offset:22528
    s_mov_b64 exec, 1
    ds_add_u32 v252, v251 offset:476
    s_mov_b64 exec, -1
    v_lshlrev_b32 v13, 16, v98
    v_and_b32 v14, s51, v98
    v_lshlrev_b32 v15, 16, v99
    v_and_b32 v16, s51, v99
    v_lshlrev_b32 v17, 16, v100
    v_and_b32 v18, s51, v100
    v_lshlrev_b32 v19, 16, v101
    v_and_b32 v20, s51, v101
    v_lshlrev_b32 v21, 16, v106
    v_and_b32 v22, s51, v106
    v_lshlrev_b32 v23, 16, v107
    v_and_b32 v24, s51, v107
    v_lshlrev_b32 v25, 16, v108
    v_and_b32 v54, s51, v108
    v_lshlrev_b32 v55, 16, v109
    v_and_b32 v56, s51, v109
    v_sub_f32 v13, v13, v21
    v_sub_f32 v14, v14, v22
    v_sub_f32 v15, v15, v23
    v_sub_f32 v16, v16, v24
    v_sub_f32 v17, v17, v25
    v_sub_f32 v18, v18, v54
    v_sub_f32 v19, v19, v55
    v_sub_f32 v20, v20, v56
    v_cvt_pk_bf16_f32 v26, v13, v14
    v_cvt_pk_bf16_f32 v27, v15, v16
    v_cvt_pk_bf16_f32 v28, v17, v18
    v_cvt_pk_bf16_f32 v29, v19, v20
L_FRw8:
    ds_read_b128 v[44:47], v252 offset:336
    s_waitcnt lgkmcnt(0)
    v_and_b32 v44, v44, v45
    v_and_b32 v46, v46, v47
    v_and_b32 v44, v44, v46
    s_nop 0
    v_readfirstlane_b32 s47, v44
    s_cmp_eq_u32 s47, 1
    s_cbranch_scc1 L_FRw8_ok
    s_sleep 2
    s_branch L_FRw8
L_FRw8_ok:
    s_cmp_eq_u32 s55, 3
    s_cbranch_scc0 L_UPw8
    s_mov_b32 s48, 516096
    buffer_load_dword v254, v253, s[16:19], s48 offen sc1
L_UPw8:
    ds_write_b128 v7, v[26:29] offset:45056
    v_lshlrev_b32 v13, 16, v114
    v_and_b32 v14, s51, v114
    v_lshlrev_b32 v15, 16, v115
    v_and_b32 v16, s51, v115
    v_lshlrev_b32 v17, 16, v116
    v_and_b32 v18, s51, v116
    v_lshlrev_b32 v19, 16, v117
    v_and_b32 v20, s51, v117
    v_sub_f32 v21, v21, v13
    v_sub_f32 v22, v22, v14
    v_sub_f32 v23, v23, v15
    v_sub_f32 v24, v24, v16
    v_sub_f32 v25, v25, v17
    v_sub_f32 v54, v54, v18
    v_sub_f32 v55, v55, v19
    v_sub_f32 v56, v56, v20
    v_cvt_pk_bf16_f32 v30, v21, v22
    v_cvt_pk_bf16_f32 v31, v23, v24
    v_cvt_pk_bf16_f32 v32, v25, v54
    v_cvt_pk_bf16_f32 v33, v55, v56
    ds_write_b128 v8, v[30:33] offset:45056
    v_lshlrev_b32 v21, 16, v122
    v_and_b32 v22, s51, v122
    v_lshlrev_b32 v23, 16, v123
    v_and_b32 v24, s51, v123
    v_lshlrev_b32 v25, 16, v124
    v_and_b32 v54, s51, v124
    v_lshlrev_b32 v55, 16, v125
    v_and_b32 v56, s51, v125
    v_sub_f32 v13, v13, v21
    v_sub_f32 v14, v14, v22
    v_sub_f32 v15, v15, v23
    v_sub_f32 v16, v16, v24
    v_sub_f32 v17, v17, v25
    v_sub_f32 v18, v18, v54
    v_sub_f32 v19, v19, v55
    v_sub_f32 v20, v20, v56
    v_cvt_pk_bf16_f32 v26, v13, v14
    v_cvt_pk_bf16_f32 v27, v15, v16
    v_cvt_pk_bf16_f32 v28, v17, v18
    v_cvt_pk_bf16_f32 v29, v19, v20
    ds_write_b128 v9, v[26:29] offset:45056
    v_lshlrev_b32 v13, 16, v130
    v_and_b32 v14, s51, v130
    v_lshlrev_b32 v15, 16, v131
    v_and_b32 v16, s51, v131
    v_lshlrev_b32 v17, 16, v132
    v_and_b32 v18, s51, v132
    v_lshlrev_b32 v19, 16, v133
    v_and_b32 v20, s51, v133
    v_sub_f32 v21, v21, v13
    v_sub_f32 v22, v22, v14
    v_sub_f32 v23, v23, v15
    v_sub_f32 v24, v24, v16
    v_sub_f32 v25, v25, v17
    v_sub_f32 v54, v54, v18
    v_sub_f32 v55, v55, v19
    v_sub_f32 v56, v56, v20
    v_cvt_pk_bf16_f32 v30, v21, v22
    v_cvt_pk_bf16_f32 v31, v23, v24
    v_cvt_pk_bf16_f32 v32, v25, v54
    v_cvt_pk_bf16_f32 v33, v55, v56
    ds_write_b128 v10, v[30:33] offset:45056
    s_mov_b64 exec, 1
    ds_add_u32 v252, v251 offset:480
    s_mov_b64 exec, -1
    v_lshlrev_b32 v13, 16, v138
    v_and_b32 v14, s51, v138
    v_lshlrev_b32 v15, 16, v139
    v_and_b32 v16, s51, v139
    v_lshlrev_b32 v17, 16, v140
    v_and_b32 v18, s51, v140
    v_lshlrev_b32 v19, 16, v141
    v_and_b32 v20, s51, v141
    v_lshlrev_b32 v21, 16, v146
    v_and_b32 v22, s51, v146
    v_lshlrev_b32 v23, 16, v147
    v_and_b32 v24, s51, v147
    v_lshlrev_b32 v25, 16, v148
    v_and_b32 v54, s51, v148
    v_lshlrev_b32 v55, 16, v149
    v_and_b32 v56, s51, v149
    v_sub_f32 v13, v13, v21
    v_sub_f32 v14, v14, v22
    v_sub_f32 v15, v15, v23
    v_sub_f32 v16, v16, v24
    v_sub_f32 v17, v17, v25
    v_sub_f32 v18, v18, v54
    v_sub_f32 v19, v19, v55
    v_sub_f32 v20, v20, v56
    v_cvt_pk_bf16_f32 v26, v13, v14
    v_cvt_pk_bf16_f32 v27, v15, v16
    v_cvt_pk_bf16_f32 v28, v17, v18
    v_cvt_pk_bf16_f32 v29, v19, v20
L_FRw9:
    ds_read_b128 v[44:47], v252 offset:352
    s_waitcnt lgkmcnt(0)
    v_and_b32 v44, v44, v45
    v_and_b32 v46, v46, v47
    v_and_b32 v44, v44, v46
    s_nop 0
    v_readfirstlane_b32 s47, v44
    s_cmp_eq_u32 s47, 1
    s_cbranch_scc1 L_FRw9_ok
    s_sleep 2
    s_branch L_FRw9
L_FRw9_ok:
    s_cmp_eq_u32 s55, 3
    s_cbranch_scc0 L_UPw9
    s_mov_b32 s48, 589824
    buffer_load_dword v254, v253, s[16:19], s48 offen sc1
L_UPw9:
    ds_write_b128 v7, v[26:29] offset:0
    v_lshlrev_b32 v13, 16, v154
    v_and_b32 v14, s51, v154
    v_lshlrev_b32 v15, 16, v155
    v_and_b32 v16, s51, v155
    v_lshlrev_b32 v17, 16, v156
    v_and_b32 v18, s51, v156
    v_lshlrev_b32 v19, 16, v157
    v_and_b32 v20, s51, v157
    v_sub_f32 v21, v21, v13
    v_sub_f32 v22, v22, v14
    v_sub_f32 v23, v23, v15
    v_sub_f32 v24, v24, v16
    v_sub_f32 v25, v25, v17
    v_sub_f32 v54, v54, v18
    v_sub_f32 v55, v55, v19
    v_sub_f32 v56, v56, v20
    v_cvt_pk_bf16_f32 v30, v21, v22
    v_cvt_pk_bf16_f32 v31, v23, v24
    v_cvt_pk_bf16_f32 v32, v25, v54
    v_cvt_pk_bf16_f32 v33, v55, v56
    ds_write_b128 v8, v[30:33] offset:0
    v_lshlrev_b32 v21, 16, v162
    v_and_b32 v22, s51, v162
    v_lshlrev_b32 v23, 16, v163
    v_and_b32 v24, s51, v163
    v_lshlrev_b32 v25, 16, v164
    v_and_b32 v54, s51, v164
    v_lshlrev_b32 v55, 16, v165
    v_and_b32 v56, s51, v165
    v_sub_f32 v13, v13, v21
    v_sub_f32 v14, v14, v22
    v_sub_f32 v15, v15, v23
    v_sub_f32 v16, v16, v24
    v_sub_f32 v17, v17, v25
    v_sub_f32 v18, v18, v54
    v_sub_f32 v19, v19, v55
    v_sub_f32 v20, v20, v56
    v_cvt_pk_bf16_f32 v26, v13, v14
    v_cvt_pk_bf16_f32 v27, v15, v16
    v_cvt_pk_bf16_f32 v28, v17, v18
    v_cvt_pk_bf16_f32 v29, v19, v20
    ds_write_b128 v9, v[26:29] offset:0
    v_lshlrev_b32 v13, 16, v170
    v_and_b32 v14, s51, v170
    v_lshlrev_b32 v15, 16, v171
    v_and_b32 v16, s51, v171
    v_lshlrev_b32 v17, 16, v172
    v_and_b32 v18, s51, v172
    v_lshlrev_b32 v19, 16, v173
    v_and_b32 v20, s51, v173
    v_sub_f32 v21, v21, v13
    v_sub_f32 v22, v22, v14
    v_sub_f32 v23, v23, v15
    v_sub_f32 v24, v24, v16
    v_sub_f32 v25, v25, v17
    v_sub_f32 v54, v54, v18
    v_sub_f32 v55, v55, v19
    v_sub_f32 v56, v56, v20
    v_cvt_pk_bf16_f32 v30, v21, v22
    v_cvt_pk_bf16_f32 v31, v23, v24
    v_cvt_pk_bf16_f32 v32, v25, v54
    v_cvt_pk_bf16_f32 v33, v55, v56
    ds_write_b128 v10, v[30:33] offset:0
    s_mov_b64 exec, 1
    ds_add_u32 v252, v251 offset:484
    s_mov_b64 exec, -1
    v_lshlrev_b32 v13, 16, v102
    v_and_b32 v14, s51, v102
    v_lshlrev_b32 v15, 16, v103
    v_and_b32 v16, s51, v103
    v_lshlrev_b32 v17, 16, v104
    v_and_b32 v18, s51, v104
    v_lshlrev_b32 v19, 16, v105
    v_and_b32 v20, s51, v105
    v_lshlrev_b32 v21, 16, v110
    v_and_b32 v22, s51, v110
    v_lshlrev_b32 v23, 16, v111
    v_and_b32 v24, s51, v111
    v_lshlrev_b32 v25, 16, v112
    v_and_b32 v54, s51, v112
    v_lshlrev_b32 v55, 16, v113
    v_and_b32 v56, s51, v113
    v_subrev_f32 v13, v13, v21
    v_subrev_f32 v14, v14, v22
    v_subrev_f32 v15, v15, v23
    v_subrev_f32 v16, v16, v24
    v_subrev_f32 v17, v17, v25
    v_subrev_f32 v18, v18, v54
    v_subrev_f32 v19, v19, v55
    v_subrev_f32 v20, v20, v56
    v_cvt_pk_bf16_f32 v26, v13, v14
    v_cvt_pk_bf16_f32 v27, v15, v16
    v_cvt_pk_bf16_f32 v28, v17, v18
    v_cvt_pk_bf16_f32 v29, v19, v20
L_FRw10:
    ds_read_b128 v[44:47], v252 offset:368
    s_waitcnt lgkmcnt(0)
    v_and_b32 v44, v44, v45
    v_and_b32 v46, v46, v47
    v_and_b32 v44, v44, v46
    s_nop 0
    v_readfirstlane_b32 s47, v44
    s_cmp_eq_u32 s47, 1
    s_cbranch_scc1 L_FRw10_ok
    s_sleep 2
    s_branch L_FRw10
L_FRw10_ok:
    s_cmp_eq_u32 s55, 3
    s_cbranch_scc0 L_UPw10
    s_mov_b32 s48, 737280
    buffer_load_dword v254, v253, s[16:19], s48 offen sc1
L_UPw10:
    ds_write_b128 v7, v[26:29] offset:22528
    v_lshlrev_b32 v13, 16, v118
    v_and_b32 v14, s51, v118
    v_lshlrev_b32 v15, 16, v119
    v_and_b32 v16, s51, v119
    v_lshlrev_b32 v17, 16, v120
    v_and_b32 v18, s51, v120
    v_lshlrev_b32 v19, 16, v121
    v_and_b32 v20, s51, v121
    v_subrev_f32 v21, v21, v13
    v_subrev_f32 v22, v22, v14
    v_subrev_f32 v23, v23, v15
    v_subrev_f32 v24, v24, v16
    v_subrev_f32 v25, v25, v17
    v_subrev_f32 v54, v54, v18
    v_subrev_f32 v55, v55, v19
    v_subrev_f32 v56, v56, v20
    v_cvt_pk_bf16_f32 v30, v21, v22
    v_cvt_pk_bf16_f32 v31, v23, v24
    v_cvt_pk_bf16_f32 v32, v25, v54
    v_cvt_pk_bf16_f32 v33, v55, v56
    ds_write_b128 v8, v[30:33] offset:22528
    v_lshlrev_b32 v21, 16, v126
    v_and_b32 v22, s51, v126
    v_lshlrev_b32 v23, 16, v127
    v_and_b32 v24, s51, v127
    v_lshlrev_b32 v25, 16, v128
    v_and_b32 v54, s51, v128
    v_lshlrev_b32 v55, 16, v129
    v_and_b32 v56, s51, v129
    v_subrev_f32 v13, v13, v21
    v_subrev_f32 v14, v14, v22
    v_subrev_f32 v15, v15, v23
    v_subrev_f32 v16, v16, v24
    v_subrev_f32 v17, v17, v25
    v_subrev_f32 v18, v18, v54
    v_subrev_f32 v19, v19, v55
    v_subrev_f32 v20, v20, v56
    v_cvt_pk_bf16_f32 v26, v13, v14
    v_cvt_pk_bf16_f32 v27, v15, v16
    v_cvt_pk_bf16_f32 v28, v17, v18
    v_cvt_pk_bf16_f32 v29, v19, v20
    ds_write_b128 v9, v[26:29] offset:22528
    v_lshlrev_b32 v13, 16, v134
    v_and_b32 v14, s51, v134
    v_lshlrev_b32 v15, 16, v135
    v_and_b32 v16, s51, v135
    v_lshlrev_b32 v17, 16, v136
    v_and_b32 v18, s51, v136
    v_lshlrev_b32 v19, 16, v137
    v_and_b32 v20, s51, v137
    v_subrev_f32 v21, v21, v13
    v_subrev_f32 v22, v22, v14
    v_subrev_f32 v23, v23, v15
    v_subrev_f32 v24, v24, v16
    v_subrev_f32 v25, v25, v17
    v_subrev_f32 v54, v54, v18
    v_subrev_f32 v55, v55, v19
    v_subrev_f32 v56, v56, v20
    v_cvt_pk_bf16_f32 v30, v21, v22
    v_cvt_pk_bf16_f32 v31, v23, v24
    v_cvt_pk_bf16_f32 v32, v25, v54
    v_cvt_pk_bf16_f32 v33, v55, v56
    ds_write_b128 v10, v[30:33] offset:22528
    s_mov_b64 exec, 1
    ds_add_u32 v252, v251 offset:488
    s_mov_b64 exec, -1
    v_lshlrev_b32 v13, 16, v142
    v_and_b32 v14, s51, v142
    v_lshlrev_b32 v15, 16, v143
    v_and_b32 v16, s51, v143
    v_lshlrev_b32 v17, 16, v144
    v_and_b32 v18, s51, v144
    v_lshlrev_b32 v19, 16, v145
    v_and_b32 v20, s51, v145
    v_lshlrev_b32 v21, 16, v150
    v_and_b32 v22, s51, v150
    v_lshlrev_b32 v23, 16, v151
    v_and_b32 v24, s51, v151
    v_lshlrev_b32 v25, 16, v152
    v_and_b32 v54, s51, v152
    v_lshlrev_b32 v55, 16, v153
    v_and_b32 v56, s51, v153
    v_subrev_f32 v13, v13, v21
    v_subrev_f32 v14, v14, v22
    v_subrev_f32 v15, v15, v23
    v_subrev_f32 v16, v16, v24
    v_subrev_f32 v17, v17, v25
    v_subrev_f32 v18, v18, v54
    v_subrev_f32 v19, v19, v55
    v_subrev_f32 v20, v20, v56
    v_cvt_pk_bf16_f32 v26, v13, v14
    v_cvt_pk_bf16_f32 v27, v15, v16
    v_cvt_pk_bf16_f32 v28, v17, v18
    v_cvt_pk_bf16_f32 v29, v19, v20
L_FRw11:
    ds_read_b128 v[44:47], v252 offset:384
    s_waitcnt lgkmcnt(0)
    v_and_b32 v44, v44, v45
    v_and_b32 v46, v46, v47
    v_and_b32 v44, v44, v46
    s_nop 0
    v_readfirstlane_b32 s47, v44
    s_cmp_eq_u32 s47, 1
    s_cbranch_scc1 L_FRw11_ok
    s_sleep 2
    s_branch L_FRw11
L_FRw11_ok:
    s_cmp_eq_u32 s55, 3
    s_cbranch_scc0 L_UPw11
    s_mov_b32 s48, 811008
    buffer_load_dword v254, v253, s[16:19], s48 offen sc1
L_UPw11:
    ds_write_b128 v7, v[26:29] offset:45056
    v_lshlrev_b32 v13, 16, v158
    v_and_b32 v14, s51, v158
    v_lshlrev_b32 v15, 16, v159
    v_and_b32 v16, s51, v159
    v_lshlrev_b32 v17, 16, v160
    v_and_b32 v18, s51, v160
    v_lshlrev_b32 v19, 16, v161
    v_and_b32 v20, s51, v161
    v_subrev_f32 v21, v21, v13
    v_subrev_f32 v22, v22, v14
    v_subrev_f32 v23, v23, v15
    v_subrev_f32 v24, v24, v16
    v_subrev_f32 v25, v25, v17
    v_subrev_f32 v54, v54, v18
    v_subrev_f32 v55, v55, v19
    v_subrev_f32 v56, v56, v20
    v_cvt_pk_bf16_f32 v30, v21, v22
    v_cvt_pk_bf16_f32 v31, v23, v24
    v_cvt_pk_bf16_f32 v32, v25, v54
    v_cvt_pk_bf16_f32 v33, v55, v56
    ds_write_b128 v8, v[30:33] offset:45056
    v_lshlrev_b32 v21, 16, v166
    v_and_b32 v22, s51, v166
    v_lshlrev_b32 v23, 16, v167
    v_and_b32 v24, s51, v167
    v_lshlrev_b32 v25, 16, v168
    v_and_b32 v54, s51, v168
    v_lshlrev_b32 v55, 16, v169
    v_and_b32 v56, s51, v169
    v_subrev_f32 v13, v13, v21
    v_subrev_f32 v14, v14, v22
    v_subrev_f32 v15, v15, v23
    v_subrev_f32 v16, v16, v24
    v_subrev_f32 v17, v17, v25
    v_subrev_f32 v18, v18, v54
    v_subrev_f32 v19, v19, v55
    v_subrev_f32 v20, v20, v56
    v_cvt_pk_bf16_f32 v26, v13, v14
    v_cvt_pk_bf16_f32 v27, v15, v16
    v_cvt_pk_bf16_f32 v28, v17, v18
    v_cvt_pk_bf16_f32 v29, v19, v20
    ds_write_b128 v9, v[26:29] offset:45056
    v_lshlrev_b32 v13, 16, v174
    v_and_b32 v14, s51, v174
    v_lshlrev_b32 v15, 16, v175
    v_and_b32 v16, s51, v175
    v_lshlrev_b32 v17, 16, v176
    v_and_b32 v18, s51, v176
    v_lshlrev_b32 v19, 16, v177
    v_and_b32 v20, s51, v177
    v_subrev_f32 v21, v21, v13
    v_subrev_f32 v22, v22, v14
    v_subrev_f32 v23, v23, v15
    v_subrev_f32 v24, v24, v16
    v_subrev_f32 v25, v25, v17
    v_subrev_f32 v54, v54, v18
    v_subrev_f32 v55, v55, v19
    v_subrev_f32 v56, v56, v20
    v_cvt_pk_bf16_f32 v30, v21, v22
    v_cvt_pk_bf16_f32 v31, v23, v24
    v_cvt_pk_bf16_f32 v32, v25, v54
    v_cvt_pk_bf16_f32 v33, v55, v56
    ds_write_b128 v10, v[30:33] offset:45056
    s_mov_b64 exec, 1
    ds_add_u32 v252, v251 offset:492
    s_mov_b64 exec, -1
    s_mul_i32 s47, s39, 86016
    s_mul_i32 s48, s38, 12288
    s_add_u32 s47, s47, s48
    s_mul_i32 s48, s55, 3072
    s_add_u32 s47, s47, s48
    s_mul_i32 s48, s55, 1600
    s_add_u32 s48, s48, 68096
    v_add_u32 v13, 0, v0
    v_mul_u32_u24 v14, 1366, v13
    v_lshrrev_b32 v14, 16, v14
    v_mul_u32_u24 v15, 48, v14
    v_sub_u32 v15, v13, v15
    v_lshlrev_b32 v15, 3, v15
    v_mul_u32_u24 v16, 400, v14
    v_add3_u32 v7, v16, v15, s48
    v_mul_u32_u24 v16, 768, v14
    v_add3_u32 v10, v16, v15, s47
    v_add_u32 v20, 38400, v7
    v_add_u32 v13, 64, v0
    v_mul_u32_u24 v14, 1366, v13
    v_lshrrev_b32 v14, 16, v14
    v_mul_u32_u24 v15, 48, v14
    v_sub_u32 v15, v13, v15
    v_lshlrev_b32 v15, 3, v15
    v_mul_u32_u24 v16, 400, v14
    v_add3_u32 v8, v16, v15, s48
    v_mul_u32_u24 v16, 768, v14
    v_add3_u32 v11, v16, v15, s47
    v_add_u32 v21, 38400, v8
    v_add_u32 v13, 128, v0
    v_mul_u32_u24 v14, 1366, v13
    v_lshrrev_b32 v14, 16, v14
    v_mul_u32_u24 v15, 48, v14
    v_sub_u32 v15, v13, v15
    v_lshlrev_b32 v15, 3, v15
    v_mul_u32_u24 v16, 400, v14
    v_add3_u32 v9, v16, v15, s48
    v_mul_u32_u24 v16, 768, v14
    v_add3_u32 v12, v16, v15, s47
    v_add_u32 v22, 38400, v9
    v_add_u32 v13, 0, v0
    v_min_u32 v13, 95, v13
    v_mul_u32_u24 v14, 10923, v13
    v_lshrrev_b32 v14, 18, v14
    v_mul_u32_u24 v15, 24, v14
    v_sub_u32 v15, v13, v15
    v_lshlrev_b32 v15, 4, v15
    v_mul_u32_u24 v16, 400, v14
    v_add3_u32 v1, v16, v15, s48
    v_mul_u32_u24 v16, 768, v14
    v_add3_u32 v3, v16, v15, s47
    v_add_u32 v13, 64, v0
    v_min_u32 v13, 95, v13
    v_mul_u32_u24 v14, 10923, v13
    v_lshrrev_b32 v14, 18, v14
    v_mul_u32_u24 v15, 24, v14
    v_sub_u32 v15, v13, v15
    v_lshlrev_b32 v15, 4, v15
    v_mul_u32_u24 v16, 400, v14
    v_add3_u32 v2, v16, v15, s48
    v_mul_u32_u24 v16, 768, v14
    v_add3_u32 v4, v16, v15, s47
    v_cmp_gt_u32 vcc, 32, v0
    v_mov_b32 v17, s59
    v_add_u32 v250, 38400, v1
    v_cndmask_b32 v4, v17, v4, vcc
    v_add_u32 v251, 38400, v2
    s_lshl_b32 s47, s55, 2
    v_bfe_u32 v13, v0, 3, 2
    v_add_u32 v13, s47, v13
    v_and_b32 v14, 7, v0
    v_mul_u32_u24 v15, 144, v13
    v_lshl_add_u32 v15, v14, 4, v15
    v_add_u32 v5, 144896, v15
    v_mul_u32_u24 v13, 768, v13
    v_lshrrev_b32 v15, 1, v14
    v_mul_u32_u24 v15, 96, v15
    v_and_b32 v14, 1, v14
    v_lshl_add_u32 v15, v14, 4, v15
    s_mul_i32 s47, s42, 86016
    s_mul_i32 s48, s41, 12288
    s_add_u32 s47, s47, s48
    s_lshl_b32 s48, s43, 5
    s_add_u32 s47, s47, s48
    v_add3_u32 v6, v13, v15, s47
    v_cndmask_b32 v6, v17, v6, vcc
L_Fw0_5:
    ds_read_b128 v[16:19], v252 offset:80
    s_waitcnt lgkmcnt(0)
    v_and_b32 v16, v16, v17
    v_and_b32 v18, v18, v19
    v_and_b32 v16, v16, v18
    s_nop 0
    v_readfirstlane_b32 s47, v16
    s_cmp_eq_u32 s47, 1
    s_cbranch_scc1 L_Fw0_5_ok
    s_sleep 2
    s_branch L_Fw0_5
L_Fw0_5_ok:
    ds_read_b64 v[28:29], v7 offset:0
    ds_read_b64 v[30:31], v8 offset:0
    ds_read_b64 v[32:33], v9 offset:0
    ds_read_b64 v[36:37], v7 offset:6400
    ds_read_b64 v[38:39], v8 offset:6400
    ds_read_b64 v[40:41], v9 offset:6400
    ds_read_b64 v[44:45], v7 offset:12800
    ds_read_b64 v[46:47], v8 offset:12800
    ds_read_b64 v[48:49], v9 offset:12800
    ds_read_b64 v[52:53], v7 offset:19200
    ds_read_b64 v[54:55], v8 offset:19200
    ds_read_b64 v[56:57], v9 offset:19200
    ds_read_b64 v[60:61], v7 offset:25600
    ds_read_b64 v[62:63], v8 offset:25600
    ds_read_b64 v[64:65], v9 offset:25600
    ds_read_b64 v[68:69], v7 offset:32000
    ds_read_b64 v[70:71], v8 offset:32000
    ds_read_b64 v[72:73], v9 offset:32000
L_FwGO14:
    ds_read_b128 v[16:19], v252 offset:224
    s_waitcnt lgkmcnt(0)
    v_and_b32 v16, v16, v17
    v_and_b32 v18, v18, v19
    v_and_b32 v16, v16, v18
    s_nop 0
    v_readfirstlane_b32 s47, v16
    s_cmp_eq_u32 s47, 1
    s_cbranch_scc1 L_FwGO14_ok
    s_sleep 1
    s_branch L_FwGO14
L_FwGO14_ok:
    s_mov_b32 s53, 0
    buffer_store_dwordx2 v[28:29], v10, s[12:15], s53 offen offset:0 nt
    buffer_store_dwordx2 v[30:31], v11, s[12:15], s53 offen offset:0 nt
    buffer_store_dwordx2 v[32:33], v12, s[12:15], s53 offen offset:0 nt
    s_mov_b32 s53, 86016
    buffer_store_dwordx2 v[36:37], v10, s[12:15], s53 offen offset:0 nt
    buffer_store_dwordx2 v[38:39], v11, s[12:15], s53 offen offset:0 nt
    buffer_store_dwordx2 v[40:41], v12, s[12:15], s53 offen offset:0 nt
    s_mov_b32 s53, 172032
    buffer_store_dwordx2 v[44:45], v10, s[12:15], s53 offen offset:0 nt
    buffer_store_dwordx2 v[46:47], v11, s[12:15], s53 offen offset:0 nt
    buffer_store_dwordx2 v[48:49], v12, s[12:15], s53 offen offset:0 nt
    s_mov_b32 s53, 258048
    buffer_store_dwordx2 v[52:53], v10, s[12:15], s53 offen offset:0 nt
    buffer_store_dwordx2 v[54:55], v11, s[12:15], s53 offen offset:0 nt
    buffer_store_dwordx2 v[56:57], v12, s[12:15], s53 offen offset:0 nt
    s_mov_b32 s53, 344064
    buffer_store_dwordx2 v[60:61], v10, s[12:15], s53 offen offset:0 nt
    buffer_store_dwordx2 v[62:63], v11, s[12:15], s53 offen offset:0 nt
    buffer_store_dwordx2 v[64:65], v12, s[12:15], s53 offen offset:0 nt
    s_mov_b32 s53, 430080
    buffer_store_dwordx2 v[68:69], v10, s[12:15], s53 offen offset:0 nt
    buffer_store_dwordx2 v[70:71], v11, s[12:15], s53 offen offset:0 nt
    buffer_store_dwordx2 v[72:73], v12, s[12:15], s53 offen offset:0 nt
L_Fw1_0:
    ds_read_b128 v[16:19], v252 offset:96
    s_waitcnt lgkmcnt(0)
    v_and_b32 v16, v16, v17
    v_and_b32 v18, v18, v19
    v_and_b32 v16, v16, v18
    s_nop 0
    v_readfirstlane_b32 s47, v16
    s_cmp_eq_u32 s47, 1
    s_cbranch_scc1 L_Fw1_0_ok
    s_sleep 1
    s_branch L_Fw1_0
L_Fw1_0_ok:
    ds_read_b64 v[84:85], v20 offset:0
    ds_read_b64 v[86:87], v21 offset:0
    ds_read_b64 v[88:89], v22 offset:0
    s_mov_b32 s53, 0
    s_waitcnt lgkmcnt(2)
    buffer_store_dwordx2 v[84:85], v10, s[12:15], s53 offen offset:384 nt
    s_waitcnt lgkmcnt(1)
    buffer_store_dwordx2 v[86:87], v11, s[12:15], s53 offen offset:384 nt
    s_waitcnt lgkmcnt(0)
    buffer_store_dwordx2 v[88:89], v12, s[12:15], s53 offen offset:384 nt
L_Fw1_1:
    ds_read_b128 v[16:19], v252 offset:112
    s_waitcnt lgkmcnt(0)
    v_and_b32 v16, v16, v17
    v_and_b32 v18, v18, v19
    v_and_b32 v16, v16, v18
    s_nop 0
    v_readfirstlane_b32 s47, v16
    s_cmp_eq_u32 s47, 1
    s_cbranch_scc1 L_Fw1_1_ok
    s_sleep 1
    s_branch L_Fw1_1
L_Fw1_1_ok:
    ds_read_b64 v[92:93], v20 offset:6400
    ds_read_b64 v[94:95], v21 offset:6400
    ds_read_b64 v[96:97], v22 offset:6400
    s_mov_b32 s53, 86016
    s_waitcnt lgkmcnt(2)
    buffer_store_dwordx2 v[92:93], v10, s[12:15], s53 offen offset:384 nt
    s_waitcnt lgkmcnt(1)
    buffer_store_dwordx2 v[94:95], v11, s[12:15], s53 offen offset:384 nt
    s_waitcnt lgkmcnt(0)
    buffer_store_dwordx2 v[96:97], v12, s[12:15], s53 offen offset:384 nt
L_Fw1_2:
    ds_read_b128 v[16:19], v252 offset:128
    s_waitcnt lgkmcnt(0)
    v_and_b32 v16, v16, v17
    v_and_b32 v18, v18, v19
    v_and_b32 v16, v16, v18
    s_nop 0
    v_readfirstlane_b32 s47, v16
    s_cmp_eq_u32 s47, 1
    s_cbranch_scc1 L_Fw1_2_ok
    s_sleep 1
    s_branch L_Fw1_2
L_Fw1_2_ok:
    ds_read_b64 v[100:101], v20 offset:12800
    ds_read_b64 v[102:103], v21 offset:12800
    ds_read_b64 v[104:105], v22 offset:12800
    s_mov_b32 s53, 172032
    s_waitcnt lgkmcnt(2)
    buffer_store_dwordx2 v[100:101], v10, s[12:15], s53 offen offset:384 nt
    s_waitcnt lgkmcnt(1)
    buffer_store_dwordx2 v[102:103], v11, s[12:15], s53 offen offset:384 nt
    s_waitcnt lgkmcnt(0)
    buffer_store_dwordx2 v[104:105], v12, s[12:15], s53 offen offset:384 nt
L_Fw1_3:
    ds_read_b128 v[16:19], v252 offset:144
    s_waitcnt lgkmcnt(0)
    v_and_b32 v16, v16, v17
    v_and_b32 v18, v18, v19
    v_and_b32 v16, v16, v18
    s_nop 0
    v_readfirstlane_b32 s47, v16
    s_cmp_eq_u32 s47, 1
    s_cbranch_scc1 L_Fw1_3_ok
    s_sleep 1
    s_branch L_Fw1_3
L_Fw1_3_ok:
    ds_read_b64 v[108:109], v20 offset:19200
    ds_read_b64 v[110:111], v21 offset:19200
    ds_read_b64 v[112:113], v22 offset:19200
    s_mov_b32 s53, 258048
    s_waitcnt lgkmcnt(2)
    buffer_store_dwordx2 v[108:109], v10, s[12:15], s53 offen offset:384 nt
    s_waitcnt lgkmcnt(1)
    buffer_store_dwordx2 v[110:111], v11, s[12:15], s53 offen offset:384 nt
    s_waitcnt lgkmcnt(0)
    buffer_store_dwordx2 v[112:113], v12, s[12:15], s53 offen offset:384 nt
L_Fw1_4:
    ds_read_b128 v[16:19], v252 offset:160
    s_waitcnt lgkmcnt(0)
    v_and_b32 v16, v16, v17
    v_and_b32 v18, v18, v19
    v_and_b32 v16, v16, v18
    s_nop 0
    v_readfirstlane_b32 s47, v16
    s_cmp_eq_u32 s47, 1
    s_cbranch_scc1 L_Fw1_4_ok
    s_branch L_Fw1_4
L_Fw1_4_ok:
    ds_read_b64 v[116:117], v20 offset:25600
    ds_read_b64 v[118:119], v21 offset:25600
    ds_read_b64 v[120:121], v22 offset:25600
    s_mov_b32 s53, 344064
    s_waitcnt lgkmcnt(2)
    buffer_store_dwordx2 v[116:117], v10, s[12:15], s53 offen offset:384 nt
    s_waitcnt lgkmcnt(1)
    buffer_store_dwordx2 v[118:119], v11, s[12:15], s53 offen offset:384 nt
    s_waitcnt lgkmcnt(0)
    buffer_store_dwordx2 v[120:121], v12, s[12:15], s53 offen offset:384 nt
L_Fw1_5:
    ds_read_b128 v[16:19], v252 offset:176
    s_waitcnt lgkmcnt(0)
    v_and_b32 v16, v16, v17
    v_and_b32 v18, v18, v19
    v_and_b32 v16, v16, v18
    s_nop 0
    v_readfirstlane_b32 s47, v16
    s_cmp_eq_u32 s47, 1
    s_cbranch_scc1 L_Fw1_5_ok
    s_branch L_Fw1_5
L_Fw1_5_ok:
    ds_read_b64 v[124:125], v20 offset:32000
    ds_read_b64 v[126:127], v21 offset:32000
    ds_read_b64 v[128:129], v22 offset:32000
    s_mov_b32 s53, 430080
    s_waitcnt lgkmcnt(2)
    buffer_store_dwordx2 v[124:125], v10, s[12:15], s53 offen offset:384 nt
    s_waitcnt lgkmcnt(1)
    buffer_store_dwordx2 v[126:127], v11, s[12:15], s53 offen offset:384 nt
    s_waitcnt lgkmcnt(0)
    buffer_store_dwordx2 v[128:129], v12, s[12:15], s53 offen offset:384 nt
    s_endpgm
.org standalone__standard_2d_1d_3d_conv__vision_kernel + 38400, 0
L_CONS:
    s_and_b32 s47, s2, 7
    s_mul_i32 s47, s47, 12
    s_add_u32 s47, s47, s46
    s_sub_u32 s47, s47, 7
    s_mul_i32 s48, s47, 21846
    s_lshr_b32 s48, s48, 16
    s_mul_i32 s49, s48, 3
    s_sub_u32 s43, s47, s49
    s_cmp_eq_u32 s40, 1
    s_cselect_b32 s43, s43, 0
    s_cselect_b32 s48, s48, 0
    s_lshl_b32 s41, s48, 1
    s_and_b32 s41, s41, 12
    s_lshr_b32 s41, 0x5310, s41
    s_and_b32 s41, s41, 15
    s_and_b32 s42, s48, 1
    s_add_u32 s42, s42, 222
    s_lshr_b32 s50, s48, 3
    s_lshl_b32 s50, s50, 1
    s_and_b32 s49, s48, 7
    s_add_u32 s49, s49, 216
    s_cmp_lt_u32 s48, 8
    s_cselect_b32 s41, s41, s50
    s_cselect_b32 s42, s42, s49
    s_add_u32 s44, s43, 1
    s_cmp_eq_u32 s44, 3
    s_cselect_b32 s44, 0, s44
    s_add_u32 s45, s44, 1
    s_cmp_eq_u32 s45, 3
    s_cselect_b32 s45, 0, s45
    v_lshrrev_b32 v8, 4, v0
    s_mul_i32 s47, s36, 96
    v_lshlrev_b32 v12, 3, v8
    v_add_u32 v12, s47, v12
    s_lshl_b32 s48, s43, 5
    v_add_u32 v13, s48, v12
    s_lshl_b32 s48, s44, 5
    v_add_u32 v14, s48, v12
    s_lshl_b32 s48, s45, 5
    v_add_u32 v15, s48, v12
    s_mul_i32 s48, s46, 36
    v_min_u32 v9, 35, v0
    v_add_u32 v9, s48, v9
    v_mul_u32_u24 v10, 10923, v9
    v_lshrrev_b32 v10, 21, v10
    v_add_u32 v11, 1, v10
    v_lshrrev_b32 v11, 1, v11
    v_mul_u32_u24 v11, 576, v11
    v_mul_u32_u24 v10, 384, v10
    v_add3_u32 v9, v9, v10, v11
    s_mul_i32 s48, s36, 24576
    s_add_u32 s48, s48, 2048
    v_lshl_add_u32 v252, v9, 7, s48
    s_waitcnt lgkmcnt(0)
    s_mov_b32 s20, s32
    s_mov_b32 s21, s33
    s_mov_b32 s22, 384
    s_mov_b32 s23, 0x20000
    s_sub_u32 s8, s30, 2048
    s_subb_u32 s9, s31, 0
    s_mov_b32 s10, 665600
    s_mov_b32 s11, 0x20000
    s_mov_b32 s16, s26
    s_mov_b32 s17, s27
    s_mov_b32 s18, 884736
    s_mov_b32 s19, 0x20000
    s_cmp_ge_u32 s36, 1
    s_cbranch_scc1 L_NOWPF
    buffer_load_dword v255, v252, s[8:11], 0 offen
L_NOWPF:
    s_cmp_eq_u32 s36, 2
    s_cbranch_scc0 L_NOCPF
    s_getpc_b64 s[56:57]
L_PC0:
    s_sub_u32 s56, s56, L_PC0-standalone__standard_2d_1d_3d_conv__vision_kernel
    s_subb_u32 s57, s57, 0
    s_mul_i32 s48, s46, 2560
    v_min_u32 v252, 19, v0
    v_lshl_add_u32 v252, v252, 7, s48
    v_min_u32 v252, L_END-standalone__standard_2d_1d_3d_conv__vision_kernel, v252
    global_load_dword v255, v252, s[56:57]
L_NOCPF:
    buffer_load_dwordx2 v[16:17], v13, s[20:23], 0 offen
    buffer_load_dwordx2 v[18:19], v14, s[20:23], 0 offen
    buffer_load_dwordx2 v[20:21], v15, s[20:23], 0 offen
    v_and_b32 v9, 15, v0
    v_xor_b32 v10, v8, v9
    v_lshl_add_u32 v10, v8, 4, v10
    v_lshlrev_b32 v1, 4, v10
    v_add_u32 v2, 0x8000, v1
    s_mul_i32 s52, s36, 18432
    s_add_u32 s52, s52, 68096
    v_lshrrev_b32 v10, 2, v0
    v_mul_u32_u24 v10, 96, v10
    v_and_b32 v11, 3, v0
    v_lshl_add_u32 v10, v11, 3, v10
    v_add_u32 v3, s52, v10
    v_add_u32 v9, 0, v0
    v_mul_u32_u24 v10, 43691, v9
    v_lshrrev_b32 v10, 18, v10
    v_mul_u32_u24 v11, 6, v10
    v_sub_u32 v9, v9, v11
    v_bfe_u32 v11, v10, 2, 2
    v_lshlrev_b32 v11, 3, v11
    v_lshrrev_b32 v12, 4, v10
    v_lshl_add_u32 v11, v12, 2, v11
    v_and_b32 v10, 3, v10
    v_add_u32 v10, v10, v11
    v_mul_u32_u24 v10, 384, v10
    v_lshrrev_b32 v11, 1, v9
    v_add_u32 v11, s43, v11
    v_subrev_u32 v12, 3, v11
    v_min_u32 v11, v11, v12
    v_lshl_add_u32 v10, v11, 5, v10
    v_and_b32 v9, 1, v9
    v_lshl_add_u32 v10, v9, 4, v10
    v_add_u32 v10, s47, v10
    v_add_u32 v4, 2048, v10
    v_add_u32 v9, 64, v0
    v_mul_u32_u24 v10, 43691, v9
    v_lshrrev_b32 v10, 18, v10
    v_mul_u32_u24 v11, 6, v10
    v_sub_u32 v9, v9, v11
    v_bfe_u32 v11, v10, 2, 2
    v_lshlrev_b32 v11, 3, v11
    v_lshrrev_b32 v12, 4, v10
    v_lshl_add_u32 v11, v12, 2, v11
    v_and_b32 v10, 3, v10
    v_add_u32 v10, v10, v11
    v_mul_u32_u24 v10, 384, v10
    v_lshrrev_b32 v11, 1, v9
    v_add_u32 v11, s43, v11
    v_subrev_u32 v12, 3, v11
    v_min_u32 v11, v11, v12
    v_lshl_add_u32 v10, v11, 5, v10
    v_and_b32 v9, 1, v9
    v_lshl_add_u32 v10, v9, 4, v10
    v_add_u32 v10, s47, v10
    v_add_u32 v5, 1024, v10
    v_add_u32 v9, 128, v0
    v_mul_u32_u24 v10, 43691, v9
    v_lshrrev_b32 v10, 18, v10
    v_mul_u32_u24 v11, 6, v10
    v_sub_u32 v9, v9, v11
    v_bfe_u32 v11, v10, 2, 2
    v_lshlrev_b32 v11, 3, v11
    v_lshrrev_b32 v12, 4, v10
    v_lshl_add_u32 v11, v12, 2, v11
    v_and_b32 v10, 3, v10
    v_add_u32 v10, v10, v11
    v_mul_u32_u24 v10, 384, v10
    v_lshrrev_b32 v11, 1, v9
    v_add_u32 v11, s43, v11
    v_subrev_u32 v12, 3, v11
    v_min_u32 v11, v11, v12
    v_lshl_add_u32 v10, v11, 5, v10
    v_and_b32 v9, 1, v9
    v_lshl_add_u32 v10, v9, 4, v10
    v_add_u32 v10, s47, v10
    v_add_u32 v6, 0, v10
    s_mul_i32 s48, s36, 9216
    s_mul_i32 s47, s43, 3072
    s_add_u32 s47, s47, s48
    v_lshl_add_u32 v7, v0, 4, s47
    s_mul_i32 s47, s44, 3072
    s_add_u32 s47, s47, s48
    v_lshl_add_u32 v253, v0, 4, s47
    s_mul_i32 s47, s45, 3072
    s_add_u32 s47, s47, s48
    v_lshl_add_u32 v254, v0, 4, s47
    s_cmp_eq_u32 s40, 0
    s_cbranch_scc1 L_CN
    v_lshlrev_b32 v8, 3, v0
    v_add_u32 v8, 67584, v8
    v_mov_b32 v10, 0
    v_mov_b32 v11, 0
    ds_write_b64 v8, v[10:11]
    s_waitcnt lgkmcnt(0)
    s_barrier
    s_add_u32 m0, s52, 0
    s_mov_b32 s54, 0
    buffer_load_dwordx4 v4, s[8:11], s54 offen offset:0 lds
    buffer_load_dwordx4 v5, s[8:11], s54 offen offset:1024 lds
    buffer_load_dwordx4 v6, s[8:11], s54 offen offset:2048 lds
    s_add_u32 m0, s52, 3072
    s_mov_b32 s54, 221184
    buffer_load_dwordx4 v4, s[8:11], s54 offen offset:0 lds
    buffer_load_dwordx4 v5, s[8:11], s54 offen offset:1024 lds
    buffer_load_dwordx4 v6, s[8:11], s54 offen offset:2048 lds
    s_add_u32 m0, s52, 6144
    s_mov_b32 s54, 442368
    buffer_load_dwordx4 v4, s[8:11], s54 offen offset:0 lds
    buffer_load_dwordx4 v5, s[8:11], s54 offen offset:1024 lds
    buffer_load_dwordx4 v6, s[8:11], s54 offen offset:2048 lds
    s_add_u32 m0, s52, 9216
    s_mov_b32 s54, 12288
    buffer_load_dwordx4 v4, s[8:11], s54 offen offset:0 lds
    buffer_load_dwordx4 v5, s[8:11], s54 offen offset:1024 lds
    buffer_load_dwordx4 v6, s[8:11], s54 offen offset:2048 lds
    s_add_u32 m0, s52, 12288
    s_mov_b32 s54, 233472
    buffer_load_dwordx4 v4, s[8:11], s54 offen offset:0 lds
    buffer_load_dwordx4 v5, s[8:11], s54 offen offset:1024 lds
    buffer_load_dwordx4 v6, s[8:11], s54 offen offset:2048 lds
    s_add_u32 m0, s52, 15360
    s_mov_b32 s54, 454656
    buffer_load_dwordx4 v4, s[8:11], s54 offen offset:0 lds
    buffer_load_dwordx4 v5, s[8:11], s54 offen offset:1024 lds
    buffer_load_dwordx4 v6, s[8:11], s54 offen offset:2048 lds
    s_waitcnt vmcnt(18)
    v_lshlrev_b32 v216, 16, v16
    v_and_b32 v217, s51, v16
    v_lshlrev_b32 v218, 16, v17
    v_and_b32 v219, s51, v17
    v_xor_b32 v228, s59, v216
    v_xor_b32 v229, s59, v217
    v_xor_b32 v230, s59, v218
    v_xor_b32 v231, s59, v219
    v_lshlrev_b32 v220, 16, v18
    v_and_b32 v221, s51, v18
    v_lshlrev_b32 v222, 16, v19
    v_and_b32 v223, s51, v19
    v_xor_b32 v232, s59, v220
    v_xor_b32 v233, s59, v221
    v_xor_b32 v234, s59, v222
    v_xor_b32 v235, s59, v223
    v_lshlrev_b32 v224, 16, v20
    v_and_b32 v225, s51, v20
    v_lshlrev_b32 v226, 16, v21
    v_and_b32 v227, s51, v21
    v_xor_b32 v236, s59, v224
    v_xor_b32 v237, s59, v225
    v_xor_b32 v238, s59, v226
    v_xor_b32 v239, s59, v227
    s_waitcnt vmcnt(15)
    ds_read_b64_tr_b16 v[24:25], v3 offset:0
    ds_read_b64_tr_b16 v[26:27], v3 offset:1536
    ds_read_b64_tr_b16 v[28:29], v3 offset:32
    ds_read_b64_tr_b16 v[30:31], v3 offset:1568
    ds_read_b64_tr_b16 v[32:33], v3 offset:64
    ds_read_b64_tr_b16 v[34:35], v3 offset:1600
    s_waitcnt vmcnt(12)
    ds_read_b64_tr_b16 v[36:37], v3 offset:3072
    ds_read_b64_tr_b16 v[38:39], v3 offset:4608
    ds_read_b64_tr_b16 v[40:41], v3 offset:3104
    ds_read_b64_tr_b16 v[42:43], v3 offset:4640
    ds_read_b64_tr_b16 v[44:45], v3 offset:3136
    ds_read_b64_tr_b16 v[46:47], v3 offset:4672
    s_waitcnt vmcnt(9)
    ds_read_b64_tr_b16 v[48:49], v3 offset:6144
    ds_read_b64_tr_b16 v[50:51], v3 offset:7680
    ds_read_b64_tr_b16 v[52:53], v3 offset:6176
    ds_read_b64_tr_b16 v[54:55], v3 offset:7712
    ds_read_b64_tr_b16 v[56:57], v3 offset:6208
    ds_read_b64_tr_b16 v[58:59], v3 offset:7744
    s_lshl_b32 s47, s36, 2
    s_add_u32 s47, s47, 67584
    v_mov_b32 v255, s47
    v_mov_b32 v252, 1
    ds_read_b32 v0, v2 offset:35264
    s_waitcnt lgkmcnt(0)
    v_readfirstlane_b32 s47, v0
    s_cmp_eq_u32 s47, 4
    s_cbranch_scc0 L_CKxrdy0_spin
L_CKxrdy0:
    ds_read_b128 v[8:11], v1 offset:0
    ds_read_b128 v[12:15], v1 offset:1024
    ds_read_b128 v[16:19], v1 offset:8192
    ds_read_b128 v[20:23], v1 offset:2048
    s_waitcnt lgkmcnt(3)
    v_mfma_f32_16x16x32_bf16 v[96:99], v[24:27], v[8:11], v[216:219]
    s_add_u32 m0, s52, 0
    s_mov_b32 s54, 147456
    v_mfma_f32_16x16x32_bf16 v[100:103], v[28:31], v[8:11], v[220:223]
    buffer_load_dwordx4 v4, s[8:11], s54 offen offset:0 lds
    v_mfma_f32_16x16x32_bf16 v[104:107], v[32:35], v[8:11], v[224:227]
    ds_read_b128 v[8:11], v1 offset:9216
    s_waitcnt lgkmcnt(3)
    v_mfma_f32_16x16x32_bf16 v[96:99], v[36:39], v[12:15], v[96:99]
    v_mfma_f32_16x16x32_bf16 v[100:103], v[40:43], v[12:15], v[100:103]
    s_waitcnt vmcnt(7)
    ds_read_b64_tr_b16 v[60:61], v3 offset:9216
    v_mfma_f32_16x16x32_bf16 v[104:107], v[44:47], v[12:15], v[104:107]
    buffer_load_dwordx4 v5, s[8:11], s54 offen offset:1024 lds
    ds_read_b64_tr_b16 v[62:63], v3 offset:10752
    v_mfma_f32_16x16x32_bf16 v[120:123], v[24:27], v[12:15], v[216:219]
    ds_read_b64_tr_b16 v[64:65], v3 offset:9248
    v_mfma_f32_16x16x32_bf16 v[124:127], v[28:31], v[12:15], v[220:223]
    ds_read_b64_tr_b16 v[66:67], v3 offset:10784
    v_mfma_f32_16x16x32_bf16 v[128:131], v[32:35], v[12:15], v[224:227]
    ds_read_b128 v[12:15], v1 offset:3072
    s_waitcnt lgkmcnt(7)
    v_mfma_f32_16x16x32_bf16 v[240:243], v[24:27], v[16:19], v[216:219]
    ds_read_b128 v[16:19], v1 offset:10240
    s_waitcnt lgkmcnt(7)
    v_mfma_f32_16x16x32_bf16 v[96:99], v[48:51], v[20:23], v[96:99]
    buffer_load_dwordx4 v6, s[8:11], s54 offen offset:2048 lds
    ds_read_b64_tr_b16 v[68:69], v3 offset:9280
    v_mfma_f32_16x16x32_bf16 v[100:103], v[52:55], v[20:23], v[100:103]
    ds_read_b64_tr_b16 v[70:71], v3 offset:10816
    v_mfma_f32_16x16x32_bf16 v[104:107], v[56:59], v[20:23], v[104:107]
    s_waitcnt vmcnt(6)
    ds_read_b64_tr_b16 v[72:73], v3 offset:12288
    v_mfma_f32_16x16x32_bf16 v[120:123], v[36:39], v[20:23], v[120:123]
    s_add_u32 m0, s52, 3072
    s_mov_b32 s54, 368640
    v_mfma_f32_16x16x32_bf16 v[124:127], v[40:43], v[20:23], v[124:127]
    buffer_load_dwordx4 v4, s[8:11], s54 offen offset:0 lds
    ds_read_b64_tr_b16 v[74:75], v3 offset:13824
    v_mfma_f32_16x16x32_bf16 v[128:131], v[44:47], v[20:23], v[128:131]
    ds_read_b64_tr_b16 v[76:77], v3 offset:12320
    v_mfma_f32_16x16x32_bf16 v[144:147], v[24:27], v[20:23], v[216:219]
    ds_read_b64_tr_b16 v[78:79], v3 offset:13856
    v_mfma_f32_16x16x32_bf16 v[148:151], v[28:31], v[20:23], v[220:223]
    ds_read_b64_tr_b16 v[80:81], v3 offset:12352
    v_mfma_f32_16x16x32_bf16 v[152:155], v[32:35], v[20:23], v[224:227]
    ds_read_b128 v[20:23], v1 offset:4096
    s_waitcnt lgkmcnt(14)
    v_mfma_f32_16x16x32_bf16 v[240:243], v[36:39], v[8:11], v[240:243]
    ds_read_b128 v[8:11], v1 offset:5120
    s_waitcnt lgkmcnt(10)
    v_mfma_f32_16x16x32_bf16 v[120:123], v[48:51], v[12:15], v[120:123]
    buffer_load_dwordx4 v5, s[8:11], s54 offen offset:1024 lds
    ds_read_b64_tr_b16 v[82:83], v3 offset:13888
    v_mfma_f32_16x16x32_bf16 v[124:127], v[52:55], v[12:15], v[124:127]
    s_waitcnt vmcnt(5)
    ds_read_b64_tr_b16 v[84:85], v3 offset:15360
    v_mfma_f32_16x16x32_bf16 v[128:131], v[56:59], v[12:15], v[128:131]
    ds_read_b64_tr_b16 v[86:87], v3 offset:16896
    v_mfma_f32_16x16x32_bf16 v[144:147], v[36:39], v[12:15], v[144:147]
    buffer_load_dwordx4 v6, s[8:11], s54 offen offset:2048 lds
    ds_read_b64_tr_b16 v[88:89], v3 offset:15392
    v_mfma_f32_16x16x32_bf16 v[148:151], v[40:43], v[12:15], v[148:151]
    ds_read_b64_tr_b16 v[90:91], v3 offset:16928
    v_mfma_f32_16x16x32_bf16 v[152:155], v[44:47], v[12:15], v[152:155]
    ds_read_b64_tr_b16 v[92:93], v3 offset:15424
    v_mfma_f32_16x16x32_bf16 v[168:171], v[24:27], v[12:15], v[216:219]
    ds_read_b64_tr_b16 v[94:95], v3 offset:16960
    v_mfma_f32_16x16x32_bf16 v[172:175], v[28:31], v[12:15], v[220:223]
    s_add_u32 m0, s52, 6144
    s_mov_b32 s54, 589824
    v_mfma_f32_16x16x32_bf16 v[176:179], v[32:35], v[12:15], v[224:227]
    ds_read_b128 v[12:15], v1 offset:6144
    s_waitcnt lgkmcnt(15)
    v_mfma_f32_16x16x32_bf16 v[240:243], v[48:51], v[16:19], v[240:243]
    ds_read_b128 v[16:19], v1 offset:7168
    s_waitcnt lgkmcnt(10)
    v_mfma_f32_16x16x32_bf16 v[144:147], v[48:51], v[20:23], v[144:147]
    buffer_load_dwordx4 v4, s[8:11], s54 offen offset:0 lds
    v_mfma_f32_16x16x32_bf16 v[148:151], v[52:55], v[20:23], v[148:151]
    v_mfma_f32_16x16x32_bf16 v[152:155], v[56:59], v[20:23], v[152:155]
    buffer_load_dwordx4 v5, s[8:11], s54 offen offset:1024 lds
    v_mfma_f32_16x16x32_bf16 v[168:171], v[36:39], v[20:23], v[168:171]
    v_mfma_f32_16x16x32_bf16 v[172:175], v[40:43], v[20:23], v[172:175]
    v_mfma_f32_16x16x32_bf16 v[176:179], v[44:47], v[20:23], v[176:179]
    v_mfma_f32_16x16x32_bf16 v[192:195], v[24:27], v[20:23], v[216:219]
    v_mfma_f32_16x16x32_bf16 v[196:199], v[28:31], v[20:23], v[220:223]
    buffer_load_dwordx4 v6, s[8:11], s54 offen offset:2048 lds
    v_mfma_f32_16x16x32_bf16 v[200:203], v[32:35], v[20:23], v[224:227]
    ds_read_b128 v[20:23], v1 offset:11264
    s_waitcnt lgkmcnt(10)
    v_mfma_f32_16x16x32_bf16 v[168:171], v[48:51], v[8:11], v[168:171]
    v_mfma_f32_16x16x32_bf16 v[172:175], v[52:55], v[8:11], v[172:175]
    s_add_u32 m0, s52, 9216
    s_mov_b32 s54, 159744
    v_mfma_f32_16x16x32_bf16 v[176:179], v[56:59], v[8:11], v[176:179]
    buffer_load_dwordx4 v4, s[8:11], s54 offen offset:0 lds
    v_mfma_f32_16x16x32_bf16 v[192:195], v[36:39], v[8:11], v[192:195]
    v_mfma_f32_16x16x32_bf16 v[196:199], v[40:43], v[8:11], v[196:199]
    v_mfma_f32_16x16x32_bf16 v[200:203], v[44:47], v[8:11], v[200:203]
    v_mfma_f32_16x16x32_bf16 v[216:219], v[24:27], v[8:11], v[216:219]
    v_mfma_f32_16x16x32_bf16 v[220:223], v[28:31], v[8:11], v[220:223]
    buffer_load_dwordx4 v5, s[8:11], s54 offen offset:1024 lds
    v_mfma_f32_16x16x32_bf16 v[224:227], v[32:35], v[8:11], v[224:227]
    ds_read_b128 v[8:11], v1 offset:12288
    s_waitcnt lgkmcnt(3)
    v_mfma_f32_16x16x32_bf16 v[192:195], v[48:51], v[12:15], v[192:195]
    v_mfma_f32_16x16x32_bf16 v[196:199], v[52:55], v[12:15], v[196:199]
    v_mfma_f32_16x16x32_bf16 v[200:203], v[56:59], v[12:15], v[200:203]
    buffer_load_dwordx4 v6, s[8:11], s54 offen offset:2048 lds
    v_mfma_f32_16x16x32_bf16 v[216:219], v[36:39], v[12:15], v[216:219]
    v_mfma_f32_16x16x32_bf16 v[220:223], v[40:43], v[12:15], v[220:223]
    v_mfma_f32_16x16x32_bf16 v[224:227], v[44:47], v[12:15], v[224:227]
    ds_read_b128 v[12:15], v1 offset:19456
    s_waitcnt lgkmcnt(3)
    v_mfma_f32_16x16x32_bf16 v[216:219], v[48:51], v[16:19], v[216:219]
    s_add_u32 m0, s52, 12288
    s_mov_b32 s54, 380928
    v_mfma_f32_16x16x32_bf16 v[220:223], v[52:55], v[16:19], v[220:223]
    buffer_load_dwordx4 v4, s[8:11], s54 offen offset:0 lds
    v_mfma_f32_16x16x32_bf16 v[224:227], v[56:59], v[16:19], v[224:227]
    ds_read_b128 v[16:19], v1 offset:13312
    s_waitcnt lgkmcnt(3)
    v_mfma_f32_16x16x32_bf16 v[96:99], v[60:63], v[20:23], v[96:99]
    v_mfma_f32_16x16x32_bf16 v[100:103], v[64:67], v[20:23], v[100:103]
    v_mfma_f32_16x16x32_bf16 v[104:107], v[68:71], v[20:23], v[104:107]
    ds_read_b128 v[20:23], v1 offset:20480
    s_waitcnt lgkmcnt(3)
    v_mfma_f32_16x16x32_bf16 v[96:99], v[72:75], v[8:11], v[96:99]
    buffer_load_dwordx4 v5, s[8:11], s54 offen offset:1024 lds
    v_mfma_f32_16x16x32_bf16 v[100:103], v[76:79], v[8:11], v[100:103]
    v_mfma_f32_16x16x32_bf16 v[104:107], v[80:83], v[8:11], v[104:107]
    v_mfma_f32_16x16x32_bf16 v[120:123], v[60:63], v[8:11], v[120:123]
    v_mfma_f32_16x16x32_bf16 v[124:127], v[64:67], v[8:11], v[124:127]
    buffer_load_dwordx4 v6, s[8:11], s54 offen offset:2048 lds
    v_mfma_f32_16x16x32_bf16 v[128:131], v[68:71], v[8:11], v[128:131]
    ds_read_b128 v[8:11], v1 offset:14336
    s_waitcnt lgkmcnt(3)
    v_mfma_f32_16x16x32_bf16 v[240:243], v[60:63], v[12:15], v[240:243]
    ds_read_b128 v[12:15], v1 offset:21504
    s_waitcnt lgkmcnt(3)
    v_mfma_f32_16x16x32_bf16 v[96:99], v[84:87], v[16:19], v[96:99]
    s_add_u32 m0, s52, 15360
    s_mov_b32 s54, 602112
    v_mfma_f32_16x16x32_bf16 v[100:103], v[88:91], v[16:19], v[100:103]
    buffer_load_dwordx4 v4, s[8:11], s54 offen offset:0 lds
    v_mfma_f32_16x16x32_bf16 v[104:107], v[92:95], v[16:19], v[104:107]
    v_mfma_f32_16x16x32_bf16 v[120:123], v[72:75], v[16:19], v[120:123]
    v_mfma_f32_16x16x32_bf16 v[124:127], v[76:79], v[16:19], v[124:127]
    v_mfma_f32_16x16x32_bf16 v[128:131], v[80:83], v[16:19], v[128:131]
    v_mfma_f32_16x16x32_bf16 v[144:147], v[60:63], v[16:19], v[144:147]
    buffer_load_dwordx4 v5, s[8:11], s54 offen offset:1024 lds
    v_mfma_f32_16x16x32_bf16 v[148:151], v[64:67], v[16:19], v[148:151]
    v_mfma_f32_16x16x32_bf16 v[152:155], v[68:71], v[16:19], v[152:155]
    ds_read_b128 v[16:19], v1 offset:15360
    s_waitcnt lgkmcnt(3)
    v_mfma_f32_16x16x32_bf16 v[240:243], v[72:75], v[20:23], v[240:243]
    ds_read_b128 v[20:23], v1 offset:16384
    s_waitcnt lgkmcnt(3)
    v_mfma_f32_16x16x32_bf16 v[120:123], v[84:87], v[8:11], v[120:123]
    buffer_load_dwordx4 v6, s[8:11], s54 offen offset:2048 lds
    v_mfma_f32_16x16x32_bf16 v[124:127], v[88:91], v[8:11], v[124:127]
    ds_write_b32 v255, v252 offset:496
    v_mfma_f32_16x16x32_bf16 v[128:131], v[92:95], v[8:11], v[128:131]
    v_mfma_f32_16x16x32_bf16 v[144:147], v[72:75], v[8:11], v[144:147]
    v_mfma_f32_16x16x32_bf16 v[148:151], v[76:79], v[8:11], v[148:151]
    v_mfma_f32_16x16x32_bf16 v[152:155], v[80:83], v[8:11], v[152:155]
    v_mfma_f32_16x16x32_bf16 v[168:171], v[60:63], v[8:11], v[168:171]
    v_mfma_f32_16x16x32_bf16 v[172:175], v[64:67], v[8:11], v[172:175]
    v_mfma_f32_16x16x32_bf16 v[176:179], v[68:71], v[8:11], v[176:179]
    ds_read_b128 v[8:11], v1 offset:17408
    s_waitcnt lgkmcnt(4)
    v_mfma_f32_16x16x32_bf16 v[240:243], v[84:87], v[12:15], v[240:243]
    ds_read_b128 v[12:15], v1 offset:18432
    s_waitcnt lgkmcnt(4)
    v_mfma_f32_16x16x32_bf16 v[144:147], v[84:87], v[16:19], v[144:147]
    ds_read_b32 v0, v2 offset:35268
    v_mfma_f32_16x16x32_bf16 v[148:151], v[88:91], v[16:19], v[148:151]
    v_mfma_f32_16x16x32_bf16 v[152:155], v[92:95], v[16:19], v[152:155]
    v_mfma_f32_16x16x32_bf16 v[168:171], v[72:75], v[16:19], v[168:171]
    s_waitcnt vmcnt(15)
    ds_read_b64_tr_b16 v[24:25], v3 offset:0
    v_mfma_f32_16x16x32_bf16 v[172:175], v[76:79], v[16:19], v[172:175]
    ds_read_b64_tr_b16 v[26:27], v3 offset:1536
    v_mfma_f32_16x16x32_bf16 v[176:179], v[80:83], v[16:19], v[176:179]
    ds_read_b64_tr_b16 v[28:29], v3 offset:32
    v_mfma_f32_16x16x32_bf16 v[192:195], v[60:63], v[16:19], v[192:195]
    s_waitcnt lgkmcnt(3)
    v_readfirstlane_b32 s47, v0
    v_mfma_f32_16x16x32_bf16 v[196:199], v[64:67], v[16:19], v[196:199]
    s_cmp_eq_u32 s47, 4
    s_cbranch_scc0 L_CKxrdy1_spin
L_CKxrdy1:
    v_mfma_f32_16x16x32_bf16 v[200:203], v[68:71], v[16:19], v[200:203]
    ds_read_b128 v[16:19], v1 offset:22528
    v_mfma_f32_16x16x32_bf16 v[168:171], v[84:87], v[20:23], v[168:171]
    ds_read_b64_tr_b16 v[30:31], v3 offset:1568
    v_mfma_f32_16x16x32_bf16 v[172:175], v[88:91], v[20:23], v[172:175]
    ds_read_b64_tr_b16 v[32:33], v3 offset:64
    v_mfma_f32_16x16x32_bf16 v[176:179], v[92:95], v[20:23], v[176:179]
    ds_read_b64_tr_b16 v[34:35], v3 offset:1600
    v_mfma_f32_16x16x32_bf16 v[192:195], v[72:75], v[20:23], v[192:195]
    s_waitcnt vmcnt(12)
    ds_read_b64_tr_b16 v[36:37], v3 offset:3072
    v_mfma_f32_16x16x32_bf16 v[196:199], v[76:79], v[20:23], v[196:199]
    ds_read_b64_tr_b16 v[38:39], v3 offset:4608
    v_mfma_f32_16x16x32_bf16 v[200:203], v[80:83], v[20:23], v[200:203]
    ds_read_b64_tr_b16 v[40:41], v3 offset:3104
    v_mfma_f32_16x16x32_bf16 v[216:219], v[60:63], v[20:23], v[216:219]
    ds_read_b64_tr_b16 v[42:43], v3 offset:4640
    v_mfma_f32_16x16x32_bf16 v[220:223], v[64:67], v[20:23], v[220:223]
    ds_read_b64_tr_b16 v[44:45], v3 offset:3136
    v_mfma_f32_16x16x32_bf16 v[224:227], v[68:71], v[20:23], v[224:227]
    ds_read_b128 v[20:23], v1 offset:23552
    v_mfma_f32_16x16x32_bf16 v[192:195], v[84:87], v[8:11], v[192:195]
    ds_read_b64_tr_b16 v[46:47], v3 offset:4672
    v_mfma_f32_16x16x32_bf16 v[196:199], v[88:91], v[8:11], v[196:199]
    s_waitcnt vmcnt(9)
    ds_read_b64_tr_b16 v[48:49], v3 offset:6144
    v_mfma_f32_16x16x32_bf16 v[200:203], v[92:95], v[8:11], v[200:203]
    ds_read_b64_tr_b16 v[50:51], v3 offset:7680
    v_mfma_f32_16x16x32_bf16 v[216:219], v[72:75], v[8:11], v[216:219]
    ds_read_b64_tr_b16 v[52:53], v3 offset:6176
    v_mfma_f32_16x16x32_bf16 v[220:223], v[76:79], v[8:11], v[220:223]
    ds_read_b64_tr_b16 v[54:55], v3 offset:7712
    v_mfma_f32_16x16x32_bf16 v[224:227], v[80:83], v[8:11], v[224:227]
    ds_read_b128 v[8:11], v1 offset:30720
    v_mfma_f32_16x16x32_bf16 v[216:219], v[84:87], v[12:15], v[216:219]
    ds_write_b32 v255, v252 offset:256
    v_mfma_f32_16x16x32_bf16 v[220:223], v[88:91], v[12:15], v[220:223]
    ds_read_b64_tr_b16 v[56:57], v3 offset:6208
    v_mfma_f32_16x16x32_bf16 v[224:227], v[92:95], v[12:15], v[224:227]
    ds_read_b128 v[12:15], v1 offset:24576
    s_waitcnt lgkmcnt(15)
    v_mfma_f32_16x16x32_bf16 v[108:111], v[24:27], v[16:19], v[228:231]
    ds_read_b64_tr_b16 v[58:59], v3 offset:7744
    v_mfma_f32_16x16x32_bf16 v[112:115], v[28:31], v[16:19], v[232:235]
    v_mfma_f32_16x16x32_bf16 v[116:119], v[32:35], v[16:19], v[236:239]
    ds_read_b128 v[16:19], v1 offset:31744
    s_waitcnt lgkmcnt(10)
    v_mfma_f32_16x16x32_bf16 v[108:111], v[36:39], v[20:23], v[108:111]
    v_mfma_f32_16x16x32_bf16 v[112:115], v[40:43], v[20:23], v[112:115]
    v_mfma_f32_16x16x32_bf16 v[116:119], v[44:47], v[20:23], v[116:119]
    v_mfma_f32_16x16x32_bf16 v[132:135], v[24:27], v[20:23], v[228:231]
    v_mfma_f32_16x16x32_bf16 v[136:139], v[28:31], v[20:23], v[232:235]
    v_mfma_f32_16x16x32_bf16 v[140:143], v[32:35], v[20:23], v[236:239]
    ds_read_b128 v[20:23], v1 offset:25600
    s_waitcnt lgkmcnt(6)
    v_mfma_f32_16x16x32_bf16 v[244:247], v[24:27], v[8:11], v[228:231]
    ds_read_b128 v[8:11], v2 offset:0
    s_waitcnt lgkmcnt(3)
    v_mfma_f32_16x16x32_bf16 v[108:111], v[48:51], v[12:15], v[108:111]
    v_mfma_f32_16x16x32_bf16 v[112:115], v[52:55], v[12:15], v[112:115]
    v_mfma_f32_16x16x32_bf16 v[116:119], v[56:59], v[12:15], v[116:119]
    v_mfma_f32_16x16x32_bf16 v[132:135], v[36:39], v[12:15], v[132:135]
    v_mfma_f32_16x16x32_bf16 v[136:139], v[40:43], v[12:15], v[136:139]
    v_mfma_f32_16x16x32_bf16 v[140:143], v[44:47], v[12:15], v[140:143]
    v_mfma_f32_16x16x32_bf16 v[156:159], v[24:27], v[12:15], v[228:231]
    v_mfma_f32_16x16x32_bf16 v[160:163], v[28:31], v[12:15], v[232:235]
    v_mfma_f32_16x16x32_bf16 v[164:167], v[32:35], v[12:15], v[236:239]
    ds_read_b128 v[12:15], v1 offset:26624
    s_waitcnt lgkmcnt(3)
    v_mfma_f32_16x16x32_bf16 v[244:247], v[36:39], v[16:19], v[244:247]
    ds_read_b128 v[16:19], v1 offset:27648
    s_waitcnt lgkmcnt(3)
    v_mfma_f32_16x16x32_bf16 v[132:135], v[48:51], v[20:23], v[132:135]
    v_mfma_f32_16x16x32_bf16 v[136:139], v[52:55], v[20:23], v[136:139]
    v_mfma_f32_16x16x32_bf16 v[140:143], v[56:59], v[20:23], v[140:143]
    v_mfma_f32_16x16x32_bf16 v[156:159], v[36:39], v[20:23], v[156:159]
    v_mfma_f32_16x16x32_bf16 v[160:163], v[40:43], v[20:23], v[160:163]
    v_mfma_f32_16x16x32_bf16 v[164:167], v[44:47], v[20:23], v[164:167]
    v_mfma_f32_16x16x32_bf16 v[180:183], v[24:27], v[20:23], v[228:231]
    v_mfma_f32_16x16x32_bf16 v[184:187], v[28:31], v[20:23], v[232:235]
    v_mfma_f32_16x16x32_bf16 v[188:191], v[32:35], v[20:23], v[236:239]
    ds_read_b128 v[20:23], v1 offset:28672
    s_waitcnt lgkmcnt(3)
    v_mfma_f32_16x16x32_bf16 v[244:247], v[48:51], v[8:11], v[244:247]
    ds_read_b128 v[8:11], v1 offset:29696
    s_waitcnt lgkmcnt(3)
    v_mfma_f32_16x16x32_bf16 v[156:159], v[48:51], v[12:15], v[156:159]
    v_mfma_f32_16x16x32_bf16 v[160:163], v[52:55], v[12:15], v[160:163]
    v_mfma_f32_16x16x32_bf16 v[164:167], v[56:59], v[12:15], v[164:167]
    v_mfma_f32_16x16x32_bf16 v[180:183], v[36:39], v[12:15], v[180:183]
    s_waitcnt vmcnt(6)
    ds_read_b64_tr_b16 v[60:61], v3 offset:9216
    v_mfma_f32_16x16x32_bf16 v[184:187], v[40:43], v[12:15], v[184:187]
    ds_read_b64_tr_b16 v[62:63], v3 offset:10752
    v_mfma_f32_16x16x32_bf16 v[188:191], v[44:47], v[12:15], v[188:191]
    ds_read_b64_tr_b16 v[64:65], v3 offset:9248
    v_mfma_f32_16x16x32_bf16 v[204:207], v[24:27], v[12:15], v[228:231]
    ds_read_b64_tr_b16 v[66:67], v3 offset:10784
    v_mfma_f32_16x16x32_bf16 v[208:211], v[28:31], v[12:15], v[232:235]
    ds_read_b64_tr_b16 v[68:69], v3 offset:9280
    v_mfma_f32_16x16x32_bf16 v[212:215], v[32:35], v[12:15], v[236:239]
    ds_read_b128 v[12:15], v2 offset:1024
    s_waitcnt lgkmcnt(8)
    v_mfma_f32_16x16x32_bf16 v[180:183], v[48:51], v[16:19], v[180:183]
    ds_read_b64_tr_b16 v[70:71], v3 offset:10816
    v_mfma_f32_16x16x32_bf16 v[184:187], v[52:55], v[16:19], v[184:187]
    s_waitcnt vmcnt(3)
    ds_read_b64_tr_b16 v[72:73], v3 offset:12288
    v_mfma_f32_16x16x32_bf16 v[188:191], v[56:59], v[16:19], v[188:191]
    ds_read_b64_tr_b16 v[74:75], v3 offset:13824
    v_mfma_f32_16x16x32_bf16 v[204:207], v[36:39], v[16:19], v[204:207]
    ds_read_b64_tr_b16 v[76:77], v3 offset:12320
    v_mfma_f32_16x16x32_bf16 v[208:211], v[40:43], v[16:19], v[208:211]
    ds_read_b64_tr_b16 v[78:79], v3 offset:13856
    v_mfma_f32_16x16x32_bf16 v[212:215], v[44:47], v[16:19], v[212:215]
    ds_read_b64_tr_b16 v[80:81], v3 offset:12352
    v_mfma_f32_16x16x32_bf16 v[228:231], v[24:27], v[16:19], v[228:231]
    ds_read_b64_tr_b16 v[82:83], v3 offset:13888
    v_mfma_f32_16x16x32_bf16 v[232:235], v[28:31], v[16:19], v[232:235]
    s_waitcnt vmcnt(0)
    ds_read_b64_tr_b16 v[84:85], v3 offset:15360
    v_mfma_f32_16x16x32_bf16 v[236:239], v[32:35], v[16:19], v[236:239]
    ds_read_b128 v[16:19], v2 offset:2048
    s_waitcnt lgkmcnt(15)
    v_mfma_f32_16x16x32_bf16 v[204:207], v[48:51], v[20:23], v[204:207]
    ds_read_b64_tr_b16 v[86:87], v3 offset:16896
    v_mfma_f32_16x16x32_bf16 v[208:211], v[52:55], v[20:23], v[208:211]
    ds_read_b64_tr_b16 v[88:89], v3 offset:15392
    v_mfma_f32_16x16x32_bf16 v[212:215], v[56:59], v[20:23], v[212:215]
    ds_read_b64_tr_b16 v[90:91], v3 offset:16928
    v_mfma_f32_16x16x32_bf16 v[228:231], v[36:39], v[20:23], v[228:231]
    ds_read_b64_tr_b16 v[92:93], v3 offset:15424
    v_mfma_f32_16x16x32_bf16 v[232:235], v[40:43], v[20:23], v[232:235]
    ds_read_b64_tr_b16 v[94:95], v3 offset:16960
    v_mfma_f32_16x16x32_bf16 v[236:239], v[44:47], v[20:23], v[236:239]
    ds_read_b128 v[20:23], v2 offset:9216
    v_readfirstlane_b32 s47, v0
    v_mfma_f32_16x16x32_bf16 v[228:231], v[48:51], v[8:11], v[228:231]
    ds_read_b32 v0, v2 offset:35056
    s_cmp_eq_u32 s47, 1
    s_cbranch_scc0 L_CKxuflag_spin
L_CKxuflag:
    v_mfma_f32_16x16x32_bf16 v[232:235], v[52:55], v[8:11], v[232:235]
    s_mov_b32 s53, 0
    v_mfma_f32_16x16x32_bf16 v[236:239], v[56:59], v[8:11], v[236:239]
    ds_read_b128 v[8:11], v2 offset:3072
    s_waitcnt lgkmcnt(15)
    v_mfma_f32_16x16x32_bf16 v[108:111], v[60:63], v[12:15], v[108:111]
    buffer_load_dwordx4 v[24:27], v7, s[16:19], s53 offen offset:0 sc1
    v_mfma_f32_16x16x32_bf16 v[112:115], v[64:67], v[12:15], v[112:115]
    v_mfma_f32_16x16x32_bf16 v[116:119], v[68:71], v[12:15], v[116:119]
    ds_read_b128 v[12:15], v2 offset:10240
    s_waitcnt lgkmcnt(9)
    v_mfma_f32_16x16x32_bf16 v[108:111], v[72:75], v[16:19], v[108:111]
    v_mfma_f32_16x16x32_bf16 v[112:115], v[76:79], v[16:19], v[112:115]
    buffer_load_dwordx4 v[28:31], v253, s[16:19], s53 offen offset:0 sc1
    v_mfma_f32_16x16x32_bf16 v[116:119], v[80:83], v[16:19], v[116:119]
    v_mfma_f32_16x16x32_bf16 v[132:135], v[60:63], v[16:19], v[132:135]
    v_mfma_f32_16x16x32_bf16 v[136:139], v[64:67], v[16:19], v[136:139]
    v_mfma_f32_16x16x32_bf16 v[140:143], v[68:71], v[16:19], v[140:143]
    ds_read_b128 v[16:19], v2 offset:4096
    s_waitcnt lgkmcnt(4)
    v_mfma_f32_16x16x32_bf16 v[244:247], v[60:63], v[20:23], v[244:247]
    ds_read_b128 v[20:23], v2 offset:11264
    s_waitcnt lgkmcnt(3)
    v_mfma_f32_16x16x32_bf16 v[108:111], v[84:87], v[8:11], v[108:111]
    buffer_load_dwordx4 v[32:35], v254, s[16:19], s53 offen offset:0 sc1
    v_mfma_f32_16x16x32_bf16 v[112:115], v[88:91], v[8:11], v[112:115]
    v_mfma_f32_16x16x32_bf16 v[116:119], v[92:95], v[8:11], v[116:119]
    v_mfma_f32_16x16x32_bf16 v[132:135], v[72:75], v[8:11], v[132:135]
    v_mfma_f32_16x16x32_bf16 v[136:139], v[76:79], v[8:11], v[136:139]
    buffer_load_dwordx4 v[36:39], v7, s[16:19], s53 offen offset:1024 sc1
    v_mfma_f32_16x16x32_bf16 v[140:143], v[80:83], v[8:11], v[140:143]
    v_mfma_f32_16x16x32_bf16 v[156:159], v[60:63], v[8:11], v[156:159]
    v_mfma_f32_16x16x32_bf16 v[160:163], v[64:67], v[8:11], v[160:163]
    v_mfma_f32_16x16x32_bf16 v[164:167], v[68:71], v[8:11], v[164:167]
    ds_read_b128 v[8:11], v2 offset:5120
    s_waitcnt lgkmcnt(3)
    v_mfma_f32_16x16x32_bf16 v[244:247], v[72:75], v[12:15], v[244:247]
    ds_read_b128 v[12:15], v2 offset:6144
    s_waitcnt lgkmcnt(3)
    v_mfma_f32_16x16x32_bf16 v[132:135], v[84:87], v[16:19], v[132:135]
    buffer_load_dwordx4 v[40:43], v253, s[16:19], s53 offen offset:1024 sc1
    v_sub_f32_e64 v248, v96, v108 div:2
    v_mfma_f32_16x16x32_bf16 v[136:139], v[88:91], v[16:19], v[136:139]
    v_sub_f32_e64 v249, v97, v109 div:2
    v_sub_f32_e64 v250, v98, v110 div:2
    v_mfma_f32_16x16x32_bf16 v[140:143], v[92:95], v[16:19], v[140:143]
    v_sub_f32_e64 v251, v99, v111 div:2
    v_add_f32_e64 v108, v96, v108 div:2
    v_mfma_f32_16x16x32_bf16 v[156:159], v[72:75], v[16:19], v[156:159]
    v_add_f32_e64 v109, v97, v109 div:2
    v_add_f32_e64 v110, v98, v110 div:2
    v_mfma_f32_16x16x32_bf16 v[160:163], v[76:79], v[16:19], v[160:163]
    buffer_load_dwordx4 v[44:47], v254, s[16:19], s53 offen offset:1024 sc1
    v_add_f32_e64 v111, v99, v111 div:2
    v_mfma_f32_16x16x32_bf16 v[164:167], v[80:83], v[16:19], v[164:167]
    v_sub_f32_e64 v96, v100, v112 div:2
    v_sub_f32_e64 v97, v101, v113 div:2
    v_mfma_f32_16x16x32_bf16 v[180:183], v[60:63], v[16:19], v[180:183]
    v_sub_f32_e64 v98, v102, v114 div:2
    v_sub_f32_e64 v99, v103, v115 div:2
    v_mfma_f32_16x16x32_bf16 v[184:187], v[64:67], v[16:19], v[184:187]
    v_add_f32_e64 v112, v100, v112 div:2
    v_add_f32_e64 v113, v101, v113 div:2
    v_mfma_f32_16x16x32_bf16 v[188:191], v[68:71], v[16:19], v[188:191]
    ds_read_b128 v[16:19], v2 offset:7168
    s_waitcnt lgkmcnt(3)
    v_mfma_f32_16x16x32_bf16 v[244:247], v[84:87], v[20:23], v[244:247]
    ds_read_b128 v[20:23], v2 offset:8192
    s_waitcnt lgkmcnt(3)
    v_mfma_f32_16x16x32_bf16 v[156:159], v[84:87], v[8:11], v[156:159]
    ds_read_b32 v0, v2 offset:35272
    buffer_load_dwordx4 v[48:51], v7, s[16:19], s53 offen offset:2048 sc1
    v_mfma_f32_16x16x32_bf16 v[160:163], v[88:91], v[8:11], v[160:163]
    v_add_f32_e64 v114, v102, v114 div:2
    v_add_f32_e64 v115, v103, v115 div:2
    v_sub_f32_e64 v100, v104, v116 div:2
    v_mfma_f32_16x16x32_bf16 v[164:167], v[92:95], v[8:11], v[164:167]
    v_sub_f32_e64 v101, v105, v117 div:2
    v_sub_f32_e64 v102, v106, v118 div:2
    v_mfma_f32_16x16x32_bf16 v[180:183], v[72:75], v[8:11], v[180:183]
    v_sub_f32_e64 v103, v107, v119 div:2
    v_add_f32_e64 v116, v104, v116 div:2
    v_mfma_f32_16x16x32_bf16 v[184:187], v[76:79], v[8:11], v[184:187]
    buffer_load_dwordx4 v[52:55], v253, s[16:19], s53 offen offset:2048 sc1
    v_add_f32_e64 v117, v105, v117 div:2
    v_mfma_f32_16x16x32_bf16 v[188:191], v[80:83], v[8:11], v[188:191]
    v_add_f32_e64 v118, v106, v118 div:2
    v_add_f32_e64 v119, v107, v119 div:2
    v_sub_f32_e64 v104, v120, v132 div:2
    v_sub_f32_e64 v105, v121, v133 div:2
    v_sub_f32_e64 v106, v122, v134 div:2
    v_mfma_f32_16x16x32_bf16 v[204:207], v[60:63], v[8:11], v[204:207]
    s_waitcnt lgkmcnt(0)
    v_readfirstlane_b32 s47, v0
    v_mfma_f32_16x16x32_bf16 v[208:211], v[64:67], v[8:11], v[208:211]
    s_cmp_eq_u32 s47, 4
    s_cbranch_scc0 L_CKxrdy2_spin
L_CKxrdy2:
    v_mfma_f32_16x16x32_bf16 v[212:215], v[68:71], v[8:11], v[212:215]
    ds_read_b128 v[8:11], v2 offset:12288
    v_mfma_f32_16x16x32_bf16 v[180:183], v[84:87], v[12:15], v[180:183]
    buffer_load_dwordx4 v[56:59], v254, s[16:19], s53 offen offset:2048 sc1
    v_sub_f32_e64 v107, v123, v135 div:2
    v_mfma_f32_16x16x32_bf16 v[184:187], v[88:91], v[12:15], v[184:187]
    v_add_f32_e64 v132, v120, v132 div:2
    v_add_f32_e64 v133, v121, v133 div:2
    v_mfma_f32_16x16x32_bf16 v[188:191], v[92:95], v[12:15], v[188:191]
    v_add_f32_e64 v134, v122, v134 div:2
    v_add_f32_e64 v135, v123, v135 div:2
    v_sub_f32_e64 v120, v124, v136 div:2
    v_sub_f32_e64 v121, v125, v137 div:2
    v_mfma_f32_16x16x32_bf16 v[204:207], v[72:75], v[12:15], v[204:207]
    v_sub_f32_e64 v122, v126, v138 div:2
    v_sub_f32_e64 v123, v127, v139 div:2
    v_mfma_f32_16x16x32_bf16 v[208:211], v[76:79], v[12:15], v[208:211]
    s_mov_b32 s53, 36864
    v_add_f32_e64 v136, v124, v136 div:2
    v_mfma_f32_16x16x32_bf16 v[212:215], v[80:83], v[12:15], v[212:215]
    v_add_f32_e64 v137, v125, v137 div:2
    v_add_f32_e64 v138, v126, v138 div:2
    v_mfma_f32_16x16x32_bf16 v[228:231], v[60:63], v[12:15], v[228:231]
    buffer_load_dwordx4 v[60:63], v7, s[16:19], s53 offen offset:0 sc1
    v_add_f32_e64 v139, v127, v139 div:2
    v_sub_f32_e64 v124, v128, v140 div:2
    v_sub_f32_e64 v125, v129, v141 div:2
    v_sub_f32_e64 v126, v130, v142 div:2
    v_mfma_f32_16x16x32_bf16 v[232:235], v[64:67], v[12:15], v[232:235]
    v_sub_f32_e64 v127, v131, v143 div:2
    v_add_f32_e64 v140, v128, v140 div:2
    v_mfma_f32_16x16x32_bf16 v[236:239], v[68:71], v[12:15], v[236:239]
    ds_read_b128 v[12:15], v2 offset:13312
    v_mfma_f32_16x16x32_bf16 v[204:207], v[84:87], v[16:19], v[204:207]
    buffer_load_dwordx4 v[64:67], v253, s[16:19], s53 offen offset:0 sc1
    v_add_f32_e64 v141, v129, v141 div:2
    v_mfma_f32_16x16x32_bf16 v[208:211], v[88:91], v[16:19], v[208:211]
    v_add_f32_e64 v142, v130, v142 div:2
    v_add_f32_e64 v143, v131, v143 div:2
    v_sub_f32_e64 v128, v240, v244 div:2
    v_sub_f32_e64 v129, v241, v245 div:2
    v_sub_f32_e64 v130, v242, v246 div:2
    v_mfma_f32_16x16x32_bf16 v[212:215], v[92:95], v[16:19], v[212:215]
    v_sub_f32_e64 v131, v243, v247 div:2
    v_add_f32_e64 v244, v240, v244 div:2
    v_mfma_f32_16x16x32_bf16 v[228:231], v[72:75], v[16:19], v[228:231]
    buffer_load_dwordx4 v[68:71], v254, s[16:19], s53 offen offset:0 sc1
    v_add_f32_e64 v245, v241, v245 div:2
    v_mfma_f32_16x16x32_bf16 v[232:235], v[76:79], v[16:19], v[232:235]
    v_add_f32_e64 v246, v242, v246 div:2
    v_add_f32_e64 v247, v243, v247 div:2
    v_sub_f32_e64 v240, v144, v156 div:2
    v_sub_f32_e64 v241, v145, v157 div:2
    v_sub_f32_e64 v242, v146, v158 div:2
    v_mfma_f32_16x16x32_bf16 v[236:239], v[80:83], v[16:19], v[236:239]
    ds_read_b128 v[16:19], v2 offset:20480
    v_sub_f32_e64 v243, v147, v159 div:2
    v_add_f32_e64 v156, v144, v156 div:2
    v_mfma_f32_16x16x32_bf16 v[228:231], v[84:87], v[20:23], v[228:231]
    ds_write_b32 v255, v252 offset:272
    buffer_load_dwordx4 v[72:75], v7, s[16:19], s53 offen offset:1024 sc1
    v_mfma_f32_16x16x32_bf16 v[232:235], v[88:91], v[20:23], v[232:235]
    v_add_f32_e64 v157, v145, v157 div:2
    v_add_f32_e64 v158, v146, v158 div:2
    v_mfma_f32_16x16x32_bf16 v[236:239], v[92:95], v[20:23], v[236:239]
    ds_read_b128 v[20:23], v2 offset:14336
    s_waitcnt vmcnt(10) lgkmcnt(4)
    v_mfma_f32_16x16x32_bf16 v[248:251], v[24:27], v[8:11], v[248:251]
    buffer_load_dwordx4 v[76:79], v253, s[16:19], s53 offen offset:1024 sc1
    v_add_f32_e64 v159, v147, v159 div:2
    v_sub_f32_e64 v144, v148, v160 div:2
    v_sub_f32_e64 v145, v149, v161 div:2
    v_sub_f32_e64 v146, v150, v162 div:2
    v_mfma_f32_16x16x32_bf16 v[96:99], v[28:31], v[8:11], v[96:99]
    v_sub_f32_e64 v147, v151, v163 div:2
    v_add_f32_e64 v160, v148, v160 div:2
    v_mfma_f32_16x16x32_bf16 v[100:103], v[32:35], v[8:11], v[100:103]
    ds_read_b128 v[8:11], v2 offset:21504
    s_waitcnt vmcnt(8) lgkmcnt(4)
    v_mfma_f32_16x16x32_bf16 v[248:251], v[36:39], v[12:15], v[248:251]
    buffer_load_dwordx4 v[80:83], v254, s[16:19], s53 offen offset:1024 sc1
    v_add_f32_e64 v161, v149, v161 div:2
    v_mfma_f32_16x16x32_bf16 v[96:99], v[40:43], v[12:15], v[96:99]
    v_add_f32_e64 v162, v150, v162 div:2
    v_add_f32_e64 v163, v151, v163 div:2
    v_sub_f32_e64 v148, v152, v164 div:2
    v_sub_f32_e64 v149, v153, v165 div:2
    v_sub_f32_e64 v150, v154, v166 div:2
    v_mfma_f32_16x16x32_bf16 v[100:103], v[44:47], v[12:15], v[100:103]
    v_sub_f32_e64 v151, v155, v167 div:2
    v_add_f32_e64 v164, v152, v164 div:2
    v_mfma_f32_16x16x32_bf16 v[104:107], v[24:27], v[12:15], v[104:107]
    buffer_load_dwordx4 v[84:87], v7, s[16:19], s53 offen offset:2048 sc1
    v_add_f32_e64 v165, v153, v165 div:2
    v_mfma_f32_16x16x32_bf16 v[120:123], v[28:31], v[12:15], v[120:123]
    v_add_f32_e64 v166, v154, v166 div:2
    v_add_f32_e64 v167, v155, v167 div:2
    v_sub_f32_e64 v152, v168, v180 div:2
    v_sub_f32_e64 v153, v169, v181 div:2
    v_sub_f32_e64 v154, v170, v182 div:2
    v_mfma_f32_16x16x32_bf16 v[124:127], v[32:35], v[12:15], v[124:127]
    ds_read_b128 v[12:15], v2 offset:15360
    v_sub_f32_e64 v155, v171, v183 div:2
    s_waitcnt lgkmcnt(4)
    v_mfma_f32_16x16x32_bf16 v[128:131], v[24:27], v[16:19], v[128:131]
    ds_read_b128 v[16:19], v2 offset:22528
    s_waitcnt vmcnt(7) lgkmcnt(3)
    v_mfma_f32_16x16x32_bf16 v[248:251], v[48:51], v[20:23], v[248:251]
    buffer_load_dwordx4 v[88:91], v253, s[16:19], s53 offen offset:2048 sc1
    v_add_f32_e64 v180, v168, v180 div:2
    v_mfma_f32_16x16x32_bf16 v[96:99], v[52:55], v[20:23], v[96:99]
    v_add_f32_e64 v181, v169, v181 div:2
    v_add_f32_e64 v182, v170, v182 div:2
    v_mfma_f32_16x16x32_bf16 v[100:103], v[56:59], v[20:23], v[100:103]
    buffer_load_dwordx4 v[92:95], v254, s[16:19], s53 offen offset:2048 sc1
    v_add_f32_e64 v183, v171, v183 div:2
    v_mfma_f32_16x16x32_bf16 v[104:107], v[36:39], v[20:23], v[104:107]
    v_sub_f32_e64 v168, v172, v184 div:2
    v_sub_f32_e64 v169, v173, v185 div:2
    v_mfma_f32_16x16x32_bf16 v[120:123], v[40:43], v[20:23], v[120:123]
    v_sub_f32_e64 v170, v174, v186 div:2
    v_sub_f32_e64 v171, v175, v187 div:2
    v_mfma_f32_16x16x32_bf16 v[124:127], v[44:47], v[20:23], v[124:127]
    v_add_f32_e64 v184, v172, v184 div:2
    v_add_f32_e64 v185, v173, v185 div:2
    v_mfma_f32_16x16x32_bf16 v[240:243], v[24:27], v[20:23], v[240:243]
    v_add_f32_e64 v186, v174, v186 div:2
    v_add_f32_e64 v187, v175, v187 div:2
    v_sub_f32_e64 v172, v176, v188 div:2
    v_sub_f32_e64 v173, v177, v189 div:2
    v_sub_f32_e64 v174, v178, v190 div:2
    v_mfma_f32_16x16x32_bf16 v[144:147], v[28:31], v[20:23], v[144:147]
    v_sub_f32_e64 v175, v179, v191 div:2
    v_add_f32_e64 v188, v176, v188 div:2
    v_add_f32_e64 v189, v177, v189 div:2
    v_mfma_f32_16x16x32_bf16 v[148:151], v[32:35], v[20:23], v[148:151]
    ds_read_b128 v[20:23], v2 offset:16384
    s_waitcnt lgkmcnt(3)
    v_mfma_f32_16x16x32_bf16 v[128:131], v[36:39], v[8:11], v[128:131]
    ds_read_b128 v[8:11], v2 offset:17408
    s_waitcnt lgkmcnt(3)
    v_mfma_f32_16x16x32_bf16 v[104:107], v[48:51], v[12:15], v[104:107]
    v_add_f32_e64 v190, v178, v190 div:2
    v_add_f32_e64 v191, v179, v191 div:2
    v_mfma_f32_16x16x32_bf16 v[120:123], v[52:55], v[12:15], v[120:123]
    v_sub_f32_e64 v176, v192, v204 div:2
    v_sub_f32_e64 v177, v193, v205 div:2
    v_mfma_f32_16x16x32_bf16 v[124:127], v[56:59], v[12:15], v[124:127]
    v_sub_f32_e64 v178, v194, v206 div:2
    v_sub_f32_e64 v179, v195, v207 div:2
    v_mfma_f32_16x16x32_bf16 v[240:243], v[36:39], v[12:15], v[240:243]
    v_add_f32_e64 v204, v192, v204 div:2
    v_add_f32_e64 v205, v193, v205 div:2
    v_mfma_f32_16x16x32_bf16 v[144:147], v[40:43], v[12:15], v[144:147]
    v_add_f32_e64 v206, v194, v206 div:2
    v_add_f32_e64 v207, v195, v207 div:2
    v_sub_f32_e64 v192, v196, v208 div:2
    v_sub_f32_e64 v193, v197, v209 div:2
    v_mfma_f32_16x16x32_bf16 v[148:151], v[44:47], v[12:15], v[148:151]
    v_sub_f32_e64 v194, v198, v210 div:2
    v_sub_f32_e64 v195, v199, v211 div:2
    v_mfma_f32_16x16x32_bf16 v[152:155], v[24:27], v[12:15], v[152:155]
    v_add_f32_e64 v208, v196, v208 div:2
    v_add_f32_e64 v209, v197, v209 div:2
    v_mfma_f32_16x16x32_bf16 v[168:171], v[28:31], v[12:15], v[168:171]
    v_add_f32_e64 v210, v198, v210 div:2
    v_add_f32_e64 v211, v199, v211 div:2
    v_sub_f32_e64 v196, v200, v212 div:2
    v_sub_f32_e64 v197, v201, v213 div:2
    v_mfma_f32_16x16x32_bf16 v[172:175], v[32:35], v[12:15], v[172:175]
    ds_read_b128 v[12:15], v2 offset:18432
    s_waitcnt lgkmcnt(3)
    v_mfma_f32_16x16x32_bf16 v[128:131], v[48:51], v[16:19], v[128:131]
    ds_read_b128 v[16:19], v2 offset:19456
    s_waitcnt lgkmcnt(3)
    v_mfma_f32_16x16x32_bf16 v[240:243], v[48:51], v[20:23], v[240:243]
    v_sub_f32_e64 v198, v202, v214 div:2
    v_sub_f32_e64 v199, v203, v215 div:2
    v_mfma_f32_16x16x32_bf16 v[144:147], v[52:55], v[20:23], v[144:147]
    v_add_f32_e64 v212, v200, v212 div:2
    v_add_f32_e64 v213, v201, v213 div:2
    v_mfma_f32_16x16x32_bf16 v[148:151], v[56:59], v[20:23], v[148:151]
    v_add_f32_e64 v214, v202, v214 div:2
    v_add_f32_e64 v215, v203, v215 div:2
    v_mfma_f32_16x16x32_bf16 v[152:155], v[36:39], v[20:23], v[152:155]
    v_sub_f32_e64 v200, v216, v228 div:2
    v_sub_f32_e64 v201, v217, v229 div:2
    v_mfma_f32_16x16x32_bf16 v[168:171], v[40:43], v[20:23], v[168:171]
    v_sub_f32_e64 v202, v218, v230 div:2
    v_sub_f32_e64 v203, v219, v231 div:2
    v_mfma_f32_16x16x32_bf16 v[172:175], v[44:47], v[20:23], v[172:175]
    v_add_f32_e64 v228, v216, v228 div:2
    v_add_f32_e64 v229, v217, v229 div:2
    v_mfma_f32_16x16x32_bf16 v[176:179], v[24:27], v[20:23], v[176:179]
    v_add_f32_e64 v230, v218, v230 div:2
    v_add_f32_e64 v231, v219, v231 div:2
    v_sub_f32_e64 v216, v220, v232 div:2
    v_sub_f32_e64 v217, v221, v233 div:2
    v_mfma_f32_16x16x32_bf16 v[192:195], v[28:31], v[20:23], v[192:195]
    v_sub_f32_e64 v218, v222, v234 div:2
    v_sub_f32_e64 v219, v223, v235 div:2
    v_mfma_f32_16x16x32_bf16 v[196:199], v[32:35], v[20:23], v[196:199]
    ds_read_b128 v[20:23], v2 offset:23552
    s_waitcnt lgkmcnt(3)
    v_mfma_f32_16x16x32_bf16 v[152:155], v[48:51], v[8:11], v[152:155]
    v_add_f32_e64 v232, v220, v232 div:2
    v_add_f32_e64 v233, v221, v233 div:2
    v_mfma_f32_16x16x32_bf16 v[168:171], v[52:55], v[8:11], v[168:171]
    v_add_f32_e64 v234, v222, v234 div:2
    v_add_f32_e64 v235, v223, v235 div:2
    v_sub_f32_e64 v220, v224, v236 div:2
    v_mfma_f32_16x16x32_bf16 v[172:175], v[56:59], v[8:11], v[172:175]
    v_sub_f32_e64 v221, v225, v237 div:2
    v_sub_f32_e64 v222, v226, v238 div:2
    v_mfma_f32_16x16x32_bf16 v[176:179], v[36:39], v[8:11], v[176:179]
    v_sub_f32_e64 v223, v227, v239 div:2
    v_add_f32_e64 v236, v224, v236 div:2
    v_mfma_f32_16x16x32_bf16 v[192:195], v[40:43], v[8:11], v[192:195]
    s_mov_b32 s53, 221184
    v_add_f32_e64 v237, v225, v237 div:2
    v_mfma_f32_16x16x32_bf16 v[196:199], v[44:47], v[8:11], v[196:199]
    v_add_f32_e64 v238, v226, v238 div:2
    v_add_f32_e64 v239, v227, v239 div:2
    v_mfma_f32_16x16x32_bf16 v[200:203], v[24:27], v[8:11], v[200:203]
    buffer_load_dwordx4 v[24:27], v7, s[16:19], s53 offen offset:0 sc1
    v_mfma_f32_16x16x32_bf16 v[216:219], v[28:31], v[8:11], v[216:219]
    v_mfma_f32_16x16x32_bf16 v[220:223], v[32:35], v[8:11], v[220:223]
    ds_read_b128 v[8:11], v2 offset:24576
    s_waitcnt lgkmcnt(3)
    v_mfma_f32_16x16x32_bf16 v[176:179], v[48:51], v[12:15], v[176:179]
    buffer_load_dwordx4 v[28:31], v253, s[16:19], s53 offen offset:0 sc1
    v_mfma_f32_16x16x32_bf16 v[192:195], v[52:55], v[12:15], v[192:195]
    v_mfma_f32_16x16x32_bf16 v[196:199], v[56:59], v[12:15], v[196:199]
    v_mfma_f32_16x16x32_bf16 v[200:203], v[36:39], v[12:15], v[200:203]
    buffer_load_dwordx4 v[32:35], v254, s[16:19], s53 offen offset:0 sc1
    v_mfma_f32_16x16x32_bf16 v[216:219], v[40:43], v[12:15], v[216:219]
    v_mfma_f32_16x16x32_bf16 v[220:223], v[44:47], v[12:15], v[220:223]
    ds_read_b128 v[12:15], v2 offset:31744
    s_waitcnt lgkmcnt(3)
    v_mfma_f32_16x16x32_bf16 v[200:203], v[48:51], v[16:19], v[200:203]
    buffer_load_dwordx4 v[36:39], v7, s[16:19], s53 offen offset:1024 sc1
    v_mfma_f32_16x16x32_bf16 v[216:219], v[52:55], v[16:19], v[216:219]
    v_mfma_f32_16x16x32_bf16 v[220:223], v[56:59], v[16:19], v[220:223]
    ds_read_b128 v[16:19], v2 offset:25600
    s_waitcnt vmcnt(10) lgkmcnt(3)
    v_mfma_f32_16x16x32_bf16 v[248:251], v[60:63], v[20:23], v[248:251]
    buffer_load_dwordx4 v[40:43], v253, s[16:19], s53 offen offset:1024 sc1
    v_mfma_f32_16x16x32_bf16 v[96:99], v[64:67], v[20:23], v[96:99]
    v_mfma_f32_16x16x32_bf16 v[100:103], v[68:71], v[20:23], v[100:103]
    ds_read_b128 v[20:23], v2 offset:32768
    s_waitcnt vmcnt(8) lgkmcnt(3)
    v_mfma_f32_16x16x32_bf16 v[248:251], v[72:75], v[8:11], v[248:251]
    buffer_load_dwordx4 v[44:47], v254, s[16:19], s53 offen offset:1024 sc1
    v_mfma_f32_16x16x32_bf16 v[96:99], v[76:79], v[8:11], v[96:99]
    v_mfma_f32_16x16x32_bf16 v[100:103], v[80:83], v[8:11], v[100:103]
    v_mfma_f32_16x16x32_bf16 v[104:107], v[60:63], v[8:11], v[104:107]
    buffer_load_dwordx4 v[48:51], v7, s[16:19], s53 offen offset:2048 sc1
    v_mfma_f32_16x16x32_bf16 v[120:123], v[64:67], v[8:11], v[120:123]
    v_mfma_f32_16x16x32_bf16 v[124:127], v[68:71], v[8:11], v[124:127]
    ds_read_b128 v[8:11], v2 offset:26624
    s_waitcnt lgkmcnt(3)
    v_mfma_f32_16x16x32_bf16 v[128:131], v[60:63], v[12:15], v[128:131]
    ds_read_b128 v[12:15], v2 offset:33792
    s_waitcnt vmcnt(7) lgkmcnt(3)
    v_mfma_f32_16x16x32_bf16 v[248:251], v[84:87], v[16:19], v[248:251]
    buffer_load_dwordx4 v[52:55], v253, s[16:19], s53 offen offset:2048 sc1
    v_mfma_f32_16x16x32_bf16 v[96:99], v[88:91], v[16:19], v[96:99]
    v_mfma_f32_16x16x32_bf16 v[100:103], v[92:95], v[16:19], v[100:103]
    buffer_load_dwordx4 v[56:59], v254, s[16:19], s53 offen offset:2048 sc1
    v_mfma_f32_16x16x32_bf16 v[104:107], v[72:75], v[16:19], v[104:107]
    v_mfma_f32_16x16x32_bf16 v[120:123], v[76:79], v[16:19], v[120:123]
    v_mfma_f32_16x16x32_bf16 v[124:127], v[80:83], v[16:19], v[124:127]
    v_mfma_f32_16x16x32_bf16 v[240:243], v[60:63], v[16:19], v[240:243]
    v_mfma_f32_16x16x32_bf16 v[144:147], v[64:67], v[16:19], v[144:147]
    v_mfma_f32_16x16x32_bf16 v[148:151], v[68:71], v[16:19], v[148:151]
    ds_read_b128 v[16:19], v2 offset:27648
    s_waitcnt lgkmcnt(3)
    v_mfma_f32_16x16x32_bf16 v[128:131], v[72:75], v[20:23], v[128:131]
    ds_read_b128 v[20:23], v2 offset:28672
    s_waitcnt lgkmcnt(3)
    v_mfma_f32_16x16x32_bf16 v[104:107], v[84:87], v[8:11], v[104:107]
    v_mfma_f32_16x16x32_bf16 v[120:123], v[88:91], v[8:11], v[120:123]
    v_mfma_f32_16x16x32_bf16 v[124:127], v[92:95], v[8:11], v[124:127]
    v_mfma_f32_16x16x32_bf16 v[240:243], v[72:75], v[8:11], v[240:243]
    v_mfma_f32_16x16x32_bf16 v[144:147], v[76:79], v[8:11], v[144:147]
    v_mfma_f32_16x16x32_bf16 v[148:151], v[80:83], v[8:11], v[148:151]
    v_mfma_f32_16x16x32_bf16 v[152:155], v[60:63], v[8:11], v[152:155]
    v_mfma_f32_16x16x32_bf16 v[168:171], v[64:67], v[8:11], v[168:171]
    v_mfma_f32_16x16x32_bf16 v[172:175], v[68:71], v[8:11], v[172:175]
    ds_read_b128 v[8:11], v2 offset:29696
    s_waitcnt lgkmcnt(3)
    v_mfma_f32_16x16x32_bf16 v[128:131], v[84:87], v[12:15], v[128:131]
    ds_read_b128 v[12:15], v2 offset:30720
    s_waitcnt lgkmcnt(3)
    v_mfma_f32_16x16x32_bf16 v[240:243], v[84:87], v[16:19], v[240:243]
    ds_read_b32 v0, v2 offset:35276
    v_mfma_f32_16x16x32_bf16 v[144:147], v[88:91], v[16:19], v[144:147]
    v_mfma_f32_16x16x32_bf16 v[148:151], v[92:95], v[16:19], v[148:151]
    v_mfma_f32_16x16x32_bf16 v[152:155], v[72:75], v[16:19], v[152:155]
    v_mfma_f32_16x16x32_bf16 v[168:171], v[76:79], v[16:19], v[168:171]
    v_mfma_f32_16x16x32_bf16 v[172:175], v[80:83], v[16:19], v[172:175]
    v_mfma_f32_16x16x32_bf16 v[176:179], v[60:63], v[16:19], v[176:179]
    s_waitcnt lgkmcnt(0)
    v_readfirstlane_b32 s47, v0
    v_mfma_f32_16x16x32_bf16 v[192:195], v[64:67], v[16:19], v[192:195]
    s_cmp_eq_u32 s47, 4
    s_cbranch_scc0 L_CKxrdy3_spin
L_CKxrdy3:
    v_mfma_f32_16x16x32_bf16 v[196:199], v[68:71], v[16:19], v[196:199]
    ds_read_b128 v[16:19], v1 offset:0
    v_mfma_f32_16x16x32_bf16 v[152:155], v[84:87], v[20:23], v[152:155]
    v_mfma_f32_16x16x32_bf16 v[168:171], v[88:91], v[20:23], v[168:171]
    v_mfma_f32_16x16x32_bf16 v[172:175], v[92:95], v[20:23], v[172:175]
    v_mfma_f32_16x16x32_bf16 v[176:179], v[72:75], v[20:23], v[176:179]
    v_mfma_f32_16x16x32_bf16 v[192:195], v[76:79], v[20:23], v[192:195]
    s_mov_b32 s53, 258048
    v_mfma_f32_16x16x32_bf16 v[196:199], v[80:83], v[20:23], v[196:199]
    v_mfma_f32_16x16x32_bf16 v[200:203], v[60:63], v[20:23], v[200:203]
    buffer_load_dwordx4 v[60:63], v7, s[16:19], s53 offen offset:0 sc1
    v_mfma_f32_16x16x32_bf16 v[216:219], v[64:67], v[20:23], v[216:219]
    v_mfma_f32_16x16x32_bf16 v[220:223], v[68:71], v[20:23], v[220:223]
    ds_read_b128 v[20:23], v1 offset:1024
    v_mfma_f32_16x16x32_bf16 v[176:179], v[84:87], v[8:11], v[176:179]
    buffer_load_dwordx4 v[64:67], v253, s[16:19], s53 offen offset:0 sc1
    v_mfma_f32_16x16x32_bf16 v[192:195], v[88:91], v[8:11], v[192:195]
    v_mfma_f32_16x16x32_bf16 v[196:199], v[92:95], v[8:11], v[196:199]
    v_mfma_f32_16x16x32_bf16 v[200:203], v[72:75], v[8:11], v[200:203]
    buffer_load_dwordx4 v[68:71], v254, s[16:19], s53 offen offset:0 sc1
    v_mfma_f32_16x16x32_bf16 v[216:219], v[76:79], v[8:11], v[216:219]
    v_mfma_f32_16x16x32_bf16 v[220:223], v[80:83], v[8:11], v[220:223]
    ds_read_b128 v[8:11], v1 offset:8192
    v_mfma_f32_16x16x32_bf16 v[200:203], v[84:87], v[12:15], v[200:203]
    ds_write_b32 v255, v252 offset:288
    buffer_load_dwordx4 v[72:75], v7, s[16:19], s53 offen offset:1024 sc1
    v_mfma_f32_16x16x32_bf16 v[216:219], v[88:91], v[12:15], v[216:219]
    v_mfma_f32_16x16x32_bf16 v[220:223], v[92:95], v[12:15], v[220:223]
    ds_read_b128 v[12:15], v1 offset:2048
    s_waitcnt vmcnt(10) lgkmcnt(4)
    v_mfma_f32_16x16x32_bf16 v[108:111], v[24:27], v[16:19], v[108:111]
    buffer_load_dwordx4 v[76:79], v253, s[16:19], s53 offen offset:1024 sc1
    v_mfma_f32_16x16x32_bf16 v[112:115], v[28:31], v[16:19], v[112:115]
    v_mfma_f32_16x16x32_bf16 v[116:119], v[32:35], v[16:19], v[116:119]
    ds_read_b128 v[16:19], v1 offset:9216
    s_waitcnt vmcnt(8) lgkmcnt(4)
    v_mfma_f32_16x16x32_bf16 v[108:111], v[36:39], v[20:23], v[108:111]
    buffer_load_dwordx4 v[80:83], v254, s[16:19], s53 offen offset:1024 sc1
    v_mfma_f32_16x16x32_bf16 v[112:115], v[40:43], v[20:23], v[112:115]
    v_mfma_f32_16x16x32_bf16 v[116:119], v[44:47], v[20:23], v[116:119]
    v_mfma_f32_16x16x32_bf16 v[132:135], v[24:27], v[20:23], v[132:135]
    buffer_load_dwordx4 v[84:87], v7, s[16:19], s53 offen offset:2048 sc1
    v_mfma_f32_16x16x32_bf16 v[136:139], v[28:31], v[20:23], v[136:139]
    v_mfma_f32_16x16x32_bf16 v[140:143], v[32:35], v[20:23], v[140:143]
    ds_read_b128 v[20:23], v1 offset:3072
    s_waitcnt lgkmcnt(4)
    v_mfma_f32_16x16x32_bf16 v[244:247], v[24:27], v[8:11], v[244:247]
    ds_read_b128 v[8:11], v1 offset:10240
    s_waitcnt vmcnt(7) lgkmcnt(3)
    v_mfma_f32_16x16x32_bf16 v[108:111], v[48:51], v[12:15], v[108:111]
    buffer_load_dwordx4 v[88:91], v253, s[16:19], s53 offen offset:2048 sc1
    v_mfma_f32_16x16x32_bf16 v[112:115], v[52:55], v[12:15], v[112:115]
    v_mfma_f32_16x16x32_bf16 v[116:119], v[56:59], v[12:15], v[116:119]
    buffer_load_dwordx4 v[92:95], v254, s[16:19], s53 offen offset:2048 sc1
    v_mfma_f32_16x16x32_bf16 v[132:135], v[36:39], v[12:15], v[132:135]
    v_mfma_f32_16x16x32_bf16 v[136:139], v[40:43], v[12:15], v[136:139]
    v_mfma_f32_16x16x32_bf16 v[140:143], v[44:47], v[12:15], v[140:143]
    v_mfma_f32_16x16x32_bf16 v[156:159], v[24:27], v[12:15], v[156:159]
    v_mfma_f32_16x16x32_bf16 v[160:163], v[28:31], v[12:15], v[160:163]
    v_mfma_f32_16x16x32_bf16 v[164:167], v[32:35], v[12:15], v[164:167]
    ds_read_b128 v[12:15], v1 offset:4096
    s_waitcnt lgkmcnt(3)
    v_mfma_f32_16x16x32_bf16 v[244:247], v[36:39], v[16:19], v[244:247]
    ds_read_b128 v[16:19], v1 offset:5120
    s_waitcnt lgkmcnt(3)
    v_mfma_f32_16x16x32_bf16 v[132:135], v[48:51], v[20:23], v[132:135]
    v_mfma_f32_16x16x32_bf16 v[136:139], v[52:55], v[20:23], v[136:139]
    v_mfma_f32_16x16x32_bf16 v[140:143], v[56:59], v[20:23], v[140:143]
    v_mfma_f32_16x16x32_bf16 v[156:159], v[36:39], v[20:23], v[156:159]
    v_mfma_f32_16x16x32_bf16 v[160:163], v[40:43], v[20:23], v[160:163]
    v_mfma_f32_16x16x32_bf16 v[164:167], v[44:47], v[20:23], v[164:167]
    v_mfma_f32_16x16x32_bf16 v[180:183], v[24:27], v[20:23], v[180:183]
    v_mfma_f32_16x16x32_bf16 v[184:187], v[28:31], v[20:23], v[184:187]
    v_mfma_f32_16x16x32_bf16 v[188:191], v[32:35], v[20:23], v[188:191]
    ds_read_b128 v[20:23], v1 offset:6144
    s_waitcnt lgkmcnt(3)
    v_mfma_f32_16x16x32_bf16 v[244:247], v[48:51], v[8:11], v[244:247]
    ds_read_b128 v[8:11], v1 offset:7168
    s_waitcnt lgkmcnt(3)
    v_mfma_f32_16x16x32_bf16 v[156:159], v[48:51], v[12:15], v[156:159]
    v_mfma_f32_16x16x32_bf16 v[160:163], v[52:55], v[12:15], v[160:163]
    v_mfma_f32_16x16x32_bf16 v[164:167], v[56:59], v[12:15], v[164:167]
    v_mfma_f32_16x16x32_bf16 v[180:183], v[36:39], v[12:15], v[180:183]
    v_mfma_f32_16x16x32_bf16 v[184:187], v[40:43], v[12:15], v[184:187]
    v_mfma_f32_16x16x32_bf16 v[188:191], v[44:47], v[12:15], v[188:191]
    v_mfma_f32_16x16x32_bf16 v[204:207], v[24:27], v[12:15], v[204:207]
    v_mfma_f32_16x16x32_bf16 v[208:211], v[28:31], v[12:15], v[208:211]
    v_mfma_f32_16x16x32_bf16 v[212:215], v[32:35], v[12:15], v[212:215]
    ds_read_b128 v[12:15], v1 offset:11264
    s_waitcnt lgkmcnt(3)
    v_mfma_f32_16x16x32_bf16 v[180:183], v[48:51], v[16:19], v[180:183]
    v_mfma_f32_16x16x32_bf16 v[184:187], v[52:55], v[16:19], v[184:187]
    v_mfma_f32_16x16x32_bf16 v[188:191], v[56:59], v[16:19], v[188:191]
    v_mfma_f32_16x16x32_bf16 v[204:207], v[36:39], v[16:19], v[204:207]
    v_mfma_f32_16x16x32_bf16 v[208:211], v[40:43], v[16:19], v[208:211]
    s_mov_b32 s53, 73728
    v_mfma_f32_16x16x32_bf16 v[212:215], v[44:47], v[16:19], v[212:215]
    v_mfma_f32_16x16x32_bf16 v[228:231], v[24:27], v[16:19], v[228:231]
    buffer_load_dwordx4 v[24:27], v7, s[16:19], s53 offen offset:0 sc1
    v_mfma_f32_16x16x32_bf16 v[232:235], v[28:31], v[16:19], v[232:235]
    v_mfma_f32_16x16x32_bf16 v[236:239], v[32:35], v[16:19], v[236:239]
    ds_read_b128 v[16:19], v1 offset:12288
    s_waitcnt lgkmcnt(3)
    v_mfma_f32_16x16x32_bf16 v[204:207], v[48:51], v[20:23], v[204:207]
    buffer_load_dwordx4 v[28:31], v253, s[16:19], s53 offen offset:0 sc1
    v_mfma_f32_16x16x32_bf16 v[208:211], v[52:55], v[20:23], v[208:211]
    v_mfma_f32_16x16x32_bf16 v[212:215], v[56:59], v[20:23], v[212:215]
    v_mfma_f32_16x16x32_bf16 v[228:231], v[36:39], v[20:23], v[228:231]
    buffer_load_dwordx4 v[32:35], v254, s[16:19], s53 offen offset:0 sc1
    v_mfma_f32_16x16x32_bf16 v[232:235], v[40:43], v[20:23], v[232:235]
    v_mfma_f32_16x16x32_bf16 v[236:239], v[44:47], v[20:23], v[236:239]
    ds_read_b128 v[20:23], v1 offset:19456
    s_waitcnt lgkmcnt(3)
    v_mfma_f32_16x16x32_bf16 v[228:231], v[48:51], v[8:11], v[228:231]
    buffer_load_dwordx4 v[36:39], v7, s[16:19], s53 offen offset:1024 sc1
    v_mfma_f32_16x16x32_bf16 v[232:235], v[52:55], v[8:11], v[232:235]
    v_mfma_f32_16x16x32_bf16 v[236:239], v[56:59], v[8:11], v[236:239]
    ds_read_b128 v[8:11], v1 offset:13312
    s_waitcnt vmcnt(10) lgkmcnt(3)
    v_mfma_f32_16x16x32_bf16 v[108:111], v[60:63], v[12:15], v[108:111]
    buffer_load_dwordx4 v[40:43], v253, s[16:19], s53 offen offset:1024 sc1
    v_mfma_f32_16x16x32_bf16 v[112:115], v[64:67], v[12:15], v[112:115]
    v_mfma_f32_16x16x32_bf16 v[116:119], v[68:71], v[12:15], v[116:119]
    ds_read_b128 v[12:15], v1 offset:20480
    s_waitcnt vmcnt(8) lgkmcnt(3)
    v_mfma_f32_16x16x32_bf16 v[108:111], v[72:75], v[16:19], v[108:111]
    buffer_load_dwordx4 v[44:47], v254, s[16:19], s53 offen offset:1024 sc1
    v_mfma_f32_16x16x32_bf16 v[112:115], v[76:79], v[16:19], v[112:115]
    v_mfma_f32_16x16x32_bf16 v[116:119], v[80:83], v[16:19], v[116:119]
    v_mfma_f32_16x16x32_bf16 v[132:135], v[60:63], v[16:19], v[132:135]
    buffer_load_dwordx4 v[48:51], v7, s[16:19], s53 offen offset:2048 sc1
    v_mfma_f32_16x16x32_bf16 v[136:139], v[64:67], v[16:19], v[136:139]
    v_mfma_f32_16x16x32_bf16 v[140:143], v[68:71], v[16:19], v[140:143]
    ds_read_b128 v[16:19], v1 offset:14336
    s_waitcnt lgkmcnt(3)
    v_mfma_f32_16x16x32_bf16 v[244:247], v[60:63], v[20:23], v[244:247]
    ds_read_b128 v[20:23], v1 offset:21504
    s_waitcnt vmcnt(7) lgkmcnt(3)
    v_mfma_f32_16x16x32_bf16 v[108:111], v[84:87], v[8:11], v[108:111]
    buffer_load_dwordx4 v[52:55], v253, s[16:19], s53 offen offset:2048 sc1
    v_mfma_f32_16x16x32_bf16 v[112:115], v[88:91], v[8:11], v[112:115]
    v_mfma_f32_16x16x32_bf16 v[116:119], v[92:95], v[8:11], v[116:119]
    buffer_load_dwordx4 v[56:59], v254, s[16:19], s53 offen offset:2048 sc1
    v_mfma_f32_16x16x32_bf16 v[132:135], v[72:75], v[8:11], v[132:135]
    v_mfma_f32_16x16x32_bf16 v[136:139], v[76:79], v[8:11], v[136:139]
    v_mfma_f32_16x16x32_bf16 v[140:143], v[80:83], v[8:11], v[140:143]
    v_mfma_f32_16x16x32_bf16 v[156:159], v[60:63], v[8:11], v[156:159]
    v_mfma_f32_16x16x32_bf16 v[160:163], v[64:67], v[8:11], v[160:163]
    v_mfma_f32_16x16x32_bf16 v[164:167], v[68:71], v[8:11], v[164:167]
    ds_read_b128 v[8:11], v1 offset:15360
    s_waitcnt lgkmcnt(3)
    v_mfma_f32_16x16x32_bf16 v[244:247], v[72:75], v[12:15], v[244:247]
    ds_read_b128 v[12:15], v1 offset:16384
    s_waitcnt lgkmcnt(3)
    v_mfma_f32_16x16x32_bf16 v[132:135], v[84:87], v[16:19], v[132:135]
    v_mfma_f32_16x16x32_bf16 v[136:139], v[88:91], v[16:19], v[136:139]
    v_mfma_f32_16x16x32_bf16 v[140:143], v[92:95], v[16:19], v[140:143]
    v_mfma_f32_16x16x32_bf16 v[156:159], v[72:75], v[16:19], v[156:159]
    v_mfma_f32_16x16x32_bf16 v[160:163], v[76:79], v[16:19], v[160:163]
    v_mfma_f32_16x16x32_bf16 v[164:167], v[80:83], v[16:19], v[164:167]
    v_mfma_f32_16x16x32_bf16 v[180:183], v[60:63], v[16:19], v[180:183]
    v_mfma_f32_16x16x32_bf16 v[184:187], v[64:67], v[16:19], v[184:187]
    v_mfma_f32_16x16x32_bf16 v[188:191], v[68:71], v[16:19], v[188:191]
    ds_read_b128 v[16:19], v1 offset:17408
    s_waitcnt lgkmcnt(3)
    v_mfma_f32_16x16x32_bf16 v[244:247], v[84:87], v[20:23], v[244:247]
    ds_read_b128 v[20:23], v1 offset:18432
    s_waitcnt lgkmcnt(3)
    v_mfma_f32_16x16x32_bf16 v[156:159], v[84:87], v[8:11], v[156:159]
    ds_read_b32 v0, v2 offset:35280
    v_mfma_f32_16x16x32_bf16 v[160:163], v[88:91], v[8:11], v[160:163]
    v_mfma_f32_16x16x32_bf16 v[164:167], v[92:95], v[8:11], v[164:167]
    v_mfma_f32_16x16x32_bf16 v[180:183], v[72:75], v[8:11], v[180:183]
    v_mfma_f32_16x16x32_bf16 v[184:187], v[76:79], v[8:11], v[184:187]
    v_mfma_f32_16x16x32_bf16 v[188:191], v[80:83], v[8:11], v[188:191]
    v_mfma_f32_16x16x32_bf16 v[204:207], v[60:63], v[8:11], v[204:207]
    s_waitcnt lgkmcnt(0)
    v_readfirstlane_b32 s47, v0
    v_mfma_f32_16x16x32_bf16 v[208:211], v[64:67], v[8:11], v[208:211]
    s_cmp_eq_u32 s47, 4
    s_cbranch_scc0 L_CKxrdy4_spin
L_CKxrdy4:
    v_mfma_f32_16x16x32_bf16 v[212:215], v[68:71], v[8:11], v[212:215]
    ds_read_b128 v[8:11], v1 offset:22528
    v_mfma_f32_16x16x32_bf16 v[180:183], v[84:87], v[12:15], v[180:183]
    v_mfma_f32_16x16x32_bf16 v[184:187], v[88:91], v[12:15], v[184:187]
    v_mfma_f32_16x16x32_bf16 v[188:191], v[92:95], v[12:15], v[188:191]
    v_mfma_f32_16x16x32_bf16 v[204:207], v[72:75], v[12:15], v[204:207]
    v_mfma_f32_16x16x32_bf16 v[208:211], v[76:79], v[12:15], v[208:211]
    s_mov_b32 s53, 110592
    v_mfma_f32_16x16x32_bf16 v[212:215], v[80:83], v[12:15], v[212:215]
    v_mfma_f32_16x16x32_bf16 v[228:231], v[60:63], v[12:15], v[228:231]
    buffer_load_dwordx4 v[60:63], v7, s[16:19], s53 offen offset:0 sc1
    v_mfma_f32_16x16x32_bf16 v[232:235], v[64:67], v[12:15], v[232:235]
    v_mfma_f32_16x16x32_bf16 v[236:239], v[68:71], v[12:15], v[236:239]
    ds_read_b128 v[12:15], v1 offset:23552
    v_mfma_f32_16x16x32_bf16 v[204:207], v[84:87], v[16:19], v[204:207]
    buffer_load_dwordx4 v[64:67], v253, s[16:19], s53 offen offset:0 sc1
    v_mfma_f32_16x16x32_bf16 v[208:211], v[88:91], v[16:19], v[208:211]
    v_mfma_f32_16x16x32_bf16 v[212:215], v[92:95], v[16:19], v[212:215]
    v_mfma_f32_16x16x32_bf16 v[228:231], v[72:75], v[16:19], v[228:231]
    buffer_load_dwordx4 v[68:71], v254, s[16:19], s53 offen offset:0 sc1
    v_mfma_f32_16x16x32_bf16 v[232:235], v[76:79], v[16:19], v[232:235]
    v_mfma_f32_16x16x32_bf16 v[236:239], v[80:83], v[16:19], v[236:239]
    ds_read_b128 v[16:19], v1 offset:30720
    v_mfma_f32_16x16x32_bf16 v[228:231], v[84:87], v[20:23], v[228:231]
    ds_write_b32 v255, v252 offset:304
    buffer_load_dwordx4 v[72:75], v7, s[16:19], s53 offen offset:1024 sc1
    v_mfma_f32_16x16x32_bf16 v[232:235], v[88:91], v[20:23], v[232:235]
    v_mfma_f32_16x16x32_bf16 v[236:239], v[92:95], v[20:23], v[236:239]
    ds_read_b128 v[20:23], v1 offset:24576
    s_waitcnt vmcnt(10) lgkmcnt(4)
    v_mfma_f32_16x16x32_bf16 v[248:251], v[24:27], v[8:11], v[248:251]
    buffer_load_dwordx4 v[76:79], v253, s[16:19], s53 offen offset:1024 sc1
    v_mfma_f32_16x16x32_bf16 v[96:99], v[28:31], v[8:11], v[96:99]
    v_mfma_f32_16x16x32_bf16 v[100:103], v[32:35], v[8:11], v[100:103]
    ds_read_b128 v[8:11], v1 offset:31744
    s_waitcnt vmcnt(8) lgkmcnt(4)
    v_mfma_f32_16x16x32_bf16 v[248:251], v[36:39], v[12:15], v[248:251]
    buffer_load_dwordx4 v[80:83], v254, s[16:19], s53 offen offset:1024 sc1
    v_mfma_f32_16x16x32_bf16 v[96:99], v[40:43], v[12:15], v[96:99]
    v_mfma_f32_16x16x32_bf16 v[100:103], v[44:47], v[12:15], v[100:103]
    v_mfma_f32_16x16x32_bf16 v[104:107], v[24:27], v[12:15], v[104:107]
    buffer_load_dwordx4 v[84:87], v7, s[16:19], s53 offen offset:2048 sc1
    v_mfma_f32_16x16x32_bf16 v[120:123], v[28:31], v[12:15], v[120:123]
    v_mfma_f32_16x16x32_bf16 v[124:127], v[32:35], v[12:15], v[124:127]
    ds_read_b128 v[12:15], v1 offset:25600
    s_waitcnt lgkmcnt(4)
    v_mfma_f32_16x16x32_bf16 v[128:131], v[24:27], v[16:19], v[128:131]
    ds_read_b128 v[16:19], v2 offset:0
    s_waitcnt vmcnt(7) lgkmcnt(3)
    v_mfma_f32_16x16x32_bf16 v[248:251], v[48:51], v[20:23], v[248:251]
    buffer_load_dwordx4 v[88:91], v253, s[16:19], s53 offen offset:2048 sc1
    v_mfma_f32_16x16x32_bf16 v[96:99], v[52:55], v[20:23], v[96:99]
    v_mfma_f32_16x16x32_bf16 v[100:103], v[56:59], v[20:23], v[100:103]
    buffer_load_dwordx4 v[92:95], v254, s[16:19], s53 offen offset:2048 sc1
    v_mfma_f32_16x16x32_bf16 v[104:107], v[36:39], v[20:23], v[104:107]
    v_mfma_f32_16x16x32_bf16 v[120:123], v[40:43], v[20:23], v[120:123]
    v_mfma_f32_16x16x32_bf16 v[124:127], v[44:47], v[20:23], v[124:127]
    v_mfma_f32_16x16x32_bf16 v[240:243], v[24:27], v[20:23], v[240:243]
    v_mfma_f32_16x16x32_bf16 v[144:147], v[28:31], v[20:23], v[144:147]
    v_mfma_f32_16x16x32_bf16 v[148:151], v[32:35], v[20:23], v[148:151]
    ds_read_b128 v[20:23], v1 offset:26624
    s_waitcnt lgkmcnt(3)
    v_mfma_f32_16x16x32_bf16 v[128:131], v[36:39], v[8:11], v[128:131]
    ds_read_b128 v[8:11], v1 offset:27648
    s_waitcnt lgkmcnt(3)
    v_mfma_f32_16x16x32_bf16 v[104:107], v[48:51], v[12:15], v[104:107]
    v_mfma_f32_16x16x32_bf16 v[120:123], v[52:55], v[12:15], v[120:123]
    v_mfma_f32_16x16x32_bf16 v[124:127], v[56:59], v[12:15], v[124:127]
    v_mfma_f32_16x16x32_bf16 v[240:243], v[36:39], v[12:15], v[240:243]
    v_mfma_f32_16x16x32_bf16 v[144:147], v[40:43], v[12:15], v[144:147]
    v_mfma_f32_16x16x32_bf16 v[148:151], v[44:47], v[12:15], v[148:151]
    v_mfma_f32_16x16x32_bf16 v[152:155], v[24:27], v[12:15], v[152:155]
    v_mfma_f32_16x16x32_bf16 v[168:171], v[28:31], v[12:15], v[168:171]
    v_mfma_f32_16x16x32_bf16 v[172:175], v[32:35], v[12:15], v[172:175]
    ds_read_b128 v[12:15], v1 offset:28672
    s_waitcnt lgkmcnt(3)
    v_mfma_f32_16x16x32_bf16 v[128:131], v[48:51], v[16:19], v[128:131]
    ds_read_b128 v[16:19], v1 offset:29696
    s_waitcnt lgkmcnt(3)
    v_mfma_f32_16x16x32_bf16 v[240:243], v[48:51], v[20:23], v[240:243]
    v_mfma_f32_16x16x32_bf16 v[144:147], v[52:55], v[20:23], v[144:147]
    v_mfma_f32_16x16x32_bf16 v[148:151], v[56:59], v[20:23], v[148:151]
    v_mfma_f32_16x16x32_bf16 v[152:155], v[36:39], v[20:23], v[152:155]
    v_mfma_f32_16x16x32_bf16 v[168:171], v[40:43], v[20:23], v[168:171]
    v_mfma_f32_16x16x32_bf16 v[172:175], v[44:47], v[20:23], v[172:175]
    v_mfma_f32_16x16x32_bf16 v[176:179], v[24:27], v[20:23], v[176:179]
    v_mfma_f32_16x16x32_bf16 v[192:195], v[28:31], v[20:23], v[192:195]
    v_mfma_f32_16x16x32_bf16 v[196:199], v[32:35], v[20:23], v[196:199]
    ds_read_b128 v[20:23], v2 offset:1024
    s_waitcnt lgkmcnt(3)
    v_mfma_f32_16x16x32_bf16 v[152:155], v[48:51], v[8:11], v[152:155]
    v_mfma_f32_16x16x32_bf16 v[168:171], v[52:55], v[8:11], v[168:171]
    v_mfma_f32_16x16x32_bf16 v[172:175], v[56:59], v[8:11], v[172:175]
    v_mfma_f32_16x16x32_bf16 v[176:179], v[36:39], v[8:11], v[176:179]
    v_mfma_f32_16x16x32_bf16 v[192:195], v[40:43], v[8:11], v[192:195]
    s_mov_b32 s53, 294912
    v_mfma_f32_16x16x32_bf16 v[196:199], v[44:47], v[8:11], v[196:199]
    v_mfma_f32_16x16x32_bf16 v[200:203], v[24:27], v[8:11], v[200:203]
    buffer_load_dwordx4 v[24:27], v7, s[16:19], s53 offen offset:0 sc1
    v_mfma_f32_16x16x32_bf16 v[216:219], v[28:31], v[8:11], v[216:219]
    v_mfma_f32_16x16x32_bf16 v[220:223], v[32:35], v[8:11], v[220:223]
    ds_read_b128 v[8:11], v2 offset:2048
    s_waitcnt lgkmcnt(3)
    v_mfma_f32_16x16x32_bf16 v[176:179], v[48:51], v[12:15], v[176:179]
    buffer_load_dwordx4 v[28:31], v253, s[16:19], s53 offen offset:0 sc1
    v_mfma_f32_16x16x32_bf16 v[192:195], v[52:55], v[12:15], v[192:195]
    v_mfma_f32_16x16x32_bf16 v[196:199], v[56:59], v[12:15], v[196:199]
    v_mfma_f32_16x16x32_bf16 v[200:203], v[36:39], v[12:15], v[200:203]
    buffer_load_dwordx4 v[32:35], v254, s[16:19], s53 offen offset:0 sc1
    v_mfma_f32_16x16x32_bf16 v[216:219], v[40:43], v[12:15], v[216:219]
    v_mfma_f32_16x16x32_bf16 v[220:223], v[44:47], v[12:15], v[220:223]
    ds_read_b128 v[12:15], v2 offset:9216
    s_waitcnt lgkmcnt(3)
    v_mfma_f32_16x16x32_bf16 v[200:203], v[48:51], v[16:19], v[200:203]
    buffer_load_dwordx4 v[36:39], v7, s[16:19], s53 offen offset:1024 sc1
    v_mfma_f32_16x16x32_bf16 v[216:219], v[52:55], v[16:19], v[216:219]
    v_mfma_f32_16x16x32_bf16 v[220:223], v[56:59], v[16:19], v[220:223]
    ds_read_b128 v[16:19], v2 offset:3072
    s_waitcnt vmcnt(10) lgkmcnt(3)
    v_mfma_f32_16x16x32_bf16 v[248:251], v[60:63], v[20:23], v[248:251]
    buffer_load_dwordx4 v[40:43], v253, s[16:19], s53 offen offset:1024 sc1
    v_mfma_f32_16x16x32_bf16 v[96:99], v[64:67], v[20:23], v[96:99]
    v_mfma_f32_16x16x32_bf16 v[100:103], v[68:71], v[20:23], v[100:103]
    ds_read_b128 v[20:23], v2 offset:10240
    s_waitcnt vmcnt(8) lgkmcnt(3)
    v_mfma_f32_16x16x32_bf16 v[248:251], v[72:75], v[8:11], v[248:251]
    buffer_load_dwordx4 v[44:47], v254, s[16:19], s53 offen offset:1024 sc1
    v_mfma_f32_16x16x32_bf16 v[96:99], v[76:79], v[8:11], v[96:99]
    v_mfma_f32_16x16x32_bf16 v[100:103], v[80:83], v[8:11], v[100:103]
    v_mfma_f32_16x16x32_bf16 v[104:107], v[60:63], v[8:11], v[104:107]
    buffer_load_dwordx4 v[48:51], v7, s[16:19], s53 offen offset:2048 sc1
    v_mfma_f32_16x16x32_bf16 v[120:123], v[64:67], v[8:11], v[120:123]
    v_mfma_f32_16x16x32_bf16 v[124:127], v[68:71], v[8:11], v[124:127]
    ds_read_b128 v[8:11], v2 offset:4096
    s_waitcnt lgkmcnt(3)
    v_mfma_f32_16x16x32_bf16 v[128:131], v[60:63], v[12:15], v[128:131]
    ds_read_b128 v[12:15], v2 offset:11264
    s_waitcnt vmcnt(7) lgkmcnt(3)
    v_mfma_f32_16x16x32_bf16 v[248:251], v[84:87], v[16:19], v[248:251]
    buffer_load_dwordx4 v[52:55], v253, s[16:19], s53 offen offset:2048 sc1
    v_mfma_f32_16x16x32_bf16 v[96:99], v[88:91], v[16:19], v[96:99]
    v_mfma_f32_16x16x32_bf16 v[100:103], v[92:95], v[16:19], v[100:103]
    buffer_load_dwordx4 v[56:59], v254, s[16:19], s53 offen offset:2048 sc1
    v_mfma_f32_16x16x32_bf16 v[104:107], v[72:75], v[16:19], v[104:107]
    v_mfma_f32_16x16x32_bf16 v[120:123], v[76:79], v[16:19], v[120:123]
    v_mfma_f32_16x16x32_bf16 v[124:127], v[80:83], v[16:19], v[124:127]
    v_mfma_f32_16x16x32_bf16 v[240:243], v[60:63], v[16:19], v[240:243]
    v_mfma_f32_16x16x32_bf16 v[144:147], v[64:67], v[16:19], v[144:147]
    v_mfma_f32_16x16x32_bf16 v[148:151], v[68:71], v[16:19], v[148:151]
    ds_read_b128 v[16:19], v2 offset:5120
    s_waitcnt lgkmcnt(3)
    v_mfma_f32_16x16x32_bf16 v[128:131], v[72:75], v[20:23], v[128:131]
    ds_read_b128 v[20:23], v2 offset:6144
    s_waitcnt lgkmcnt(3)
    v_mfma_f32_16x16x32_bf16 v[104:107], v[84:87], v[8:11], v[104:107]
    v_mfma_f32_16x16x32_bf16 v[120:123], v[88:91], v[8:11], v[120:123]
    v_mfma_f32_16x16x32_bf16 v[124:127], v[92:95], v[8:11], v[124:127]
    v_mfma_f32_16x16x32_bf16 v[240:243], v[72:75], v[8:11], v[240:243]
    v_mfma_f32_16x16x32_bf16 v[144:147], v[76:79], v[8:11], v[144:147]
    v_mfma_f32_16x16x32_bf16 v[148:151], v[80:83], v[8:11], v[148:151]
    v_mfma_f32_16x16x32_bf16 v[152:155], v[60:63], v[8:11], v[152:155]
    v_mfma_f32_16x16x32_bf16 v[168:171], v[64:67], v[8:11], v[168:171]
    v_mfma_f32_16x16x32_bf16 v[172:175], v[68:71], v[8:11], v[172:175]
    ds_read_b128 v[8:11], v2 offset:7168
    s_waitcnt lgkmcnt(3)
    v_mfma_f32_16x16x32_bf16 v[128:131], v[84:87], v[12:15], v[128:131]
    ds_read_b128 v[12:15], v2 offset:8192
    s_waitcnt lgkmcnt(3)
    v_mfma_f32_16x16x32_bf16 v[240:243], v[84:87], v[16:19], v[240:243]
    ds_read_b32 v0, v2 offset:35284
    v_mfma_f32_16x16x32_bf16 v[144:147], v[88:91], v[16:19], v[144:147]
    v_mfma_f32_16x16x32_bf16 v[148:151], v[92:95], v[16:19], v[148:151]
    v_mfma_f32_16x16x32_bf16 v[152:155], v[72:75], v[16:19], v[152:155]
    v_mfma_f32_16x16x32_bf16 v[168:171], v[76:79], v[16:19], v[168:171]
    v_mfma_f32_16x16x32_bf16 v[172:175], v[80:83], v[16:19], v[172:175]
    v_mfma_f32_16x16x32_bf16 v[176:179], v[60:63], v[16:19], v[176:179]
    s_waitcnt lgkmcnt(0)
    v_readfirstlane_b32 s47, v0
    v_mfma_f32_16x16x32_bf16 v[192:195], v[64:67], v[16:19], v[192:195]
    s_cmp_eq_u32 s47, 4
    s_cbranch_scc0 L_CKxrdy5_spin
L_CKxrdy5:
    v_mfma_f32_16x16x32_bf16 v[196:199], v[68:71], v[16:19], v[196:199]
    ds_read_b128 v[16:19], v2 offset:12288
    v_mfma_f32_16x16x32_bf16 v[152:155], v[84:87], v[20:23], v[152:155]
    v_mfma_f32_16x16x32_bf16 v[168:171], v[88:91], v[20:23], v[168:171]
    v_mfma_f32_16x16x32_bf16 v[172:175], v[92:95], v[20:23], v[172:175]
    v_mfma_f32_16x16x32_bf16 v[176:179], v[72:75], v[20:23], v[176:179]
    v_mfma_f32_16x16x32_bf16 v[192:195], v[76:79], v[20:23], v[192:195]
    s_mov_b32 s53, 331776
    v_mfma_f32_16x16x32_bf16 v[196:199], v[80:83], v[20:23], v[196:199]
    v_mfma_f32_16x16x32_bf16 v[200:203], v[60:63], v[20:23], v[200:203]
    buffer_load_dwordx4 v[60:63], v7, s[16:19], s53 offen offset:0 sc1
    v_mfma_f32_16x16x32_bf16 v[216:219], v[64:67], v[20:23], v[216:219]
    v_mfma_f32_16x16x32_bf16 v[220:223], v[68:71], v[20:23], v[220:223]
    ds_read_b128 v[20:23], v2 offset:13312
    v_mfma_f32_16x16x32_bf16 v[176:179], v[84:87], v[8:11], v[176:179]
    buffer_load_dwordx4 v[64:67], v253, s[16:19], s53 offen offset:0 sc1
    v_mfma_f32_16x16x32_bf16 v[192:195], v[88:91], v[8:11], v[192:195]
    v_mfma_f32_16x16x32_bf16 v[196:199], v[92:95], v[8:11], v[196:199]
    v_mfma_f32_16x16x32_bf16 v[200:203], v[72:75], v[8:11], v[200:203]
    buffer_load_dwordx4 v[68:71], v254, s[16:19], s53 offen offset:0 sc1
    v_mfma_f32_16x16x32_bf16 v[216:219], v[76:79], v[8:11], v[216:219]
    v_mfma_f32_16x16x32_bf16 v[220:223], v[80:83], v[8:11], v[220:223]
    ds_read_b128 v[8:11], v2 offset:20480
    v_mfma_f32_16x16x32_bf16 v[200:203], v[84:87], v[12:15], v[200:203]
    ds_write_b32 v255, v252 offset:320
    buffer_load_dwordx4 v[72:75], v7, s[16:19], s53 offen offset:1024 sc1
    v_mfma_f32_16x16x32_bf16 v[216:219], v[88:91], v[12:15], v[216:219]
    v_mfma_f32_16x16x32_bf16 v[220:223], v[92:95], v[12:15], v[220:223]
    ds_read_b128 v[12:15], v2 offset:14336
    s_waitcnt vmcnt(10) lgkmcnt(4)
    v_mfma_f32_16x16x32_bf16 v[108:111], v[24:27], v[16:19], v[108:111]
    buffer_load_dwordx4 v[76:79], v253, s[16:19], s53 offen offset:1024 sc1
    v_lshrrev_b32 v6, 8, v1
    v_mfma_f32_16x16x32_bf16 v[112:115], v[28:31], v[16:19], v[112:115]
    v_bfe_u32 v5, v1, 4, 4
    v_xor_b32 v5, v5, v6
    v_mfma_f32_16x16x32_bf16 v[116:119], v[32:35], v[16:19], v[116:119]
    ds_read_b128 v[16:19], v2 offset:21504
    s_waitcnt vmcnt(8) lgkmcnt(4)
    v_mfma_f32_16x16x32_bf16 v[108:111], v[36:39], v[20:23], v[108:111]
    buffer_load_dwordx4 v[80:83], v254, s[16:19], s53 offen offset:1024 sc1
    v_lshlrev_b32 v6, 3, v6
    v_mfma_f32_16x16x32_bf16 v[112:115], v[40:43], v[20:23], v[112:115]
    s_lshl_b32 s48, s36, 5
    s_add_u32 s48, s48, 144896
    v_mfma_f32_16x16x32_bf16 v[116:119], v[44:47], v[20:23], v[116:119]
    v_mul_u32_u24 v3, 144, v5
    v_add3_u32 v3, v3, v6, s48
    v_mfma_f32_16x16x32_bf16 v[132:135], v[24:27], v[20:23], v[132:135]
    buffer_load_dwordx4 v[84:87], v7, s[16:19], s53 offen offset:2048 sc1
    v_mul_u32_u24 v5, 400, v5
    v_mfma_f32_16x16x32_bf16 v[136:139], v[28:31], v[20:23], v[136:139]
    v_add_u32 v6, v5, v6
    s_mul_i32 s48, s36, 96
    v_mfma_f32_16x16x32_bf16 v[140:143], v[32:35], v[20:23], v[140:143]
    ds_read_b128 v[20:23], v2 offset:15360
    s_waitcnt lgkmcnt(4)
    v_mfma_f32_16x16x32_bf16 v[244:247], v[24:27], v[8:11], v[244:247]
    ds_read_b128 v[8:11], v2 offset:22528
    s_waitcnt vmcnt(7) lgkmcnt(3)
    v_mfma_f32_16x16x32_bf16 v[108:111], v[48:51], v[12:15], v[108:111]
    buffer_load_dwordx4 v[88:91], v253, s[16:19], s53 offen offset:2048 sc1
    s_add_u32 s48, s48, 68096
    v_mfma_f32_16x16x32_bf16 v[112:115], v[52:55], v[12:15], v[112:115]
    s_lshl_b32 s49, s43, 5
    s_add_u32 s49, s49, s48
    v_mfma_f32_16x16x32_bf16 v[116:119], v[56:59], v[12:15], v[116:119]
    buffer_load_dwordx4 v[92:95], v254, s[16:19], s53 offen offset:2048 sc1
    v_add_u32 v4, s49, v6
    v_mfma_f32_16x16x32_bf16 v[132:135], v[36:39], v[12:15], v[132:135]
    s_lshl_b32 s49, s44, 5
    s_add_u32 s49, s49, s48
    v_mfma_f32_16x16x32_bf16 v[136:139], v[40:43], v[12:15], v[136:139]
    v_add_u32 v5, s49, v6
    s_lshl_b32 s49, s45, 5
    v_mfma_f32_16x16x32_bf16 v[140:143], v[44:47], v[12:15], v[140:143]
    s_add_u32 s49, s49, s48
    v_add_u32 v6, s49, v6
    v_mfma_f32_16x16x32_bf16 v[156:159], v[24:27], v[12:15], v[156:159]
    v_mfma_f32_16x16x32_bf16 v[160:163], v[28:31], v[12:15], v[160:163]
    v_mfma_f32_16x16x32_bf16 v[164:167], v[32:35], v[12:15], v[164:167]
    ds_read_b128 v[12:15], v2 offset:16384
    s_waitcnt lgkmcnt(3)
    v_mfma_f32_16x16x32_bf16 v[244:247], v[36:39], v[16:19], v[244:247]
    ds_read_b128 v[16:19], v2 offset:17408
    s_waitcnt lgkmcnt(3)
    v_mfma_f32_16x16x32_bf16 v[132:135], v[48:51], v[20:23], v[132:135]
    v_mfma_f32_16x16x32_bf16 v[136:139], v[52:55], v[20:23], v[136:139]
    v_mfma_f32_16x16x32_bf16 v[140:143], v[56:59], v[20:23], v[140:143]
    v_mfma_f32_16x16x32_bf16 v[156:159], v[36:39], v[20:23], v[156:159]
    v_mfma_f32_16x16x32_bf16 v[160:163], v[40:43], v[20:23], v[160:163]
    v_mfma_f32_16x16x32_bf16 v[164:167], v[44:47], v[20:23], v[164:167]
    v_mfma_f32_16x16x32_bf16 v[180:183], v[24:27], v[20:23], v[180:183]
    v_mfma_f32_16x16x32_bf16 v[184:187], v[28:31], v[20:23], v[184:187]
    v_mfma_f32_16x16x32_bf16 v[188:191], v[32:35], v[20:23], v[188:191]
    ds_read_b128 v[20:23], v2 offset:18432
    s_waitcnt lgkmcnt(3)
    v_mfma_f32_16x16x32_bf16 v[244:247], v[48:51], v[8:11], v[244:247]
    ds_read_b128 v[8:11], v2 offset:19456
    s_waitcnt lgkmcnt(3)
    v_mfma_f32_16x16x32_bf16 v[156:159], v[48:51], v[12:15], v[156:159]
    v_mfma_f32_16x16x32_bf16 v[160:163], v[52:55], v[12:15], v[160:163]
    v_mfma_f32_16x16x32_bf16 v[164:167], v[56:59], v[12:15], v[164:167]
    v_mfma_f32_16x16x32_bf16 v[180:183], v[36:39], v[12:15], v[180:183]
    v_mfma_f32_16x16x32_bf16 v[184:187], v[40:43], v[12:15], v[184:187]
    v_mfma_f32_16x16x32_bf16 v[188:191], v[44:47], v[12:15], v[188:191]
    v_mfma_f32_16x16x32_bf16 v[204:207], v[24:27], v[12:15], v[204:207]
    v_mfma_f32_16x16x32_bf16 v[208:211], v[28:31], v[12:15], v[208:211]
    v_mfma_f32_16x16x32_bf16 v[212:215], v[32:35], v[12:15], v[212:215]
    ds_read_b128 v[12:15], v2 offset:23552
    s_waitcnt lgkmcnt(3)
    v_mfma_f32_16x16x32_bf16 v[180:183], v[48:51], v[16:19], v[180:183]
    v_mfma_f32_16x16x32_bf16 v[184:187], v[52:55], v[16:19], v[184:187]
    v_mfma_f32_16x16x32_bf16 v[188:191], v[56:59], v[16:19], v[188:191]
    v_mfma_f32_16x16x32_bf16 v[204:207], v[36:39], v[16:19], v[204:207]
    v_mfma_f32_16x16x32_bf16 v[208:211], v[40:43], v[16:19], v[208:211]
    s_mov_b32 s53, 147456
    v_mfma_f32_16x16x32_bf16 v[212:215], v[44:47], v[16:19], v[212:215]
    v_mfma_f32_16x16x32_bf16 v[228:231], v[24:27], v[16:19], v[228:231]
    buffer_load_dwordx4 v[24:27], v7, s[16:19], s53 offen offset:0 sc1
    v_mfma_f32_16x16x32_bf16 v[232:235], v[28:31], v[16:19], v[232:235]
    v_mfma_f32_16x16x32_bf16 v[236:239], v[32:35], v[16:19], v[236:239]
    ds_read_b128 v[16:19], v2 offset:24576
    s_waitcnt lgkmcnt(3)
    v_mfma_f32_16x16x32_bf16 v[204:207], v[48:51], v[20:23], v[204:207]
    buffer_load_dwordx4 v[28:31], v253, s[16:19], s53 offen offset:0 sc1
    v_mfma_f32_16x16x32_bf16 v[208:211], v[52:55], v[20:23], v[208:211]
    v_mfma_f32_16x16x32_bf16 v[212:215], v[56:59], v[20:23], v[212:215]
    v_mfma_f32_16x16x32_bf16 v[228:231], v[36:39], v[20:23], v[228:231]
    buffer_load_dwordx4 v[32:35], v254, s[16:19], s53 offen offset:0 sc1
    v_mfma_f32_16x16x32_bf16 v[232:235], v[40:43], v[20:23], v[232:235]
    v_mfma_f32_16x16x32_bf16 v[236:239], v[44:47], v[20:23], v[236:239]
    ds_read_b128 v[20:23], v2 offset:31744
    s_waitcnt lgkmcnt(3)
    v_mfma_f32_16x16x32_bf16 v[228:231], v[48:51], v[8:11], v[228:231]
    buffer_load_dwordx4 v[36:39], v7, s[16:19], s53 offen offset:1024 sc1
    v_mfma_f32_16x16x32_bf16 v[232:235], v[52:55], v[8:11], v[232:235]
    v_mfma_f32_16x16x32_bf16 v[236:239], v[56:59], v[8:11], v[236:239]
    ds_read_b128 v[8:11], v2 offset:25600
    s_waitcnt vmcnt(10) lgkmcnt(3)
    v_mfma_f32_16x16x32_bf16 v[108:111], v[60:63], v[12:15], v[108:111]
    buffer_load_dwordx4 v[40:43], v253, s[16:19], s53 offen offset:1024 sc1
    v_mfma_f32_16x16x32_bf16 v[112:115], v[64:67], v[12:15], v[112:115]
    v_mfma_f32_16x16x32_bf16 v[116:119], v[68:71], v[12:15], v[116:119]
    ds_read_b128 v[12:15], v2 offset:32768
    s_waitcnt vmcnt(8) lgkmcnt(3)
    v_mfma_f32_16x16x32_bf16 v[108:111], v[72:75], v[16:19], v[108:111]
    buffer_load_dwordx4 v[44:47], v254, s[16:19], s53 offen offset:1024 sc1
    v_mfma_f32_16x16x32_bf16 v[112:115], v[76:79], v[16:19], v[112:115]
    v_mfma_f32_16x16x32_bf16 v[116:119], v[80:83], v[16:19], v[116:119]
    v_mfma_f32_16x16x32_bf16 v[132:135], v[60:63], v[16:19], v[132:135]
    buffer_load_dwordx4 v[48:51], v7, s[16:19], s53 offen offset:2048 sc1
    v_mfma_f32_16x16x32_bf16 v[136:139], v[64:67], v[16:19], v[136:139]
    v_mfma_f32_16x16x32_bf16 v[140:143], v[68:71], v[16:19], v[140:143]
    ds_read_b128 v[16:19], v2 offset:26624
    s_waitcnt lgkmcnt(3)
    v_mfma_f32_16x16x32_bf16 v[244:247], v[60:63], v[20:23], v[244:247]
    ds_read_b128 v[20:23], v2 offset:33792
    s_waitcnt vmcnt(7) lgkmcnt(3)
    v_mfma_f32_16x16x32_bf16 v[108:111], v[84:87], v[8:11], v[108:111]
    buffer_load_dwordx4 v[52:55], v253, s[16:19], s53 offen offset:2048 sc1
    v_mfma_f32_16x16x32_bf16 v[112:115], v[88:91], v[8:11], v[112:115]
    v_mfma_f32_16x16x32_bf16 v[116:119], v[92:95], v[8:11], v[116:119]
    buffer_load_dwordx4 v[56:59], v254, s[16:19], s53 offen offset:2048 sc1
    v_mfma_f32_16x16x32_bf16 v[132:135], v[72:75], v[8:11], v[132:135]
    v_mfma_f32_16x16x32_bf16 v[136:139], v[76:79], v[8:11], v[136:139]
    v_mfma_f32_16x16x32_bf16 v[140:143], v[80:83], v[8:11], v[140:143]
    v_mfma_f32_16x16x32_bf16 v[156:159], v[60:63], v[8:11], v[156:159]
    v_mfma_f32_16x16x32_bf16 v[160:163], v[64:67], v[8:11], v[160:163]
    v_mfma_f32_16x16x32_bf16 v[164:167], v[68:71], v[8:11], v[164:167]
    ds_read_b128 v[8:11], v2 offset:27648
    s_waitcnt lgkmcnt(3)
    v_mfma_f32_16x16x32_bf16 v[244:247], v[72:75], v[12:15], v[244:247]
    ds_read_b128 v[12:15], v2 offset:28672
    s_waitcnt lgkmcnt(3)
    v_mfma_f32_16x16x32_bf16 v[132:135], v[84:87], v[16:19], v[132:135]
    v_mfma_f32_16x16x32_bf16 v[136:139], v[88:91], v[16:19], v[136:139]
    v_mfma_f32_16x16x32_bf16 v[140:143], v[92:95], v[16:19], v[140:143]
    v_mfma_f32_16x16x32_bf16 v[156:159], v[72:75], v[16:19], v[156:159]
    v_mfma_f32_16x16x32_bf16 v[160:163], v[76:79], v[16:19], v[160:163]
    v_mfma_f32_16x16x32_bf16 v[164:167], v[80:83], v[16:19], v[164:167]
    v_mfma_f32_16x16x32_bf16 v[180:183], v[60:63], v[16:19], v[180:183]
    v_mfma_f32_16x16x32_bf16 v[184:187], v[64:67], v[16:19], v[184:187]
    v_mfma_f32_16x16x32_bf16 v[188:191], v[68:71], v[16:19], v[188:191]
    ds_read_b128 v[16:19], v2 offset:29696
    s_waitcnt lgkmcnt(3)
    v_mfma_f32_16x16x32_bf16 v[244:247], v[84:87], v[20:23], v[244:247]
    ds_read_b128 v[20:23], v2 offset:30720
    s_waitcnt lgkmcnt(3)
    v_mfma_f32_16x16x32_bf16 v[156:159], v[84:87], v[8:11], v[156:159]
    ds_read_b32 v0, v2 offset:35288
    v_mfma_f32_16x16x32_bf16 v[160:163], v[88:91], v[8:11], v[160:163]
    v_mfma_f32_16x16x32_bf16 v[164:167], v[92:95], v[8:11], v[164:167]
    v_mfma_f32_16x16x32_bf16 v[180:183], v[72:75], v[8:11], v[180:183]
    v_mfma_f32_16x16x32_bf16 v[184:187], v[76:79], v[8:11], v[184:187]
    v_mfma_f32_16x16x32_bf16 v[188:191], v[80:83], v[8:11], v[188:191]
    v_mfma_f32_16x16x32_bf16 v[204:207], v[60:63], v[8:11], v[204:207]
    s_waitcnt lgkmcnt(0)
    v_readfirstlane_b32 s47, v0
    v_mfma_f32_16x16x32_bf16 v[208:211], v[64:67], v[8:11], v[208:211]
    s_cmp_eq_u32 s47, 4
    s_cbranch_scc0 L_CKxrdy6_spin
L_CKxrdy6:
    v_mfma_f32_16x16x32_bf16 v[212:215], v[68:71], v[8:11], v[212:215]
    ds_read_b128 v[8:11], v1 offset:0
    v_mfma_f32_16x16x32_bf16 v[180:183], v[84:87], v[12:15], v[180:183]
    v_mfma_f32_16x16x32_bf16 v[184:187], v[88:91], v[12:15], v[184:187]
    v_mfma_f32_16x16x32_bf16 v[188:191], v[92:95], v[12:15], v[188:191]
    v_mfma_f32_16x16x32_bf16 v[204:207], v[72:75], v[12:15], v[204:207]
    v_mfma_f32_16x16x32_bf16 v[208:211], v[76:79], v[12:15], v[208:211]
    s_mov_b32 s53, 184320
    v_mfma_f32_16x16x32_bf16 v[212:215], v[80:83], v[12:15], v[212:215]
    v_mfma_f32_16x16x32_bf16 v[228:231], v[60:63], v[12:15], v[228:231]
    buffer_load_dwordx4 v[60:63], v7, s[16:19], s53 offen offset:0 sc1
    v_mfma_f32_16x16x32_bf16 v[232:235], v[64:67], v[12:15], v[232:235]
    v_mfma_f32_16x16x32_bf16 v[236:239], v[68:71], v[12:15], v[236:239]
    ds_read_b128 v[12:15], v1 offset:1024
    v_mfma_f32_16x16x32_bf16 v[204:207], v[84:87], v[16:19], v[204:207]
    buffer_load_dwordx4 v[64:67], v253, s[16:19], s53 offen offset:0 sc1
    v_mfma_f32_16x16x32_bf16 v[208:211], v[88:91], v[16:19], v[208:211]
    v_mfma_f32_16x16x32_bf16 v[212:215], v[92:95], v[16:19], v[212:215]
    v_mfma_f32_16x16x32_bf16 v[228:231], v[72:75], v[16:19], v[228:231]
    buffer_load_dwordx4 v[68:71], v254, s[16:19], s53 offen offset:0 sc1
    v_mfma_f32_16x16x32_bf16 v[232:235], v[76:79], v[16:19], v[232:235]
    v_mfma_f32_16x16x32_bf16 v[236:239], v[80:83], v[16:19], v[236:239]
    ds_read_b128 v[16:19], v1 offset:8192
    v_mfma_f32_16x16x32_bf16 v[228:231], v[84:87], v[20:23], v[228:231]
    ds_write_b32 v255, v252 offset:336
    buffer_load_dwordx4 v[72:75], v7, s[16:19], s53 offen offset:1024 sc1
    v_mfma_f32_16x16x32_bf16 v[232:235], v[88:91], v[20:23], v[232:235]
    v_mfma_f32_16x16x32_bf16 v[236:239], v[92:95], v[20:23], v[236:239]
    ds_read_b128 v[20:23], v1 offset:2048
    s_waitcnt vmcnt(10) lgkmcnt(4)
    v_mfma_f32_16x16x32_bf16 v[248:251], v[24:27], v[8:11], v[248:251]
    buffer_load_dwordx4 v[76:79], v253, s[16:19], s53 offen offset:1024 sc1
    v_mfma_f32_16x16x32_bf16 v[96:99], v[28:31], v[8:11], v[96:99]
    v_mfma_f32_16x16x32_bf16 v[100:103], v[32:35], v[8:11], v[100:103]
    ds_read_b128 v[8:11], v1 offset:9216
    s_waitcnt vmcnt(8) lgkmcnt(4)
    v_mfma_f32_16x16x32_bf16 v[248:251], v[36:39], v[12:15], v[248:251]
    buffer_load_dwordx4 v[80:83], v254, s[16:19], s53 offen offset:1024 sc1
    v_mfma_f32_16x16x32_bf16 v[96:99], v[40:43], v[12:15], v[96:99]
    v_mfma_f32_16x16x32_bf16 v[100:103], v[44:47], v[12:15], v[100:103]
    v_mfma_f32_16x16x32_bf16 v[104:107], v[24:27], v[12:15], v[104:107]
    buffer_load_dwordx4 v[84:87], v7, s[16:19], s53 offen offset:2048 sc1
    v_mfma_f32_16x16x32_bf16 v[120:123], v[28:31], v[12:15], v[120:123]
    v_mfma_f32_16x16x32_bf16 v[124:127], v[32:35], v[12:15], v[124:127]
    ds_read_b128 v[12:15], v1 offset:3072
    s_waitcnt lgkmcnt(4)
    v_mfma_f32_16x16x32_bf16 v[128:131], v[24:27], v[16:19], v[128:131]
    ds_read_b128 v[16:19], v1 offset:10240
    s_waitcnt vmcnt(7) lgkmcnt(3)
    v_mfma_f32_16x16x32_bf16 v[248:251], v[48:51], v[20:23], v[248:251]
    buffer_load_dwordx4 v[88:91], v253, s[16:19], s53 offen offset:2048 sc1
    v_mfma_f32_16x16x32_bf16 v[96:99], v[52:55], v[20:23], v[96:99]
    v_mfma_f32_16x16x32_bf16 v[100:103], v[56:59], v[20:23], v[100:103]
    buffer_load_dwordx4 v[92:95], v254, s[16:19], s53 offen offset:2048 sc1
    v_mfma_f32_16x16x32_bf16 v[104:107], v[36:39], v[20:23], v[104:107]
    v_mfma_f32_16x16x32_bf16 v[120:123], v[40:43], v[20:23], v[120:123]
    v_mfma_f32_16x16x32_bf16 v[124:127], v[44:47], v[20:23], v[124:127]
    v_mfma_f32_16x16x32_bf16 v[240:243], v[24:27], v[20:23], v[240:243]
    v_mfma_f32_16x16x32_bf16 v[144:147], v[28:31], v[20:23], v[144:147]
    v_mfma_f32_16x16x32_bf16 v[148:151], v[32:35], v[20:23], v[148:151]
    ds_read_b128 v[20:23], v1 offset:4096
    s_waitcnt lgkmcnt(3)
    v_mfma_f32_16x16x32_bf16 v[128:131], v[36:39], v[8:11], v[128:131]
    ds_read_b128 v[8:11], v1 offset:5120
    s_waitcnt lgkmcnt(3)
    v_mfma_f32_16x16x32_bf16 v[104:107], v[48:51], v[12:15], v[104:107]
    v_mfma_f32_16x16x32_bf16 v[120:123], v[52:55], v[12:15], v[120:123]
    v_mfma_f32_16x16x32_bf16 v[124:127], v[56:59], v[12:15], v[124:127]
    v_mfma_f32_16x16x32_bf16 v[240:243], v[36:39], v[12:15], v[240:243]
    v_mfma_f32_16x16x32_bf16 v[144:147], v[40:43], v[12:15], v[144:147]
    v_mfma_f32_16x16x32_bf16 v[148:151], v[44:47], v[12:15], v[148:151]
    v_mfma_f32_16x16x32_bf16 v[152:155], v[24:27], v[12:15], v[152:155]
    v_mfma_f32_16x16x32_bf16 v[168:171], v[28:31], v[12:15], v[168:171]
    v_mfma_f32_16x16x32_bf16 v[172:175], v[32:35], v[12:15], v[172:175]
    ds_read_b128 v[12:15], v1 offset:6144
    s_waitcnt lgkmcnt(3)
    v_mfma_f32_16x16x32_bf16 v[128:131], v[48:51], v[16:19], v[128:131]
    ds_read_b128 v[16:19], v1 offset:7168
    s_waitcnt lgkmcnt(3)
    v_mfma_f32_16x16x32_bf16 v[240:243], v[48:51], v[20:23], v[240:243]
    v_mfma_f32_16x16x32_bf16 v[144:147], v[52:55], v[20:23], v[144:147]
    v_mfma_f32_16x16x32_bf16 v[148:151], v[56:59], v[20:23], v[148:151]
    v_mfma_f32_16x16x32_bf16 v[152:155], v[36:39], v[20:23], v[152:155]
    v_mfma_f32_16x16x32_bf16 v[168:171], v[40:43], v[20:23], v[168:171]
    v_mfma_f32_16x16x32_bf16 v[172:175], v[44:47], v[20:23], v[172:175]
    v_mfma_f32_16x16x32_bf16 v[176:179], v[24:27], v[20:23], v[176:179]
    v_mfma_f32_16x16x32_bf16 v[192:195], v[28:31], v[20:23], v[192:195]
    v_mfma_f32_16x16x32_bf16 v[196:199], v[32:35], v[20:23], v[196:199]
    ds_read_b128 v[20:23], v1 offset:11264
    s_waitcnt lgkmcnt(3)
    v_mfma_f32_16x16x32_bf16 v[152:155], v[48:51], v[8:11], v[152:155]
    v_mfma_f32_16x16x32_bf16 v[168:171], v[52:55], v[8:11], v[168:171]
    v_mfma_f32_16x16x32_bf16 v[172:175], v[56:59], v[8:11], v[172:175]
    v_mfma_f32_16x16x32_bf16 v[176:179], v[36:39], v[8:11], v[176:179]
    v_mfma_f32_16x16x32_bf16 v[192:195], v[40:43], v[8:11], v[192:195]
    s_mov_b32 s53, 368640
    v_mfma_f32_16x16x32_bf16 v[196:199], v[44:47], v[8:11], v[196:199]
    v_mfma_f32_16x16x32_bf16 v[200:203], v[24:27], v[8:11], v[200:203]
    buffer_load_dwordx4 v[24:27], v7, s[16:19], s53 offen offset:0 sc1
    v_mfma_f32_16x16x32_bf16 v[216:219], v[28:31], v[8:11], v[216:219]
    v_mfma_f32_16x16x32_bf16 v[220:223], v[32:35], v[8:11], v[220:223]
    ds_read_b128 v[8:11], v1 offset:12288
    s_waitcnt lgkmcnt(3)
    v_mfma_f32_16x16x32_bf16 v[176:179], v[48:51], v[12:15], v[176:179]
    buffer_load_dwordx4 v[28:31], v253, s[16:19], s53 offen offset:0 sc1
    v_mfma_f32_16x16x32_bf16 v[192:195], v[52:55], v[12:15], v[192:195]
    v_mfma_f32_16x16x32_bf16 v[196:199], v[56:59], v[12:15], v[196:199]
    v_mfma_f32_16x16x32_bf16 v[200:203], v[36:39], v[12:15], v[200:203]
    buffer_load_dwordx4 v[32:35], v254, s[16:19], s53 offen offset:0 sc1
    v_mfma_f32_16x16x32_bf16 v[216:219], v[40:43], v[12:15], v[216:219]
    v_mfma_f32_16x16x32_bf16 v[220:223], v[44:47], v[12:15], v[220:223]
    ds_read_b128 v[12:15], v1 offset:19456
    s_waitcnt lgkmcnt(3)
    v_mfma_f32_16x16x32_bf16 v[200:203], v[48:51], v[16:19], v[200:203]
    buffer_load_dwordx4 v[36:39], v7, s[16:19], s53 offen offset:1024 sc1
    v_mfma_f32_16x16x32_bf16 v[216:219], v[52:55], v[16:19], v[216:219]
    v_mfma_f32_16x16x32_bf16 v[220:223], v[56:59], v[16:19], v[220:223]
    ds_read_b128 v[16:19], v1 offset:13312
    s_waitcnt vmcnt(10) lgkmcnt(3)
    v_mfma_f32_16x16x32_bf16 v[248:251], v[60:63], v[20:23], v[248:251]
    buffer_load_dwordx4 v[40:43], v253, s[16:19], s53 offen offset:1024 sc1
    v_mfma_f32_16x16x32_bf16 v[96:99], v[64:67], v[20:23], v[96:99]
    v_mfma_f32_16x16x32_bf16 v[100:103], v[68:71], v[20:23], v[100:103]
    ds_read_b128 v[20:23], v1 offset:20480
    s_waitcnt vmcnt(8) lgkmcnt(3)
    v_mfma_f32_16x16x32_bf16 v[248:251], v[72:75], v[8:11], v[248:251]
    buffer_load_dwordx4 v[44:47], v254, s[16:19], s53 offen offset:1024 sc1
    v_mfma_f32_16x16x32_bf16 v[96:99], v[76:79], v[8:11], v[96:99]
    v_mfma_f32_16x16x32_bf16 v[100:103], v[80:83], v[8:11], v[100:103]
    v_mfma_f32_16x16x32_bf16 v[104:107], v[60:63], v[8:11], v[104:107]
    buffer_load_dwordx4 v[48:51], v7, s[16:19], s53 offen offset:2048 sc1
    v_mfma_f32_16x16x32_bf16 v[120:123], v[64:67], v[8:11], v[120:123]
    v_mfma_f32_16x16x32_bf16 v[124:127], v[68:71], v[8:11], v[124:127]
    ds_read_b128 v[8:11], v1 offset:14336
    s_waitcnt lgkmcnt(3)
    v_mfma_f32_16x16x32_bf16 v[128:131], v[60:63], v[12:15], v[128:131]
    ds_read_b128 v[12:15], v1 offset:21504
    s_waitcnt vmcnt(7) lgkmcnt(3)
    v_mfma_f32_16x16x32_bf16 v[248:251], v[84:87], v[16:19], v[248:251]
    buffer_load_dwordx4 v[52:55], v253, s[16:19], s53 offen offset:2048 sc1
    v_mfma_f32_16x16x32_bf16 v[96:99], v[88:91], v[16:19], v[96:99]
    v_mfma_f32_16x16x32_bf16 v[100:103], v[92:95], v[16:19], v[100:103]
    buffer_load_dwordx4 v[56:59], v254, s[16:19], s53 offen offset:2048 sc1
    v_mfma_f32_16x16x32_bf16 v[104:107], v[72:75], v[16:19], v[104:107]
    v_mfma_f32_16x16x32_bf16 v[120:123], v[76:79], v[16:19], v[120:123]
    v_mfma_f32_16x16x32_bf16 v[124:127], v[80:83], v[16:19], v[124:127]
    v_mfma_f32_16x16x32_bf16 v[240:243], v[60:63], v[16:19], v[240:243]
    v_mfma_f32_16x16x32_bf16 v[144:147], v[64:67], v[16:19], v[144:147]
    v_mfma_f32_16x16x32_bf16 v[148:151], v[68:71], v[16:19], v[148:151]
    ds_read_b128 v[16:19], v1 offset:15360
    s_waitcnt lgkmcnt(3)
    v_mfma_f32_16x16x32_bf16 v[128:131], v[72:75], v[20:23], v[128:131]
    ds_read_b128 v[20:23], v1 offset:16384
    s_waitcnt lgkmcnt(3)
    v_mfma_f32_16x16x32_bf16 v[104:107], v[84:87], v[8:11], v[104:107]
    v_mfma_f32_16x16x32_bf16 v[120:123], v[88:91], v[8:11], v[120:123]
    v_mfma_f32_16x16x32_bf16 v[124:127], v[92:95], v[8:11], v[124:127]
    v_mfma_f32_16x16x32_bf16 v[240:243], v[72:75], v[8:11], v[240:243]
    v_mfma_f32_16x16x32_bf16 v[144:147], v[76:79], v[8:11], v[144:147]
    v_mfma_f32_16x16x32_bf16 v[148:151], v[80:83], v[8:11], v[148:151]
    v_mfma_f32_16x16x32_bf16 v[152:155], v[60:63], v[8:11], v[152:155]
    v_mfma_f32_16x16x32_bf16 v[168:171], v[64:67], v[8:11], v[168:171]
    v_mfma_f32_16x16x32_bf16 v[172:175], v[68:71], v[8:11], v[172:175]
    ds_read_b128 v[8:11], v1 offset:17408
    s_waitcnt lgkmcnt(3)
    v_mfma_f32_16x16x32_bf16 v[128:131], v[84:87], v[12:15], v[128:131]
    ds_read_b128 v[12:15], v1 offset:18432
    s_waitcnt lgkmcnt(3)
    v_mfma_f32_16x16x32_bf16 v[240:243], v[84:87], v[16:19], v[240:243]
    ds_read_b32 v0, v2 offset:35292
    v_mfma_f32_16x16x32_bf16 v[144:147], v[88:91], v[16:19], v[144:147]
    v_mfma_f32_16x16x32_bf16 v[148:151], v[92:95], v[16:19], v[148:151]
    v_mfma_f32_16x16x32_bf16 v[152:155], v[72:75], v[16:19], v[152:155]
    v_mfma_f32_16x16x32_bf16 v[168:171], v[76:79], v[16:19], v[168:171]
    v_mfma_f32_16x16x32_bf16 v[172:175], v[80:83], v[16:19], v[172:175]
    v_mfma_f32_16x16x32_bf16 v[176:179], v[60:63], v[16:19], v[176:179]
    s_waitcnt lgkmcnt(0)
    v_readfirstlane_b32 s47, v0
    v_mfma_f32_16x16x32_bf16 v[192:195], v[64:67], v[16:19], v[192:195]
    s_cmp_eq_u32 s47, 4
    s_cbranch_scc0 L_CKxrdy7_spin
L_CKxrdy7:
    v_mfma_f32_16x16x32_bf16 v[196:199], v[68:71], v[16:19], v[196:199]
    ds_read_b128 v[16:19], v1 offset:22528
    v_mfma_f32_16x16x32_bf16 v[152:155], v[84:87], v[20:23], v[152:155]
    v_mfma_f32_16x16x32_bf16 v[168:171], v[88:91], v[20:23], v[168:171]
    v_mfma_f32_16x16x32_bf16 v[172:175], v[92:95], v[20:23], v[172:175]
    v_mfma_f32_16x16x32_bf16 v[176:179], v[72:75], v[20:23], v[176:179]
    v_mfma_f32_16x16x32_bf16 v[192:195], v[76:79], v[20:23], v[192:195]
    s_mov_b32 s53, 405504
    v_mfma_f32_16x16x32_bf16 v[196:199], v[80:83], v[20:23], v[196:199]
    v_mfma_f32_16x16x32_bf16 v[200:203], v[60:63], v[20:23], v[200:203]
    buffer_load_dwordx4 v[60:63], v7, s[16:19], s53 offen offset:0 sc1
    v_mfma_f32_16x16x32_bf16 v[216:219], v[64:67], v[20:23], v[216:219]
    v_mfma_f32_16x16x32_bf16 v[220:223], v[68:71], v[20:23], v[220:223]
    ds_read_b128 v[20:23], v1 offset:23552
    v_mfma_f32_16x16x32_bf16 v[176:179], v[84:87], v[8:11], v[176:179]
    buffer_load_dwordx4 v[64:67], v253, s[16:19], s53 offen offset:0 sc1
    v_mfma_f32_16x16x32_bf16 v[192:195], v[88:91], v[8:11], v[192:195]
    v_mfma_f32_16x16x32_bf16 v[196:199], v[92:95], v[8:11], v[196:199]
    v_mfma_f32_16x16x32_bf16 v[200:203], v[72:75], v[8:11], v[200:203]
    buffer_load_dwordx4 v[68:71], v254, s[16:19], s53 offen offset:0 sc1
    v_mfma_f32_16x16x32_bf16 v[216:219], v[76:79], v[8:11], v[216:219]
    v_mfma_f32_16x16x32_bf16 v[220:223], v[80:83], v[8:11], v[220:223]
    ds_read_b128 v[8:11], v1 offset:30720
    v_mfma_f32_16x16x32_bf16 v[200:203], v[84:87], v[12:15], v[200:203]
    ds_write_b32 v255, v252 offset:352
    buffer_load_dwordx4 v[72:75], v7, s[16:19], s53 offen offset:1024 sc1
    v_mfma_f32_16x16x32_bf16 v[216:219], v[88:91], v[12:15], v[216:219]
    v_mfma_f32_16x16x32_bf16 v[220:223], v[92:95], v[12:15], v[220:223]
    ds_read_b128 v[12:15], v1 offset:24576
    s_waitcnt vmcnt(10) lgkmcnt(4)
    v_mfma_f32_16x16x32_bf16 v[108:111], v[24:27], v[16:19], v[108:111]
    buffer_load_dwordx4 v[76:79], v253, s[16:19], s53 offen offset:1024 sc1
    v_mfma_f32_16x16x32_bf16 v[112:115], v[28:31], v[16:19], v[112:115]
    v_mfma_f32_16x16x32_bf16 v[116:119], v[32:35], v[16:19], v[116:119]
    ds_read_b128 v[16:19], v1 offset:31744
    s_waitcnt vmcnt(8) lgkmcnt(4)
    v_mfma_f32_16x16x32_bf16 v[108:111], v[36:39], v[20:23], v[108:111]
    buffer_load_dwordx4 v[80:83], v254, s[16:19], s53 offen offset:1024 sc1
    v_mfma_f32_16x16x32_bf16 v[112:115], v[40:43], v[20:23], v[112:115]
    v_mfma_f32_16x16x32_bf16 v[116:119], v[44:47], v[20:23], v[116:119]
    v_mfma_f32_16x16x32_bf16 v[132:135], v[24:27], v[20:23], v[132:135]
    buffer_load_dwordx4 v[84:87], v7, s[16:19], s53 offen offset:2048 sc1
    v_mfma_f32_16x16x32_bf16 v[136:139], v[28:31], v[20:23], v[136:139]
    v_mfma_f32_16x16x32_bf16 v[140:143], v[32:35], v[20:23], v[140:143]
    ds_read_b128 v[20:23], v1 offset:25600
    s_waitcnt lgkmcnt(4)
    v_mfma_f32_16x16x32_bf16 v[244:247], v[24:27], v[8:11], v[244:247]
    ds_read_b128 v[8:11], v2 offset:0
    s_waitcnt vmcnt(7) lgkmcnt(3)
    v_mfma_f32_16x16x32_bf16 v[108:111], v[48:51], v[12:15], v[108:111]
    buffer_load_dwordx4 v[88:91], v253, s[16:19], s53 offen offset:2048 sc1
    v_mfma_f32_16x16x32_bf16 v[112:115], v[52:55], v[12:15], v[112:115]
    v_mfma_f32_16x16x32_bf16 v[116:119], v[56:59], v[12:15], v[116:119]
    buffer_load_dwordx4 v[92:95], v254, s[16:19], s53 offen offset:2048 sc1
    v_mfma_f32_16x16x32_bf16 v[132:135], v[36:39], v[12:15], v[132:135]
    v_mfma_f32_16x16x32_bf16 v[136:139], v[40:43], v[12:15], v[136:139]
    v_mfma_f32_16x16x32_bf16 v[140:143], v[44:47], v[12:15], v[140:143]
    v_mfma_f32_16x16x32_bf16 v[156:159], v[24:27], v[12:15], v[156:159]
    v_mfma_f32_16x16x32_bf16 v[160:163], v[28:31], v[12:15], v[160:163]
    v_mfma_f32_16x16x32_bf16 v[164:167], v[32:35], v[12:15], v[164:167]
    ds_read_b128 v[12:15], v1 offset:26624
    s_waitcnt lgkmcnt(3)
    v_mfma_f32_16x16x32_bf16 v[244:247], v[36:39], v[16:19], v[244:247]
    ds_read_b128 v[16:19], v1 offset:27648
    s_waitcnt lgkmcnt(3)
    v_mfma_f32_16x16x32_bf16 v[132:135], v[48:51], v[20:23], v[132:135]
    v_mfma_f32_16x16x32_bf16 v[136:139], v[52:55], v[20:23], v[136:139]
    v_mfma_f32_16x16x32_bf16 v[140:143], v[56:59], v[20:23], v[140:143]
    v_mfma_f32_16x16x32_bf16 v[156:159], v[36:39], v[20:23], v[156:159]
    v_mfma_f32_16x16x32_bf16 v[160:163], v[40:43], v[20:23], v[160:163]
    v_mfma_f32_16x16x32_bf16 v[164:167], v[44:47], v[20:23], v[164:167]
    v_mfma_f32_16x16x32_bf16 v[180:183], v[24:27], v[20:23], v[180:183]
    v_mfma_f32_16x16x32_bf16 v[184:187], v[28:31], v[20:23], v[184:187]
    v_mfma_f32_16x16x32_bf16 v[188:191], v[32:35], v[20:23], v[188:191]
    ds_read_b128 v[20:23], v1 offset:28672
    s_waitcnt lgkmcnt(3)
    v_mfma_f32_16x16x32_bf16 v[244:247], v[48:51], v[8:11], v[244:247]
    ds_read_b128 v[8:11], v1 offset:29696
    s_waitcnt lgkmcnt(3)
    v_mfma_f32_16x16x32_bf16 v[156:159], v[48:51], v[12:15], v[156:159]
    v_mfma_f32_16x16x32_bf16 v[160:163], v[52:55], v[12:15], v[160:163]
    v_mfma_f32_16x16x32_bf16 v[164:167], v[56:59], v[12:15], v[164:167]
    v_mfma_f32_16x16x32_bf16 v[180:183], v[36:39], v[12:15], v[180:183]
    v_mfma_f32_16x16x32_bf16 v[184:187], v[40:43], v[12:15], v[184:187]
    v_mfma_f32_16x16x32_bf16 v[188:191], v[44:47], v[12:15], v[188:191]
    v_mfma_f32_16x16x32_bf16 v[204:207], v[24:27], v[12:15], v[204:207]
    v_mfma_f32_16x16x32_bf16 v[208:211], v[28:31], v[12:15], v[208:211]
    v_mfma_f32_16x16x32_bf16 v[212:215], v[32:35], v[12:15], v[212:215]
    ds_read_b128 v[12:15], v2 offset:1024
    s_waitcnt lgkmcnt(3)
    v_mfma_f32_16x16x32_bf16 v[180:183], v[48:51], v[16:19], v[180:183]
    v_mfma_f32_16x16x32_bf16 v[184:187], v[52:55], v[16:19], v[184:187]
    v_mfma_f32_16x16x32_bf16 v[188:191], v[56:59], v[16:19], v[188:191]
    v_mfma_f32_16x16x32_bf16 v[204:207], v[36:39], v[16:19], v[204:207]
    v_mfma_f32_16x16x32_bf16 v[208:211], v[40:43], v[16:19], v[208:211]
    s_mov_b32 s53, 516096
    v_mfma_f32_16x16x32_bf16 v[212:215], v[44:47], v[16:19], v[212:215]
    v_mfma_f32_16x16x32_bf16 v[228:231], v[24:27], v[16:19], v[228:231]
    buffer_load_dwordx4 v[24:27], v7, s[16:19], s53 offen offset:0 sc1
    v_mfma_f32_16x16x32_bf16 v[232:235], v[28:31], v[16:19], v[232:235]
    v_mfma_f32_16x16x32_bf16 v[236:239], v[32:35], v[16:19], v[236:239]
    ds_read_b128 v[16:19], v2 offset:2048
    s_waitcnt lgkmcnt(3)
    v_mfma_f32_16x16x32_bf16 v[204:207], v[48:51], v[20:23], v[204:207]
    buffer_load_dwordx4 v[28:31], v253, s[16:19], s53 offen offset:0 sc1
    v_mfma_f32_16x16x32_bf16 v[208:211], v[52:55], v[20:23], v[208:211]
    v_mfma_f32_16x16x32_bf16 v[212:215], v[56:59], v[20:23], v[212:215]
    v_mfma_f32_16x16x32_bf16 v[228:231], v[36:39], v[20:23], v[228:231]
    buffer_load_dwordx4 v[32:35], v254, s[16:19], s53 offen offset:0 sc1
    v_mfma_f32_16x16x32_bf16 v[232:235], v[40:43], v[20:23], v[232:235]
    v_mfma_f32_16x16x32_bf16 v[236:239], v[44:47], v[20:23], v[236:239]
    ds_read_b128 v[20:23], v2 offset:9216
    s_waitcnt lgkmcnt(3)
    v_mfma_f32_16x16x32_bf16 v[228:231], v[48:51], v[8:11], v[228:231]
    buffer_load_dwordx4 v[36:39], v7, s[16:19], s53 offen offset:1024 sc1
    v_mfma_f32_16x16x32_bf16 v[232:235], v[52:55], v[8:11], v[232:235]
    v_mfma_f32_16x16x32_bf16 v[236:239], v[56:59], v[8:11], v[236:239]
    ds_read_b128 v[8:11], v2 offset:3072
    s_waitcnt vmcnt(10) lgkmcnt(3)
    v_mfma_f32_16x16x32_bf16 v[108:111], v[60:63], v[12:15], v[108:111]
    buffer_load_dwordx4 v[40:43], v253, s[16:19], s53 offen offset:1024 sc1
    v_mfma_f32_16x16x32_bf16 v[112:115], v[64:67], v[12:15], v[112:115]
    v_mfma_f32_16x16x32_bf16 v[116:119], v[68:71], v[12:15], v[116:119]
    ds_read_b128 v[12:15], v2 offset:10240
    s_waitcnt vmcnt(8) lgkmcnt(3)
    v_mfma_f32_16x16x32_bf16 v[108:111], v[72:75], v[16:19], v[108:111]
    buffer_load_dwordx4 v[44:47], v254, s[16:19], s53 offen offset:1024 sc1
    v_mfma_f32_16x16x32_bf16 v[112:115], v[76:79], v[16:19], v[112:115]
    v_mfma_f32_16x16x32_bf16 v[116:119], v[80:83], v[16:19], v[116:119]
    v_mfma_f32_16x16x32_bf16 v[132:135], v[60:63], v[16:19], v[132:135]
    buffer_load_dwordx4 v[48:51], v7, s[16:19], s53 offen offset:2048 sc1
    v_mfma_f32_16x16x32_bf16 v[136:139], v[64:67], v[16:19], v[136:139]
    v_mfma_f32_16x16x32_bf16 v[140:143], v[68:71], v[16:19], v[140:143]
    ds_read_b128 v[16:19], v2 offset:4096
    s_waitcnt lgkmcnt(3)
    v_mfma_f32_16x16x32_bf16 v[244:247], v[60:63], v[20:23], v[244:247]
    ds_read_b128 v[20:23], v2 offset:11264
    s_waitcnt vmcnt(7) lgkmcnt(3)
    v_mfma_f32_16x16x32_bf16 v[108:111], v[84:87], v[8:11], v[108:111]
    buffer_load_dwordx4 v[52:55], v253, s[16:19], s53 offen offset:2048 sc1
    v_mfma_f32_16x16x32_bf16 v[112:115], v[88:91], v[8:11], v[112:115]
    v_mfma_f32_16x16x32_bf16 v[116:119], v[92:95], v[8:11], v[116:119]
    buffer_load_dwordx4 v[56:59], v254, s[16:19], s53 offen offset:2048 sc1
    v_mfma_f32_16x16x32_bf16 v[132:135], v[72:75], v[8:11], v[132:135]
    v_mfma_f32_16x16x32_bf16 v[136:139], v[76:79], v[8:11], v[136:139]
    v_mfma_f32_16x16x32_bf16 v[140:143], v[80:83], v[8:11], v[140:143]
    v_mfma_f32_16x16x32_bf16 v[156:159], v[60:63], v[8:11], v[156:159]
    v_mfma_f32_16x16x32_bf16 v[160:163], v[64:67], v[8:11], v[160:163]
    v_mfma_f32_16x16x32_bf16 v[164:167], v[68:71], v[8:11], v[164:167]
    ds_read_b128 v[8:11], v2 offset:5120
    s_waitcnt lgkmcnt(3)
    v_mfma_f32_16x16x32_bf16 v[244:247], v[72:75], v[12:15], v[244:247]
    ds_read_b128 v[12:15], v2 offset:6144
    s_waitcnt lgkmcnt(3)
    v_mfma_f32_16x16x32_bf16 v[132:135], v[84:87], v[16:19], v[132:135]
    v_add_f32 v224, v248, v108
    v_add_f32 v225, v249, v109
    v_mfma_f32_16x16x32_bf16 v[136:139], v[88:91], v[16:19], v[136:139]
    v_add_f32 v226, v250, v110
    v_add_f32 v227, v251, v111
    v_mfma_f32_16x16x32_bf16 v[140:143], v[92:95], v[16:19], v[140:143]
    v_sub_f32 v108, v248, v108
    v_sub_f32 v109, v249, v109
    v_mfma_f32_16x16x32_bf16 v[156:159], v[72:75], v[16:19], v[156:159]
    v_sub_f32 v110, v250, v110
    v_sub_f32 v111, v251, v111
    v_mfma_f32_16x16x32_bf16 v[160:163], v[76:79], v[16:19], v[160:163]
    v_add_f32 v248, v96, v112
    v_add_f32 v249, v97, v113
    v_mfma_f32_16x16x32_bf16 v[164:167], v[80:83], v[16:19], v[164:167]
    v_add_f32 v250, v98, v114
    v_add_f32 v251, v99, v115
    v_mfma_f32_16x16x32_bf16 v[180:183], v[60:63], v[16:19], v[180:183]
    v_sub_f32 v112, v96, v112
    v_sub_f32 v113, v97, v113
    v_mfma_f32_16x16x32_bf16 v[184:187], v[64:67], v[16:19], v[184:187]
    v_sub_f32 v114, v98, v114
    v_sub_f32 v115, v99, v115
    v_mfma_f32_16x16x32_bf16 v[188:191], v[68:71], v[16:19], v[188:191]
    ds_read_b128 v[16:19], v2 offset:7168
    s_waitcnt lgkmcnt(3)
    v_mfma_f32_16x16x32_bf16 v[244:247], v[84:87], v[20:23], v[244:247]
    ds_read_b128 v[20:23], v2 offset:8192
    s_waitcnt lgkmcnt(3)
    v_mfma_f32_16x16x32_bf16 v[156:159], v[84:87], v[8:11], v[156:159]
    ds_read_b32 v0, v2 offset:35296
    v_add_f32 v96, v100, v116
    v_mfma_f32_16x16x32_bf16 v[160:163], v[88:91], v[8:11], v[160:163]
    v_add_f32 v97, v101, v117
    v_add_f32 v98, v102, v118
    v_mfma_f32_16x16x32_bf16 v[164:167], v[92:95], v[8:11], v[164:167]
    v_add_f32 v99, v103, v119
    v_sub_f32 v116, v100, v116
    v_mfma_f32_16x16x32_bf16 v[180:183], v[72:75], v[8:11], v[180:183]
    v_sub_f32 v117, v101, v117
    v_sub_f32 v118, v102, v118
    v_mfma_f32_16x16x32_bf16 v[184:187], v[76:79], v[8:11], v[184:187]
    v_sub_f32 v119, v103, v119
    v_add_f32 v100, v104, v132
    v_mfma_f32_16x16x32_bf16 v[188:191], v[80:83], v[8:11], v[188:191]
    v_add_f32 v101, v105, v133
    v_add_f32 v102, v106, v134
    v_mfma_f32_16x16x32_bf16 v[204:207], v[60:63], v[8:11], v[204:207]
    s_waitcnt lgkmcnt(0)
    v_readfirstlane_b32 s47, v0
    v_mfma_f32_16x16x32_bf16 v[208:211], v[64:67], v[8:11], v[208:211]
    s_cmp_eq_u32 s47, 4
    s_cbranch_scc0 L_CKxrdy8_spin
L_CKxrdy8:
    v_mfma_f32_16x16x32_bf16 v[212:215], v[68:71], v[8:11], v[212:215]
    ds_read_b128 v[8:11], v2 offset:12288
    v_mfma_f32_16x16x32_bf16 v[180:183], v[84:87], v[12:15], v[180:183]
    v_add_f32 v103, v107, v135
    v_sub_f32 v132, v104, v132
    v_mfma_f32_16x16x32_bf16 v[184:187], v[88:91], v[12:15], v[184:187]
    v_sub_f32 v133, v105, v133
    v_sub_f32 v134, v106, v134
    v_mfma_f32_16x16x32_bf16 v[188:191], v[92:95], v[12:15], v[188:191]
    v_sub_f32 v135, v107, v135
    v_add_f32 v104, v120, v136
    v_add_f32 v105, v121, v137
    v_mfma_f32_16x16x32_bf16 v[204:207], v[72:75], v[12:15], v[204:207]
    v_add_f32 v106, v122, v138
    v_add_f32 v107, v123, v139
    v_mfma_f32_16x16x32_bf16 v[208:211], v[76:79], v[12:15], v[208:211]
    s_mov_b32 s53, 552960
    v_sub_f32 v136, v120, v136
    v_mfma_f32_16x16x32_bf16 v[212:215], v[80:83], v[12:15], v[212:215]
    v_sub_f32 v137, v121, v137
    v_sub_f32 v138, v122, v138
    v_mfma_f32_16x16x32_bf16 v[228:231], v[60:63], v[12:15], v[228:231]
    buffer_load_dwordx4 v[60:63], v7, s[16:19], s53 offen offset:0 sc1
    v_sub_f32 v139, v123, v139
    v_add_f32 v120, v124, v140
    v_add_f32 v121, v125, v141
    v_add_f32 v122, v126, v142
    v_mfma_f32_16x16x32_bf16 v[232:235], v[64:67], v[12:15], v[232:235]
    v_add_f32 v123, v127, v143
    v_sub_f32 v140, v124, v140
    v_mfma_f32_16x16x32_bf16 v[236:239], v[68:71], v[12:15], v[236:239]
    ds_read_b128 v[12:15], v2 offset:13312
    v_mfma_f32_16x16x32_bf16 v[204:207], v[84:87], v[16:19], v[204:207]
    buffer_load_dwordx4 v[64:67], v253, s[16:19], s53 offen offset:0 sc1
    v_sub_f32 v141, v125, v141
    v_mfma_f32_16x16x32_bf16 v[208:211], v[88:91], v[16:19], v[208:211]
    v_sub_f32 v142, v126, v142
    v_sub_f32 v143, v127, v143
    v_add_f32 v124, v128, v244
    v_add_f32 v125, v129, v245
    v_add_f32 v126, v130, v246
    v_mfma_f32_16x16x32_bf16 v[212:215], v[92:95], v[16:19], v[212:215]
    v_add_f32 v127, v131, v247
    v_sub_f32 v244, v128, v244
    v_mfma_f32_16x16x32_bf16 v[228:231], v[72:75], v[16:19], v[228:231]
    buffer_load_dwordx4 v[68:71], v254, s[16:19], s53 offen offset:0 sc1
    v_sub_f32 v245, v129, v245
    v_mfma_f32_16x16x32_bf16 v[232:235], v[76:79], v[16:19], v[232:235]
    v_sub_f32 v246, v130, v246
    v_sub_f32 v247, v131, v247
    v_add_f32 v128, v240, v156
    v_add_f32 v129, v241, v157
    v_add_f32 v130, v242, v158
    v_mfma_f32_16x16x32_bf16 v[236:239], v[80:83], v[16:19], v[236:239]
    ds_read_b128 v[16:19], v2 offset:20480
    v_add_f32 v131, v243, v159
    v_sub_f32 v156, v240, v156
    v_mfma_f32_16x16x32_bf16 v[228:231], v[84:87], v[20:23], v[228:231]
    ds_write_b32 v255, v252 offset:368
    buffer_load_dwordx4 v[72:75], v7, s[16:19], s53 offen offset:1024 sc1
    v_mfma_f32_16x16x32_bf16 v[232:235], v[88:91], v[20:23], v[232:235]
    v_sub_f32 v157, v241, v157
    v_sub_f32 v158, v242, v158
    v_mfma_f32_16x16x32_bf16 v[236:239], v[92:95], v[20:23], v[236:239]
    ds_read_b128 v[20:23], v2 offset:14336
    s_waitcnt vmcnt(10) lgkmcnt(4)
    v_mfma_f32_16x16x32_bf16 v[224:227], v[24:27], v[8:11], v[224:227]
    buffer_load_dwordx4 v[76:79], v253, s[16:19], s53 offen offset:1024 sc1
    v_sub_f32 v159, v243, v159
    v_add_f32 v240, v144, v160
    v_add_f32 v241, v145, v161
    v_add_f32 v242, v146, v162
    v_mfma_f32_16x16x32_bf16 v[248:251], v[28:31], v[8:11], v[248:251]
    v_add_f32 v243, v147, v163
    v_sub_f32 v160, v144, v160
    v_mfma_f32_16x16x32_bf16 v[96:99], v[32:35], v[8:11], v[96:99]
    ds_read_b128 v[8:11], v2 offset:21504
    s_waitcnt vmcnt(8) lgkmcnt(4)
    v_mfma_f32_16x16x32_bf16 v[224:227], v[36:39], v[12:15], v[224:227]
    buffer_load_dwordx4 v[80:83], v254, s[16:19], s53 offen offset:1024 sc1
    v_sub_f32 v161, v145, v161
    v_mfma_f32_16x16x32_bf16 v[248:251], v[40:43], v[12:15], v[248:251]
    v_sub_f32 v162, v146, v162
    v_sub_f32 v163, v147, v163
    v_add_f32 v144, v148, v164
    v_add_f32 v145, v149, v165
    v_add_f32 v146, v150, v166
    v_mfma_f32_16x16x32_bf16 v[96:99], v[44:47], v[12:15], v[96:99]
    v_add_f32 v147, v151, v167
    v_sub_f32 v164, v148, v164
    v_mfma_f32_16x16x32_bf16 v[100:103], v[24:27], v[12:15], v[100:103]
    buffer_load_dwordx4 v[84:87], v7, s[16:19], s53 offen offset:2048 sc1
    v_sub_f32 v165, v149, v165
    v_mfma_f32_16x16x32_bf16 v[104:107], v[28:31], v[12:15], v[104:107]
    v_sub_f32 v166, v150, v166
    v_sub_f32 v167, v151, v167
    v_add_f32 v148, v152, v180
    v_add_f32 v149, v153, v181
    v_add_f32 v150, v154, v182
    v_mfma_f32_16x16x32_bf16 v[120:123], v[32:35], v[12:15], v[120:123]
    ds_read_b128 v[12:15], v2 offset:15360
    v_add_f32 v151, v155, v183
    s_waitcnt lgkmcnt(4)
    v_mfma_f32_16x16x32_bf16 v[124:127], v[24:27], v[16:19], v[124:127]
    ds_read_b128 v[16:19], v2 offset:22528
    s_waitcnt vmcnt(7) lgkmcnt(3)
    v_mfma_f32_16x16x32_bf16 v[224:227], v[48:51], v[20:23], v[224:227]
    buffer_load_dwordx4 v[88:91], v253, s[16:19], s53 offen offset:2048 sc1
    v_sub_f32 v180, v152, v180
    v_mfma_f32_16x16x32_bf16 v[248:251], v[52:55], v[20:23], v[248:251]
    v_sub_f32 v181, v153, v181
    v_sub_f32 v182, v154, v182
    v_mfma_f32_16x16x32_bf16 v[96:99], v[56:59], v[20:23], v[96:99]
    buffer_load_dwordx4 v[92:95], v254, s[16:19], s53 offen offset:2048 sc1
    v_sub_f32 v183, v155, v183
    v_mfma_f32_16x16x32_bf16 v[100:103], v[36:39], v[20:23], v[100:103]
    v_add_f32 v152, v168, v184
    v_add_f32 v153, v169, v185
    v_mfma_f32_16x16x32_bf16 v[104:107], v[40:43], v[20:23], v[104:107]
    v_add_f32 v154, v170, v186
    v_add_f32 v155, v171, v187
    v_mfma_f32_16x16x32_bf16 v[120:123], v[44:47], v[20:23], v[120:123]
    v_sub_f32 v184, v168, v184
    v_sub_f32 v185, v169, v185
    v_mfma_f32_16x16x32_bf16 v[128:131], v[24:27], v[20:23], v[128:131]
    v_sub_f32 v186, v170, v186
    v_sub_f32 v187, v171, v187
    v_add_f32 v168, v172, v188
    v_add_f32 v169, v173, v189
    v_add_f32 v170, v174, v190
    v_mfma_f32_16x16x32_bf16 v[240:243], v[28:31], v[20:23], v[240:243]
    v_add_f32 v171, v175, v191
    v_sub_f32 v188, v172, v188
    v_sub_f32 v189, v173, v189
    v_mfma_f32_16x16x32_bf16 v[144:147], v[32:35], v[20:23], v[144:147]
    ds_read_b128 v[20:23], v2 offset:16384
    s_waitcnt lgkmcnt(3)
    v_mfma_f32_16x16x32_bf16 v[124:127], v[36:39], v[8:11], v[124:127]
    ds_read_b128 v[8:11], v2 offset:17408
    s_waitcnt lgkmcnt(3)
    v_mfma_f32_16x16x32_bf16 v[100:103], v[48:51], v[12:15], v[100:103]
    v_sub_f32 v190, v174, v190
    v_sub_f32 v191, v175, v191
    v_mfma_f32_16x16x32_bf16 v[104:107], v[52:55], v[12:15], v[104:107]
    v_add_f32 v172, v176, v204
    v_add_f32 v173, v177, v205
    v_mfma_f32_16x16x32_bf16 v[120:123], v[56:59], v[12:15], v[120:123]
    v_add_f32 v174, v178, v206
    v_add_f32 v175, v179, v207
    v_mfma_f32_16x16x32_bf16 v[128:131], v[36:39], v[12:15], v[128:131]
    v_sub_f32 v204, v176, v204
    v_sub_f32 v205, v177, v205
    v_mfma_f32_16x16x32_bf16 v[240:243], v[40:43], v[12:15], v[240:243]
    v_sub_f32 v206, v178, v206
    v_sub_f32 v207, v179, v207
    v_add_f32 v176, v192, v208
    v_add_f32 v177, v193, v209
    v_mfma_f32_16x16x32_bf16 v[144:147], v[44:47], v[12:15], v[144:147]
    v_add_f32 v178, v194, v210
    v_add_f32 v179, v195, v211
    v_mfma_f32_16x16x32_bf16 v[148:151], v[24:27], v[12:15], v[148:151]
    v_sub_f32 v208, v192, v208
    v_sub_f32 v209, v193, v209
    v_mfma_f32_16x16x32_bf16 v[152:155], v[28:31], v[12:15], v[152:155]
    v_sub_f32 v210, v194, v210
    v_sub_f32 v211, v195, v211
    v_add_f32 v192, v196, v212
    v_add_f32 v193, v197, v213
    v_mfma_f32_16x16x32_bf16 v[168:171], v[32:35], v[12:15], v[168:171]
    ds_read_b128 v[12:15], v2 offset:18432
    s_waitcnt lgkmcnt(3)
    v_mfma_f32_16x16x32_bf16 v[124:127], v[48:51], v[16:19], v[124:127]
    ds_read_b128 v[16:19], v2 offset:19456
    s_waitcnt lgkmcnt(3)
    v_mfma_f32_16x16x32_bf16 v[128:131], v[48:51], v[20:23], v[128:131]
    v_add_f32 v194, v198, v214
    v_add_f32 v195, v199, v215
    v_mfma_f32_16x16x32_bf16 v[240:243], v[52:55], v[20:23], v[240:243]
    v_sub_f32 v212, v196, v212
    v_sub_f32 v213, v197, v213
    v_mfma_f32_16x16x32_bf16 v[144:147], v[56:59], v[20:23], v[144:147]
    v_sub_f32 v214, v198, v214
    v_sub_f32 v215, v199, v215
    v_mfma_f32_16x16x32_bf16 v[148:151], v[36:39], v[20:23], v[148:151]
    v_add_f32 v196, v200, v228
    v_add_f32 v197, v201, v229
    v_mfma_f32_16x16x32_bf16 v[152:155], v[40:43], v[20:23], v[152:155]
    v_add_f32 v198, v202, v230
    v_add_f32 v199, v203, v231
    v_mfma_f32_16x16x32_bf16 v[168:171], v[44:47], v[20:23], v[168:171]
    v_sub_f32 v228, v200, v228
    v_sub_f32 v229, v201, v229
    v_mfma_f32_16x16x32_bf16 v[172:175], v[24:27], v[20:23], v[172:175]
    v_sub_f32 v230, v202, v230
    v_sub_f32 v231, v203, v231
    v_add_f32 v200, v216, v232
    v_add_f32 v201, v217, v233
    v_mfma_f32_16x16x32_bf16 v[176:179], v[28:31], v[20:23], v[176:179]
    v_add_f32 v202, v218, v234
    v_add_f32 v203, v219, v235
    v_mfma_f32_16x16x32_bf16 v[192:195], v[32:35], v[20:23], v[192:195]
    ds_read_b128 v[20:23], v2 offset:23552
    s_waitcnt lgkmcnt(3)
    v_mfma_f32_16x16x32_bf16 v[148:151], v[48:51], v[8:11], v[148:151]
    v_sub_f32 v232, v216, v232
    v_sub_f32 v233, v217, v233
    v_mfma_f32_16x16x32_bf16 v[152:155], v[52:55], v[8:11], v[152:155]
    v_sub_f32 v234, v218, v234
    v_sub_f32 v235, v219, v235
    v_add_f32 v216, v220, v236
    v_mfma_f32_16x16x32_bf16 v[168:171], v[56:59], v[8:11], v[168:171]
    v_add_f32 v217, v221, v237
    v_add_f32 v218, v222, v238
    v_mfma_f32_16x16x32_bf16 v[172:175], v[36:39], v[8:11], v[172:175]
    v_add_f32 v219, v223, v239
    v_sub_f32 v236, v220, v236
    v_mfma_f32_16x16x32_bf16 v[176:179], v[40:43], v[8:11], v[176:179]
    s_mov_b32 s53, 589824
    v_sub_f32 v237, v221, v237
    v_mfma_f32_16x16x32_bf16 v[192:195], v[44:47], v[8:11], v[192:195]
    v_sub_f32 v238, v222, v238
    v_sub_f32 v239, v223, v239
    v_mfma_f32_16x16x32_bf16 v[196:199], v[24:27], v[8:11], v[196:199]
    buffer_load_dwordx4 v[24:27], v7, s[16:19], s53 offen offset:0 sc1
    v_mfma_f32_16x16x32_bf16 v[200:203], v[28:31], v[8:11], v[200:203]
    v_mfma_f32_16x16x32_bf16 v[216:219], v[32:35], v[8:11], v[216:219]
    ds_read_b128 v[8:11], v2 offset:24576
    s_waitcnt lgkmcnt(3)
    v_mfma_f32_16x16x32_bf16 v[172:175], v[48:51], v[12:15], v[172:175]
    buffer_load_dwordx4 v[28:31], v253, s[16:19], s53 offen offset:0 sc1
    v_mfma_f32_16x16x32_bf16 v[176:179], v[52:55], v[12:15], v[176:179]
    v_mfma_f32_16x16x32_bf16 v[192:195], v[56:59], v[12:15], v[192:195]
    v_mfma_f32_16x16x32_bf16 v[196:199], v[36:39], v[12:15], v[196:199]
    buffer_load_dwordx4 v[32:35], v254, s[16:19], s53 offen offset:0 sc1
    v_mfma_f32_16x16x32_bf16 v[200:203], v[40:43], v[12:15], v[200:203]
    v_mfma_f32_16x16x32_bf16 v[216:219], v[44:47], v[12:15], v[216:219]
    ds_read_b128 v[12:15], v2 offset:31744
    s_waitcnt lgkmcnt(3)
    v_mfma_f32_16x16x32_bf16 v[196:199], v[48:51], v[16:19], v[196:199]
    buffer_load_dwordx4 v[36:39], v7, s[16:19], s53 offen offset:1024 sc1
    v_mfma_f32_16x16x32_bf16 v[200:203], v[52:55], v[16:19], v[200:203]
    v_mfma_f32_16x16x32_bf16 v[216:219], v[56:59], v[16:19], v[216:219]
    ds_read_b128 v[16:19], v2 offset:25600
    s_waitcnt vmcnt(10) lgkmcnt(3)
    v_mfma_f32_16x16x32_bf16 v[224:227], v[60:63], v[20:23], v[224:227]
    buffer_load_dwordx4 v[40:43], v253, s[16:19], s53 offen offset:1024 sc1
    v_mfma_f32_16x16x32_bf16 v[248:251], v[64:67], v[20:23], v[248:251]
    v_mfma_f32_16x16x32_bf16 v[96:99], v[68:71], v[20:23], v[96:99]
    ds_read_b128 v[20:23], v2 offset:32768
    s_waitcnt vmcnt(8) lgkmcnt(3)
    v_mfma_f32_16x16x32_bf16 v[224:227], v[72:75], v[8:11], v[224:227]
    buffer_load_dwordx4 v[44:47], v254, s[16:19], s53 offen offset:1024 sc1
    v_mfma_f32_16x16x32_bf16 v[248:251], v[76:79], v[8:11], v[248:251]
    v_mfma_f32_16x16x32_bf16 v[96:99], v[80:83], v[8:11], v[96:99]
    v_mfma_f32_16x16x32_bf16 v[100:103], v[60:63], v[8:11], v[100:103]
    buffer_load_dwordx4 v[48:51], v7, s[16:19], s53 offen offset:2048 sc1
    v_mfma_f32_16x16x32_bf16 v[104:107], v[64:67], v[8:11], v[104:107]
    v_mfma_f32_16x16x32_bf16 v[120:123], v[68:71], v[8:11], v[120:123]
    ds_read_b128 v[8:11], v2 offset:26624
    s_waitcnt lgkmcnt(3)
    v_mfma_f32_16x16x32_bf16 v[124:127], v[60:63], v[12:15], v[124:127]
    ds_read_b128 v[12:15], v2 offset:33792
    s_waitcnt vmcnt(7) lgkmcnt(3)
    v_mfma_f32_16x16x32_bf16 v[224:227], v[84:87], v[16:19], v[224:227]
    buffer_load_dwordx4 v[52:55], v253, s[16:19], s53 offen offset:2048 sc1
    v_mfma_f32_16x16x32_bf16 v[248:251], v[88:91], v[16:19], v[248:251]
    v_mfma_f32_16x16x32_bf16 v[96:99], v[92:95], v[16:19], v[96:99]
    buffer_load_dwordx4 v[56:59], v254, s[16:19], s53 offen offset:2048 sc1
    v_mfma_f32_16x16x32_bf16 v[100:103], v[72:75], v[16:19], v[100:103]
    v_mfma_f32_16x16x32_bf16 v[104:107], v[76:79], v[16:19], v[104:107]
    v_mfma_f32_16x16x32_bf16 v[120:123], v[80:83], v[16:19], v[120:123]
    v_mfma_f32_16x16x32_bf16 v[128:131], v[60:63], v[16:19], v[128:131]
    v_mfma_f32_16x16x32_bf16 v[240:243], v[64:67], v[16:19], v[240:243]
    v_mfma_f32_16x16x32_bf16 v[144:147], v[68:71], v[16:19], v[144:147]
    ds_read_b128 v[16:19], v2 offset:27648
    s_waitcnt lgkmcnt(3)
    v_mfma_f32_16x16x32_bf16 v[124:127], v[72:75], v[20:23], v[124:127]
    ds_read_b128 v[20:23], v2 offset:28672
    s_waitcnt lgkmcnt(3)
    v_mfma_f32_16x16x32_bf16 v[100:103], v[84:87], v[8:11], v[100:103]
    v_mfma_f32_16x16x32_bf16 v[104:107], v[88:91], v[8:11], v[104:107]
    v_mfma_f32_16x16x32_bf16 v[120:123], v[92:95], v[8:11], v[120:123]
    v_mfma_f32_16x16x32_bf16 v[128:131], v[72:75], v[8:11], v[128:131]
    v_mfma_f32_16x16x32_bf16 v[240:243], v[76:79], v[8:11], v[240:243]
    v_mfma_f32_16x16x32_bf16 v[144:147], v[80:83], v[8:11], v[144:147]
    v_mfma_f32_16x16x32_bf16 v[148:151], v[60:63], v[8:11], v[148:151]
    v_mfma_f32_16x16x32_bf16 v[152:155], v[64:67], v[8:11], v[152:155]
    v_mfma_f32_16x16x32_bf16 v[168:171], v[68:71], v[8:11], v[168:171]
    ds_read_b128 v[8:11], v2 offset:29696
    s_waitcnt lgkmcnt(3)
    v_mfma_f32_16x16x32_bf16 v[124:127], v[84:87], v[12:15], v[124:127]
    ds_read_b128 v[12:15], v2 offset:30720
    s_waitcnt lgkmcnt(3)
    v_mfma_f32_16x16x32_bf16 v[128:131], v[84:87], v[16:19], v[128:131]
    ds_read_b32 v0, v2 offset:35300
    v_mfma_f32_16x16x32_bf16 v[240:243], v[88:91], v[16:19], v[240:243]
    v_mfma_f32_16x16x32_bf16 v[144:147], v[92:95], v[16:19], v[144:147]
    v_mfma_f32_16x16x32_bf16 v[148:151], v[72:75], v[16:19], v[148:151]
    v_mfma_f32_16x16x32_bf16 v[152:155], v[76:79], v[16:19], v[152:155]
    v_mfma_f32_16x16x32_bf16 v[168:171], v[80:83], v[16:19], v[168:171]
    v_mfma_f32_16x16x32_bf16 v[172:175], v[60:63], v[16:19], v[172:175]
    s_waitcnt lgkmcnt(0)
    v_readfirstlane_b32 s47, v0
    v_mfma_f32_16x16x32_bf16 v[176:179], v[64:67], v[16:19], v[176:179]
    s_cmp_eq_u32 s47, 4
    s_cbranch_scc0 L_CKxrdy9_spin
L_CKxrdy9:
    v_mfma_f32_16x16x32_bf16 v[192:195], v[68:71], v[16:19], v[192:195]
    ds_read_b128 v[16:19], v1 offset:0
    v_mfma_f32_16x16x32_bf16 v[148:151], v[84:87], v[20:23], v[148:151]
    v_mfma_f32_16x16x32_bf16 v[152:155], v[88:91], v[20:23], v[152:155]
    v_mfma_f32_16x16x32_bf16 v[168:171], v[92:95], v[20:23], v[168:171]
    v_mfma_f32_16x16x32_bf16 v[172:175], v[72:75], v[20:23], v[172:175]
    v_mfma_f32_16x16x32_bf16 v[176:179], v[76:79], v[20:23], v[176:179]
    s_mov_b32 s53, 626688
    v_mfma_f32_16x16x32_bf16 v[192:195], v[80:83], v[20:23], v[192:195]
    v_mfma_f32_16x16x32_bf16 v[196:199], v[60:63], v[20:23], v[196:199]
    buffer_load_dwordx4 v[60:63], v7, s[16:19], s53 offen offset:0 sc1
    v_mfma_f32_16x16x32_bf16 v[200:203], v[64:67], v[20:23], v[200:203]
    v_mfma_f32_16x16x32_bf16 v[216:219], v[68:71], v[20:23], v[216:219]
    ds_read_b128 v[20:23], v1 offset:1024
    v_mfma_f32_16x16x32_bf16 v[172:175], v[84:87], v[8:11], v[172:175]
    buffer_load_dwordx4 v[64:67], v253, s[16:19], s53 offen offset:0 sc1
    v_mfma_f32_16x16x32_bf16 v[176:179], v[88:91], v[8:11], v[176:179]
    v_mfma_f32_16x16x32_bf16 v[192:195], v[92:95], v[8:11], v[192:195]
    v_mfma_f32_16x16x32_bf16 v[196:199], v[72:75], v[8:11], v[196:199]
    buffer_load_dwordx4 v[68:71], v254, s[16:19], s53 offen offset:0 sc1
    v_mfma_f32_16x16x32_bf16 v[200:203], v[76:79], v[8:11], v[200:203]
    v_mfma_f32_16x16x32_bf16 v[216:219], v[80:83], v[8:11], v[216:219]
    ds_read_b128 v[8:11], v1 offset:8192
    v_mfma_f32_16x16x32_bf16 v[196:199], v[84:87], v[12:15], v[196:199]
    ds_write_b32 v255, v252 offset:384
    buffer_load_dwordx4 v[72:75], v7, s[16:19], s53 offen offset:1024 sc1
    v_mfma_f32_16x16x32_bf16 v[200:203], v[88:91], v[12:15], v[200:203]
    v_mfma_f32_16x16x32_bf16 v[216:219], v[92:95], v[12:15], v[216:219]
    ds_read_b128 v[12:15], v1 offset:2048
    s_waitcnt vmcnt(10) lgkmcnt(4)
    v_mfma_f32_16x16x32_bf16 v[224:227], v[24:27], v[16:19], v[224:227]
    buffer_load_dwordx4 v[76:79], v253, s[16:19], s53 offen offset:1024 sc1
    v_mfma_f32_16x16x32_bf16 v[248:251], v[28:31], v[16:19], v[248:251]
    v_mfma_f32_16x16x32_bf16 v[96:99], v[32:35], v[16:19], v[96:99]
    ds_read_b128 v[16:19], v1 offset:9216
    s_waitcnt vmcnt(8) lgkmcnt(4)
    v_mfma_f32_16x16x32_bf16 v[224:227], v[36:39], v[20:23], v[224:227]
    buffer_load_dwordx4 v[80:83], v254, s[16:19], s53 offen offset:1024 sc1
    v_mfma_f32_16x16x32_bf16 v[248:251], v[40:43], v[20:23], v[248:251]
    v_mfma_f32_16x16x32_bf16 v[96:99], v[44:47], v[20:23], v[96:99]
    v_mfma_f32_16x16x32_bf16 v[100:103], v[24:27], v[20:23], v[100:103]
    buffer_load_dwordx4 v[84:87], v7, s[16:19], s53 offen offset:2048 sc1
    v_mfma_f32_16x16x32_bf16 v[104:107], v[28:31], v[20:23], v[104:107]
    v_mfma_f32_16x16x32_bf16 v[120:123], v[32:35], v[20:23], v[120:123]
    ds_read_b128 v[20:23], v1 offset:3072
    s_waitcnt lgkmcnt(4)
    v_mfma_f32_16x16x32_bf16 v[124:127], v[24:27], v[8:11], v[124:127]
    ds_read_b128 v[8:11], v1 offset:10240
    s_waitcnt vmcnt(7) lgkmcnt(3)
    v_mfma_f32_16x16x32_bf16 v[224:227], v[48:51], v[12:15], v[224:227]
    buffer_load_dwordx4 v[88:91], v253, s[16:19], s53 offen offset:2048 sc1
    v_mfma_f32_16x16x32_bf16 v[248:251], v[52:55], v[12:15], v[248:251]
    v_mfma_f32_16x16x32_bf16 v[96:99], v[56:59], v[12:15], v[96:99]
    buffer_load_dwordx4 v[92:95], v254, s[16:19], s53 offen offset:2048 sc1
    v_mfma_f32_16x16x32_bf16 v[100:103], v[36:39], v[12:15], v[100:103]
    v_mfma_f32_16x16x32_bf16 v[104:107], v[40:43], v[12:15], v[104:107]
    v_mfma_f32_16x16x32_bf16 v[120:123], v[44:47], v[12:15], v[120:123]
    v_mfma_f32_16x16x32_bf16 v[128:131], v[24:27], v[12:15], v[128:131]
    v_mfma_f32_16x16x32_bf16 v[240:243], v[28:31], v[12:15], v[240:243]
    v_mfma_f32_16x16x32_bf16 v[144:147], v[32:35], v[12:15], v[144:147]
    ds_read_b128 v[12:15], v1 offset:4096
    s_waitcnt lgkmcnt(3)
    v_mfma_f32_16x16x32_bf16 v[124:127], v[36:39], v[16:19], v[124:127]
    ds_read_b128 v[16:19], v1 offset:5120
    s_waitcnt lgkmcnt(3)
    v_mfma_f32_16x16x32_bf16 v[100:103], v[48:51], v[20:23], v[100:103]
    v_mfma_f32_16x16x32_bf16 v[104:107], v[52:55], v[20:23], v[104:107]
    v_mfma_f32_16x16x32_bf16 v[120:123], v[56:59], v[20:23], v[120:123]
    v_mfma_f32_16x16x32_bf16 v[128:131], v[36:39], v[20:23], v[128:131]
    v_mfma_f32_16x16x32_bf16 v[240:243], v[40:43], v[20:23], v[240:243]
    v_mfma_f32_16x16x32_bf16 v[144:147], v[44:47], v[20:23], v[144:147]
    v_mfma_f32_16x16x32_bf16 v[148:151], v[24:27], v[20:23], v[148:151]
    v_mfma_f32_16x16x32_bf16 v[152:155], v[28:31], v[20:23], v[152:155]
    v_mfma_f32_16x16x32_bf16 v[168:171], v[32:35], v[20:23], v[168:171]
    ds_read_b128 v[20:23], v1 offset:6144
    s_waitcnt lgkmcnt(3)
    v_mfma_f32_16x16x32_bf16 v[124:127], v[48:51], v[8:11], v[124:127]
    ds_read_b128 v[8:11], v1 offset:7168
    s_waitcnt lgkmcnt(3)
    v_mfma_f32_16x16x32_bf16 v[128:131], v[48:51], v[12:15], v[128:131]
    v_mfma_f32_16x16x32_bf16 v[240:243], v[52:55], v[12:15], v[240:243]
    v_mfma_f32_16x16x32_bf16 v[144:147], v[56:59], v[12:15], v[144:147]
    v_mfma_f32_16x16x32_bf16 v[148:151], v[36:39], v[12:15], v[148:151]
    v_mfma_f32_16x16x32_bf16 v[152:155], v[40:43], v[12:15], v[152:155]
    v_mfma_f32_16x16x32_bf16 v[168:171], v[44:47], v[12:15], v[168:171]
    v_mfma_f32_16x16x32_bf16 v[172:175], v[24:27], v[12:15], v[172:175]
    v_mfma_f32_16x16x32_bf16 v[176:179], v[28:31], v[12:15], v[176:179]
    v_mfma_f32_16x16x32_bf16 v[192:195], v[32:35], v[12:15], v[192:195]
    ds_read_b128 v[12:15], v1 offset:11264
    s_waitcnt lgkmcnt(3)
    v_mfma_f32_16x16x32_bf16 v[148:151], v[48:51], v[16:19], v[148:151]
    v_mfma_f32_16x16x32_bf16 v[152:155], v[52:55], v[16:19], v[152:155]
    v_mfma_f32_16x16x32_bf16 v[168:171], v[56:59], v[16:19], v[168:171]
    v_mfma_f32_16x16x32_bf16 v[172:175], v[36:39], v[16:19], v[172:175]
    v_mfma_f32_16x16x32_bf16 v[176:179], v[40:43], v[16:19], v[176:179]
    s_mov_b32 s53, 737280
    v_mfma_f32_16x16x32_bf16 v[192:195], v[44:47], v[16:19], v[192:195]
    v_mfma_f32_16x16x32_bf16 v[196:199], v[24:27], v[16:19], v[196:199]
    buffer_load_dwordx4 v[24:27], v7, s[16:19], s53 offen offset:0 sc1
    v_mfma_f32_16x16x32_bf16 v[200:203], v[28:31], v[16:19], v[200:203]
    v_mfma_f32_16x16x32_bf16 v[216:219], v[32:35], v[16:19], v[216:219]
    ds_read_b128 v[16:19], v1 offset:12288
    s_waitcnt lgkmcnt(3)
    v_mfma_f32_16x16x32_bf16 v[172:175], v[48:51], v[20:23], v[172:175]
    buffer_load_dwordx4 v[28:31], v253, s[16:19], s53 offen offset:0 sc1
    v_mfma_f32_16x16x32_bf16 v[176:179], v[52:55], v[20:23], v[176:179]
    v_mfma_f32_16x16x32_bf16 v[192:195], v[56:59], v[20:23], v[192:195]
    v_mfma_f32_16x16x32_bf16 v[196:199], v[36:39], v[20:23], v[196:199]
    buffer_load_dwordx4 v[32:35], v254, s[16:19], s53 offen offset:0 sc1
    v_mfma_f32_16x16x32_bf16 v[200:203], v[40:43], v[20:23], v[200:203]
    v_mfma_f32_16x16x32_bf16 v[216:219], v[44:47], v[20:23], v[216:219]
    ds_read_b128 v[20:23], v1 offset:19456
    s_waitcnt lgkmcnt(3)
    v_mfma_f32_16x16x32_bf16 v[196:199], v[48:51], v[8:11], v[196:199]
    buffer_load_dwordx4 v[36:39], v7, s[16:19], s53 offen offset:1024 sc1
    v_mfma_f32_16x16x32_bf16 v[200:203], v[52:55], v[8:11], v[200:203]
    v_mfma_f32_16x16x32_bf16 v[216:219], v[56:59], v[8:11], v[216:219]
    ds_read_b128 v[8:11], v1 offset:13312
    s_waitcnt vmcnt(10) lgkmcnt(3)
    v_mfma_f32_16x16x32_bf16 v[224:227], v[60:63], v[12:15], v[224:227]
    buffer_load_dwordx4 v[40:43], v253, s[16:19], s53 offen offset:1024 sc1
    v_mfma_f32_16x16x32_bf16 v[248:251], v[64:67], v[12:15], v[248:251]
    v_mfma_f32_16x16x32_bf16 v[96:99], v[68:71], v[12:15], v[96:99]
    ds_read_b128 v[12:15], v1 offset:20480
    s_waitcnt vmcnt(8) lgkmcnt(3)
    v_mfma_f32_16x16x32_bf16 v[224:227], v[72:75], v[16:19], v[224:227]
    buffer_load_dwordx4 v[44:47], v254, s[16:19], s53 offen offset:1024 sc1
    v_mfma_f32_16x16x32_bf16 v[248:251], v[76:79], v[16:19], v[248:251]
    v_mfma_f32_16x16x32_bf16 v[96:99], v[80:83], v[16:19], v[96:99]
    v_mfma_f32_16x16x32_bf16 v[100:103], v[60:63], v[16:19], v[100:103]
    buffer_load_dwordx4 v[48:51], v7, s[16:19], s53 offen offset:2048 sc1
    v_mfma_f32_16x16x32_bf16 v[104:107], v[64:67], v[16:19], v[104:107]
    v_mfma_f32_16x16x32_bf16 v[120:123], v[68:71], v[16:19], v[120:123]
    ds_read_b128 v[16:19], v1 offset:14336
    s_waitcnt lgkmcnt(3)
    v_mfma_f32_16x16x32_bf16 v[124:127], v[60:63], v[20:23], v[124:127]
    ds_read_b128 v[20:23], v1 offset:21504
    s_waitcnt vmcnt(7) lgkmcnt(3)
    v_mfma_f32_16x16x32_bf16 v[224:227], v[84:87], v[8:11], v[224:227]
    buffer_load_dwordx4 v[52:55], v253, s[16:19], s53 offen offset:2048 sc1
    v_mfma_f32_16x16x32_bf16 v[248:251], v[88:91], v[8:11], v[248:251]
    v_mfma_f32_16x16x32_bf16 v[96:99], v[92:95], v[8:11], v[96:99]
    buffer_load_dwordx4 v[56:59], v254, s[16:19], s53 offen offset:2048 sc1
    v_mfma_f32_16x16x32_bf16 v[100:103], v[72:75], v[8:11], v[100:103]
    v_mfma_f32_16x16x32_bf16 v[104:107], v[76:79], v[8:11], v[104:107]
    v_mfma_f32_16x16x32_bf16 v[120:123], v[80:83], v[8:11], v[120:123]
    v_mfma_f32_16x16x32_bf16 v[128:131], v[60:63], v[8:11], v[128:131]
    v_cvt_pk_bf16_f32 v224, v224, v225
    v_cvt_pk_bf16_f32 v225, v226, v227
    v_mfma_f32_16x16x32_bf16 v[240:243], v[64:67], v[8:11], v[240:243]
    ds_write_b64 v4, v[224:225] offset:0
    v_mfma_f32_16x16x32_bf16 v[144:147], v[68:71], v[8:11], v[144:147]
    ds_read_b128 v[8:11], v1 offset:15360
    s_waitcnt lgkmcnt(4)
    v_mfma_f32_16x16x32_bf16 v[124:127], v[72:75], v[12:15], v[124:127]
    ds_read_b128 v[12:15], v1 offset:16384
    s_waitcnt lgkmcnt(4)
    v_mfma_f32_16x16x32_bf16 v[100:103], v[84:87], v[16:19], v[100:103]
    v_cvt_pk_bf16_f32 v248, v248, v249
    v_cvt_pk_bf16_f32 v249, v250, v251
    v_mfma_f32_16x16x32_bf16 v[104:107], v[88:91], v[16:19], v[104:107]
    ds_write_b64 v5, v[248:249] offset:0
    v_mfma_f32_16x16x32_bf16 v[120:123], v[92:95], v[16:19], v[120:123]
    v_cvt_pk_bf16_f32 v96, v96, v97
    v_cvt_pk_bf16_f32 v97, v98, v99
    v_mfma_f32_16x16x32_bf16 v[128:131], v[72:75], v[16:19], v[128:131]
    ds_write_b64 v6, v[96:97] offset:0
    v_mfma_f32_16x16x32_bf16 v[240:243], v[76:79], v[16:19], v[240:243]
    ds_write_b32 v255, v252 offset:0
    v_cvt_pk_bf16_f32 v100, v100, v101
    v_mfma_f32_16x16x32_bf16 v[144:147], v[80:83], v[16:19], v[144:147]
    v_cvt_pk_bf16_f32 v101, v102, v103
    v_mfma_f32_16x16x32_bf16 v[148:151], v[60:63], v[16:19], v[148:151]
    ds_write_b64 v4, v[100:101] offset:6400
    v_mfma_f32_16x16x32_bf16 v[152:155], v[64:67], v[16:19], v[152:155]
    v_cvt_pk_bf16_f32 v104, v104, v105
    v_cvt_pk_bf16_f32 v105, v106, v107
    v_mfma_f32_16x16x32_bf16 v[168:171], v[68:71], v[16:19], v[168:171]
    ds_read_b128 v[16:19], v1 offset:17408
    s_waitcnt lgkmcnt(8)
    v_mfma_f32_16x16x32_bf16 v[124:127], v[84:87], v[20:23], v[124:127]
    ds_read_b128 v[20:23], v1 offset:18432
    s_waitcnt lgkmcnt(7)
    v_mfma_f32_16x16x32_bf16 v[128:131], v[84:87], v[8:11], v[128:131]
    ds_read_b32 v0, v2 offset:35304
    v_mfma_f32_16x16x32_bf16 v[240:243], v[88:91], v[8:11], v[240:243]
    ds_write_b64 v5, v[104:105] offset:6400
    v_mfma_f32_16x16x32_bf16 v[144:147], v[92:95], v[8:11], v[144:147]
    v_cvt_pk_bf16_f32 v120, v120, v121
    v_cvt_pk_bf16_f32 v121, v122, v123
    v_mfma_f32_16x16x32_bf16 v[148:151], v[72:75], v[8:11], v[148:151]
    ds_write_b64 v6, v[120:121] offset:6400
    v_mfma_f32_16x16x32_bf16 v[152:155], v[76:79], v[8:11], v[152:155]
    ds_write_b32 v255, v252 offset:16
    v_cvt_pk_bf16_f32 v124, v124, v125
    v_mfma_f32_16x16x32_bf16 v[168:171], v[80:83], v[8:11], v[168:171]
    v_cvt_pk_bf16_f32 v125, v126, v127
    v_mfma_f32_16x16x32_bf16 v[172:175], v[60:63], v[8:11], v[172:175]
    s_waitcnt lgkmcnt(3)
    v_readfirstlane_b32 s47, v0
    v_mfma_f32_16x16x32_bf16 v[176:179], v[64:67], v[8:11], v[176:179]
    s_cmp_eq_u32 s47, 4
    s_cbranch_scc0 L_CKxrdy10_spin
L_CKxrdy10:
    v_mfma_f32_16x16x32_bf16 v[192:195], v[68:71], v[8:11], v[192:195]
    ds_read_b128 v[8:11], v1 offset:22528
    v_mfma_f32_16x16x32_bf16 v[148:151], v[84:87], v[12:15], v[148:151]
    ds_write_b64 v3, v[124:125] offset:0
    v_mfma_f32_16x16x32_bf16 v[152:155], v[88:91], v[12:15], v[152:155]
    ds_write_b32 v255, v252 offset:192
    v_cvt_pk_bf16_f32 v128, v128, v129
    v_mfma_f32_16x16x32_bf16 v[168:171], v[92:95], v[12:15], v[168:171]
    v_cvt_pk_bf16_f32 v129, v130, v131
    v_mfma_f32_16x16x32_bf16 v[172:175], v[72:75], v[12:15], v[172:175]
    ds_write_b64 v4, v[128:129] offset:12800
    v_mfma_f32_16x16x32_bf16 v[176:179], v[76:79], v[12:15], v[176:179]
    s_mov_b32 s53, 774144
    v_cvt_pk_bf16_f32 v240, v240, v241
    v_mfma_f32_16x16x32_bf16 v[192:195], v[80:83], v[12:15], v[192:195]
    v_cvt_pk_bf16_f32 v241, v242, v243
    v_mfma_f32_16x16x32_bf16 v[196:199], v[60:63], v[12:15], v[196:199]
    buffer_load_dwordx4 v[60:63], v7, s[16:19], s53 offen offset:0 sc1
    v_mfma_f32_16x16x32_bf16 v[200:203], v[64:67], v[12:15], v[200:203]
    ds_write_b64 v5, v[240:241] offset:12800
    v_mfma_f32_16x16x32_bf16 v[216:219], v[68:71], v[12:15], v[216:219]
    ds_read_b128 v[12:15], v1 offset:23552
    v_mfma_f32_16x16x32_bf16 v[172:175], v[84:87], v[16:19], v[172:175]
    buffer_load_dwordx4 v[64:67], v253, s[16:19], s53 offen offset:0 sc1
    v_cvt_pk_bf16_f32 v144, v144, v145
    v_mfma_f32_16x16x32_bf16 v[176:179], v[88:91], v[16:19], v[176:179]
    v_cvt_pk_bf16_f32 v145, v146, v147
    v_mfma_f32_16x16x32_bf16 v[192:195], v[92:95], v[16:19], v[192:195]
    ds_write_b64 v6, v[144:145] offset:12800
    v_mfma_f32_16x16x32_bf16 v[196:199], v[72:75], v[16:19], v[196:199]
    buffer_load_dwordx4 v[68:71], v254, s[16:19], s53 offen offset:0 sc1
    ds_write_b32 v255, v252 offset:32
    v_mfma_f32_16x16x32_bf16 v[200:203], v[76:79], v[16:19], v[200:203]
    v_cvt_pk_bf16_f32 v148, v148, v149
    v_cvt_pk_bf16_f32 v149, v150, v151
    v_mfma_f32_16x16x32_bf16 v[216:219], v[80:83], v[16:19], v[216:219]
    ds_read_b128 v[16:19], v1 offset:30720
    v_mfma_f32_16x16x32_bf16 v[196:199], v[84:87], v[20:23], v[196:199]
    buffer_load_dwordx4 v[72:75], v7, s[16:19], s53 offen offset:1024 sc1
    v_mfma_f32_16x16x32_bf16 v[200:203], v[88:91], v[20:23], v[200:203]
    ds_write_b64 v4, v[148:149] offset:19200
    v_mfma_f32_16x16x32_bf16 v[216:219], v[92:95], v[20:23], v[216:219]
    ds_read_b128 v[20:23], v1 offset:24576
    s_waitcnt vmcnt(10) lgkmcnt(10)
    v_mfma_f32_16x16x32_bf16 v[108:111], v[24:27], v[8:11], v[108:111]
    buffer_load_dwordx4 v[76:79], v253, s[16:19], s53 offen offset:1024 sc1
    v_cvt_pk_bf16_f32 v152, v152, v153
    v_mfma_f32_16x16x32_bf16 v[112:115], v[28:31], v[8:11], v[112:115]
    v_cvt_pk_bf16_f32 v153, v154, v155
    v_mfma_f32_16x16x32_bf16 v[116:119], v[32:35], v[8:11], v[116:119]
    ds_read_b128 v[8:11], v1 offset:31744
    s_waitcnt vmcnt(8) lgkmcnt(6)
    v_mfma_f32_16x16x32_bf16 v[108:111], v[36:39], v[12:15], v[108:111]
    buffer_load_dwordx4 v[80:83], v254, s[16:19], s53 offen offset:1024 sc1
    v_mfma_f32_16x16x32_bf16 v[112:115], v[40:43], v[12:15], v[112:115]
    ds_write_b64 v5, v[152:153] offset:19200
    v_mfma_f32_16x16x32_bf16 v[116:119], v[44:47], v[12:15], v[116:119]
    v_cvt_pk_bf16_f32 v168, v168, v169
    v_cvt_pk_bf16_f32 v169, v170, v171
    v_mfma_f32_16x16x32_bf16 v[132:135], v[24:27], v[12:15], v[132:135]
    buffer_load_dwordx4 v[84:87], v7, s[16:19], s53 offen offset:2048 sc1
    v_mfma_f32_16x16x32_bf16 v[136:139], v[28:31], v[12:15], v[136:139]
    ds_write_b64 v6, v[168:169] offset:19200
    v_mfma_f32_16x16x32_bf16 v[140:143], v[32:35], v[12:15], v[140:143]
    ds_read_b128 v[12:15], v1 offset:25600
    s_waitcnt lgkmcnt(6)
    v_mfma_f32_16x16x32_bf16 v[244:247], v[24:27], v[16:19], v[244:247]
    ds_read_b128 v[16:19], v2 offset:0
    s_waitcnt vmcnt(7) lgkmcnt(5)
    v_mfma_f32_16x16x32_bf16 v[108:111], v[48:51], v[20:23], v[108:111]
    buffer_load_dwordx4 v[88:91], v253, s[16:19], s53 offen offset:2048 sc1
    ds_write_b32 v255, v252 offset:48
    v_mfma_f32_16x16x32_bf16 v[112:115], v[52:55], v[20:23], v[112:115]
    v_cvt_pk_bf16_f32 v172, v172, v173
    v_cvt_pk_bf16_f32 v173, v174, v175
    v_mfma_f32_16x16x32_bf16 v[116:119], v[56:59], v[20:23], v[116:119]
    buffer_load_dwordx4 v[92:95], v254, s[16:19], s53 offen offset:2048 sc1
    v_mfma_f32_16x16x32_bf16 v[132:135], v[36:39], v[20:23], v[132:135]
    ds_write_b64 v4, v[172:173] offset:25600
    v_mfma_f32_16x16x32_bf16 v[136:139], v[40:43], v[20:23], v[136:139]
    v_cvt_pk_bf16_f32 v176, v176, v177
    v_cvt_pk_bf16_f32 v177, v178, v179
    v_mfma_f32_16x16x32_bf16 v[140:143], v[44:47], v[20:23], v[140:143]
    ds_write_b64 v5, v[176:177] offset:25600
    v_mfma_f32_16x16x32_bf16 v[156:159], v[24:27], v[20:23], v[156:159]
    v_cvt_pk_bf16_f32 v192, v192, v193
    v_cvt_pk_bf16_f32 v193, v194, v195
    v_mfma_f32_16x16x32_bf16 v[160:163], v[28:31], v[20:23], v[160:163]
    ds_write_b64 v6, v[192:193] offset:25600
    v_mfma_f32_16x16x32_bf16 v[164:167], v[32:35], v[20:23], v[164:167]
    ds_read_b128 v[20:23], v1 offset:26624
    s_waitcnt lgkmcnt(9)
    v_mfma_f32_16x16x32_bf16 v[244:247], v[36:39], v[8:11], v[244:247]
    ds_read_b128 v[8:11], v1 offset:27648
    s_waitcnt lgkmcnt(7)
    v_mfma_f32_16x16x32_bf16 v[132:135], v[48:51], v[12:15], v[132:135]
    ds_write_b32 v255, v252 offset:64
    v_cvt_pk_bf16_f32 v196, v196, v197
    v_mfma_f32_16x16x32_bf16 v[136:139], v[52:55], v[12:15], v[136:139]
    v_cvt_pk_bf16_f32 v197, v198, v199
    v_mfma_f32_16x16x32_bf16 v[140:143], v[56:59], v[12:15], v[140:143]
    ds_write_b64 v4, v[196:197] offset:32000
    v_mfma_f32_16x16x32_bf16 v[156:159], v[36:39], v[12:15], v[156:159]
    v_cvt_pk_bf16_f32 v200, v200, v201
    v_cvt_pk_bf16_f32 v201, v202, v203
    v_mfma_f32_16x16x32_bf16 v[160:163], v[40:43], v[12:15], v[160:163]
    ds_write_b64 v5, v[200:201] offset:32000
    v_mfma_f32_16x16x32_bf16 v[164:167], v[44:47], v[12:15], v[164:167]
    v_cvt_pk_bf16_f32 v216, v216, v217
    v_cvt_pk_bf16_f32 v217, v218, v219
    v_mfma_f32_16x16x32_bf16 v[180:183], v[24:27], v[12:15], v[180:183]
    ds_write_b64 v6, v[216:217] offset:32000
    v_mfma_f32_16x16x32_bf16 v[184:187], v[28:31], v[12:15], v[184:187]
    ds_write_b32 v255, v252 offset:80
    v_add_u32 v4, 38400, v4
    v_mfma_f32_16x16x32_bf16 v[188:191], v[32:35], v[12:15], v[188:191]
    ds_read_b128 v[12:15], v1 offset:28672
    s_waitcnt lgkmcnt(12)
    v_mfma_f32_16x16x32_bf16 v[244:247], v[48:51], v[16:19], v[244:247]
    ds_read_b128 v[16:19], v1 offset:29696
    s_waitcnt lgkmcnt(8)
    v_mfma_f32_16x16x32_bf16 v[156:159], v[48:51], v[20:23], v[156:159]
    v_add_u32 v5, 38400, v5
    v_add_u32 v6, 38400, v6
    v_mfma_f32_16x16x32_bf16 v[160:163], v[52:55], v[20:23], v[160:163]
    v_mfma_f32_16x16x32_bf16 v[164:167], v[56:59], v[20:23], v[164:167]
    v_mfma_f32_16x16x32_bf16 v[180:183], v[36:39], v[20:23], v[180:183]
    v_mfma_f32_16x16x32_bf16 v[184:187], v[40:43], v[20:23], v[184:187]
    v_mfma_f32_16x16x32_bf16 v[188:191], v[44:47], v[20:23], v[188:191]
    v_mfma_f32_16x16x32_bf16 v[204:207], v[24:27], v[20:23], v[204:207]
    v_mfma_f32_16x16x32_bf16 v[208:211], v[28:31], v[20:23], v[208:211]
    v_mfma_f32_16x16x32_bf16 v[212:215], v[32:35], v[20:23], v[212:215]
    ds_read_b128 v[20:23], v2 offset:1024
    s_waitcnt lgkmcnt(8)
    v_mfma_f32_16x16x32_bf16 v[180:183], v[48:51], v[8:11], v[180:183]
    v_mfma_f32_16x16x32_bf16 v[184:187], v[52:55], v[8:11], v[184:187]
    v_mfma_f32_16x16x32_bf16 v[188:191], v[56:59], v[8:11], v[188:191]
    v_mfma_f32_16x16x32_bf16 v[204:207], v[36:39], v[8:11], v[204:207]
    v_mfma_f32_16x16x32_bf16 v[208:211], v[40:43], v[8:11], v[208:211]
    s_mov_b32 s53, 811008
    v_mfma_f32_16x16x32_bf16 v[212:215], v[44:47], v[8:11], v[212:215]
    v_mfma_f32_16x16x32_bf16 v[228:231], v[24:27], v[8:11], v[228:231]
    buffer_load_dwordx4 v[24:27], v7, s[16:19], s53 offen offset:0 sc1
    v_mfma_f32_16x16x32_bf16 v[232:235], v[28:31], v[8:11], v[232:235]
    v_mfma_f32_16x16x32_bf16 v[236:239], v[32:35], v[8:11], v[236:239]
    ds_read_b128 v[8:11], v2 offset:2048
    s_waitcnt lgkmcnt(3)
    v_mfma_f32_16x16x32_bf16 v[204:207], v[48:51], v[12:15], v[204:207]
    buffer_load_dwordx4 v[28:31], v253, s[16:19], s53 offen offset:0 sc1
    v_mfma_f32_16x16x32_bf16 v[208:211], v[52:55], v[12:15], v[208:211]
    v_mfma_f32_16x16x32_bf16 v[212:215], v[56:59], v[12:15], v[212:215]
    v_mfma_f32_16x16x32_bf16 v[228:231], v[36:39], v[12:15], v[228:231]
    buffer_load_dwordx4 v[32:35], v254, s[16:19], s53 offen offset:0 sc1
    v_mfma_f32_16x16x32_bf16 v[232:235], v[40:43], v[12:15], v[232:235]
    v_mfma_f32_16x16x32_bf16 v[236:239], v[44:47], v[12:15], v[236:239]
    ds_read_b128 v[12:15], v2 offset:9216
    s_waitcnt lgkmcnt(3)
    v_mfma_f32_16x16x32_bf16 v[228:231], v[48:51], v[16:19], v[228:231]
    buffer_load_dwordx4 v[36:39], v7, s[16:19], s53 offen offset:1024 sc1
    v_mfma_f32_16x16x32_bf16 v[232:235], v[52:55], v[16:19], v[232:235]
    v_mfma_f32_16x16x32_bf16 v[236:239], v[56:59], v[16:19], v[236:239]
    ds_read_b128 v[16:19], v2 offset:3072
    s_waitcnt vmcnt(10) lgkmcnt(3)
    v_mfma_f32_16x16x32_bf16 v[108:111], v[60:63], v[20:23], v[108:111]
    buffer_load_dwordx4 v[40:43], v253, s[16:19], s53 offen offset:1024 sc1
    v_mfma_f32_16x16x32_bf16 v[112:115], v[64:67], v[20:23], v[112:115]
    v_mfma_f32_16x16x32_bf16 v[116:119], v[68:71], v[20:23], v[116:119]
    ds_read_b128 v[20:23], v2 offset:10240
    s_waitcnt vmcnt(8) lgkmcnt(3)
    v_mfma_f32_16x16x32_bf16 v[108:111], v[72:75], v[8:11], v[108:111]
    buffer_load_dwordx4 v[44:47], v254, s[16:19], s53 offen offset:1024 sc1
    v_mfma_f32_16x16x32_bf16 v[112:115], v[76:79], v[8:11], v[112:115]
    v_mfma_f32_16x16x32_bf16 v[116:119], v[80:83], v[8:11], v[116:119]
    v_mfma_f32_16x16x32_bf16 v[132:135], v[60:63], v[8:11], v[132:135]
    buffer_load_dwordx4 v[48:51], v7, s[16:19], s53 offen offset:2048 sc1
    v_mfma_f32_16x16x32_bf16 v[136:139], v[64:67], v[8:11], v[136:139]
    v_mfma_f32_16x16x32_bf16 v[140:143], v[68:71], v[8:11], v[140:143]
    ds_read_b128 v[8:11], v2 offset:4096
    s_waitcnt lgkmcnt(3)
    v_mfma_f32_16x16x32_bf16 v[244:247], v[60:63], v[12:15], v[244:247]
    ds_read_b128 v[12:15], v2 offset:11264
    s_waitcnt vmcnt(7) lgkmcnt(3)
    v_mfma_f32_16x16x32_bf16 v[108:111], v[84:87], v[16:19], v[108:111]
    buffer_load_dwordx4 v[52:55], v253, s[16:19], s53 offen offset:2048 sc1
    v_mfma_f32_16x16x32_bf16 v[112:115], v[88:91], v[16:19], v[112:115]
    v_mfma_f32_16x16x32_bf16 v[116:119], v[92:95], v[16:19], v[116:119]
    buffer_load_dwordx4 v[56:59], v254, s[16:19], s53 offen offset:2048 sc1
    v_mfma_f32_16x16x32_bf16 v[132:135], v[72:75], v[16:19], v[132:135]
    v_mfma_f32_16x16x32_bf16 v[136:139], v[76:79], v[16:19], v[136:139]
    v_mfma_f32_16x16x32_bf16 v[140:143], v[80:83], v[16:19], v[140:143]
    v_mfma_f32_16x16x32_bf16 v[156:159], v[60:63], v[16:19], v[156:159]
    v_mfma_f32_16x16x32_bf16 v[160:163], v[64:67], v[16:19], v[160:163]
    v_mfma_f32_16x16x32_bf16 v[164:167], v[68:71], v[16:19], v[164:167]
    ds_read_b128 v[16:19], v2 offset:5120
    s_waitcnt lgkmcnt(3)
    v_mfma_f32_16x16x32_bf16 v[244:247], v[72:75], v[20:23], v[244:247]
    ds_read_b128 v[20:23], v2 offset:6144
    s_waitcnt lgkmcnt(3)
    v_mfma_f32_16x16x32_bf16 v[132:135], v[84:87], v[8:11], v[132:135]
    v_mfma_f32_16x16x32_bf16 v[136:139], v[88:91], v[8:11], v[136:139]
    v_mfma_f32_16x16x32_bf16 v[140:143], v[92:95], v[8:11], v[140:143]
    v_mfma_f32_16x16x32_bf16 v[156:159], v[72:75], v[8:11], v[156:159]
    v_mfma_f32_16x16x32_bf16 v[160:163], v[76:79], v[8:11], v[160:163]
    v_mfma_f32_16x16x32_bf16 v[164:167], v[80:83], v[8:11], v[164:167]
    v_mfma_f32_16x16x32_bf16 v[180:183], v[60:63], v[8:11], v[180:183]
    v_mfma_f32_16x16x32_bf16 v[184:187], v[64:67], v[8:11], v[184:187]
    v_mfma_f32_16x16x32_bf16 v[188:191], v[68:71], v[8:11], v[188:191]
    ds_read_b128 v[8:11], v2 offset:7168
    s_waitcnt lgkmcnt(3)
    v_mfma_f32_16x16x32_bf16 v[244:247], v[84:87], v[12:15], v[244:247]
    ds_read_b128 v[12:15], v2 offset:8192
    s_waitcnt lgkmcnt(3)
    v_mfma_f32_16x16x32_bf16 v[156:159], v[84:87], v[16:19], v[156:159]
    ds_read_b32 v0, v2 offset:35308
    v_mfma_f32_16x16x32_bf16 v[160:163], v[88:91], v[16:19], v[160:163]
    v_mfma_f32_16x16x32_bf16 v[164:167], v[92:95], v[16:19], v[164:167]
    v_mfma_f32_16x16x32_bf16 v[180:183], v[72:75], v[16:19], v[180:183]
    v_mfma_f32_16x16x32_bf16 v[184:187], v[76:79], v[16:19], v[184:187]
    v_mfma_f32_16x16x32_bf16 v[188:191], v[80:83], v[16:19], v[188:191]
    v_mfma_f32_16x16x32_bf16 v[204:207], v[60:63], v[16:19], v[204:207]
    s_waitcnt lgkmcnt(0)
    v_readfirstlane_b32 s47, v0
    v_mfma_f32_16x16x32_bf16 v[208:211], v[64:67], v[16:19], v[208:211]
    s_cmp_eq_u32 s47, 4
    s_cbranch_scc0 L_CKxrdy11_spin
L_CKxrdy11:
    v_mfma_f32_16x16x32_bf16 v[212:215], v[68:71], v[16:19], v[212:215]
    ds_read_b128 v[16:19], v2 offset:12288
    v_mfma_f32_16x16x32_bf16 v[180:183], v[84:87], v[20:23], v[180:183]
    v_mfma_f32_16x16x32_bf16 v[184:187], v[88:91], v[20:23], v[184:187]
    v_mfma_f32_16x16x32_bf16 v[188:191], v[92:95], v[20:23], v[188:191]
    v_mfma_f32_16x16x32_bf16 v[204:207], v[72:75], v[20:23], v[204:207]
    v_mfma_f32_16x16x32_bf16 v[208:211], v[76:79], v[20:23], v[208:211]
    s_mov_b32 s53, 847872
    v_mfma_f32_16x16x32_bf16 v[212:215], v[80:83], v[20:23], v[212:215]
    v_mfma_f32_16x16x32_bf16 v[228:231], v[60:63], v[20:23], v[228:231]
    buffer_load_dwordx4 v[60:63], v7, s[16:19], s53 offen offset:0 sc1
    v_mfma_f32_16x16x32_bf16 v[232:235], v[64:67], v[20:23], v[232:235]
    v_mfma_f32_16x16x32_bf16 v[236:239], v[68:71], v[20:23], v[236:239]
    ds_read_b128 v[20:23], v2 offset:13312
    v_mfma_f32_16x16x32_bf16 v[204:207], v[84:87], v[8:11], v[204:207]
    buffer_load_dwordx4 v[64:67], v253, s[16:19], s53 offen offset:0 sc1
    v_mfma_f32_16x16x32_bf16 v[208:211], v[88:91], v[8:11], v[208:211]
    buffer_load_dwordx4 v[68:71], v254, s[16:19], s53 offen offset:0 sc1
    v_mfma_f32_16x16x32_bf16 v[212:215], v[92:95], v[8:11], v[212:215]
    v_mfma_f32_16x16x32_bf16 v[228:231], v[72:75], v[8:11], v[228:231]
    buffer_load_dwordx4 v[72:75], v7, s[16:19], s53 offen offset:1024 sc1
    v_mfma_f32_16x16x32_bf16 v[232:235], v[76:79], v[8:11], v[232:235]
    v_mfma_f32_16x16x32_bf16 v[236:239], v[80:83], v[8:11], v[236:239]
    ds_read_b128 v[8:11], v2 offset:20480
    v_mfma_f32_16x16x32_bf16 v[228:231], v[84:87], v[12:15], v[228:231]
    buffer_load_dwordx4 v[76:79], v253, s[16:19], s53 offen offset:1024 sc1
    v_mfma_f32_16x16x32_bf16 v[232:235], v[88:91], v[12:15], v[232:235]
    buffer_load_dwordx4 v[80:83], v254, s[16:19], s53 offen offset:1024 sc1
    v_mfma_f32_16x16x32_bf16 v[236:239], v[92:95], v[12:15], v[236:239]
    ds_read_b128 v[12:15], v2 offset:14336
    s_waitcnt vmcnt(12) lgkmcnt(3)
    v_mfma_f32_16x16x32_bf16 v[108:111], v[24:27], v[16:19], v[108:111]
    buffer_load_dwordx4 v[84:87], v7, s[16:19], s53 offen offset:2048 sc1
    v_mfma_f32_16x16x32_bf16 v[112:115], v[28:31], v[16:19], v[112:115]
    v_mfma_f32_16x16x32_bf16 v[116:119], v[32:35], v[16:19], v[116:119]
    ds_read_b128 v[16:19], v2 offset:21504
    s_waitcnt vmcnt(10) lgkmcnt(3)
    v_mfma_f32_16x16x32_bf16 v[108:111], v[36:39], v[20:23], v[108:111]
    buffer_load_dwordx4 v[88:91], v253, s[16:19], s53 offen offset:2048 sc1
    v_mfma_f32_16x16x32_bf16 v[112:115], v[40:43], v[20:23], v[112:115]
    buffer_load_dwordx4 v[92:95], v254, s[16:19], s53 offen offset:2048 sc1
    v_mfma_f32_16x16x32_bf16 v[116:119], v[44:47], v[20:23], v[116:119]
    ds_write_b32 v255, v252 offset:224
    v_mfma_f32_16x16x32_bf16 v[132:135], v[24:27], v[20:23], v[132:135]
    v_mfma_f32_16x16x32_bf16 v[136:139], v[28:31], v[20:23], v[136:139]
    v_mfma_f32_16x16x32_bf16 v[140:143], v[32:35], v[20:23], v[140:143]
    ds_read_b128 v[20:23], v2 offset:23552
    s_waitcnt lgkmcnt(4)
    v_mfma_f32_16x16x32_bf16 v[244:247], v[24:27], v[8:11], v[244:247]
    ds_read_b128 v[8:11], v2 offset:15360
    s_waitcnt vmcnt(9) lgkmcnt(4)
    v_mfma_f32_16x16x32_bf16 v[108:111], v[48:51], v[12:15], v[108:111]
    v_mfma_f32_16x16x32_bf16 v[112:115], v[52:55], v[12:15], v[112:115]
    v_mfma_f32_16x16x32_bf16 v[116:119], v[56:59], v[12:15], v[116:119]
    v_mfma_f32_16x16x32_bf16 v[132:135], v[36:39], v[12:15], v[132:135]
    v_mfma_f32_16x16x32_bf16 v[136:139], v[40:43], v[12:15], v[136:139]
    v_mfma_f32_16x16x32_bf16 v[140:143], v[44:47], v[12:15], v[140:143]
    v_mfma_f32_16x16x32_bf16 v[156:159], v[24:27], v[12:15], v[156:159]
    v_mfma_f32_16x16x32_bf16 v[160:163], v[28:31], v[12:15], v[160:163]
    v_mfma_f32_16x16x32_bf16 v[164:167], v[32:35], v[12:15], v[164:167]
    ds_read_b128 v[12:15], v2 offset:22528
    s_waitcnt lgkmcnt(4)
    v_mfma_f32_16x16x32_bf16 v[244:247], v[36:39], v[16:19], v[244:247]
    ds_read_b128 v[16:19], v2 offset:24576
    s_waitcnt vmcnt(6) lgkmcnt(3)
    v_mfma_f32_16x16x32_bf16 v[108:111], v[60:63], v[20:23], v[108:111]
    v_mfma_f32_16x16x32_bf16 v[112:115], v[64:67], v[20:23], v[112:115]
    v_mfma_f32_16x16x32_bf16 v[116:119], v[68:71], v[20:23], v[116:119]
    ds_read_b128 v[20:23], v2 offset:31744
    s_waitcnt lgkmcnt(3)
    v_mfma_f32_16x16x32_bf16 v[132:135], v[48:51], v[8:11], v[132:135]
    v_mfma_f32_16x16x32_bf16 v[136:139], v[52:55], v[8:11], v[136:139]
    v_mfma_f32_16x16x32_bf16 v[140:143], v[56:59], v[8:11], v[140:143]
    v_mfma_f32_16x16x32_bf16 v[156:159], v[36:39], v[8:11], v[156:159]
    v_mfma_f32_16x16x32_bf16 v[160:163], v[40:43], v[8:11], v[160:163]
    v_mfma_f32_16x16x32_bf16 v[164:167], v[44:47], v[8:11], v[164:167]
    v_mfma_f32_16x16x32_bf16 v[180:183], v[24:27], v[8:11], v[180:183]
    v_mfma_f32_16x16x32_bf16 v[184:187], v[28:31], v[8:11], v[184:187]
    v_mfma_f32_16x16x32_bf16 v[188:191], v[32:35], v[8:11], v[188:191]
    ds_read_b128 v[8:11], v2 offset:25600
    s_waitcnt lgkmcnt(3)
    v_mfma_f32_16x16x32_bf16 v[244:247], v[48:51], v[12:15], v[244:247]
    ds_read_b128 v[12:15], v2 offset:32768
    s_waitcnt vmcnt(3) lgkmcnt(3)
    v_mfma_f32_16x16x32_bf16 v[108:111], v[72:75], v[16:19], v[108:111]
    v_mfma_f32_16x16x32_bf16 v[112:115], v[76:79], v[16:19], v[112:115]
    v_mfma_f32_16x16x32_bf16 v[116:119], v[80:83], v[16:19], v[116:119]
    v_mfma_f32_16x16x32_bf16 v[132:135], v[60:63], v[16:19], v[132:135]
    v_mfma_f32_16x16x32_bf16 v[136:139], v[64:67], v[16:19], v[136:139]
    v_mfma_f32_16x16x32_bf16 v[140:143], v[68:71], v[16:19], v[140:143]
    ds_read_b128 v[16:19], v2 offset:26624
    s_waitcnt lgkmcnt(3)
    v_mfma_f32_16x16x32_bf16 v[244:247], v[60:63], v[20:23], v[244:247]
    ds_read_b128 v[20:23], v2 offset:33792
    s_waitcnt vmcnt(0) lgkmcnt(3)
    v_mfma_f32_16x16x32_bf16 v[108:111], v[84:87], v[8:11], v[108:111]
    v_mfma_f32_16x16x32_bf16 v[112:115], v[88:91], v[8:11], v[112:115]
    v_mfma_f32_16x16x32_bf16 v[116:119], v[92:95], v[8:11], v[116:119]
    v_mfma_f32_16x16x32_bf16 v[132:135], v[72:75], v[8:11], v[132:135]
    v_mfma_f32_16x16x32_bf16 v[136:139], v[76:79], v[8:11], v[136:139]
    v_mfma_f32_16x16x32_bf16 v[140:143], v[80:83], v[8:11], v[140:143]
    v_mfma_f32_16x16x32_bf16 v[156:159], v[60:63], v[8:11], v[156:159]
    v_mfma_f32_16x16x32_bf16 v[160:163], v[64:67], v[8:11], v[160:163]
    v_mfma_f32_16x16x32_bf16 v[164:167], v[68:71], v[8:11], v[164:167]
    ds_read_b128 v[8:11], v2 offset:16384
    s_waitcnt lgkmcnt(3)
    v_mfma_f32_16x16x32_bf16 v[244:247], v[72:75], v[12:15], v[244:247]
    ds_read_b128 v[12:15], v2 offset:27648
    s_waitcnt lgkmcnt(3)
    v_mfma_f32_16x16x32_bf16 v[132:135], v[84:87], v[16:19], v[132:135]
    v_cvt_pk_bf16_f32 v108, v108, v109
    v_cvt_pk_bf16_f32 v109, v110, v111
    v_mfma_f32_16x16x32_bf16 v[136:139], v[88:91], v[16:19], v[136:139]
    ds_write_b64 v4, v[108:109] offset:0
    v_mfma_f32_16x16x32_bf16 v[140:143], v[92:95], v[16:19], v[140:143]
    v_cvt_pk_bf16_f32 v112, v112, v113
    v_cvt_pk_bf16_f32 v113, v114, v115
    v_mfma_f32_16x16x32_bf16 v[156:159], v[72:75], v[16:19], v[156:159]
    ds_write_b64 v5, v[112:113] offset:0
    v_mfma_f32_16x16x32_bf16 v[160:163], v[76:79], v[16:19], v[160:163]
    v_cvt_pk_bf16_f32 v116, v116, v117
    v_cvt_pk_bf16_f32 v117, v118, v119
    v_mfma_f32_16x16x32_bf16 v[164:167], v[80:83], v[16:19], v[164:167]
    ds_write_b64 v6, v[116:117] offset:0
    v_mfma_f32_16x16x32_bf16 v[180:183], v[60:63], v[16:19], v[180:183]
    ds_write_b32 v255, v252 offset:96
    v_cvt_pk_bf16_f32 v132, v132, v133
    v_mfma_f32_16x16x32_bf16 v[184:187], v[64:67], v[16:19], v[184:187]
    v_cvt_pk_bf16_f32 v133, v134, v135
    v_mfma_f32_16x16x32_bf16 v[188:191], v[68:71], v[16:19], v[188:191]
    ds_read_b128 v[16:19], v2 offset:17408
    s_waitcnt lgkmcnt(7)
    v_mfma_f32_16x16x32_bf16 v[244:247], v[84:87], v[20:23], v[244:247]
    ds_read_b128 v[20:23], v2 offset:28672
    s_waitcnt lgkmcnt(7)
    v_mfma_f32_16x16x32_bf16 v[156:159], v[48:51], v[8:11], v[156:159]
    ds_write_b64 v4, v[132:133] offset:6400
    v_mfma_f32_16x16x32_bf16 v[160:163], v[52:55], v[8:11], v[160:163]
    v_cvt_pk_bf16_f32 v136, v136, v137
    v_cvt_pk_bf16_f32 v137, v138, v139
    v_mfma_f32_16x16x32_bf16 v[164:167], v[56:59], v[8:11], v[164:167]
    ds_write_b64 v5, v[136:137] offset:6400
    v_mfma_f32_16x16x32_bf16 v[180:183], v[36:39], v[8:11], v[180:183]
    v_cvt_pk_bf16_f32 v140, v140, v141
    v_cvt_pk_bf16_f32 v141, v142, v143
    v_mfma_f32_16x16x32_bf16 v[184:187], v[40:43], v[8:11], v[184:187]
    ds_write_b64 v6, v[140:141] offset:6400
    v_mfma_f32_16x16x32_bf16 v[188:191], v[44:47], v[8:11], v[188:191]
    ds_write_b32 v255, v252 offset:112
    v_cvt_pk_bf16_f32 v244, v244, v245
    v_mfma_f32_16x16x32_bf16 v[204:207], v[24:27], v[8:11], v[204:207]
    v_cvt_pk_bf16_f32 v245, v246, v247
    v_mfma_f32_16x16x32_bf16 v[208:211], v[28:31], v[8:11], v[208:211]
    ds_write_b64 v3, v[244:245] offset:2304
    v_mfma_f32_16x16x32_bf16 v[212:215], v[32:35], v[8:11], v[212:215]
    ds_read_b128 v[8:11], v2 offset:18432
    s_waitcnt lgkmcnt(12)
    v_mfma_f32_16x16x32_bf16 v[156:159], v[84:87], v[12:15], v[156:159]
    ds_write_b32 v255, v252 offset:208
    v_mfma_f32_16x16x32_bf16 v[160:163], v[88:91], v[12:15], v[160:163]
    v_mfma_f32_16x16x32_bf16 v[164:167], v[92:95], v[12:15], v[164:167]
    v_mfma_f32_16x16x32_bf16 v[180:183], v[72:75], v[12:15], v[180:183]
    v_mfma_f32_16x16x32_bf16 v[184:187], v[76:79], v[12:15], v[184:187]
    v_mfma_f32_16x16x32_bf16 v[188:191], v[80:83], v[12:15], v[188:191]
    v_mfma_f32_16x16x32_bf16 v[204:207], v[60:63], v[12:15], v[204:207]
    v_mfma_f32_16x16x32_bf16 v[208:211], v[64:67], v[12:15], v[208:211]
    v_cvt_pk_bf16_f32 v156, v156, v157
    v_cvt_pk_bf16_f32 v157, v158, v159
    v_mfma_f32_16x16x32_bf16 v[212:215], v[68:71], v[12:15], v[212:215]
    ds_read_b128 v[12:15], v2 offset:29696
    s_waitcnt lgkmcnt(9)
    v_mfma_f32_16x16x32_bf16 v[180:183], v[48:51], v[16:19], v[180:183]
    ds_write_b64 v4, v[156:157] offset:12800
    v_mfma_f32_16x16x32_bf16 v[184:187], v[52:55], v[16:19], v[184:187]
    v_cvt_pk_bf16_f32 v160, v160, v161
    v_cvt_pk_bf16_f32 v161, v162, v163
    v_mfma_f32_16x16x32_bf16 v[188:191], v[56:59], v[16:19], v[188:191]
    ds_write_b64 v5, v[160:161] offset:12800
    v_mfma_f32_16x16x32_bf16 v[204:207], v[36:39], v[16:19], v[204:207]
    v_cvt_pk_bf16_f32 v164, v164, v165
    v_cvt_pk_bf16_f32 v165, v166, v167
    v_mfma_f32_16x16x32_bf16 v[208:211], v[40:43], v[16:19], v[208:211]
    ds_write_b64 v6, v[164:165] offset:12800
    v_mfma_f32_16x16x32_bf16 v[212:215], v[44:47], v[16:19], v[212:215]
    ds_write_b32 v255, v252 offset:128
    v_mfma_f32_16x16x32_bf16 v[228:231], v[24:27], v[16:19], v[228:231]
    v_mfma_f32_16x16x32_bf16 v[232:235], v[28:31], v[16:19], v[232:235]
    v_mfma_f32_16x16x32_bf16 v[236:239], v[32:35], v[16:19], v[236:239]
    ds_read_b128 v[16:19], v2 offset:19456
    s_waitcnt lgkmcnt(13)
    v_mfma_f32_16x16x32_bf16 v[180:183], v[84:87], v[20:23], v[180:183]
    v_mfma_f32_16x16x32_bf16 v[184:187], v[88:91], v[20:23], v[184:187]
    v_mfma_f32_16x16x32_bf16 v[188:191], v[92:95], v[20:23], v[188:191]
    v_mfma_f32_16x16x32_bf16 v[204:207], v[72:75], v[20:23], v[204:207]
    v_mfma_f32_16x16x32_bf16 v[208:211], v[76:79], v[20:23], v[208:211]
    v_mfma_f32_16x16x32_bf16 v[212:215], v[80:83], v[20:23], v[212:215]
    v_mfma_f32_16x16x32_bf16 v[228:231], v[60:63], v[20:23], v[228:231]
    v_mfma_f32_16x16x32_bf16 v[232:235], v[64:67], v[20:23], v[232:235]
    v_mfma_f32_16x16x32_bf16 v[236:239], v[68:71], v[20:23], v[236:239]
    ds_read_b128 v[20:23], v2 offset:30720
    s_waitcnt lgkmcnt(8)
    v_mfma_f32_16x16x32_bf16 v[204:207], v[48:51], v[8:11], v[204:207]
    v_cvt_pk_bf16_f32 v180, v180, v181
    v_cvt_pk_bf16_f32 v181, v182, v183
    v_mfma_f32_16x16x32_bf16 v[208:211], v[52:55], v[8:11], v[208:211]
    ds_write_b64 v4, v[180:181] offset:19200
    v_mfma_f32_16x16x32_bf16 v[212:215], v[56:59], v[8:11], v[212:215]
    v_cvt_pk_bf16_f32 v184, v184, v185
    v_cvt_pk_bf16_f32 v185, v186, v187
    v_mfma_f32_16x16x32_bf16 v[228:231], v[36:39], v[8:11], v[228:231]
    ds_write_b64 v5, v[184:185] offset:19200
    v_mfma_f32_16x16x32_bf16 v[232:235], v[40:43], v[8:11], v[232:235]
    v_cvt_pk_bf16_f32 v188, v188, v189
    v_cvt_pk_bf16_f32 v189, v190, v191
    v_mfma_f32_16x16x32_bf16 v[236:239], v[44:47], v[8:11], v[236:239]
    s_waitcnt lgkmcnt(8)
    v_mfma_f32_16x16x32_bf16 v[204:207], v[84:87], v[12:15], v[204:207]
    ds_write_b64 v6, v[188:189] offset:19200
    v_mfma_f32_16x16x32_bf16 v[208:211], v[88:91], v[12:15], v[208:211]
    ds_write_b32 v255, v252 offset:144
    v_mfma_f32_16x16x32_bf16 v[212:215], v[92:95], v[12:15], v[212:215]
    v_mfma_f32_16x16x32_bf16 v[228:231], v[72:75], v[12:15], v[228:231]
    v_mfma_f32_16x16x32_bf16 v[232:235], v[76:79], v[12:15], v[232:235]
    v_mfma_f32_16x16x32_bf16 v[236:239], v[80:83], v[12:15], v[236:239]
    s_waitcnt lgkmcnt(5)
    v_mfma_f32_16x16x32_bf16 v[228:231], v[48:51], v[16:19], v[228:231]
    v_cvt_pk_bf16_f32 v204, v204, v205
    v_cvt_pk_bf16_f32 v205, v206, v207
    v_mfma_f32_16x16x32_bf16 v[232:235], v[52:55], v[16:19], v[232:235]
    ds_write_b64 v4, v[204:205] offset:25600
    v_mfma_f32_16x16x32_bf16 v[236:239], v[56:59], v[16:19], v[236:239]
    v_cvt_pk_bf16_f32 v208, v208, v209
    s_waitcnt lgkmcnt(5)
    v_mfma_f32_16x16x32_bf16 v[228:231], v[84:87], v[20:23], v[228:231]
    v_cvt_pk_bf16_f32 v209, v210, v211
    v_mfma_f32_16x16x32_bf16 v[232:235], v[88:91], v[20:23], v[232:235]
    ds_write_b64 v5, v[208:209] offset:25600
    v_mfma_f32_16x16x32_bf16 v[236:239], v[92:95], v[20:23], v[236:239]
    v_cvt_pk_bf16_f32 v212, v212, v213
    v_cvt_pk_bf16_f32 v213, v214, v215
    ds_write_b64 v6, v[212:213] offset:25600
    ds_write_b32 v255, v252 offset:160
    s_nop 3
    v_cvt_pk_bf16_f32 v228, v228, v229
    v_cvt_pk_bf16_f32 v229, v230, v231
    v_cvt_pk_bf16_f32 v232, v232, v233
    v_cvt_pk_bf16_f32 v233, v234, v235
    v_cvt_pk_bf16_f32 v236, v236, v237
    v_cvt_pk_bf16_f32 v237, v238, v239
    ds_write_b64 v4, v[228:229] offset:32000
    ds_write_b64 v5, v[232:233] offset:32000
    ds_write_b64 v6, v[236:237] offset:32000
    ds_write_b32 v255, v252 offset:176
    s_endpgm
L_CKxrdy0_spin:
    ds_read_b32 v0, v2 offset:35264
    s_waitcnt lgkmcnt(0)
    v_readfirstlane_b32 s47, v0
    s_cmp_eq_u32 s47, 4
    s_cbranch_scc0 L_CKxrdy0_spin
    s_branch L_CKxrdy0
L_CKxrdy1_spin:
    ds_read_b32 v0, v2 offset:35268
    s_waitcnt lgkmcnt(0)
    v_readfirstlane_b32 s47, v0
    s_cmp_eq_u32 s47, 4
    s_cbranch_scc0 L_CKxrdy1_spin
    s_branch L_CKxrdy1
L_CKxuflag_spin:
    ds_read_b32 v0, v2 offset:35056
    s_waitcnt lgkmcnt(0)
    v_readfirstlane_b32 s47, v0
    s_cmp_eq_u32 s47, 1
    s_cbranch_scc0 L_CKxuflag_spin
    s_branch L_CKxuflag
L_CKxrdy2_spin:
    ds_read_b32 v0, v2 offset:35272
    s_waitcnt lgkmcnt(0)
    v_readfirstlane_b32 s47, v0
    s_cmp_eq_u32 s47, 4
    s_cbranch_scc0 L_CKxrdy2_spin
    s_branch L_CKxrdy2
L_CKxrdy3_spin:
    ds_read_b32 v0, v2 offset:35276
    s_waitcnt lgkmcnt(0)
    v_readfirstlane_b32 s47, v0
    s_cmp_eq_u32 s47, 4
    s_cbranch_scc0 L_CKxrdy3_spin
    s_branch L_CKxrdy3
L_CKxrdy4_spin:
    ds_read_b32 v0, v2 offset:35280
    s_waitcnt lgkmcnt(0)
    v_readfirstlane_b32 s47, v0
    s_cmp_eq_u32 s47, 4
    s_cbranch_scc0 L_CKxrdy4_spin
    s_branch L_CKxrdy4
L_CKxrdy5_spin:
    ds_read_b32 v0, v2 offset:35284
    s_waitcnt lgkmcnt(0)
    v_readfirstlane_b32 s47, v0
    s_cmp_eq_u32 s47, 4
    s_cbranch_scc0 L_CKxrdy5_spin
    s_branch L_CKxrdy5
L_CKxrdy6_spin:
    ds_read_b32 v0, v2 offset:35288
    s_waitcnt lgkmcnt(0)
    v_readfirstlane_b32 s47, v0
    s_cmp_eq_u32 s47, 4
    s_cbranch_scc0 L_CKxrdy6_spin
    s_branch L_CKxrdy6
L_CKxrdy7_spin:
    ds_read_b32 v0, v2 offset:35292
    s_waitcnt lgkmcnt(0)
    v_readfirstlane_b32 s47, v0
    s_cmp_eq_u32 s47, 4
    s_cbranch_scc0 L_CKxrdy7_spin
    s_branch L_CKxrdy7
L_CKxrdy8_spin:
    ds_read_b32 v0, v2 offset:35296
    s_waitcnt lgkmcnt(0)
    v_readfirstlane_b32 s47, v0
    s_cmp_eq_u32 s47, 4
    s_cbranch_scc0 L_CKxrdy8_spin
    s_branch L_CKxrdy8
L_CKxrdy9_spin:
    ds_read_b32 v0, v2 offset:35300
    s_waitcnt lgkmcnt(0)
    v_readfirstlane_b32 s47, v0
    s_cmp_eq_u32 s47, 4
    s_cbranch_scc0 L_CKxrdy9_spin
    s_branch L_CKxrdy9
L_CKxrdy10_spin:
    ds_read_b32 v0, v2 offset:35304
    s_waitcnt lgkmcnt(0)
    v_readfirstlane_b32 s47, v0
    s_cmp_eq_u32 s47, 4
    s_cbranch_scc0 L_CKxrdy10_spin
    s_branch L_CKxrdy10
L_CKxrdy11_spin:
    ds_read_b32 v0, v2 offset:35308
    s_waitcnt lgkmcnt(0)
    v_readfirstlane_b32 s47, v0
    s_cmp_eq_u32 s47, 4
    s_cbranch_scc0 L_CKxrdy11_spin
    s_branch L_CKxrdy11
.org standalone__standard_2d_1d_3d_conv__vision_kernel + 64000, 0
L_CN:
    v_lshlrev_b32 v8, 3, v0
    v_add_u32 v8, 67584, v8
    v_mov_b32 v10, 0
    v_mov_b32 v11, 0
    ds_write_b64 v8, v[10:11]
    s_waitcnt lgkmcnt(0)
    s_barrier
    s_add_u32 m0, s52, 0
    s_mov_b32 s54, 0
    buffer_load_dwordx4 v4, s[8:11], s54 offen offset:0 lds
    buffer_load_dwordx4 v5, s[8:11], s54 offen offset:1024 lds
    buffer_load_dwordx4 v6, s[8:11], s54 offen offset:2048 lds
    s_add_u32 m0, s52, 3072
    s_mov_b32 s54, 221184
    buffer_load_dwordx4 v4, s[8:11], s54 offen offset:0 lds
    buffer_load_dwordx4 v5, s[8:11], s54 offen offset:1024 lds
    buffer_load_dwordx4 v6, s[8:11], s54 offen offset:2048 lds
    s_add_u32 m0, s52, 6144
    s_mov_b32 s54, 442368
    buffer_load_dwordx4 v4, s[8:11], s54 offen offset:0 lds
    buffer_load_dwordx4 v5, s[8:11], s54 offen offset:1024 lds
    buffer_load_dwordx4 v6, s[8:11], s54 offen offset:2048 lds
    s_add_u32 m0, s52, 9216
    s_mov_b32 s54, 12288
    buffer_load_dwordx4 v4, s[8:11], s54 offen offset:0 lds
    buffer_load_dwordx4 v5, s[8:11], s54 offen offset:1024 lds
    buffer_load_dwordx4 v6, s[8:11], s54 offen offset:2048 lds
    s_add_u32 m0, s52, 12288
    s_mov_b32 s54, 233472
    buffer_load_dwordx4 v4, s[8:11], s54 offen offset:0 lds
    buffer_load_dwordx4 v5, s[8:11], s54 offen offset:1024 lds
    buffer_load_dwordx4 v6, s[8:11], s54 offen offset:2048 lds
    s_add_u32 m0, s52, 15360
    s_mov_b32 s54, 454656
    buffer_load_dwordx4 v4, s[8:11], s54 offen offset:0 lds
    buffer_load_dwordx4 v5, s[8:11], s54 offen offset:1024 lds
    buffer_load_dwordx4 v6, s[8:11], s54 offen offset:2048 lds
    s_waitcnt vmcnt(18)
    v_lshlrev_b32 v216, 16, v16
    v_and_b32 v217, s51, v16
    v_lshlrev_b32 v218, 16, v17
    v_and_b32 v219, s51, v17
    v_xor_b32 v228, s59, v216
    v_xor_b32 v229, s59, v217
    v_xor_b32 v230, s59, v218
    v_xor_b32 v231, s59, v219
    v_lshlrev_b32 v220, 16, v18
    v_and_b32 v221, s51, v18
    v_lshlrev_b32 v222, 16, v19
    v_and_b32 v223, s51, v19
    v_xor_b32 v232, s59, v220
    v_xor_b32 v233, s59, v221
    v_xor_b32 v234, s59, v222
    v_xor_b32 v235, s59, v223
    v_lshlrev_b32 v224, 16, v20
    v_and_b32 v225, s51, v20
    v_lshlrev_b32 v226, 16, v21
    v_and_b32 v227, s51, v21
    v_xor_b32 v236, s59, v224
    v_xor_b32 v237, s59, v225
    v_xor_b32 v238, s59, v226
    v_xor_b32 v239, s59, v227
    s_waitcnt vmcnt(15)
    ds_read_b64_tr_b16 v[24:25], v3 offset:0
    ds_read_b64_tr_b16 v[26:27], v3 offset:1536
    ds_read_b64_tr_b16 v[28:29], v3 offset:32
    ds_read_b64_tr_b16 v[30:31], v3 offset:1568
    ds_read_b64_tr_b16 v[32:33], v3 offset:64
    ds_read_b64_tr_b16 v[34:35], v3 offset:1600
    s_waitcnt vmcnt(12)
    ds_read_b64_tr_b16 v[36:37], v3 offset:3072
    ds_read_b64_tr_b16 v[38:39], v3 offset:4608
    ds_read_b64_tr_b16 v[40:41], v3 offset:3104
    ds_read_b64_tr_b16 v[42:43], v3 offset:4640
    ds_read_b64_tr_b16 v[44:45], v3 offset:3136
    ds_read_b64_tr_b16 v[46:47], v3 offset:4672
    s_waitcnt vmcnt(9)
    ds_read_b64_tr_b16 v[48:49], v3 offset:6144
    ds_read_b64_tr_b16 v[50:51], v3 offset:7680
    ds_read_b64_tr_b16 v[52:53], v3 offset:6176
    ds_read_b64_tr_b16 v[54:55], v3 offset:7712
    ds_read_b64_tr_b16 v[56:57], v3 offset:6208
    ds_read_b64_tr_b16 v[58:59], v3 offset:7744
    s_lshl_b32 s47, s36, 2
    s_add_u32 s47, s47, 67584
    v_mov_b32 v255, s47
    v_mov_b32 v252, 1
    ds_read_b32 v0, v2 offset:35264
    s_waitcnt lgkmcnt(0)
    v_readfirstlane_b32 s47, v0
    s_cmp_eq_u32 s47, 4
    s_cbranch_scc0 L_CKnrdy0_spin
L_CKnrdy0:
    ds_read_b128 v[8:11], v1 offset:0
    ds_read_b128 v[12:15], v1 offset:1024
    ds_read_b128 v[16:19], v1 offset:2048
    ds_read_b128 v[20:23], v1 offset:3072
    s_waitcnt lgkmcnt(3)
    v_mfma_f32_16x16x32_bf16 v[96:99], v[24:27], v[8:11], v[216:219]
    s_add_u32 m0, s52, 0
    s_mov_b32 s54, 147456
    v_mfma_f32_16x16x32_bf16 v[100:103], v[28:31], v[8:11], v[220:223]
    buffer_load_dwordx4 v4, s[8:11], s54 offen offset:0 lds
    v_mfma_f32_16x16x32_bf16 v[104:107], v[32:35], v[8:11], v[224:227]
    ds_read_b128 v[8:11], v1 offset:4096
    s_waitcnt lgkmcnt(3)
    v_mfma_f32_16x16x32_bf16 v[96:99], v[36:39], v[12:15], v[96:99]
    v_mfma_f32_16x16x32_bf16 v[100:103], v[40:43], v[12:15], v[100:103]
    s_waitcnt vmcnt(7)
    ds_read_b64_tr_b16 v[60:61], v3 offset:9216
    v_mfma_f32_16x16x32_bf16 v[104:107], v[44:47], v[12:15], v[104:107]
    buffer_load_dwordx4 v5, s[8:11], s54 offen offset:1024 lds
    ds_read_b64_tr_b16 v[62:63], v3 offset:10752
    v_mfma_f32_16x16x32_bf16 v[120:123], v[24:27], v[12:15], v[216:219]
    ds_read_b64_tr_b16 v[64:65], v3 offset:9248
    v_mfma_f32_16x16x32_bf16 v[124:127], v[28:31], v[12:15], v[220:223]
    ds_read_b64_tr_b16 v[66:67], v3 offset:10784
    v_mfma_f32_16x16x32_bf16 v[128:131], v[32:35], v[12:15], v[224:227]
    ds_read_b128 v[12:15], v1 offset:5120
    s_waitcnt lgkmcnt(7)
    v_mfma_f32_16x16x32_bf16 v[96:99], v[48:51], v[16:19], v[96:99]
    ds_read_b64_tr_b16 v[68:69], v3 offset:9280
    v_mfma_f32_16x16x32_bf16 v[100:103], v[52:55], v[16:19], v[100:103]
    buffer_load_dwordx4 v6, s[8:11], s54 offen offset:2048 lds
    ds_read_b64_tr_b16 v[70:71], v3 offset:10816
    v_mfma_f32_16x16x32_bf16 v[104:107], v[56:59], v[16:19], v[104:107]
    v_mfma_f32_16x16x32_bf16 v[120:123], v[36:39], v[16:19], v[120:123]
    s_waitcnt vmcnt(6)
    ds_read_b64_tr_b16 v[72:73], v3 offset:12288
    v_mfma_f32_16x16x32_bf16 v[124:127], v[40:43], v[16:19], v[124:127]
    s_add_u32 m0, s52, 3072
    s_mov_b32 s54, 368640
    v_mfma_f32_16x16x32_bf16 v[128:131], v[44:47], v[16:19], v[128:131]
    buffer_load_dwordx4 v4, s[8:11], s54 offen offset:0 lds
    ds_read_b64_tr_b16 v[74:75], v3 offset:13824
    v_mfma_f32_16x16x32_bf16 v[144:147], v[24:27], v[16:19], v[216:219]
    ds_read_b64_tr_b16 v[76:77], v3 offset:12320
    v_mfma_f32_16x16x32_bf16 v[148:151], v[28:31], v[16:19], v[220:223]
    ds_read_b64_tr_b16 v[78:79], v3 offset:13856
    v_mfma_f32_16x16x32_bf16 v[152:155], v[32:35], v[16:19], v[224:227]
    ds_read_b128 v[16:19], v1 offset:6144
    s_waitcnt lgkmcnt(13)
    v_mfma_f32_16x16x32_bf16 v[120:123], v[48:51], v[20:23], v[120:123]
    ds_read_b64_tr_b16 v[80:81], v3 offset:12352
    v_mfma_f32_16x16x32_bf16 v[124:127], v[52:55], v[20:23], v[124:127]
    buffer_load_dwordx4 v5, s[8:11], s54 offen offset:1024 lds
    ds_read_b64_tr_b16 v[82:83], v3 offset:13888
    v_mfma_f32_16x16x32_bf16 v[128:131], v[56:59], v[20:23], v[128:131]
    s_waitcnt vmcnt(5)
    ds_read_b64_tr_b16 v[84:85], v3 offset:15360
    v_mfma_f32_16x16x32_bf16 v[144:147], v[36:39], v[20:23], v[144:147]
    ds_read_b64_tr_b16 v[86:87], v3 offset:16896
    v_mfma_f32_16x16x32_bf16 v[148:151], v[40:43], v[20:23], v[148:151]
    ds_read_b64_tr_b16 v[88:89], v3 offset:15392
    v_mfma_f32_16x16x32_bf16 v[152:155], v[44:47], v[20:23], v[152:155]
    buffer_load_dwordx4 v6, s[8:11], s54 offen offset:2048 lds
    ds_read_b64_tr_b16 v[90:91], v3 offset:16928
    v_mfma_f32_16x16x32_bf16 v[168:171], v[24:27], v[20:23], v[216:219]
    ds_read_b64_tr_b16 v[92:93], v3 offset:15424
    v_mfma_f32_16x16x32_bf16 v[172:175], v[28:31], v[20:23], v[220:223]
    ds_read_b64_tr_b16 v[94:95], v3 offset:16960
    v_mfma_f32_16x16x32_bf16 v[176:179], v[32:35], v[20:23], v[224:227]
    ds_read_b128 v[20:23], v1 offset:7168
    s_waitcnt lgkmcnt(15)
    v_mfma_f32_16x16x32_bf16 v[144:147], v[48:51], v[8:11], v[144:147]
    s_add_u32 m0, s52, 6144
    s_mov_b32 s54, 589824
    v_mfma_f32_16x16x32_bf16 v[148:151], v[52:55], v[8:11], v[148:151]
    buffer_load_dwordx4 v4, s[8:11], s54 offen offset:0 lds
    v_mfma_f32_16x16x32_bf16 v[152:155], v[56:59], v[8:11], v[152:155]
    v_mfma_f32_16x16x32_bf16 v[168:171], v[36:39], v[8:11], v[168:171]
    v_mfma_f32_16x16x32_bf16 v[172:175], v[40:43], v[8:11], v[172:175]
    v_mfma_f32_16x16x32_bf16 v[176:179], v[44:47], v[8:11], v[176:179]
    buffer_load_dwordx4 v5, s[8:11], s54 offen offset:1024 lds
    v_mfma_f32_16x16x32_bf16 v[192:195], v[24:27], v[8:11], v[216:219]
    v_mfma_f32_16x16x32_bf16 v[196:199], v[28:31], v[8:11], v[220:223]
    v_mfma_f32_16x16x32_bf16 v[200:203], v[32:35], v[8:11], v[224:227]
    ds_read_b128 v[8:11], v1 offset:11264
    v_mfma_f32_16x16x32_bf16 v[168:171], v[48:51], v[12:15], v[168:171]
    v_mfma_f32_16x16x32_bf16 v[172:175], v[52:55], v[12:15], v[172:175]
    buffer_load_dwordx4 v6, s[8:11], s54 offen offset:2048 lds
    v_mfma_f32_16x16x32_bf16 v[176:179], v[56:59], v[12:15], v[176:179]
    v_mfma_f32_16x16x32_bf16 v[192:195], v[36:39], v[12:15], v[192:195]
    v_mfma_f32_16x16x32_bf16 v[196:199], v[40:43], v[12:15], v[196:199]
    s_add_u32 m0, s52, 9216
    s_mov_b32 s54, 159744
    v_mfma_f32_16x16x32_bf16 v[200:203], v[44:47], v[12:15], v[200:203]
    s_waitcnt lgkmcnt(15)
    buffer_load_dwordx4 v4, s[8:11], s54 offen offset:0 lds
    v_mfma_f32_16x16x32_bf16 v[216:219], v[24:27], v[12:15], v[216:219]
    v_mfma_f32_16x16x32_bf16 v[220:223], v[28:31], v[12:15], v[220:223]
    v_mfma_f32_16x16x32_bf16 v[224:227], v[32:35], v[12:15], v[224:227]
    ds_read_b128 v[12:15], v1 offset:12288
    s_waitcnt lgkmcnt(11)
    v_mfma_f32_16x16x32_bf16 v[192:195], v[48:51], v[16:19], v[192:195]
    v_mfma_f32_16x16x32_bf16 v[196:199], v[52:55], v[16:19], v[196:199]
    buffer_load_dwordx4 v5, s[8:11], s54 offen offset:1024 lds
    v_mfma_f32_16x16x32_bf16 v[200:203], v[56:59], v[16:19], v[200:203]
    v_mfma_f32_16x16x32_bf16 v[216:219], v[36:39], v[16:19], v[216:219]
    v_mfma_f32_16x16x32_bf16 v[220:223], v[40:43], v[16:19], v[220:223]
    v_mfma_f32_16x16x32_bf16 v[224:227], v[44:47], v[16:19], v[224:227]
    ds_read_b128 v[16:19], v1 offset:13312
    s_waitcnt lgkmcnt(3)
    v_mfma_f32_16x16x32_bf16 v[216:219], v[48:51], v[20:23], v[216:219]
    buffer_load_dwordx4 v6, s[8:11], s54 offen offset:2048 lds
    v_mfma_f32_16x16x32_bf16 v[220:223], v[52:55], v[20:23], v[220:223]
    v_mfma_f32_16x16x32_bf16 v[224:227], v[56:59], v[20:23], v[224:227]
    ds_read_b128 v[20:23], v1 offset:14336
    s_waitcnt lgkmcnt(3)
    v_mfma_f32_16x16x32_bf16 v[96:99], v[60:63], v[8:11], v[96:99]
    s_add_u32 m0, s52, 12288
    s_mov_b32 s54, 380928
    v_mfma_f32_16x16x32_bf16 v[100:103], v[64:67], v[8:11], v[100:103]
    buffer_load_dwordx4 v4, s[8:11], s54 offen offset:0 lds
    v_mfma_f32_16x16x32_bf16 v[104:107], v[68:71], v[8:11], v[104:107]
    ds_read_b128 v[8:11], v1 offset:15360
    s_waitcnt lgkmcnt(3)
    v_mfma_f32_16x16x32_bf16 v[96:99], v[72:75], v[12:15], v[96:99]
    v_mfma_f32_16x16x32_bf16 v[100:103], v[76:79], v[12:15], v[100:103]
    v_mfma_f32_16x16x32_bf16 v[104:107], v[80:83], v[12:15], v[104:107]
    buffer_load_dwordx4 v5, s[8:11], s54 offen offset:1024 lds
    v_mfma_f32_16x16x32_bf16 v[120:123], v[60:63], v[12:15], v[120:123]
    v_mfma_f32_16x16x32_bf16 v[124:127], v[64:67], v[12:15], v[124:127]
    v_mfma_f32_16x16x32_bf16 v[128:131], v[68:71], v[12:15], v[128:131]
    ds_read_b128 v[12:15], v1 offset:16384
    s_waitcnt lgkmcnt(3)
    v_mfma_f32_16x16x32_bf16 v[96:99], v[84:87], v[16:19], v[96:99]
    v_mfma_f32_16x16x32_bf16 v[100:103], v[88:91], v[16:19], v[100:103]
    buffer_load_dwordx4 v6, s[8:11], s54 offen offset:2048 lds
    v_mfma_f32_16x16x32_bf16 v[104:107], v[92:95], v[16:19], v[104:107]
    v_mfma_f32_16x16x32_bf16 v[120:123], v[72:75], v[16:19], v[120:123]
    v_mfma_f32_16x16x32_bf16 v[124:127], v[76:79], v[16:19], v[124:127]
    s_add_u32 m0, s52, 15360
    s_mov_b32 s54, 602112
    v_mfma_f32_16x16x32_bf16 v[128:131], v[80:83], v[16:19], v[128:131]
    buffer_load_dwordx4 v4, s[8:11], s54 offen offset:0 lds
    v_mfma_f32_16x16x32_bf16 v[144:147], v[60:63], v[16:19], v[144:147]
    v_mfma_f32_16x16x32_bf16 v[148:151], v[64:67], v[16:19], v[148:151]
    v_mfma_f32_16x16x32_bf16 v[152:155], v[68:71], v[16:19], v[152:155]
    ds_read_b128 v[16:19], v1 offset:17408
    s_waitcnt lgkmcnt(3)
    v_mfma_f32_16x16x32_bf16 v[120:123], v[84:87], v[20:23], v[120:123]
    v_mfma_f32_16x16x32_bf16 v[124:127], v[88:91], v[20:23], v[124:127]
    buffer_load_dwordx4 v5, s[8:11], s54 offen offset:1024 lds
    v_mfma_f32_16x16x32_bf16 v[128:131], v[92:95], v[20:23], v[128:131]
    v_mfma_f32_16x16x32_bf16 v[144:147], v[72:75], v[20:23], v[144:147]
    v_mfma_f32_16x16x32_bf16 v[148:151], v[76:79], v[20:23], v[148:151]
    v_mfma_f32_16x16x32_bf16 v[152:155], v[80:83], v[20:23], v[152:155]
    buffer_load_dwordx4 v6, s[8:11], s54 offen offset:2048 lds
    v_mfma_f32_16x16x32_bf16 v[168:171], v[60:63], v[20:23], v[168:171]
    ds_write_b32 v255, v252 offset:496
    v_mfma_f32_16x16x32_bf16 v[172:175], v[64:67], v[20:23], v[172:175]
    v_mfma_f32_16x16x32_bf16 v[176:179], v[68:71], v[20:23], v[176:179]
    ds_read_b128 v[20:23], v1 offset:18432
    s_waitcnt lgkmcnt(4)
    v_mfma_f32_16x16x32_bf16 v[144:147], v[84:87], v[8:11], v[144:147]
    ds_read_b32 v0, v2 offset:35268
    v_mfma_f32_16x16x32_bf16 v[148:151], v[88:91], v[8:11], v[148:151]
    v_mfma_f32_16x16x32_bf16 v[152:155], v[92:95], v[8:11], v[152:155]
    v_mfma_f32_16x16x32_bf16 v[168:171], v[72:75], v[8:11], v[168:171]
    s_waitcnt vmcnt(15)
    ds_read_b64_tr_b16 v[24:25], v3 offset:0
    v_mfma_f32_16x16x32_bf16 v[172:175], v[76:79], v[8:11], v[172:175]
    ds_read_b64_tr_b16 v[26:27], v3 offset:1536
    v_mfma_f32_16x16x32_bf16 v[176:179], v[80:83], v[8:11], v[176:179]
    ds_read_b64_tr_b16 v[28:29], v3 offset:32
    v_mfma_f32_16x16x32_bf16 v[192:195], v[60:63], v[8:11], v[192:195]
    s_waitcnt lgkmcnt(3)
    v_readfirstlane_b32 s47, v0
    v_mfma_f32_16x16x32_bf16 v[196:199], v[64:67], v[8:11], v[196:199]
    s_cmp_eq_u32 s47, 4
    s_cbranch_scc0 L_CKnrdy1_spin
L_CKnrdy1:
    v_mfma_f32_16x16x32_bf16 v[200:203], v[68:71], v[8:11], v[200:203]
    ds_read_b128 v[8:11], v1 offset:22528
    v_mfma_f32_16x16x32_bf16 v[168:171], v[84:87], v[12:15], v[168:171]
    ds_read_b64_tr_b16 v[30:31], v3 offset:1568
    v_mfma_f32_16x16x32_bf16 v[172:175], v[88:91], v[12:15], v[172:175]
    ds_read_b64_tr_b16 v[32:33], v3 offset:64
    v_mfma_f32_16x16x32_bf16 v[176:179], v[92:95], v[12:15], v[176:179]
    ds_read_b64_tr_b16 v[34:35], v3 offset:1600
    v_mfma_f32_16x16x32_bf16 v[192:195], v[72:75], v[12:15], v[192:195]
    s_waitcnt vmcnt(12)
    ds_read_b64_tr_b16 v[36:37], v3 offset:3072
    v_mfma_f32_16x16x32_bf16 v[196:199], v[76:79], v[12:15], v[196:199]
    ds_read_b64_tr_b16 v[38:39], v3 offset:4608
    v_mfma_f32_16x16x32_bf16 v[200:203], v[80:83], v[12:15], v[200:203]
    ds_read_b64_tr_b16 v[40:41], v3 offset:3104
    v_mfma_f32_16x16x32_bf16 v[216:219], v[60:63], v[12:15], v[216:219]
    ds_read_b64_tr_b16 v[42:43], v3 offset:4640
    v_mfma_f32_16x16x32_bf16 v[220:223], v[64:67], v[12:15], v[220:223]
    ds_read_b64_tr_b16 v[44:45], v3 offset:3136
    v_mfma_f32_16x16x32_bf16 v[224:227], v[68:71], v[12:15], v[224:227]
    ds_read_b128 v[12:15], v1 offset:23552
    v_mfma_f32_16x16x32_bf16 v[192:195], v[84:87], v[16:19], v[192:195]
    ds_read_b64_tr_b16 v[46:47], v3 offset:4672
    v_mfma_f32_16x16x32_bf16 v[196:199], v[88:91], v[16:19], v[196:199]
    s_waitcnt vmcnt(9)
    ds_read_b64_tr_b16 v[48:49], v3 offset:6144
    v_mfma_f32_16x16x32_bf16 v[200:203], v[92:95], v[16:19], v[200:203]
    ds_read_b64_tr_b16 v[50:51], v3 offset:7680
    v_mfma_f32_16x16x32_bf16 v[216:219], v[72:75], v[16:19], v[216:219]
    ds_read_b64_tr_b16 v[52:53], v3 offset:6176
    v_mfma_f32_16x16x32_bf16 v[220:223], v[76:79], v[16:19], v[220:223]
    ds_read_b64_tr_b16 v[54:55], v3 offset:7712
    v_mfma_f32_16x16x32_bf16 v[224:227], v[80:83], v[16:19], v[224:227]
    ds_read_b128 v[16:19], v1 offset:24576
    v_mfma_f32_16x16x32_bf16 v[216:219], v[84:87], v[20:23], v[216:219]
    ds_write_b32 v255, v252 offset:256
    v_mfma_f32_16x16x32_bf16 v[220:223], v[88:91], v[20:23], v[220:223]
    ds_read_b64_tr_b16 v[56:57], v3 offset:6208
    v_mfma_f32_16x16x32_bf16 v[224:227], v[92:95], v[20:23], v[224:227]
    ds_read_b128 v[20:23], v1 offset:25600
    s_waitcnt lgkmcnt(15)
    v_mfma_f32_16x16x32_bf16 v[108:111], v[24:27], v[8:11], v[228:231]
    ds_read_b64_tr_b16 v[58:59], v3 offset:7744
    v_mfma_f32_16x16x32_bf16 v[112:115], v[28:31], v[8:11], v[232:235]
    v_mfma_f32_16x16x32_bf16 v[116:119], v[32:35], v[8:11], v[236:239]
    ds_read_b128 v[8:11], v1 offset:26624
    s_waitcnt lgkmcnt(10)
    v_mfma_f32_16x16x32_bf16 v[108:111], v[36:39], v[12:15], v[108:111]
    v_mfma_f32_16x16x32_bf16 v[112:115], v[40:43], v[12:15], v[112:115]
    v_mfma_f32_16x16x32_bf16 v[116:119], v[44:47], v[12:15], v[116:119]
    v_mfma_f32_16x16x32_bf16 v[132:135], v[24:27], v[12:15], v[228:231]
    v_mfma_f32_16x16x32_bf16 v[136:139], v[28:31], v[12:15], v[232:235]
    v_mfma_f32_16x16x32_bf16 v[140:143], v[32:35], v[12:15], v[236:239]
    ds_read_b128 v[12:15], v1 offset:27648
    s_waitcnt lgkmcnt(2)
    v_mfma_f32_16x16x32_bf16 v[108:111], v[48:51], v[16:19], v[108:111]
    v_mfma_f32_16x16x32_bf16 v[112:115], v[52:55], v[16:19], v[112:115]
    v_mfma_f32_16x16x32_bf16 v[116:119], v[56:59], v[16:19], v[116:119]
    v_mfma_f32_16x16x32_bf16 v[132:135], v[36:39], v[16:19], v[132:135]
    v_mfma_f32_16x16x32_bf16 v[136:139], v[40:43], v[16:19], v[136:139]
    v_mfma_f32_16x16x32_bf16 v[140:143], v[44:47], v[16:19], v[140:143]
    v_mfma_f32_16x16x32_bf16 v[156:159], v[24:27], v[16:19], v[228:231]
    v_mfma_f32_16x16x32_bf16 v[160:163], v[28:31], v[16:19], v[232:235]
    v_mfma_f32_16x16x32_bf16 v[164:167], v[32:35], v[16:19], v[236:239]
    ds_read_b128 v[16:19], v1 offset:28672
    v_mfma_f32_16x16x32_bf16 v[132:135], v[48:51], v[20:23], v[132:135]
    v_mfma_f32_16x16x32_bf16 v[136:139], v[52:55], v[20:23], v[136:139]
    v_mfma_f32_16x16x32_bf16 v[140:143], v[56:59], v[20:23], v[140:143]
    v_mfma_f32_16x16x32_bf16 v[156:159], v[36:39], v[20:23], v[156:159]
    v_mfma_f32_16x16x32_bf16 v[160:163], v[40:43], v[20:23], v[160:163]
    v_mfma_f32_16x16x32_bf16 v[164:167], v[44:47], v[20:23], v[164:167]
    v_mfma_f32_16x16x32_bf16 v[180:183], v[24:27], v[20:23], v[228:231]
    v_mfma_f32_16x16x32_bf16 v[184:187], v[28:31], v[20:23], v[232:235]
    v_mfma_f32_16x16x32_bf16 v[188:191], v[32:35], v[20:23], v[236:239]
    ds_read_b128 v[20:23], v1 offset:29696
    s_waitcnt lgkmcnt(3)
    v_mfma_f32_16x16x32_bf16 v[156:159], v[48:51], v[8:11], v[156:159]
    v_mfma_f32_16x16x32_bf16 v[160:163], v[52:55], v[8:11], v[160:163]
    v_mfma_f32_16x16x32_bf16 v[164:167], v[56:59], v[8:11], v[164:167]
    v_mfma_f32_16x16x32_bf16 v[180:183], v[36:39], v[8:11], v[180:183]
    s_waitcnt vmcnt(6)
    ds_read_b64_tr_b16 v[60:61], v3 offset:9216
    v_mfma_f32_16x16x32_bf16 v[184:187], v[40:43], v[8:11], v[184:187]
    ds_read_b64_tr_b16 v[62:63], v3 offset:10752
    v_mfma_f32_16x16x32_bf16 v[188:191], v[44:47], v[8:11], v[188:191]
    ds_read_b64_tr_b16 v[64:65], v3 offset:9248
    v_mfma_f32_16x16x32_bf16 v[204:207], v[24:27], v[8:11], v[228:231]
    ds_read_b64_tr_b16 v[66:67], v3 offset:10784
    v_mfma_f32_16x16x32_bf16 v[208:211], v[28:31], v[8:11], v[232:235]
    ds_read_b64_tr_b16 v[68:69], v3 offset:9280
    v_mfma_f32_16x16x32_bf16 v[212:215], v[32:35], v[8:11], v[236:239]
    ds_read_b128 v[8:11], v2 offset:1024
    s_waitcnt lgkmcnt(8)
    v_mfma_f32_16x16x32_bf16 v[180:183], v[48:51], v[12:15], v[180:183]
    ds_read_b64_tr_b16 v[70:71], v3 offset:10816
    v_mfma_f32_16x16x32_bf16 v[184:187], v[52:55], v[12:15], v[184:187]
    s_waitcnt vmcnt(3)
    ds_read_b64_tr_b16 v[72:73], v3 offset:12288
    v_mfma_f32_16x16x32_bf16 v[188:191], v[56:59], v[12:15], v[188:191]
    ds_read_b64_tr_b16 v[74:75], v3 offset:13824
    v_mfma_f32_16x16x32_bf16 v[204:207], v[36:39], v[12:15], v[204:207]
    ds_read_b64_tr_b16 v[76:77], v3 offset:12320
    v_mfma_f32_16x16x32_bf16 v[208:211], v[40:43], v[12:15], v[208:211]
    ds_read_b64_tr_b16 v[78:79], v3 offset:13856
    v_mfma_f32_16x16x32_bf16 v[212:215], v[44:47], v[12:15], v[212:215]
    ds_read_b64_tr_b16 v[80:81], v3 offset:12352
    v_mfma_f32_16x16x32_bf16 v[228:231], v[24:27], v[12:15], v[228:231]
    ds_read_b64_tr_b16 v[82:83], v3 offset:13888
    v_mfma_f32_16x16x32_bf16 v[232:235], v[28:31], v[12:15], v[232:235]
    s_waitcnt vmcnt(0)
    ds_read_b64_tr_b16 v[84:85], v3 offset:15360
    v_mfma_f32_16x16x32_bf16 v[236:239], v[32:35], v[12:15], v[236:239]
    ds_read_b128 v[12:15], v2 offset:2048
    s_waitcnt lgkmcnt(15)
    v_mfma_f32_16x16x32_bf16 v[204:207], v[48:51], v[16:19], v[204:207]
    ds_read_b64_tr_b16 v[86:87], v3 offset:16896
    v_mfma_f32_16x16x32_bf16 v[208:211], v[52:55], v[16:19], v[208:211]
    ds_read_b64_tr_b16 v[88:89], v3 offset:15392
    v_mfma_f32_16x16x32_bf16 v[212:215], v[56:59], v[16:19], v[212:215]
    ds_read_b64_tr_b16 v[90:91], v3 offset:16928
    v_mfma_f32_16x16x32_bf16 v[228:231], v[36:39], v[16:19], v[228:231]
    ds_read_b64_tr_b16 v[92:93], v3 offset:15424
    v_mfma_f32_16x16x32_bf16 v[232:235], v[40:43], v[16:19], v[232:235]
    ds_read_b64_tr_b16 v[94:95], v3 offset:16960
    v_mfma_f32_16x16x32_bf16 v[236:239], v[44:47], v[16:19], v[236:239]
    ds_read_b128 v[16:19], v2 offset:3072
    v_readfirstlane_b32 s47, v0
    v_mfma_f32_16x16x32_bf16 v[228:231], v[48:51], v[20:23], v[228:231]
    ds_read_b32 v0, v2 offset:35056
    s_cmp_eq_u32 s47, 1
    s_cbranch_scc0 L_CKnuflag_spin
L_CKnuflag:
    v_mfma_f32_16x16x32_bf16 v[232:235], v[52:55], v[20:23], v[232:235]
    s_mov_b32 s53, 0
    v_mfma_f32_16x16x32_bf16 v[236:239], v[56:59], v[20:23], v[236:239]
    ds_read_b128 v[20:23], v2 offset:4096
    s_waitcnt lgkmcnt(15)
    v_mfma_f32_16x16x32_bf16 v[108:111], v[60:63], v[8:11], v[108:111]
    buffer_load_dwordx4 v[24:27], v7, s[16:19], s53 offen offset:0 sc1
    v_mfma_f32_16x16x32_bf16 v[112:115], v[64:67], v[8:11], v[112:115]
    v_mfma_f32_16x16x32_bf16 v[116:119], v[68:71], v[8:11], v[116:119]
    ds_read_b128 v[8:11], v2 offset:5120
    s_waitcnt lgkmcnt(9)
    v_mfma_f32_16x16x32_bf16 v[108:111], v[72:75], v[12:15], v[108:111]
    v_mfma_f32_16x16x32_bf16 v[112:115], v[76:79], v[12:15], v[112:115]
    buffer_load_dwordx4 v[28:31], v253, s[16:19], s53 offen offset:0 sc1
    v_mfma_f32_16x16x32_bf16 v[116:119], v[80:83], v[12:15], v[116:119]
    v_mfma_f32_16x16x32_bf16 v[132:135], v[60:63], v[12:15], v[132:135]
    v_mfma_f32_16x16x32_bf16 v[136:139], v[64:67], v[12:15], v[136:139]
    v_mfma_f32_16x16x32_bf16 v[140:143], v[68:71], v[12:15], v[140:143]
    ds_read_b128 v[12:15], v2 offset:6144
    s_waitcnt lgkmcnt(4)
    v_mfma_f32_16x16x32_bf16 v[108:111], v[84:87], v[16:19], v[108:111]
    buffer_load_dwordx4 v[32:35], v254, s[16:19], s53 offen offset:0 sc1
    v_mfma_f32_16x16x32_bf16 v[112:115], v[88:91], v[16:19], v[112:115]
    v_mfma_f32_16x16x32_bf16 v[116:119], v[92:95], v[16:19], v[116:119]
    v_mfma_f32_16x16x32_bf16 v[132:135], v[72:75], v[16:19], v[132:135]
    v_mfma_f32_16x16x32_bf16 v[136:139], v[76:79], v[16:19], v[136:139]
    v_mfma_f32_16x16x32_bf16 v[140:143], v[80:83], v[16:19], v[140:143]
    buffer_load_dwordx4 v[36:39], v7, s[16:19], s53 offen offset:1024 sc1
    v_mfma_f32_16x16x32_bf16 v[156:159], v[60:63], v[16:19], v[156:159]
    v_mfma_f32_16x16x32_bf16 v[160:163], v[64:67], v[16:19], v[160:163]
    v_mfma_f32_16x16x32_bf16 v[164:167], v[68:71], v[16:19], v[164:167]
    ds_read_b128 v[16:19], v2 offset:7168
    s_waitcnt lgkmcnt(3)
    v_mfma_f32_16x16x32_bf16 v[132:135], v[84:87], v[20:23], v[132:135]
    v_sub_f32_e64 v248, v96, v108 div:2
    v_sub_f32_e64 v249, v97, v109 div:2
    v_mfma_f32_16x16x32_bf16 v[136:139], v[88:91], v[20:23], v[136:139]
    buffer_load_dwordx4 v[40:43], v253, s[16:19], s53 offen offset:1024 sc1
    v_sub_f32_e64 v250, v98, v110 div:2
    v_mfma_f32_16x16x32_bf16 v[140:143], v[92:95], v[20:23], v[140:143]
    v_sub_f32_e64 v251, v99, v111 div:2
    v_add_f32_e64 v108, v96, v108 div:2
    v_mfma_f32_16x16x32_bf16 v[156:159], v[72:75], v[20:23], v[156:159]
    v_add_f32_e64 v109, v97, v109 div:2
    v_add_f32_e64 v110, v98, v110 div:2
    v_mfma_f32_16x16x32_bf16 v[160:163], v[76:79], v[20:23], v[160:163]
    v_add_f32_e64 v111, v99, v111 div:2
    v_sub_f32_e64 v96, v100, v112 div:2
    v_mfma_f32_16x16x32_bf16 v[164:167], v[80:83], v[20:23], v[164:167]
    v_sub_f32_e64 v97, v101, v113 div:2
    v_sub_f32_e64 v98, v102, v114 div:2
    v_mfma_f32_16x16x32_bf16 v[180:183], v[60:63], v[20:23], v[180:183]
    buffer_load_dwordx4 v[44:47], v254, s[16:19], s53 offen offset:1024 sc1
    v_sub_f32_e64 v99, v103, v115 div:2
    v_mfma_f32_16x16x32_bf16 v[184:187], v[64:67], v[20:23], v[184:187]
    v_add_f32_e64 v112, v100, v112 div:2
    v_add_f32_e64 v113, v101, v113 div:2
    v_mfma_f32_16x16x32_bf16 v[188:191], v[68:71], v[20:23], v[188:191]
    ds_read_b128 v[20:23], v2 offset:8192
    s_waitcnt lgkmcnt(3)
    v_mfma_f32_16x16x32_bf16 v[156:159], v[84:87], v[8:11], v[156:159]
    ds_read_b32 v0, v2 offset:35272
    v_add_f32_e64 v114, v102, v114 div:2
    v_mfma_f32_16x16x32_bf16 v[160:163], v[88:91], v[8:11], v[160:163]
    v_add_f32_e64 v115, v103, v115 div:2
    v_sub_f32_e64 v100, v104, v116 div:2
    v_mfma_f32_16x16x32_bf16 v[164:167], v[92:95], v[8:11], v[164:167]
    buffer_load_dwordx4 v[48:51], v7, s[16:19], s53 offen offset:2048 sc1
    v_sub_f32_e64 v101, v105, v117 div:2
    v_mfma_f32_16x16x32_bf16 v[180:183], v[72:75], v[8:11], v[180:183]
    v_sub_f32_e64 v102, v106, v118 div:2
    v_sub_f32_e64 v103, v107, v119 div:2
    v_mfma_f32_16x16x32_bf16 v[184:187], v[76:79], v[8:11], v[184:187]
    v_add_f32_e64 v116, v104, v116 div:2
    v_add_f32_e64 v117, v105, v117 div:2
    v_mfma_f32_16x16x32_bf16 v[188:191], v[80:83], v[8:11], v[188:191]
    v_add_f32_e64 v118, v106, v118 div:2
    v_add_f32_e64 v119, v107, v119 div:2
    v_sub_f32_e64 v104, v120, v132 div:2
    v_sub_f32_e64 v105, v121, v133 div:2
    v_mfma_f32_16x16x32_bf16 v[204:207], v[60:63], v[8:11], v[204:207]
    s_waitcnt lgkmcnt(0)
    v_readfirstlane_b32 s47, v0
    v_mfma_f32_16x16x32_bf16 v[208:211], v[64:67], v[8:11], v[208:211]
    s_cmp_eq_u32 s47, 4
    s_cbranch_scc0 L_CKnrdy2_spin
L_CKnrdy2:
    v_mfma_f32_16x16x32_bf16 v[212:215], v[68:71], v[8:11], v[212:215]
    ds_read_b128 v[8:11], v2 offset:12288
    v_mfma_f32_16x16x32_bf16 v[180:183], v[84:87], v[12:15], v[180:183]
    buffer_load_dwordx4 v[52:55], v253, s[16:19], s53 offen offset:2048 sc1
    v_sub_f32_e64 v106, v122, v134 div:2
    v_mfma_f32_16x16x32_bf16 v[184:187], v[88:91], v[12:15], v[184:187]
    v_sub_f32_e64 v107, v123, v135 div:2
    v_add_f32_e64 v132, v120, v132 div:2
    v_mfma_f32_16x16x32_bf16 v[188:191], v[92:95], v[12:15], v[188:191]
    v_add_f32_e64 v133, v121, v133 div:2
    v_add_f32_e64 v134, v122, v134 div:2
    v_mfma_f32_16x16x32_bf16 v[204:207], v[72:75], v[12:15], v[204:207]
    buffer_load_dwordx4 v[56:59], v254, s[16:19], s53 offen offset:2048 sc1
    v_add_f32_e64 v135, v123, v135 div:2
    v_sub_f32_e64 v120, v124, v136 div:2
    v_sub_f32_e64 v121, v125, v137 div:2
    v_mfma_f32_16x16x32_bf16 v[208:211], v[76:79], v[12:15], v[208:211]
    s_mov_b32 s53, 36864
    v_sub_f32_e64 v122, v126, v138 div:2
    v_mfma_f32_16x16x32_bf16 v[212:215], v[80:83], v[12:15], v[212:215]
    v_sub_f32_e64 v123, v127, v139 div:2
    v_add_f32_e64 v136, v124, v136 div:2
    v_mfma_f32_16x16x32_bf16 v[228:231], v[60:63], v[12:15], v[228:231]
    buffer_load_dwordx4 v[60:63], v7, s[16:19], s53 offen offset:0 sc1
    v_add_f32_e64 v137, v125, v137 div:2
    v_mfma_f32_16x16x32_bf16 v[232:235], v[64:67], v[12:15], v[232:235]
    v_add_f32_e64 v138, v126, v138 div:2
    v_add_f32_e64 v139, v127, v139 div:2
    v_sub_f32_e64 v124, v128, v140 div:2
    v_sub_f32_e64 v125, v129, v141 div:2
    v_sub_f32_e64 v126, v130, v142 div:2
    v_mfma_f32_16x16x32_bf16 v[236:239], v[68:71], v[12:15], v[236:239]
    ds_read_b128 v[12:15], v2 offset:13312
    v_sub_f32_e64 v127, v131, v143 div:2
    v_mfma_f32_16x16x32_bf16 v[204:207], v[84:87], v[16:19], v[204:207]
    buffer_load_dwordx4 v[64:67], v253, s[16:19], s53 offen offset:0 sc1
    v_add_f32_e64 v140, v128, v140 div:2
    v_mfma_f32_16x16x32_bf16 v[208:211], v[88:91], v[16:19], v[208:211]
    v_add_f32_e64 v141, v129, v141 div:2
    v_add_f32_e64 v142, v130, v142 div:2
    v_mfma_f32_16x16x32_bf16 v[212:215], v[92:95], v[16:19], v[212:215]
    buffer_load_dwordx4 v[68:71], v254, s[16:19], s53 offen offset:0 sc1
    v_add_f32_e64 v143, v131, v143 div:2
    v_sub_f32_e64 v128, v144, v156 div:2
    v_sub_f32_e64 v129, v145, v157 div:2
    v_sub_f32_e64 v130, v146, v158 div:2
    v_mfma_f32_16x16x32_bf16 v[228:231], v[72:75], v[16:19], v[228:231]
    v_sub_f32_e64 v131, v147, v159 div:2
    v_add_f32_e64 v156, v144, v156 div:2
    v_add_f32_e64 v157, v145, v157 div:2
    v_mfma_f32_16x16x32_bf16 v[232:235], v[76:79], v[16:19], v[232:235]
    v_add_f32_e64 v158, v146, v158 div:2
    v_add_f32_e64 v159, v147, v159 div:2
    v_sub_f32_e64 v144, v148, v160 div:2
    v_sub_f32_e64 v145, v149, v161 div:2
    v_sub_f32_e64 v146, v150, v162 div:2
    v_mfma_f32_16x16x32_bf16 v[236:239], v[80:83], v[16:19], v[236:239]
    ds_read_b128 v[16:19], v2 offset:14336
    v_mfma_f32_16x16x32_bf16 v[228:231], v[84:87], v[20:23], v[228:231]
    ds_write_b32 v255, v252 offset:272
    buffer_load_dwordx4 v[72:75], v7, s[16:19], s53 offen offset:1024 sc1
    v_mfma_f32_16x16x32_bf16 v[232:235], v[88:91], v[20:23], v[232:235]
    v_sub_f32_e64 v147, v151, v163 div:2
    v_add_f32_e64 v160, v148, v160 div:2
    v_mfma_f32_16x16x32_bf16 v[236:239], v[92:95], v[20:23], v[236:239]
    ds_read_b128 v[20:23], v2 offset:15360
    s_waitcnt vmcnt(10) lgkmcnt(4)
    v_mfma_f32_16x16x32_bf16 v[248:251], v[24:27], v[8:11], v[248:251]
    buffer_load_dwordx4 v[76:79], v253, s[16:19], s53 offen offset:1024 sc1
    v_add_f32_e64 v161, v149, v161 div:2
    v_mfma_f32_16x16x32_bf16 v[96:99], v[28:31], v[8:11], v[96:99]
    v_add_f32_e64 v162, v150, v162 div:2
    v_add_f32_e64 v163, v151, v163 div:2
    v_sub_f32_e64 v148, v152, v164 div:2
    v_sub_f32_e64 v149, v153, v165 div:2
    v_sub_f32_e64 v150, v154, v166 div:2
    v_mfma_f32_16x16x32_bf16 v[100:103], v[32:35], v[8:11], v[100:103]
    ds_read_b128 v[8:11], v2 offset:16384
    v_sub_f32_e64 v151, v155, v167 div:2
    s_waitcnt vmcnt(8) lgkmcnt(4)
    v_mfma_f32_16x16x32_bf16 v[248:251], v[36:39], v[12:15], v[248:251]
    buffer_load_dwordx4 v[80:83], v254, s[16:19], s53 offen offset:1024 sc1
    v_add_f32_e64 v164, v152, v164 div:2
    v_mfma_f32_16x16x32_bf16 v[96:99], v[40:43], v[12:15], v[96:99]
    v_add_f32_e64 v165, v153, v165 div:2
    v_add_f32_e64 v166, v154, v166 div:2
    v_mfma_f32_16x16x32_bf16 v[100:103], v[44:47], v[12:15], v[100:103]
    buffer_load_dwordx4 v[84:87], v7, s[16:19], s53 offen offset:2048 sc1
    v_add_f32_e64 v167, v155, v167 div:2
    v_sub_f32_e64 v152, v168, v180 div:2
    v_sub_f32_e64 v153, v169, v181 div:2
    v_sub_f32_e64 v154, v170, v182 div:2
    v_mfma_f32_16x16x32_bf16 v[104:107], v[24:27], v[12:15], v[104:107]
    v_sub_f32_e64 v155, v171, v183 div:2
    v_add_f32_e64 v180, v168, v180 div:2
    v_mfma_f32_16x16x32_bf16 v[120:123], v[28:31], v[12:15], v[120:123]
    buffer_load_dwordx4 v[88:91], v253, s[16:19], s53 offen offset:2048 sc1
    v_add_f32_e64 v181, v169, v181 div:2
    v_mfma_f32_16x16x32_bf16 v[124:127], v[32:35], v[12:15], v[124:127]
    ds_read_b128 v[12:15], v2 offset:17408
    s_waitcnt vmcnt(8) lgkmcnt(4)
    v_mfma_f32_16x16x32_bf16 v[248:251], v[48:51], v[16:19], v[248:251]
    v_add_f32_e64 v182, v170, v182 div:2
    v_add_f32_e64 v183, v171, v183 div:2
    v_sub_f32_e64 v168, v172, v184 div:2
    v_mfma_f32_16x16x32_bf16 v[96:99], v[52:55], v[16:19], v[96:99]
    buffer_load_dwordx4 v[92:95], v254, s[16:19], s53 offen offset:2048 sc1
    v_sub_f32_e64 v169, v173, v185 div:2
    v_mfma_f32_16x16x32_bf16 v[100:103], v[56:59], v[16:19], v[100:103]
    v_sub_f32_e64 v170, v174, v186 div:2
    v_sub_f32_e64 v171, v175, v187 div:2
    v_mfma_f32_16x16x32_bf16 v[104:107], v[36:39], v[16:19], v[104:107]
    v_add_f32_e64 v184, v172, v184 div:2
    v_add_f32_e64 v185, v173, v185 div:2
    v_mfma_f32_16x16x32_bf16 v[120:123], v[40:43], v[16:19], v[120:123]
    v_add_f32_e64 v186, v174, v186 div:2
    v_add_f32_e64 v187, v175, v187 div:2
    v_sub_f32_e64 v172, v176, v188 div:2
    v_sub_f32_e64 v173, v177, v189 div:2
    v_mfma_f32_16x16x32_bf16 v[124:127], v[44:47], v[16:19], v[124:127]
    v_sub_f32_e64 v174, v178, v190 div:2
    v_sub_f32_e64 v175, v179, v191 div:2
    v_mfma_f32_16x16x32_bf16 v[128:131], v[24:27], v[16:19], v[128:131]
    v_add_f32_e64 v188, v176, v188 div:2
    v_add_f32_e64 v189, v177, v189 div:2
    v_mfma_f32_16x16x32_bf16 v[144:147], v[28:31], v[16:19], v[144:147]
    v_add_f32_e64 v190, v178, v190 div:2
    v_add_f32_e64 v191, v179, v191 div:2
    v_mfma_f32_16x16x32_bf16 v[148:151], v[32:35], v[16:19], v[148:151]
    ds_read_b128 v[16:19], v2 offset:18432
    s_waitcnt lgkmcnt(3)
    v_mfma_f32_16x16x32_bf16 v[104:107], v[48:51], v[20:23], v[104:107]
    v_sub_f32_e64 v176, v192, v204 div:2
    v_sub_f32_e64 v177, v193, v205 div:2
    v_mfma_f32_16x16x32_bf16 v[120:123], v[52:55], v[20:23], v[120:123]
    v_sub_f32_e64 v178, v194, v206 div:2
    v_sub_f32_e64 v179, v195, v207 div:2
    v_mfma_f32_16x16x32_bf16 v[124:127], v[56:59], v[20:23], v[124:127]
    v_add_f32_e64 v204, v192, v204 div:2
    v_add_f32_e64 v205, v193, v205 div:2
    v_mfma_f32_16x16x32_bf16 v[128:131], v[36:39], v[20:23], v[128:131]
    v_add_f32_e64 v206, v194, v206 div:2
    v_add_f32_e64 v207, v195, v207 div:2
    v_mfma_f32_16x16x32_bf16 v[144:147], v[40:43], v[20:23], v[144:147]
    v_sub_f32_e64 v192, v196, v208 div:2
    v_sub_f32_e64 v193, v197, v209 div:2
    v_mfma_f32_16x16x32_bf16 v[148:151], v[44:47], v[20:23], v[148:151]
    v_sub_f32_e64 v194, v198, v210 div:2
    v_sub_f32_e64 v195, v199, v211 div:2
    v_mfma_f32_16x16x32_bf16 v[152:155], v[24:27], v[20:23], v[152:155]
    v_add_f32_e64 v208, v196, v208 div:2
    v_add_f32_e64 v209, v197, v209 div:2
    v_mfma_f32_16x16x32_bf16 v[168:171], v[28:31], v[20:23], v[168:171]
    v_add_f32_e64 v210, v198, v210 div:2
    v_add_f32_e64 v211, v199, v211 div:2
    v_sub_f32_e64 v196, v200, v212 div:2
    v_sub_f32_e64 v197, v201, v213 div:2
    v_mfma_f32_16x16x32_bf16 v[172:175], v[32:35], v[20:23], v[172:175]
    ds_read_b128 v[20:23], v2 offset:19456
    s_waitcnt lgkmcnt(3)
    v_mfma_f32_16x16x32_bf16 v[128:131], v[48:51], v[8:11], v[128:131]
    v_sub_f32_e64 v198, v202, v214 div:2
    v_sub_f32_e64 v199, v203, v215 div:2
    v_mfma_f32_16x16x32_bf16 v[144:147], v[52:55], v[8:11], v[144:147]
    v_add_f32_e64 v212, v200, v212 div:2
    v_add_f32_e64 v213, v201, v213 div:2
    v_mfma_f32_16x16x32_bf16 v[148:151], v[56:59], v[8:11], v[148:151]
    v_add_f32_e64 v214, v202, v214 div:2
    v_add_f32_e64 v215, v203, v215 div:2
    v_mfma_f32_16x16x32_bf16 v[152:155], v[36:39], v[8:11], v[152:155]
    v_sub_f32_e64 v200, v216, v228 div:2
    v_sub_f32_e64 v201, v217, v229 div:2
    v_mfma_f32_16x16x32_bf16 v[168:171], v[40:43], v[8:11], v[168:171]
    v_sub_f32_e64 v202, v218, v230 div:2
    v_sub_f32_e64 v203, v219, v231 div:2
    v_mfma_f32_16x16x32_bf16 v[172:175], v[44:47], v[8:11], v[172:175]
    v_add_f32_e64 v228, v216, v228 div:2
    v_add_f32_e64 v229, v217, v229 div:2
    v_mfma_f32_16x16x32_bf16 v[176:179], v[24:27], v[8:11], v[176:179]
    v_add_f32_e64 v230, v218, v230 div:2
    v_add_f32_e64 v231, v219, v231 div:2
    v_sub_f32_e64 v216, v220, v232 div:2
    v_sub_f32_e64 v217, v221, v233 div:2
    v_mfma_f32_16x16x32_bf16 v[192:195], v[28:31], v[8:11], v[192:195]
    v_sub_f32_e64 v218, v222, v234 div:2
    v_sub_f32_e64 v219, v223, v235 div:2
    v_mfma_f32_16x16x32_bf16 v[196:199], v[32:35], v[8:11], v[196:199]
    ds_read_b128 v[8:11], v2 offset:23552
    s_waitcnt lgkmcnt(3)
    v_mfma_f32_16x16x32_bf16 v[152:155], v[48:51], v[12:15], v[152:155]
    v_add_f32_e64 v232, v220, v232 div:2
    v_add_f32_e64 v233, v221, v233 div:2
    v_mfma_f32_16x16x32_bf16 v[168:171], v[52:55], v[12:15], v[168:171]
    v_add_f32_e64 v234, v222, v234 div:2
    v_add_f32_e64 v235, v223, v235 div:2
    v_sub_f32_e64 v220, v224, v236 div:2
    v_mfma_f32_16x16x32_bf16 v[172:175], v[56:59], v[12:15], v[172:175]
    v_sub_f32_e64 v221, v225, v237 div:2
    v_sub_f32_e64 v222, v226, v238 div:2
    v_mfma_f32_16x16x32_bf16 v[176:179], v[36:39], v[12:15], v[176:179]
    v_sub_f32_e64 v223, v227, v239 div:2
    v_add_f32_e64 v236, v224, v236 div:2
    v_mfma_f32_16x16x32_bf16 v[192:195], v[40:43], v[12:15], v[192:195]
    s_mov_b32 s53, 221184
    v_add_f32_e64 v237, v225, v237 div:2
    v_mfma_f32_16x16x32_bf16 v[196:199], v[44:47], v[12:15], v[196:199]
    v_add_f32_e64 v238, v226, v238 div:2
    v_add_f32_e64 v239, v227, v239 div:2
    v_mfma_f32_16x16x32_bf16 v[200:203], v[24:27], v[12:15], v[200:203]
    buffer_load_dwordx4 v[24:27], v7, s[16:19], s53 offen offset:0 sc1
    v_mfma_f32_16x16x32_bf16 v[216:219], v[28:31], v[12:15], v[216:219]
    v_mfma_f32_16x16x32_bf16 v[220:223], v[32:35], v[12:15], v[220:223]
    ds_read_b128 v[12:15], v2 offset:24576
    s_waitcnt lgkmcnt(3)
    v_mfma_f32_16x16x32_bf16 v[176:179], v[48:51], v[16:19], v[176:179]
    buffer_load_dwordx4 v[28:31], v253, s[16:19], s53 offen offset:0 sc1
    v_mfma_f32_16x16x32_bf16 v[192:195], v[52:55], v[16:19], v[192:195]
    v_mfma_f32_16x16x32_bf16 v[196:199], v[56:59], v[16:19], v[196:199]
    buffer_load_dwordx4 v[32:35], v254, s[16:19], s53 offen offset:0 sc1
    v_mfma_f32_16x16x32_bf16 v[200:203], v[36:39], v[16:19], v[200:203]
    v_mfma_f32_16x16x32_bf16 v[216:219], v[40:43], v[16:19], v[216:219]
    v_mfma_f32_16x16x32_bf16 v[220:223], v[44:47], v[16:19], v[220:223]
    ds_read_b128 v[16:19], v2 offset:25600
    s_waitcnt lgkmcnt(3)
    v_mfma_f32_16x16x32_bf16 v[200:203], v[48:51], v[20:23], v[200:203]
    buffer_load_dwordx4 v[36:39], v7, s[16:19], s53 offen offset:1024 sc1
    v_mfma_f32_16x16x32_bf16 v[216:219], v[52:55], v[20:23], v[216:219]
    v_mfma_f32_16x16x32_bf16 v[220:223], v[56:59], v[20:23], v[220:223]
    ds_read_b128 v[20:23], v2 offset:26624
    s_waitcnt vmcnt(10) lgkmcnt(3)
    v_mfma_f32_16x16x32_bf16 v[248:251], v[60:63], v[8:11], v[248:251]
    buffer_load_dwordx4 v[40:43], v253, s[16:19], s53 offen offset:1024 sc1
    v_mfma_f32_16x16x32_bf16 v[96:99], v[64:67], v[8:11], v[96:99]
    v_mfma_f32_16x16x32_bf16 v[100:103], v[68:71], v[8:11], v[100:103]
    ds_read_b128 v[8:11], v2 offset:27648
    s_waitcnt vmcnt(8) lgkmcnt(3)
    v_mfma_f32_16x16x32_bf16 v[248:251], v[72:75], v[12:15], v[248:251]
    buffer_load_dwordx4 v[44:47], v254, s[16:19], s53 offen offset:1024 sc1
    v_mfma_f32_16x16x32_bf16 v[96:99], v[76:79], v[12:15], v[96:99]
    v_mfma_f32_16x16x32_bf16 v[100:103], v[80:83], v[12:15], v[100:103]
    buffer_load_dwordx4 v[48:51], v7, s[16:19], s53 offen offset:2048 sc1
    v_mfma_f32_16x16x32_bf16 v[104:107], v[60:63], v[12:15], v[104:107]
    v_mfma_f32_16x16x32_bf16 v[120:123], v[64:67], v[12:15], v[120:123]
    buffer_load_dwordx4 v[52:55], v253, s[16:19], s53 offen offset:2048 sc1
    v_mfma_f32_16x16x32_bf16 v[124:127], v[68:71], v[12:15], v[124:127]
    ds_read_b128 v[12:15], v2 offset:28672
    s_waitcnt vmcnt(8) lgkmcnt(3)
    v_mfma_f32_16x16x32_bf16 v[248:251], v[84:87], v[16:19], v[248:251]
    v_mfma_f32_16x16x32_bf16 v[96:99], v[88:91], v[16:19], v[96:99]
    buffer_load_dwordx4 v[56:59], v254, s[16:19], s53 offen offset:2048 sc1
    v_mfma_f32_16x16x32_bf16 v[100:103], v[92:95], v[16:19], v[100:103]
    v_mfma_f32_16x16x32_bf16 v[104:107], v[72:75], v[16:19], v[104:107]
    v_mfma_f32_16x16x32_bf16 v[120:123], v[76:79], v[16:19], v[120:123]
    v_mfma_f32_16x16x32_bf16 v[124:127], v[80:83], v[16:19], v[124:127]
    v_mfma_f32_16x16x32_bf16 v[128:131], v[60:63], v[16:19], v[128:131]
    v_mfma_f32_16x16x32_bf16 v[144:147], v[64:67], v[16:19], v[144:147]
    v_mfma_f32_16x16x32_bf16 v[148:151], v[68:71], v[16:19], v[148:151]
    ds_read_b128 v[16:19], v2 offset:29696
    s_waitcnt lgkmcnt(3)
    v_mfma_f32_16x16x32_bf16 v[104:107], v[84:87], v[20:23], v[104:107]
    v_mfma_f32_16x16x32_bf16 v[120:123], v[88:91], v[20:23], v[120:123]
    v_mfma_f32_16x16x32_bf16 v[124:127], v[92:95], v[20:23], v[124:127]
    v_mfma_f32_16x16x32_bf16 v[128:131], v[72:75], v[20:23], v[128:131]
    v_mfma_f32_16x16x32_bf16 v[144:147], v[76:79], v[20:23], v[144:147]
    v_mfma_f32_16x16x32_bf16 v[148:151], v[80:83], v[20:23], v[148:151]
    v_mfma_f32_16x16x32_bf16 v[152:155], v[60:63], v[20:23], v[152:155]
    v_mfma_f32_16x16x32_bf16 v[168:171], v[64:67], v[20:23], v[168:171]
    v_mfma_f32_16x16x32_bf16 v[172:175], v[68:71], v[20:23], v[172:175]
    ds_read_b128 v[20:23], v2 offset:30720
    s_waitcnt lgkmcnt(3)
    v_mfma_f32_16x16x32_bf16 v[128:131], v[84:87], v[8:11], v[128:131]
    ds_read_b32 v0, v2 offset:35276
    v_mfma_f32_16x16x32_bf16 v[144:147], v[88:91], v[8:11], v[144:147]
    v_mfma_f32_16x16x32_bf16 v[148:151], v[92:95], v[8:11], v[148:151]
    v_mfma_f32_16x16x32_bf16 v[152:155], v[72:75], v[8:11], v[152:155]
    v_mfma_f32_16x16x32_bf16 v[168:171], v[76:79], v[8:11], v[168:171]
    v_mfma_f32_16x16x32_bf16 v[172:175], v[80:83], v[8:11], v[172:175]
    v_mfma_f32_16x16x32_bf16 v[176:179], v[60:63], v[8:11], v[176:179]
    s_waitcnt lgkmcnt(0)
    v_readfirstlane_b32 s47, v0
    v_mfma_f32_16x16x32_bf16 v[192:195], v[64:67], v[8:11], v[192:195]
    s_cmp_eq_u32 s47, 4
    s_cbranch_scc0 L_CKnrdy3_spin
L_CKnrdy3:
    v_mfma_f32_16x16x32_bf16 v[196:199], v[68:71], v[8:11], v[196:199]
    ds_read_b128 v[8:11], v1 offset:0
    v_mfma_f32_16x16x32_bf16 v[152:155], v[84:87], v[12:15], v[152:155]
    v_mfma_f32_16x16x32_bf16 v[168:171], v[88:91], v[12:15], v[168:171]
    v_mfma_f32_16x16x32_bf16 v[172:175], v[92:95], v[12:15], v[172:175]
    v_mfma_f32_16x16x32_bf16 v[176:179], v[72:75], v[12:15], v[176:179]
    v_mfma_f32_16x16x32_bf16 v[192:195], v[76:79], v[12:15], v[192:195]
    s_mov_b32 s53, 258048
    v_mfma_f32_16x16x32_bf16 v[196:199], v[80:83], v[12:15], v[196:199]
    v_mfma_f32_16x16x32_bf16 v[200:203], v[60:63], v[12:15], v[200:203]
    buffer_load_dwordx4 v[60:63], v7, s[16:19], s53 offen offset:0 sc1
    v_mfma_f32_16x16x32_bf16 v[216:219], v[64:67], v[12:15], v[216:219]
    v_mfma_f32_16x16x32_bf16 v[220:223], v[68:71], v[12:15], v[220:223]
    ds_read_b128 v[12:15], v1 offset:1024
    v_mfma_f32_16x16x32_bf16 v[176:179], v[84:87], v[16:19], v[176:179]
    buffer_load_dwordx4 v[64:67], v253, s[16:19], s53 offen offset:0 sc1
    v_mfma_f32_16x16x32_bf16 v[192:195], v[88:91], v[16:19], v[192:195]
    v_mfma_f32_16x16x32_bf16 v[196:199], v[92:95], v[16:19], v[196:199]
    buffer_load_dwordx4 v[68:71], v254, s[16:19], s53 offen offset:0 sc1
    v_mfma_f32_16x16x32_bf16 v[200:203], v[72:75], v[16:19], v[200:203]
    v_mfma_f32_16x16x32_bf16 v[216:219], v[76:79], v[16:19], v[216:219]
    v_mfma_f32_16x16x32_bf16 v[220:223], v[80:83], v[16:19], v[220:223]
    ds_read_b128 v[16:19], v1 offset:2048
    v_mfma_f32_16x16x32_bf16 v[200:203], v[84:87], v[20:23], v[200:203]
    ds_write_b32 v255, v252 offset:288
    buffer_load_dwordx4 v[72:75], v7, s[16:19], s53 offen offset:1024 sc1
    v_mfma_f32_16x16x32_bf16 v[216:219], v[88:91], v[20:23], v[216:219]
    v_mfma_f32_16x16x32_bf16 v[220:223], v[92:95], v[20:23], v[220:223]
    ds_read_b128 v[20:23], v1 offset:3072
    s_waitcnt vmcnt(10) lgkmcnt(4)
    v_mfma_f32_16x16x32_bf16 v[108:111], v[24:27], v[8:11], v[108:111]
    buffer_load_dwordx4 v[76:79], v253, s[16:19], s53 offen offset:1024 sc1
    v_mfma_f32_16x16x32_bf16 v[112:115], v[28:31], v[8:11], v[112:115]
    v_mfma_f32_16x16x32_bf16 v[116:119], v[32:35], v[8:11], v[116:119]
    ds_read_b128 v[8:11], v1 offset:4096
    s_waitcnt vmcnt(8) lgkmcnt(4)
    v_mfma_f32_16x16x32_bf16 v[108:111], v[36:39], v[12:15], v[108:111]
    buffer_load_dwordx4 v[80:83], v254, s[16:19], s53 offen offset:1024 sc1
    v_mfma_f32_16x16x32_bf16 v[112:115], v[40:43], v[12:15], v[112:115]
    v_mfma_f32_16x16x32_bf16 v[116:119], v[44:47], v[12:15], v[116:119]
    buffer_load_dwordx4 v[84:87], v7, s[16:19], s53 offen offset:2048 sc1
    v_mfma_f32_16x16x32_bf16 v[132:135], v[24:27], v[12:15], v[132:135]
    v_mfma_f32_16x16x32_bf16 v[136:139], v[28:31], v[12:15], v[136:139]
    buffer_load_dwordx4 v[88:91], v253, s[16:19], s53 offen offset:2048 sc1
    v_mfma_f32_16x16x32_bf16 v[140:143], v[32:35], v[12:15], v[140:143]
    ds_read_b128 v[12:15], v1 offset:5120
    s_waitcnt vmcnt(8) lgkmcnt(4)
    v_mfma_f32_16x16x32_bf16 v[108:111], v[48:51], v[16:19], v[108:111]
    v_mfma_f32_16x16x32_bf16 v[112:115], v[52:55], v[16:19], v[112:115]
    buffer_load_dwordx4 v[92:95], v254, s[16:19], s53 offen offset:2048 sc1
    v_mfma_f32_16x16x32_bf16 v[116:119], v[56:59], v[16:19], v[116:119]
    v_mfma_f32_16x16x32_bf16 v[132:135], v[36:39], v[16:19], v[132:135]
    v_mfma_f32_16x16x32_bf16 v[136:139], v[40:43], v[16:19], v[136:139]
    v_mfma_f32_16x16x32_bf16 v[140:143], v[44:47], v[16:19], v[140:143]
    v_mfma_f32_16x16x32_bf16 v[156:159], v[24:27], v[16:19], v[156:159]
    v_mfma_f32_16x16x32_bf16 v[160:163], v[28:31], v[16:19], v[160:163]
    v_mfma_f32_16x16x32_bf16 v[164:167], v[32:35], v[16:19], v[164:167]
    ds_read_b128 v[16:19], v1 offset:6144
    s_waitcnt lgkmcnt(3)
    v_mfma_f32_16x16x32_bf16 v[132:135], v[48:51], v[20:23], v[132:135]
    v_mfma_f32_16x16x32_bf16 v[136:139], v[52:55], v[20:23], v[136:139]
    v_mfma_f32_16x16x32_bf16 v[140:143], v[56:59], v[20:23], v[140:143]
    v_mfma_f32_16x16x32_bf16 v[156:159], v[36:39], v[20:23], v[156:159]
    v_mfma_f32_16x16x32_bf16 v[160:163], v[40:43], v[20:23], v[160:163]
    v_mfma_f32_16x16x32_bf16 v[164:167], v[44:47], v[20:23], v[164:167]
    v_mfma_f32_16x16x32_bf16 v[180:183], v[24:27], v[20:23], v[180:183]
    v_mfma_f32_16x16x32_bf16 v[184:187], v[28:31], v[20:23], v[184:187]
    v_mfma_f32_16x16x32_bf16 v[188:191], v[32:35], v[20:23], v[188:191]
    ds_read_b128 v[20:23], v1 offset:7168
    s_waitcnt lgkmcnt(3)
    v_mfma_f32_16x16x32_bf16 v[156:159], v[48:51], v[8:11], v[156:159]
    v_mfma_f32_16x16x32_bf16 v[160:163], v[52:55], v[8:11], v[160:163]
    v_mfma_f32_16x16x32_bf16 v[164:167], v[56:59], v[8:11], v[164:167]
    v_mfma_f32_16x16x32_bf16 v[180:183], v[36:39], v[8:11], v[180:183]
    v_mfma_f32_16x16x32_bf16 v[184:187], v[40:43], v[8:11], v[184:187]
    v_mfma_f32_16x16x32_bf16 v[188:191], v[44:47], v[8:11], v[188:191]
    v_mfma_f32_16x16x32_bf16 v[204:207], v[24:27], v[8:11], v[204:207]
    v_mfma_f32_16x16x32_bf16 v[208:211], v[28:31], v[8:11], v[208:211]
    v_mfma_f32_16x16x32_bf16 v[212:215], v[32:35], v[8:11], v[212:215]
    ds_read_b128 v[8:11], v1 offset:11264
    s_waitcnt lgkmcnt(3)
    v_mfma_f32_16x16x32_bf16 v[180:183], v[48:51], v[12:15], v[180:183]
    v_mfma_f32_16x16x32_bf16 v[184:187], v[52:55], v[12:15], v[184:187]
    v_mfma_f32_16x16x32_bf16 v[188:191], v[56:59], v[12:15], v[188:191]
    v_mfma_f32_16x16x32_bf16 v[204:207], v[36:39], v[12:15], v[204:207]
    v_mfma_f32_16x16x32_bf16 v[208:211], v[40:43], v[12:15], v[208:211]
    s_mov_b32 s53, 73728
    v_mfma_f32_16x16x32_bf16 v[212:215], v[44:47], v[12:15], v[212:215]
    v_mfma_f32_16x16x32_bf16 v[228:231], v[24:27], v[12:15], v[228:231]
    buffer_load_dwordx4 v[24:27], v7, s[16:19], s53 offen offset:0 sc1
    v_mfma_f32_16x16x32_bf16 v[232:235], v[28:31], v[12:15], v[232:235]
    v_mfma_f32_16x16x32_bf16 v[236:239], v[32:35], v[12:15], v[236:239]
    ds_read_b128 v[12:15], v1 offset:12288
    s_waitcnt lgkmcnt(3)
    v_mfma_f32_16x16x32_bf16 v[204:207], v[48:51], v[16:19], v[204:207]
    buffer_load_dwordx4 v[28:31], v253, s[16:19], s53 offen offset:0 sc1
    v_mfma_f32_16x16x32_bf16 v[208:211], v[52:55], v[16:19], v[208:211]
    v_mfma_f32_16x16x32_bf16 v[212:215], v[56:59], v[16:19], v[212:215]
    buffer_load_dwordx4 v[32:35], v254, s[16:19], s53 offen offset:0 sc1
    v_mfma_f32_16x16x32_bf16 v[228:231], v[36:39], v[16:19], v[228:231]
    v_mfma_f32_16x16x32_bf16 v[232:235], v[40:43], v[16:19], v[232:235]
    v_mfma_f32_16x16x32_bf16 v[236:239], v[44:47], v[16:19], v[236:239]
    ds_read_b128 v[16:19], v1 offset:13312
    s_waitcnt lgkmcnt(3)
    v_mfma_f32_16x16x32_bf16 v[228:231], v[48:51], v[20:23], v[228:231]
    buffer_load_dwordx4 v[36:39], v7, s[16:19], s53 offen offset:1024 sc1
    v_mfma_f32_16x16x32_bf16 v[232:235], v[52:55], v[20:23], v[232:235]
    v_mfma_f32_16x16x32_bf16 v[236:239], v[56:59], v[20:23], v[236:239]
    ds_read_b128 v[20:23], v1 offset:14336
    s_waitcnt vmcnt(10) lgkmcnt(3)
    v_mfma_f32_16x16x32_bf16 v[108:111], v[60:63], v[8:11], v[108:111]
    buffer_load_dwordx4 v[40:43], v253, s[16:19], s53 offen offset:1024 sc1
    v_mfma_f32_16x16x32_bf16 v[112:115], v[64:67], v[8:11], v[112:115]
    v_mfma_f32_16x16x32_bf16 v[116:119], v[68:71], v[8:11], v[116:119]
    ds_read_b128 v[8:11], v1 offset:15360
    s_waitcnt vmcnt(8) lgkmcnt(3)
    v_mfma_f32_16x16x32_bf16 v[108:111], v[72:75], v[12:15], v[108:111]
    buffer_load_dwordx4 v[44:47], v254, s[16:19], s53 offen offset:1024 sc1
    v_mfma_f32_16x16x32_bf16 v[112:115], v[76:79], v[12:15], v[112:115]
    v_mfma_f32_16x16x32_bf16 v[116:119], v[80:83], v[12:15], v[116:119]
    buffer_load_dwordx4 v[48:51], v7, s[16:19], s53 offen offset:2048 sc1
    v_mfma_f32_16x16x32_bf16 v[132:135], v[60:63], v[12:15], v[132:135]
    v_mfma_f32_16x16x32_bf16 v[136:139], v[64:67], v[12:15], v[136:139]
    buffer_load_dwordx4 v[52:55], v253, s[16:19], s53 offen offset:2048 sc1
    v_mfma_f32_16x16x32_bf16 v[140:143], v[68:71], v[12:15], v[140:143]
    ds_read_b128 v[12:15], v1 offset:16384
    s_waitcnt vmcnt(8) lgkmcnt(3)
    v_mfma_f32_16x16x32_bf16 v[108:111], v[84:87], v[16:19], v[108:111]
    v_mfma_f32_16x16x32_bf16 v[112:115], v[88:91], v[16:19], v[112:115]
    buffer_load_dwordx4 v[56:59], v254, s[16:19], s53 offen offset:2048 sc1
    v_mfma_f32_16x16x32_bf16 v[116:119], v[92:95], v[16:19], v[116:119]
    v_mfma_f32_16x16x32_bf16 v[132:135], v[72:75], v[16:19], v[132:135]
    v_mfma_f32_16x16x32_bf16 v[136:139], v[76:79], v[16:19], v[136:139]
    v_mfma_f32_16x16x32_bf16 v[140:143], v[80:83], v[16:19], v[140:143]
    v_mfma_f32_16x16x32_bf16 v[156:159], v[60:63], v[16:19], v[156:159]
    v_mfma_f32_16x16x32_bf16 v[160:163], v[64:67], v[16:19], v[160:163]
    v_mfma_f32_16x16x32_bf16 v[164:167], v[68:71], v[16:19], v[164:167]
    ds_read_b128 v[16:19], v1 offset:17408
    s_waitcnt lgkmcnt(3)
    v_mfma_f32_16x16x32_bf16 v[132:135], v[84:87], v[20:23], v[132:135]
    v_mfma_f32_16x16x32_bf16 v[136:139], v[88:91], v[20:23], v[136:139]
    v_mfma_f32_16x16x32_bf16 v[140:143], v[92:95], v[20:23], v[140:143]
    v_mfma_f32_16x16x32_bf16 v[156:159], v[72:75], v[20:23], v[156:159]
    v_mfma_f32_16x16x32_bf16 v[160:163], v[76:79], v[20:23], v[160:163]
    v_mfma_f32_16x16x32_bf16 v[164:167], v[80:83], v[20:23], v[164:167]
    v_mfma_f32_16x16x32_bf16 v[180:183], v[60:63], v[20:23], v[180:183]
    v_mfma_f32_16x16x32_bf16 v[184:187], v[64:67], v[20:23], v[184:187]
    v_mfma_f32_16x16x32_bf16 v[188:191], v[68:71], v[20:23], v[188:191]
    ds_read_b128 v[20:23], v1 offset:18432
    s_waitcnt lgkmcnt(3)
    v_mfma_f32_16x16x32_bf16 v[156:159], v[84:87], v[8:11], v[156:159]
    ds_read_b32 v0, v2 offset:35280
    v_mfma_f32_16x16x32_bf16 v[160:163], v[88:91], v[8:11], v[160:163]
    v_mfma_f32_16x16x32_bf16 v[164:167], v[92:95], v[8:11], v[164:167]
    v_mfma_f32_16x16x32_bf16 v[180:183], v[72:75], v[8:11], v[180:183]
    v_mfma_f32_16x16x32_bf16 v[184:187], v[76:79], v[8:11], v[184:187]
    v_mfma_f32_16x16x32_bf16 v[188:191], v[80:83], v[8:11], v[188:191]
    v_mfma_f32_16x16x32_bf16 v[204:207], v[60:63], v[8:11], v[204:207]
    s_waitcnt lgkmcnt(0)
    v_readfirstlane_b32 s47, v0
    v_mfma_f32_16x16x32_bf16 v[208:211], v[64:67], v[8:11], v[208:211]
    s_cmp_eq_u32 s47, 4
    s_cbranch_scc0 L_CKnrdy4_spin
L_CKnrdy4:
    v_mfma_f32_16x16x32_bf16 v[212:215], v[68:71], v[8:11], v[212:215]
    ds_read_b128 v[8:11], v1 offset:22528
    v_mfma_f32_16x16x32_bf16 v[180:183], v[84:87], v[12:15], v[180:183]
    v_mfma_f32_16x16x32_bf16 v[184:187], v[88:91], v[12:15], v[184:187]
    v_mfma_f32_16x16x32_bf16 v[188:191], v[92:95], v[12:15], v[188:191]
    v_mfma_f32_16x16x32_bf16 v[204:207], v[72:75], v[12:15], v[204:207]
    v_mfma_f32_16x16x32_bf16 v[208:211], v[76:79], v[12:15], v[208:211]
    s_mov_b32 s53, 110592
    v_mfma_f32_16x16x32_bf16 v[212:215], v[80:83], v[12:15], v[212:215]
    v_mfma_f32_16x16x32_bf16 v[228:231], v[60:63], v[12:15], v[228:231]
    buffer_load_dwordx4 v[60:63], v7, s[16:19], s53 offen offset:0 sc1
    v_mfma_f32_16x16x32_bf16 v[232:235], v[64:67], v[12:15], v[232:235]
    v_mfma_f32_16x16x32_bf16 v[236:239], v[68:71], v[12:15], v[236:239]
    ds_read_b128 v[12:15], v1 offset:23552
    v_mfma_f32_16x16x32_bf16 v[204:207], v[84:87], v[16:19], v[204:207]
    buffer_load_dwordx4 v[64:67], v253, s[16:19], s53 offen offset:0 sc1
    v_mfma_f32_16x16x32_bf16 v[208:211], v[88:91], v[16:19], v[208:211]
    v_mfma_f32_16x16x32_bf16 v[212:215], v[92:95], v[16:19], v[212:215]
    buffer_load_dwordx4 v[68:71], v254, s[16:19], s53 offen offset:0 sc1
    v_mfma_f32_16x16x32_bf16 v[228:231], v[72:75], v[16:19], v[228:231]
    v_mfma_f32_16x16x32_bf16 v[232:235], v[76:79], v[16:19], v[232:235]
    v_mfma_f32_16x16x32_bf16 v[236:239], v[80:83], v[16:19], v[236:239]
    ds_read_b128 v[16:19], v1 offset:24576
    v_mfma_f32_16x16x32_bf16 v[228:231], v[84:87], v[20:23], v[228:231]
    ds_write_b32 v255, v252 offset:304
    buffer_load_dwordx4 v[72:75], v7, s[16:19], s53 offen offset:1024 sc1
    v_mfma_f32_16x16x32_bf16 v[232:235], v[88:91], v[20:23], v[232:235]
    v_mfma_f32_16x16x32_bf16 v[236:239], v[92:95], v[20:23], v[236:239]
    ds_read_b128 v[20:23], v1 offset:25600
    s_waitcnt vmcnt(10) lgkmcnt(4)
    v_mfma_f32_16x16x32_bf16 v[248:251], v[24:27], v[8:11], v[248:251]
    buffer_load_dwordx4 v[76:79], v253, s[16:19], s53 offen offset:1024 sc1
    v_mfma_f32_16x16x32_bf16 v[96:99], v[28:31], v[8:11], v[96:99]
    v_mfma_f32_16x16x32_bf16 v[100:103], v[32:35], v[8:11], v[100:103]
    ds_read_b128 v[8:11], v1 offset:26624
    s_waitcnt vmcnt(8) lgkmcnt(4)
    v_mfma_f32_16x16x32_bf16 v[248:251], v[36:39], v[12:15], v[248:251]
    buffer_load_dwordx4 v[80:83], v254, s[16:19], s53 offen offset:1024 sc1
    v_mfma_f32_16x16x32_bf16 v[96:99], v[40:43], v[12:15], v[96:99]
    v_mfma_f32_16x16x32_bf16 v[100:103], v[44:47], v[12:15], v[100:103]
    buffer_load_dwordx4 v[84:87], v7, s[16:19], s53 offen offset:2048 sc1
    v_mfma_f32_16x16x32_bf16 v[104:107], v[24:27], v[12:15], v[104:107]
    v_mfma_f32_16x16x32_bf16 v[120:123], v[28:31], v[12:15], v[120:123]
    buffer_load_dwordx4 v[88:91], v253, s[16:19], s53 offen offset:2048 sc1
    v_mfma_f32_16x16x32_bf16 v[124:127], v[32:35], v[12:15], v[124:127]
    ds_read_b128 v[12:15], v1 offset:27648
    s_waitcnt vmcnt(8) lgkmcnt(4)
    v_mfma_f32_16x16x32_bf16 v[248:251], v[48:51], v[16:19], v[248:251]
    v_mfma_f32_16x16x32_bf16 v[96:99], v[52:55], v[16:19], v[96:99]
    buffer_load_dwordx4 v[92:95], v254, s[16:19], s53 offen offset:2048 sc1
    v_mfma_f32_16x16x32_bf16 v[100:103], v[56:59], v[16:19], v[100:103]
    v_mfma_f32_16x16x32_bf16 v[104:107], v[36:39], v[16:19], v[104:107]
    v_mfma_f32_16x16x32_bf16 v[120:123], v[40:43], v[16:19], v[120:123]
    v_mfma_f32_16x16x32_bf16 v[124:127], v[44:47], v[16:19], v[124:127]
    v_mfma_f32_16x16x32_bf16 v[128:131], v[24:27], v[16:19], v[128:131]
    v_mfma_f32_16x16x32_bf16 v[144:147], v[28:31], v[16:19], v[144:147]
    v_mfma_f32_16x16x32_bf16 v[148:151], v[32:35], v[16:19], v[148:151]
    ds_read_b128 v[16:19], v1 offset:28672
    s_waitcnt lgkmcnt(3)
    v_mfma_f32_16x16x32_bf16 v[104:107], v[48:51], v[20:23], v[104:107]
    v_mfma_f32_16x16x32_bf16 v[120:123], v[52:55], v[20:23], v[120:123]
    v_mfma_f32_16x16x32_bf16 v[124:127], v[56:59], v[20:23], v[124:127]
    v_mfma_f32_16x16x32_bf16 v[128:131], v[36:39], v[20:23], v[128:131]
    v_mfma_f32_16x16x32_bf16 v[144:147], v[40:43], v[20:23], v[144:147]
    v_mfma_f32_16x16x32_bf16 v[148:151], v[44:47], v[20:23], v[148:151]
    v_mfma_f32_16x16x32_bf16 v[152:155], v[24:27], v[20:23], v[152:155]
    v_mfma_f32_16x16x32_bf16 v[168:171], v[28:31], v[20:23], v[168:171]
    v_mfma_f32_16x16x32_bf16 v[172:175], v[32:35], v[20:23], v[172:175]
    ds_read_b128 v[20:23], v1 offset:29696
    s_waitcnt lgkmcnt(3)
    v_mfma_f32_16x16x32_bf16 v[128:131], v[48:51], v[8:11], v[128:131]
    v_mfma_f32_16x16x32_bf16 v[144:147], v[52:55], v[8:11], v[144:147]
    v_mfma_f32_16x16x32_bf16 v[148:151], v[56:59], v[8:11], v[148:151]
    v_mfma_f32_16x16x32_bf16 v[152:155], v[36:39], v[8:11], v[152:155]
    v_mfma_f32_16x16x32_bf16 v[168:171], v[40:43], v[8:11], v[168:171]
    v_mfma_f32_16x16x32_bf16 v[172:175], v[44:47], v[8:11], v[172:175]
    v_mfma_f32_16x16x32_bf16 v[176:179], v[24:27], v[8:11], v[176:179]
    v_mfma_f32_16x16x32_bf16 v[192:195], v[28:31], v[8:11], v[192:195]
    v_mfma_f32_16x16x32_bf16 v[196:199], v[32:35], v[8:11], v[196:199]
    ds_read_b128 v[8:11], v2 offset:1024
    s_waitcnt lgkmcnt(3)
    v_mfma_f32_16x16x32_bf16 v[152:155], v[48:51], v[12:15], v[152:155]
    v_mfma_f32_16x16x32_bf16 v[168:171], v[52:55], v[12:15], v[168:171]
    v_mfma_f32_16x16x32_bf16 v[172:175], v[56:59], v[12:15], v[172:175]
    v_mfma_f32_16x16x32_bf16 v[176:179], v[36:39], v[12:15], v[176:179]
    v_mfma_f32_16x16x32_bf16 v[192:195], v[40:43], v[12:15], v[192:195]
    s_mov_b32 s53, 294912
    v_mfma_f32_16x16x32_bf16 v[196:199], v[44:47], v[12:15], v[196:199]
    v_mfma_f32_16x16x32_bf16 v[200:203], v[24:27], v[12:15], v[200:203]
    buffer_load_dwordx4 v[24:27], v7, s[16:19], s53 offen offset:0 sc1
    v_mfma_f32_16x16x32_bf16 v[216:219], v[28:31], v[12:15], v[216:219]
    v_mfma_f32_16x16x32_bf16 v[220:223], v[32:35], v[12:15], v[220:223]
    ds_read_b128 v[12:15], v2 offset:2048
    s_waitcnt lgkmcnt(3)
    v_mfma_f32_16x16x32_bf16 v[176:179], v[48:51], v[16:19], v[176:179]
    buffer_load_dwordx4 v[28:31], v253, s[16:19], s53 offen offset:0 sc1
    v_mfma_f32_16x16x32_bf16 v[192:195], v[52:55], v[16:19], v[192:195]
    v_mfma_f32_16x16x32_bf16 v[196:199], v[56:59], v[16:19], v[196:199]
    buffer_load_dwordx4 v[32:35], v254, s[16:19], s53 offen offset:0 sc1
    v_mfma_f32_16x16x32_bf16 v[200:203], v[36:39], v[16:19], v[200:203]
    v_mfma_f32_16x16x32_bf16 v[216:219], v[40:43], v[16:19], v[216:219]
    v_mfma_f32_16x16x32_bf16 v[220:223], v[44:47], v[16:19], v[220:223]
    ds_read_b128 v[16:19], v2 offset:3072
    s_waitcnt lgkmcnt(3)
    v_mfma_f32_16x16x32_bf16 v[200:203], v[48:51], v[20:23], v[200:203]
    buffer_load_dwordx4 v[36:39], v7, s[16:19], s53 offen offset:1024 sc1
    v_mfma_f32_16x16x32_bf16 v[216:219], v[52:55], v[20:23], v[216:219]
    v_mfma_f32_16x16x32_bf16 v[220:223], v[56:59], v[20:23], v[220:223]
    ds_read_b128 v[20:23], v2 offset:4096
    s_waitcnt vmcnt(10) lgkmcnt(3)
    v_mfma_f32_16x16x32_bf16 v[248:251], v[60:63], v[8:11], v[248:251]
    buffer_load_dwordx4 v[40:43], v253, s[16:19], s53 offen offset:1024 sc1
    v_mfma_f32_16x16x32_bf16 v[96:99], v[64:67], v[8:11], v[96:99]
    v_mfma_f32_16x16x32_bf16 v[100:103], v[68:71], v[8:11], v[100:103]
    ds_read_b128 v[8:11], v2 offset:5120
    s_waitcnt vmcnt(8) lgkmcnt(3)
    v_mfma_f32_16x16x32_bf16 v[248:251], v[72:75], v[12:15], v[248:251]
    buffer_load_dwordx4 v[44:47], v254, s[16:19], s53 offen offset:1024 sc1
    v_mfma_f32_16x16x32_bf16 v[96:99], v[76:79], v[12:15], v[96:99]
    v_mfma_f32_16x16x32_bf16 v[100:103], v[80:83], v[12:15], v[100:103]
    buffer_load_dwordx4 v[48:51], v7, s[16:19], s53 offen offset:2048 sc1
    v_mfma_f32_16x16x32_bf16 v[104:107], v[60:63], v[12:15], v[104:107]
    v_mfma_f32_16x16x32_bf16 v[120:123], v[64:67], v[12:15], v[120:123]
    buffer_load_dwordx4 v[52:55], v253, s[16:19], s53 offen offset:2048 sc1
    v_mfma_f32_16x16x32_bf16 v[124:127], v[68:71], v[12:15], v[124:127]
    ds_read_b128 v[12:15], v2 offset:6144
    s_waitcnt vmcnt(8) lgkmcnt(3)
    v_mfma_f32_16x16x32_bf16 v[248:251], v[84:87], v[16:19], v[248:251]
    v_mfma_f32_16x16x32_bf16 v[96:99], v[88:91], v[16:19], v[96:99]
    buffer_load_dwordx4 v[56:59], v254, s[16:19], s53 offen offset:2048 sc1
    v_mfma_f32_16x16x32_bf16 v[100:103], v[92:95], v[16:19], v[100:103]
    v_mfma_f32_16x16x32_bf16 v[104:107], v[72:75], v[16:19], v[104:107]
    v_mfma_f32_16x16x32_bf16 v[120:123], v[76:79], v[16:19], v[120:123]
    v_mfma_f32_16x16x32_bf16 v[124:127], v[80:83], v[16:19], v[124:127]
    v_mfma_f32_16x16x32_bf16 v[128:131], v[60:63], v[16:19], v[128:131]
    v_mfma_f32_16x16x32_bf16 v[144:147], v[64:67], v[16:19], v[144:147]
    v_mfma_f32_16x16x32_bf16 v[148:151], v[68:71], v[16:19], v[148:151]
    ds_read_b128 v[16:19], v2 offset:7168
    s_waitcnt lgkmcnt(3)
    v_mfma_f32_16x16x32_bf16 v[104:107], v[84:87], v[20:23], v[104:107]
    v_mfma_f32_16x16x32_bf16 v[120:123], v[88:91], v[20:23], v[120:123]
    v_mfma_f32_16x16x32_bf16 v[124:127], v[92:95], v[20:23], v[124:127]
    v_mfma_f32_16x16x32_bf16 v[128:131], v[72:75], v[20:23], v[128:131]
    v_mfma_f32_16x16x32_bf16 v[144:147], v[76:79], v[20:23], v[144:147]
    v_mfma_f32_16x16x32_bf16 v[148:151], v[80:83], v[20:23], v[148:151]
    v_mfma_f32_16x16x32_bf16 v[152:155], v[60:63], v[20:23], v[152:155]
    v_mfma_f32_16x16x32_bf16 v[168:171], v[64:67], v[20:23], v[168:171]
    v_mfma_f32_16x16x32_bf16 v[172:175], v[68:71], v[20:23], v[172:175]
    ds_read_b128 v[20:23], v2 offset:8192
    s_waitcnt lgkmcnt(3)
    v_mfma_f32_16x16x32_bf16 v[128:131], v[84:87], v[8:11], v[128:131]
    ds_read_b32 v0, v2 offset:35284
    v_mfma_f32_16x16x32_bf16 v[144:147], v[88:91], v[8:11], v[144:147]
    v_mfma_f32_16x16x32_bf16 v[148:151], v[92:95], v[8:11], v[148:151]
    v_mfma_f32_16x16x32_bf16 v[152:155], v[72:75], v[8:11], v[152:155]
    v_mfma_f32_16x16x32_bf16 v[168:171], v[76:79], v[8:11], v[168:171]
    v_mfma_f32_16x16x32_bf16 v[172:175], v[80:83], v[8:11], v[172:175]
    v_mfma_f32_16x16x32_bf16 v[176:179], v[60:63], v[8:11], v[176:179]
    s_waitcnt lgkmcnt(0)
    v_readfirstlane_b32 s47, v0
    v_mfma_f32_16x16x32_bf16 v[192:195], v[64:67], v[8:11], v[192:195]
    s_cmp_eq_u32 s47, 4
    s_cbranch_scc0 L_CKnrdy5_spin
L_CKnrdy5:
    v_mfma_f32_16x16x32_bf16 v[196:199], v[68:71], v[8:11], v[196:199]
    ds_read_b128 v[8:11], v2 offset:12288
    v_mfma_f32_16x16x32_bf16 v[152:155], v[84:87], v[12:15], v[152:155]
    v_mfma_f32_16x16x32_bf16 v[168:171], v[88:91], v[12:15], v[168:171]
    v_mfma_f32_16x16x32_bf16 v[172:175], v[92:95], v[12:15], v[172:175]
    v_mfma_f32_16x16x32_bf16 v[176:179], v[72:75], v[12:15], v[176:179]
    v_mfma_f32_16x16x32_bf16 v[192:195], v[76:79], v[12:15], v[192:195]
    s_mov_b32 s53, 331776
    v_mfma_f32_16x16x32_bf16 v[196:199], v[80:83], v[12:15], v[196:199]
    v_mfma_f32_16x16x32_bf16 v[200:203], v[60:63], v[12:15], v[200:203]
    buffer_load_dwordx4 v[60:63], v7, s[16:19], s53 offen offset:0 sc1
    v_mfma_f32_16x16x32_bf16 v[216:219], v[64:67], v[12:15], v[216:219]
    v_mfma_f32_16x16x32_bf16 v[220:223], v[68:71], v[12:15], v[220:223]
    ds_read_b128 v[12:15], v2 offset:13312
    v_mfma_f32_16x16x32_bf16 v[176:179], v[84:87], v[16:19], v[176:179]
    buffer_load_dwordx4 v[64:67], v253, s[16:19], s53 offen offset:0 sc1
    v_mfma_f32_16x16x32_bf16 v[192:195], v[88:91], v[16:19], v[192:195]
    v_mfma_f32_16x16x32_bf16 v[196:199], v[92:95], v[16:19], v[196:199]
    buffer_load_dwordx4 v[68:71], v254, s[16:19], s53 offen offset:0 sc1
    v_mfma_f32_16x16x32_bf16 v[200:203], v[72:75], v[16:19], v[200:203]
    v_mfma_f32_16x16x32_bf16 v[216:219], v[76:79], v[16:19], v[216:219]
    v_mfma_f32_16x16x32_bf16 v[220:223], v[80:83], v[16:19], v[220:223]
    ds_read_b128 v[16:19], v2 offset:14336
    v_mfma_f32_16x16x32_bf16 v[200:203], v[84:87], v[20:23], v[200:203]
    ds_write_b32 v255, v252 offset:320
    buffer_load_dwordx4 v[72:75], v7, s[16:19], s53 offen offset:1024 sc1
    v_mfma_f32_16x16x32_bf16 v[216:219], v[88:91], v[20:23], v[216:219]
    v_mfma_f32_16x16x32_bf16 v[220:223], v[92:95], v[20:23], v[220:223]
    ds_read_b128 v[20:23], v2 offset:15360
    s_waitcnt vmcnt(10) lgkmcnt(4)
    v_mfma_f32_16x16x32_bf16 v[108:111], v[24:27], v[8:11], v[108:111]
    buffer_load_dwordx4 v[76:79], v253, s[16:19], s53 offen offset:1024 sc1
    v_lshrrev_b32 v6, 8, v1
    v_mfma_f32_16x16x32_bf16 v[112:115], v[28:31], v[8:11], v[112:115]
    v_bfe_u32 v5, v1, 4, 4
    v_xor_b32 v5, v5, v6
    v_mfma_f32_16x16x32_bf16 v[116:119], v[32:35], v[8:11], v[116:119]
    ds_read_b128 v[8:11], v2 offset:16384
    s_waitcnt vmcnt(8) lgkmcnt(4)
    v_mfma_f32_16x16x32_bf16 v[108:111], v[36:39], v[12:15], v[108:111]
    buffer_load_dwordx4 v[80:83], v254, s[16:19], s53 offen offset:1024 sc1
    v_lshlrev_b32 v6, 3, v6
    v_mfma_f32_16x16x32_bf16 v[112:115], v[40:43], v[12:15], v[112:115]
    s_lshl_b32 s48, s36, 5
    s_add_u32 s48, s48, 144896
    v_mfma_f32_16x16x32_bf16 v[116:119], v[44:47], v[12:15], v[116:119]
    buffer_load_dwordx4 v[84:87], v7, s[16:19], s53 offen offset:2048 sc1
    v_mul_u32_u24 v3, 144, v5
    v_mfma_f32_16x16x32_bf16 v[132:135], v[24:27], v[12:15], v[132:135]
    v_add3_u32 v3, v3, v6, s48
    v_mul_u32_u24 v5, 400, v5
    v_mfma_f32_16x16x32_bf16 v[136:139], v[28:31], v[12:15], v[136:139]
    buffer_load_dwordx4 v[88:91], v253, s[16:19], s53 offen offset:2048 sc1
    v_add_u32 v6, v5, v6
    v_mfma_f32_16x16x32_bf16 v[140:143], v[32:35], v[12:15], v[140:143]
    ds_read_b128 v[12:15], v2 offset:17408
    s_waitcnt vmcnt(8) lgkmcnt(4)
    v_mfma_f32_16x16x32_bf16 v[108:111], v[48:51], v[16:19], v[108:111]
    s_mul_i32 s48, s36, 96
    s_add_u32 s48, s48, 68096
    v_mfma_f32_16x16x32_bf16 v[112:115], v[52:55], v[16:19], v[112:115]
    buffer_load_dwordx4 v[92:95], v254, s[16:19], s53 offen offset:2048 sc1
    s_lshl_b32 s49, s43, 5
    v_mfma_f32_16x16x32_bf16 v[116:119], v[56:59], v[16:19], v[116:119]
    s_add_u32 s49, s49, s48
    v_add_u32 v4, s49, v6
    v_mfma_f32_16x16x32_bf16 v[132:135], v[36:39], v[16:19], v[132:135]
    s_lshl_b32 s49, s44, 5
    s_add_u32 s49, s49, s48
    v_mfma_f32_16x16x32_bf16 v[136:139], v[40:43], v[16:19], v[136:139]
    v_add_u32 v5, s49, v6
    s_lshl_b32 s49, s45, 5
    v_mfma_f32_16x16x32_bf16 v[140:143], v[44:47], v[16:19], v[140:143]
    s_add_u32 s49, s49, s48
    v_add_u32 v6, s49, v6
    v_mfma_f32_16x16x32_bf16 v[156:159], v[24:27], v[16:19], v[156:159]
    v_mfma_f32_16x16x32_bf16 v[160:163], v[28:31], v[16:19], v[160:163]
    v_mfma_f32_16x16x32_bf16 v[164:167], v[32:35], v[16:19], v[164:167]
    ds_read_b128 v[16:19], v2 offset:18432
    s_waitcnt lgkmcnt(3)
    v_mfma_f32_16x16x32_bf16 v[132:135], v[48:51], v[20:23], v[132:135]
    v_mfma_f32_16x16x32_bf16 v[136:139], v[52:55], v[20:23], v[136:139]
    v_mfma_f32_16x16x32_bf16 v[140:143], v[56:59], v[20:23], v[140:143]
    v_mfma_f32_16x16x32_bf16 v[156:159], v[36:39], v[20:23], v[156:159]
    v_mfma_f32_16x16x32_bf16 v[160:163], v[40:43], v[20:23], v[160:163]
    v_mfma_f32_16x16x32_bf16 v[164:167], v[44:47], v[20:23], v[164:167]
    v_mfma_f32_16x16x32_bf16 v[180:183], v[24:27], v[20:23], v[180:183]
    v_mfma_f32_16x16x32_bf16 v[184:187], v[28:31], v[20:23], v[184:187]
    v_mfma_f32_16x16x32_bf16 v[188:191], v[32:35], v[20:23], v[188:191]
    ds_read_b128 v[20:23], v2 offset:19456
    s_waitcnt lgkmcnt(3)
    v_mfma_f32_16x16x32_bf16 v[156:159], v[48:51], v[8:11], v[156:159]
    v_mfma_f32_16x16x32_bf16 v[160:163], v[52:55], v[8:11], v[160:163]
    v_mfma_f32_16x16x32_bf16 v[164:167], v[56:59], v[8:11], v[164:167]
    v_mfma_f32_16x16x32_bf16 v[180:183], v[36:39], v[8:11], v[180:183]
    v_mfma_f32_16x16x32_bf16 v[184:187], v[40:43], v[8:11], v[184:187]
    v_mfma_f32_16x16x32_bf16 v[188:191], v[44:47], v[8:11], v[188:191]
    v_mfma_f32_16x16x32_bf16 v[204:207], v[24:27], v[8:11], v[204:207]
    v_mfma_f32_16x16x32_bf16 v[208:211], v[28:31], v[8:11], v[208:211]
    v_mfma_f32_16x16x32_bf16 v[212:215], v[32:35], v[8:11], v[212:215]
    ds_read_b128 v[8:11], v2 offset:23552
    s_waitcnt lgkmcnt(3)
    v_mfma_f32_16x16x32_bf16 v[180:183], v[48:51], v[12:15], v[180:183]
    v_mfma_f32_16x16x32_bf16 v[184:187], v[52:55], v[12:15], v[184:187]
    v_mfma_f32_16x16x32_bf16 v[188:191], v[56:59], v[12:15], v[188:191]
    v_mfma_f32_16x16x32_bf16 v[204:207], v[36:39], v[12:15], v[204:207]
    v_mfma_f32_16x16x32_bf16 v[208:211], v[40:43], v[12:15], v[208:211]
    s_mov_b32 s53, 147456
    v_mfma_f32_16x16x32_bf16 v[212:215], v[44:47], v[12:15], v[212:215]
    v_mfma_f32_16x16x32_bf16 v[228:231], v[24:27], v[12:15], v[228:231]
    buffer_load_dwordx4 v[24:27], v7, s[16:19], s53 offen offset:0 sc1
    v_mfma_f32_16x16x32_bf16 v[232:235], v[28:31], v[12:15], v[232:235]
    v_mfma_f32_16x16x32_bf16 v[236:239], v[32:35], v[12:15], v[236:239]
    ds_read_b128 v[12:15], v2 offset:24576
    s_waitcnt lgkmcnt(3)
    v_mfma_f32_16x16x32_bf16 v[204:207], v[48:51], v[16:19], v[204:207]
    buffer_load_dwordx4 v[28:31], v253, s[16:19], s53 offen offset:0 sc1
    v_mfma_f32_16x16x32_bf16 v[208:211], v[52:55], v[16:19], v[208:211]
    v_mfma_f32_16x16x32_bf16 v[212:215], v[56:59], v[16:19], v[212:215]
    buffer_load_dwordx4 v[32:35], v254, s[16:19], s53 offen offset:0 sc1
    v_mfma_f32_16x16x32_bf16 v[228:231], v[36:39], v[16:19], v[228:231]
    v_mfma_f32_16x16x32_bf16 v[232:235], v[40:43], v[16:19], v[232:235]
    v_mfma_f32_16x16x32_bf16 v[236:239], v[44:47], v[16:19], v[236:239]
    ds_read_b128 v[16:19], v2 offset:25600
    s_waitcnt lgkmcnt(3)
    v_mfma_f32_16x16x32_bf16 v[228:231], v[48:51], v[20:23], v[228:231]
    buffer_load_dwordx4 v[36:39], v7, s[16:19], s53 offen offset:1024 sc1
    v_mfma_f32_16x16x32_bf16 v[232:235], v[52:55], v[20:23], v[232:235]
    v_mfma_f32_16x16x32_bf16 v[236:239], v[56:59], v[20:23], v[236:239]
    ds_read_b128 v[20:23], v2 offset:26624
    s_waitcnt vmcnt(10) lgkmcnt(3)
    v_mfma_f32_16x16x32_bf16 v[108:111], v[60:63], v[8:11], v[108:111]
    buffer_load_dwordx4 v[40:43], v253, s[16:19], s53 offen offset:1024 sc1
    v_mfma_f32_16x16x32_bf16 v[112:115], v[64:67], v[8:11], v[112:115]
    v_mfma_f32_16x16x32_bf16 v[116:119], v[68:71], v[8:11], v[116:119]
    ds_read_b128 v[8:11], v2 offset:27648
    s_waitcnt vmcnt(8) lgkmcnt(3)
    v_mfma_f32_16x16x32_bf16 v[108:111], v[72:75], v[12:15], v[108:111]
    buffer_load_dwordx4 v[44:47], v254, s[16:19], s53 offen offset:1024 sc1
    v_mfma_f32_16x16x32_bf16 v[112:115], v[76:79], v[12:15], v[112:115]
    v_mfma_f32_16x16x32_bf16 v[116:119], v[80:83], v[12:15], v[116:119]
    buffer_load_dwordx4 v[48:51], v7, s[16:19], s53 offen offset:2048 sc1
    v_mfma_f32_16x16x32_bf16 v[132:135], v[60:63], v[12:15], v[132:135]
    v_mfma_f32_16x16x32_bf16 v[136:139], v[64:67], v[12:15], v[136:139]
    buffer_load_dwordx4 v[52:55], v253, s[16:19], s53 offen offset:2048 sc1
    v_mfma_f32_16x16x32_bf16 v[140:143], v[68:71], v[12:15], v[140:143]
    ds_read_b128 v[12:15], v2 offset:28672
    s_waitcnt vmcnt(8) lgkmcnt(3)
    v_mfma_f32_16x16x32_bf16 v[108:111], v[84:87], v[16:19], v[108:111]
    v_mfma_f32_16x16x32_bf16 v[112:115], v[88:91], v[16:19], v[112:115]
    buffer_load_dwordx4 v[56:59], v254, s[16:19], s53 offen offset:2048 sc1
    v_mfma_f32_16x16x32_bf16 v[116:119], v[92:95], v[16:19], v[116:119]
    v_mfma_f32_16x16x32_bf16 v[132:135], v[72:75], v[16:19], v[132:135]
    v_mfma_f32_16x16x32_bf16 v[136:139], v[76:79], v[16:19], v[136:139]
    v_mfma_f32_16x16x32_bf16 v[140:143], v[80:83], v[16:19], v[140:143]
    v_mfma_f32_16x16x32_bf16 v[156:159], v[60:63], v[16:19], v[156:159]
    v_mfma_f32_16x16x32_bf16 v[160:163], v[64:67], v[16:19], v[160:163]
    v_mfma_f32_16x16x32_bf16 v[164:167], v[68:71], v[16:19], v[164:167]
    ds_read_b128 v[16:19], v2 offset:29696
    s_waitcnt lgkmcnt(3)
    v_mfma_f32_16x16x32_bf16 v[132:135], v[84:87], v[20:23], v[132:135]
    v_mfma_f32_16x16x32_bf16 v[136:139], v[88:91], v[20:23], v[136:139]
    v_mfma_f32_16x16x32_bf16 v[140:143], v[92:95], v[20:23], v[140:143]
    v_mfma_f32_16x16x32_bf16 v[156:159], v[72:75], v[20:23], v[156:159]
    v_mfma_f32_16x16x32_bf16 v[160:163], v[76:79], v[20:23], v[160:163]
    v_mfma_f32_16x16x32_bf16 v[164:167], v[80:83], v[20:23], v[164:167]
    v_mfma_f32_16x16x32_bf16 v[180:183], v[60:63], v[20:23], v[180:183]
    v_mfma_f32_16x16x32_bf16 v[184:187], v[64:67], v[20:23], v[184:187]
    v_mfma_f32_16x16x32_bf16 v[188:191], v[68:71], v[20:23], v[188:191]
    ds_read_b128 v[20:23], v2 offset:30720
    s_waitcnt lgkmcnt(3)
    v_mfma_f32_16x16x32_bf16 v[156:159], v[84:87], v[8:11], v[156:159]
    ds_read_b32 v0, v2 offset:35288
    v_mfma_f32_16x16x32_bf16 v[160:163], v[88:91], v[8:11], v[160:163]
    v_mfma_f32_16x16x32_bf16 v[164:167], v[92:95], v[8:11], v[164:167]
    v_mfma_f32_16x16x32_bf16 v[180:183], v[72:75], v[8:11], v[180:183]
    v_mfma_f32_16x16x32_bf16 v[184:187], v[76:79], v[8:11], v[184:187]
    v_mfma_f32_16x16x32_bf16 v[188:191], v[80:83], v[8:11], v[188:191]
    v_mfma_f32_16x16x32_bf16 v[204:207], v[60:63], v[8:11], v[204:207]
    s_waitcnt lgkmcnt(0)
    v_readfirstlane_b32 s47, v0
    v_mfma_f32_16x16x32_bf16 v[208:211], v[64:67], v[8:11], v[208:211]
    s_cmp_eq_u32 s47, 4
    s_cbranch_scc0 L_CKnrdy6_spin
L_CKnrdy6:
    v_mfma_f32_16x16x32_bf16 v[212:215], v[68:71], v[8:11], v[212:215]
    ds_read_b128 v[8:11], v1 offset:0
    v_mfma_f32_16x16x32_bf16 v[180:183], v[84:87], v[12:15], v[180:183]
    v_mfma_f32_16x16x32_bf16 v[184:187], v[88:91], v[12:15], v[184:187]
    v_mfma_f32_16x16x32_bf16 v[188:191], v[92:95], v[12:15], v[188:191]
    v_mfma_f32_16x16x32_bf16 v[204:207], v[72:75], v[12:15], v[204:207]
    v_mfma_f32_16x16x32_bf16 v[208:211], v[76:79], v[12:15], v[208:211]
    s_mov_b32 s53, 184320
    v_mfma_f32_16x16x32_bf16 v[212:215], v[80:83], v[12:15], v[212:215]
    v_mfma_f32_16x16x32_bf16 v[228:231], v[60:63], v[12:15], v[228:231]
    buffer_load_dwordx4 v[60:63], v7, s[16:19], s53 offen offset:0 sc1
    v_mfma_f32_16x16x32_bf16 v[232:235], v[64:67], v[12:15], v[232:235]
    v_mfma_f32_16x16x32_bf16 v[236:239], v[68:71], v[12:15], v[236:239]
    ds_read_b128 v[12:15], v1 offset:1024
    v_mfma_f32_16x16x32_bf16 v[204:207], v[84:87], v[16:19], v[204:207]
    buffer_load_dwordx4 v[64:67], v253, s[16:19], s53 offen offset:0 sc1
    v_mfma_f32_16x16x32_bf16 v[208:211], v[88:91], v[16:19], v[208:211]
    v_mfma_f32_16x16x32_bf16 v[212:215], v[92:95], v[16:19], v[212:215]
    buffer_load_dwordx4 v[68:71], v254, s[16:19], s53 offen offset:0 sc1
    v_mfma_f32_16x16x32_bf16 v[228:231], v[72:75], v[16:19], v[228:231]
    v_mfma_f32_16x16x32_bf16 v[232:235], v[76:79], v[16:19], v[232:235]
    v_mfma_f32_16x16x32_bf16 v[236:239], v[80:83], v[16:19], v[236:239]
    ds_read_b128 v[16:19], v1 offset:2048
    v_mfma_f32_16x16x32_bf16 v[228:231], v[84:87], v[20:23], v[228:231]
    ds_write_b32 v255, v252 offset:336
    buffer_load_dwordx4 v[72:75], v7, s[16:19], s53 offen offset:1024 sc1
    v_mfma_f32_16x16x32_bf16 v[232:235], v[88:91], v[20:23], v[232:235]
    v_mfma_f32_16x16x32_bf16 v[236:239], v[92:95], v[20:23], v[236:239]
    ds_read_b128 v[20:23], v1 offset:3072
    s_waitcnt vmcnt(10) lgkmcnt(4)
    v_mfma_f32_16x16x32_bf16 v[248:251], v[24:27], v[8:11], v[248:251]
    buffer_load_dwordx4 v[76:79], v253, s[16:19], s53 offen offset:1024 sc1
    v_mfma_f32_16x16x32_bf16 v[96:99], v[28:31], v[8:11], v[96:99]
    v_mfma_f32_16x16x32_bf16 v[100:103], v[32:35], v[8:11], v[100:103]
    ds_read_b128 v[8:11], v1 offset:4096
    s_waitcnt vmcnt(8) lgkmcnt(4)
    v_mfma_f32_16x16x32_bf16 v[248:251], v[36:39], v[12:15], v[248:251]
    buffer_load_dwordx4 v[80:83], v254, s[16:19], s53 offen offset:1024 sc1
    v_mfma_f32_16x16x32_bf16 v[96:99], v[40:43], v[12:15], v[96:99]
    v_mfma_f32_16x16x32_bf16 v[100:103], v[44:47], v[12:15], v[100:103]
    buffer_load_dwordx4 v[84:87], v7, s[16:19], s53 offen offset:2048 sc1
    v_mfma_f32_16x16x32_bf16 v[104:107], v[24:27], v[12:15], v[104:107]
    v_mfma_f32_16x16x32_bf16 v[120:123], v[28:31], v[12:15], v[120:123]
    buffer_load_dwordx4 v[88:91], v253, s[16:19], s53 offen offset:2048 sc1
    v_mfma_f32_16x16x32_bf16 v[124:127], v[32:35], v[12:15], v[124:127]
    ds_read_b128 v[12:15], v1 offset:5120
    s_waitcnt vmcnt(8) lgkmcnt(4)
    v_mfma_f32_16x16x32_bf16 v[248:251], v[48:51], v[16:19], v[248:251]
    v_mfma_f32_16x16x32_bf16 v[96:99], v[52:55], v[16:19], v[96:99]
    buffer_load_dwordx4 v[92:95], v254, s[16:19], s53 offen offset:2048 sc1
    v_mfma_f32_16x16x32_bf16 v[100:103], v[56:59], v[16:19], v[100:103]
    v_mfma_f32_16x16x32_bf16 v[104:107], v[36:39], v[16:19], v[104:107]
    v_mfma_f32_16x16x32_bf16 v[120:123], v[40:43], v[16:19], v[120:123]
    v_mfma_f32_16x16x32_bf16 v[124:127], v[44:47], v[16:19], v[124:127]
    v_mfma_f32_16x16x32_bf16 v[128:131], v[24:27], v[16:19], v[128:131]
    v_mfma_f32_16x16x32_bf16 v[144:147], v[28:31], v[16:19], v[144:147]
    v_mfma_f32_16x16x32_bf16 v[148:151], v[32:35], v[16:19], v[148:151]
    ds_read_b128 v[16:19], v1 offset:6144
    s_waitcnt lgkmcnt(3)
    v_mfma_f32_16x16x32_bf16 v[104:107], v[48:51], v[20:23], v[104:107]
    v_mfma_f32_16x16x32_bf16 v[120:123], v[52:55], v[20:23], v[120:123]
    v_mfma_f32_16x16x32_bf16 v[124:127], v[56:59], v[20:23], v[124:127]
    v_mfma_f32_16x16x32_bf16 v[128:131], v[36:39], v[20:23], v[128:131]
    v_mfma_f32_16x16x32_bf16 v[144:147], v[40:43], v[20:23], v[144:147]
    v_mfma_f32_16x16x32_bf16 v[148:151], v[44:47], v[20:23], v[148:151]
    v_mfma_f32_16x16x32_bf16 v[152:155], v[24:27], v[20:23], v[152:155]
    v_mfma_f32_16x16x32_bf16 v[168:171], v[28:31], v[20:23], v[168:171]
    v_mfma_f32_16x16x32_bf16 v[172:175], v[32:35], v[20:23], v[172:175]
    ds_read_b128 v[20:23], v1 offset:7168
    s_waitcnt lgkmcnt(3)
    v_mfma_f32_16x16x32_bf16 v[128:131], v[48:51], v[8:11], v[128:131]
    v_mfma_f32_16x16x32_bf16 v[144:147], v[52:55], v[8:11], v[144:147]
    v_mfma_f32_16x16x32_bf16 v[148:151], v[56:59], v[8:11], v[148:151]
    v_mfma_f32_16x16x32_bf16 v[152:155], v[36:39], v[8:11], v[152:155]
    v_mfma_f32_16x16x32_bf16 v[168:171], v[40:43], v[8:11], v[168:171]
    v_mfma_f32_16x16x32_bf16 v[172:175], v[44:47], v[8:11], v[172:175]
    v_mfma_f32_16x16x32_bf16 v[176:179], v[24:27], v[8:11], v[176:179]
    v_mfma_f32_16x16x32_bf16 v[192:195], v[28:31], v[8:11], v[192:195]
    v_mfma_f32_16x16x32_bf16 v[196:199], v[32:35], v[8:11], v[196:199]
    ds_read_b128 v[8:11], v1 offset:11264
    s_waitcnt lgkmcnt(3)
    v_mfma_f32_16x16x32_bf16 v[152:155], v[48:51], v[12:15], v[152:155]
    v_mfma_f32_16x16x32_bf16 v[168:171], v[52:55], v[12:15], v[168:171]
    v_mfma_f32_16x16x32_bf16 v[172:175], v[56:59], v[12:15], v[172:175]
    v_mfma_f32_16x16x32_bf16 v[176:179], v[36:39], v[12:15], v[176:179]
    v_mfma_f32_16x16x32_bf16 v[192:195], v[40:43], v[12:15], v[192:195]
    s_mov_b32 s53, 368640
    v_mfma_f32_16x16x32_bf16 v[196:199], v[44:47], v[12:15], v[196:199]
    v_mfma_f32_16x16x32_bf16 v[200:203], v[24:27], v[12:15], v[200:203]
    buffer_load_dwordx4 v[24:27], v7, s[16:19], s53 offen offset:0 sc1
    v_mfma_f32_16x16x32_bf16 v[216:219], v[28:31], v[12:15], v[216:219]
    v_mfma_f32_16x16x32_bf16 v[220:223], v[32:35], v[12:15], v[220:223]
    ds_read_b128 v[12:15], v1 offset:12288
    s_waitcnt lgkmcnt(3)
    v_mfma_f32_16x16x32_bf16 v[176:179], v[48:51], v[16:19], v[176:179]
    buffer_load_dwordx4 v[28:31], v253, s[16:19], s53 offen offset:0 sc1
    v_mfma_f32_16x16x32_bf16 v[192:195], v[52:55], v[16:19], v[192:195]
    v_mfma_f32_16x16x32_bf16 v[196:199], v[56:59], v[16:19], v[196:199]
    buffer_load_dwordx4 v[32:35], v254, s[16:19], s53 offen offset:0 sc1
    v_mfma_f32_16x16x32_bf16 v[200:203], v[36:39], v[16:19], v[200:203]
    v_mfma_f32_16x16x32_bf16 v[216:219], v[40:43], v[16:19], v[216:219]
    v_mfma_f32_16x16x32_bf16 v[220:223], v[44:47], v[16:19], v[220:223]
    ds_read_b128 v[16:19], v1 offset:13312
    s_waitcnt lgkmcnt(3)
    v_mfma_f32_16x16x32_bf16 v[200:203], v[48:51], v[20:23], v[200:203]
    buffer_load_dwordx4 v[36:39], v7, s[16:19], s53 offen offset:1024 sc1
    v_mfma_f32_16x16x32_bf16 v[216:219], v[52:55], v[20:23], v[216:219]
    v_mfma_f32_16x16x32_bf16 v[220:223], v[56:59], v[20:23], v[220:223]
    ds_read_b128 v[20:23], v1 offset:14336
    s_waitcnt vmcnt(10) lgkmcnt(3)
    v_mfma_f32_16x16x32_bf16 v[248:251], v[60:63], v[8:11], v[248:251]
    buffer_load_dwordx4 v[40:43], v253, s[16:19], s53 offen offset:1024 sc1
    v_mfma_f32_16x16x32_bf16 v[96:99], v[64:67], v[8:11], v[96:99]
    v_mfma_f32_16x16x32_bf16 v[100:103], v[68:71], v[8:11], v[100:103]
    ds_read_b128 v[8:11], v1 offset:15360
    s_waitcnt vmcnt(8) lgkmcnt(3)
    v_mfma_f32_16x16x32_bf16 v[248:251], v[72:75], v[12:15], v[248:251]
    buffer_load_dwordx4 v[44:47], v254, s[16:19], s53 offen offset:1024 sc1
    v_mfma_f32_16x16x32_bf16 v[96:99], v[76:79], v[12:15], v[96:99]
    v_mfma_f32_16x16x32_bf16 v[100:103], v[80:83], v[12:15], v[100:103]
    buffer_load_dwordx4 v[48:51], v7, s[16:19], s53 offen offset:2048 sc1
    v_mfma_f32_16x16x32_bf16 v[104:107], v[60:63], v[12:15], v[104:107]
    v_mfma_f32_16x16x32_bf16 v[120:123], v[64:67], v[12:15], v[120:123]
    buffer_load_dwordx4 v[52:55], v253, s[16:19], s53 offen offset:2048 sc1
    v_mfma_f32_16x16x32_bf16 v[124:127], v[68:71], v[12:15], v[124:127]
    ds_read_b128 v[12:15], v1 offset:16384
    s_waitcnt vmcnt(8) lgkmcnt(3)
    v_mfma_f32_16x16x32_bf16 v[248:251], v[84:87], v[16:19], v[248:251]
    v_mfma_f32_16x16x32_bf16 v[96:99], v[88:91], v[16:19], v[96:99]
    buffer_load_dwordx4 v[56:59], v254, s[16:19], s53 offen offset:2048 sc1
    v_mfma_f32_16x16x32_bf16 v[100:103], v[92:95], v[16:19], v[100:103]
    v_mfma_f32_16x16x32_bf16 v[104:107], v[72:75], v[16:19], v[104:107]
    v_mfma_f32_16x16x32_bf16 v[120:123], v[76:79], v[16:19], v[120:123]
    v_mfma_f32_16x16x32_bf16 v[124:127], v[80:83], v[16:19], v[124:127]
    v_mfma_f32_16x16x32_bf16 v[128:131], v[60:63], v[16:19], v[128:131]
    v_mfma_f32_16x16x32_bf16 v[144:147], v[64:67], v[16:19], v[144:147]
    v_mfma_f32_16x16x32_bf16 v[148:151], v[68:71], v[16:19], v[148:151]
    ds_read_b128 v[16:19], v1 offset:17408
    s_waitcnt lgkmcnt(3)
    v_mfma_f32_16x16x32_bf16 v[104:107], v[84:87], v[20:23], v[104:107]
    v_mfma_f32_16x16x32_bf16 v[120:123], v[88:91], v[20:23], v[120:123]
    v_mfma_f32_16x16x32_bf16 v[124:127], v[92:95], v[20:23], v[124:127]
    v_mfma_f32_16x16x32_bf16 v[128:131], v[72:75], v[20:23], v[128:131]
    v_mfma_f32_16x16x32_bf16 v[144:147], v[76:79], v[20:23], v[144:147]
    v_mfma_f32_16x16x32_bf16 v[148:151], v[80:83], v[20:23], v[148:151]
    v_mfma_f32_16x16x32_bf16 v[152:155], v[60:63], v[20:23], v[152:155]
    v_mfma_f32_16x16x32_bf16 v[168:171], v[64:67], v[20:23], v[168:171]
    v_mfma_f32_16x16x32_bf16 v[172:175], v[68:71], v[20:23], v[172:175]
    ds_read_b128 v[20:23], v1 offset:18432
    s_waitcnt lgkmcnt(3)
    v_mfma_f32_16x16x32_bf16 v[128:131], v[84:87], v[8:11], v[128:131]
    ds_read_b32 v0, v2 offset:35292
    v_mfma_f32_16x16x32_bf16 v[144:147], v[88:91], v[8:11], v[144:147]
    v_mfma_f32_16x16x32_bf16 v[148:151], v[92:95], v[8:11], v[148:151]
    v_mfma_f32_16x16x32_bf16 v[152:155], v[72:75], v[8:11], v[152:155]
    v_mfma_f32_16x16x32_bf16 v[168:171], v[76:79], v[8:11], v[168:171]
    v_mfma_f32_16x16x32_bf16 v[172:175], v[80:83], v[8:11], v[172:175]
    v_mfma_f32_16x16x32_bf16 v[176:179], v[60:63], v[8:11], v[176:179]
    s_waitcnt lgkmcnt(0)
    v_readfirstlane_b32 s47, v0
    v_mfma_f32_16x16x32_bf16 v[192:195], v[64:67], v[8:11], v[192:195]
    s_cmp_eq_u32 s47, 4
    s_cbranch_scc0 L_CKnrdy7_spin
L_CKnrdy7:
    v_mfma_f32_16x16x32_bf16 v[196:199], v[68:71], v[8:11], v[196:199]
    ds_read_b128 v[8:11], v1 offset:22528
    v_mfma_f32_16x16x32_bf16 v[152:155], v[84:87], v[12:15], v[152:155]
    v_mfma_f32_16x16x32_bf16 v[168:171], v[88:91], v[12:15], v[168:171]
    v_mfma_f32_16x16x32_bf16 v[172:175], v[92:95], v[12:15], v[172:175]
    v_mfma_f32_16x16x32_bf16 v[176:179], v[72:75], v[12:15], v[176:179]
    v_mfma_f32_16x16x32_bf16 v[192:195], v[76:79], v[12:15], v[192:195]
    s_mov_b32 s53, 405504
    v_mfma_f32_16x16x32_bf16 v[196:199], v[80:83], v[12:15], v[196:199]
    v_mfma_f32_16x16x32_bf16 v[200:203], v[60:63], v[12:15], v[200:203]
    buffer_load_dwordx4 v[60:63], v7, s[16:19], s53 offen offset:0 sc1
    v_mfma_f32_16x16x32_bf16 v[216:219], v[64:67], v[12:15], v[216:219]
    v_mfma_f32_16x16x32_bf16 v[220:223], v[68:71], v[12:15], v[220:223]
    ds_read_b128 v[12:15], v1 offset:23552
    v_mfma_f32_16x16x32_bf16 v[176:179], v[84:87], v[16:19], v[176:179]
    buffer_load_dwordx4 v[64:67], v253, s[16:19], s53 offen offset:0 sc1
    v_mfma_f32_16x16x32_bf16 v[192:195], v[88:91], v[16:19], v[192:195]
    v_mfma_f32_16x16x32_bf16 v[196:199], v[92:95], v[16:19], v[196:199]
    buffer_load_dwordx4 v[68:71], v254, s[16:19], s53 offen offset:0 sc1
    v_mfma_f32_16x16x32_bf16 v[200:203], v[72:75], v[16:19], v[200:203]
    v_mfma_f32_16x16x32_bf16 v[216:219], v[76:79], v[16:19], v[216:219]
    v_mfma_f32_16x16x32_bf16 v[220:223], v[80:83], v[16:19], v[220:223]
    ds_read_b128 v[16:19], v1 offset:24576
    v_mfma_f32_16x16x32_bf16 v[200:203], v[84:87], v[20:23], v[200:203]
    ds_write_b32 v255, v252 offset:352
    buffer_load_dwordx4 v[72:75], v7, s[16:19], s53 offen offset:1024 sc1
    v_mfma_f32_16x16x32_bf16 v[216:219], v[88:91], v[20:23], v[216:219]
    v_mfma_f32_16x16x32_bf16 v[220:223], v[92:95], v[20:23], v[220:223]
    ds_read_b128 v[20:23], v1 offset:25600
    s_waitcnt vmcnt(10) lgkmcnt(4)
    v_mfma_f32_16x16x32_bf16 v[108:111], v[24:27], v[8:11], v[108:111]
    buffer_load_dwordx4 v[76:79], v253, s[16:19], s53 offen offset:1024 sc1
    v_mfma_f32_16x16x32_bf16 v[112:115], v[28:31], v[8:11], v[112:115]
    v_mfma_f32_16x16x32_bf16 v[116:119], v[32:35], v[8:11], v[116:119]
    ds_read_b128 v[8:11], v1 offset:26624
    s_waitcnt vmcnt(8) lgkmcnt(4)
    v_mfma_f32_16x16x32_bf16 v[108:111], v[36:39], v[12:15], v[108:111]
    buffer_load_dwordx4 v[80:83], v254, s[16:19], s53 offen offset:1024 sc1
    v_mfma_f32_16x16x32_bf16 v[112:115], v[40:43], v[12:15], v[112:115]
    v_mfma_f32_16x16x32_bf16 v[116:119], v[44:47], v[12:15], v[116:119]
    buffer_load_dwordx4 v[84:87], v7, s[16:19], s53 offen offset:2048 sc1
    v_mfma_f32_16x16x32_bf16 v[132:135], v[24:27], v[12:15], v[132:135]
    v_mfma_f32_16x16x32_bf16 v[136:139], v[28:31], v[12:15], v[136:139]
    buffer_load_dwordx4 v[88:91], v253, s[16:19], s53 offen offset:2048 sc1
    v_mfma_f32_16x16x32_bf16 v[140:143], v[32:35], v[12:15], v[140:143]
    ds_read_b128 v[12:15], v1 offset:27648
    s_waitcnt vmcnt(8) lgkmcnt(4)
    v_mfma_f32_16x16x32_bf16 v[108:111], v[48:51], v[16:19], v[108:111]
    v_mfma_f32_16x16x32_bf16 v[112:115], v[52:55], v[16:19], v[112:115]
    buffer_load_dwordx4 v[92:95], v254, s[16:19], s53 offen offset:2048 sc1
    v_mfma_f32_16x16x32_bf16 v[116:119], v[56:59], v[16:19], v[116:119]
    v_mfma_f32_16x16x32_bf16 v[132:135], v[36:39], v[16:19], v[132:135]
    v_mfma_f32_16x16x32_bf16 v[136:139], v[40:43], v[16:19], v[136:139]
    v_mfma_f32_16x16x32_bf16 v[140:143], v[44:47], v[16:19], v[140:143]
    v_mfma_f32_16x16x32_bf16 v[156:159], v[24:27], v[16:19], v[156:159]
    v_mfma_f32_16x16x32_bf16 v[160:163], v[28:31], v[16:19], v[160:163]
    v_mfma_f32_16x16x32_bf16 v[164:167], v[32:35], v[16:19], v[164:167]
    ds_read_b128 v[16:19], v1 offset:28672
    s_waitcnt lgkmcnt(3)
    v_mfma_f32_16x16x32_bf16 v[132:135], v[48:51], v[20:23], v[132:135]
    v_mfma_f32_16x16x32_bf16 v[136:139], v[52:55], v[20:23], v[136:139]
    v_mfma_f32_16x16x32_bf16 v[140:143], v[56:59], v[20:23], v[140:143]
    v_mfma_f32_16x16x32_bf16 v[156:159], v[36:39], v[20:23], v[156:159]
    v_mfma_f32_16x16x32_bf16 v[160:163], v[40:43], v[20:23], v[160:163]
    v_mfma_f32_16x16x32_bf16 v[164:167], v[44:47], v[20:23], v[164:167]
    v_mfma_f32_16x16x32_bf16 v[180:183], v[24:27], v[20:23], v[180:183]
    v_mfma_f32_16x16x32_bf16 v[184:187], v[28:31], v[20:23], v[184:187]
    v_mfma_f32_16x16x32_bf16 v[188:191], v[32:35], v[20:23], v[188:191]
    ds_read_b128 v[20:23], v1 offset:29696
    s_waitcnt lgkmcnt(3)
    v_mfma_f32_16x16x32_bf16 v[156:159], v[48:51], v[8:11], v[156:159]
    v_mfma_f32_16x16x32_bf16 v[160:163], v[52:55], v[8:11], v[160:163]
    v_mfma_f32_16x16x32_bf16 v[164:167], v[56:59], v[8:11], v[164:167]
    v_mfma_f32_16x16x32_bf16 v[180:183], v[36:39], v[8:11], v[180:183]
    v_mfma_f32_16x16x32_bf16 v[184:187], v[40:43], v[8:11], v[184:187]
    v_mfma_f32_16x16x32_bf16 v[188:191], v[44:47], v[8:11], v[188:191]
    v_mfma_f32_16x16x32_bf16 v[204:207], v[24:27], v[8:11], v[204:207]
    v_mfma_f32_16x16x32_bf16 v[208:211], v[28:31], v[8:11], v[208:211]
    v_mfma_f32_16x16x32_bf16 v[212:215], v[32:35], v[8:11], v[212:215]
    ds_read_b128 v[8:11], v2 offset:1024
    s_waitcnt lgkmcnt(3)
    v_mfma_f32_16x16x32_bf16 v[180:183], v[48:51], v[12:15], v[180:183]
    v_mfma_f32_16x16x32_bf16 v[184:187], v[52:55], v[12:15], v[184:187]
    v_mfma_f32_16x16x32_bf16 v[188:191], v[56:59], v[12:15], v[188:191]
    v_mfma_f32_16x16x32_bf16 v[204:207], v[36:39], v[12:15], v[204:207]
    v_mfma_f32_16x16x32_bf16 v[208:211], v[40:43], v[12:15], v[208:211]
    s_mov_b32 s53, 516096
    v_mfma_f32_16x16x32_bf16 v[212:215], v[44:47], v[12:15], v[212:215]
    v_mfma_f32_16x16x32_bf16 v[228:231], v[24:27], v[12:15], v[228:231]
    buffer_load_dwordx4 v[24:27], v7, s[16:19], s53 offen offset:0 sc1
    v_mfma_f32_16x16x32_bf16 v[232:235], v[28:31], v[12:15], v[232:235]
    v_mfma_f32_16x16x32_bf16 v[236:239], v[32:35], v[12:15], v[236:239]
    ds_read_b128 v[12:15], v2 offset:2048
    s_waitcnt lgkmcnt(3)
    v_mfma_f32_16x16x32_bf16 v[204:207], v[48:51], v[16:19], v[204:207]
    buffer_load_dwordx4 v[28:31], v253, s[16:19], s53 offen offset:0 sc1
    v_mfma_f32_16x16x32_bf16 v[208:211], v[52:55], v[16:19], v[208:211]
    v_mfma_f32_16x16x32_bf16 v[212:215], v[56:59], v[16:19], v[212:215]
    buffer_load_dwordx4 v[32:35], v254, s[16:19], s53 offen offset:0 sc1
    v_mfma_f32_16x16x32_bf16 v[228:231], v[36:39], v[16:19], v[228:231]
    v_mfma_f32_16x16x32_bf16 v[232:235], v[40:43], v[16:19], v[232:235]
    v_mfma_f32_16x16x32_bf16 v[236:239], v[44:47], v[16:19], v[236:239]
    ds_read_b128 v[16:19], v2 offset:3072
    s_waitcnt lgkmcnt(3)
    v_mfma_f32_16x16x32_bf16 v[228:231], v[48:51], v[20:23], v[228:231]
    buffer_load_dwordx4 v[36:39], v7, s[16:19], s53 offen offset:1024 sc1
    v_mfma_f32_16x16x32_bf16 v[232:235], v[52:55], v[20:23], v[232:235]
    v_mfma_f32_16x16x32_bf16 v[236:239], v[56:59], v[20:23], v[236:239]
    ds_read_b128 v[20:23], v2 offset:4096
    s_waitcnt vmcnt(10) lgkmcnt(3)
    v_mfma_f32_16x16x32_bf16 v[108:111], v[60:63], v[8:11], v[108:111]
    buffer_load_dwordx4 v[40:43], v253, s[16:19], s53 offen offset:1024 sc1
    v_mfma_f32_16x16x32_bf16 v[112:115], v[64:67], v[8:11], v[112:115]
    v_mfma_f32_16x16x32_bf16 v[116:119], v[68:71], v[8:11], v[116:119]
    ds_read_b128 v[8:11], v2 offset:5120
    s_waitcnt vmcnt(8) lgkmcnt(3)
    v_mfma_f32_16x16x32_bf16 v[108:111], v[72:75], v[12:15], v[108:111]
    buffer_load_dwordx4 v[44:47], v254, s[16:19], s53 offen offset:1024 sc1
    v_mfma_f32_16x16x32_bf16 v[112:115], v[76:79], v[12:15], v[112:115]
    v_mfma_f32_16x16x32_bf16 v[116:119], v[80:83], v[12:15], v[116:119]
    buffer_load_dwordx4 v[48:51], v7, s[16:19], s53 offen offset:2048 sc1
    v_mfma_f32_16x16x32_bf16 v[132:135], v[60:63], v[12:15], v[132:135]
    v_mfma_f32_16x16x32_bf16 v[136:139], v[64:67], v[12:15], v[136:139]
    buffer_load_dwordx4 v[52:55], v253, s[16:19], s53 offen offset:2048 sc1
    v_mfma_f32_16x16x32_bf16 v[140:143], v[68:71], v[12:15], v[140:143]
    ds_read_b128 v[12:15], v2 offset:6144
    s_waitcnt vmcnt(8) lgkmcnt(3)
    v_mfma_f32_16x16x32_bf16 v[108:111], v[84:87], v[16:19], v[108:111]
    v_mfma_f32_16x16x32_bf16 v[112:115], v[88:91], v[16:19], v[112:115]
    buffer_load_dwordx4 v[56:59], v254, s[16:19], s53 offen offset:2048 sc1
    v_mfma_f32_16x16x32_bf16 v[116:119], v[92:95], v[16:19], v[116:119]
    v_mfma_f32_16x16x32_bf16 v[132:135], v[72:75], v[16:19], v[132:135]
    v_mfma_f32_16x16x32_bf16 v[136:139], v[76:79], v[16:19], v[136:139]
    v_mfma_f32_16x16x32_bf16 v[140:143], v[80:83], v[16:19], v[140:143]
    v_mfma_f32_16x16x32_bf16 v[156:159], v[60:63], v[16:19], v[156:159]
    v_mfma_f32_16x16x32_bf16 v[160:163], v[64:67], v[16:19], v[160:163]
    v_mfma_f32_16x16x32_bf16 v[164:167], v[68:71], v[16:19], v[164:167]
    ds_read_b128 v[16:19], v2 offset:7168
    s_waitcnt lgkmcnt(3)
    v_mfma_f32_16x16x32_bf16 v[132:135], v[84:87], v[20:23], v[132:135]
    v_add_f32 v224, v248, v108
    v_add_f32 v225, v249, v109
    v_mfma_f32_16x16x32_bf16 v[136:139], v[88:91], v[20:23], v[136:139]
    v_add_f32 v226, v250, v110
    v_add_f32 v227, v251, v111
    v_mfma_f32_16x16x32_bf16 v[140:143], v[92:95], v[20:23], v[140:143]
    v_sub_f32 v108, v248, v108
    v_sub_f32 v109, v249, v109
    v_mfma_f32_16x16x32_bf16 v[156:159], v[72:75], v[20:23], v[156:159]
    v_sub_f32 v110, v250, v110
    v_sub_f32 v111, v251, v111
    v_mfma_f32_16x16x32_bf16 v[160:163], v[76:79], v[20:23], v[160:163]
    v_add_f32 v248, v96, v112
    v_add_f32 v249, v97, v113
    v_mfma_f32_16x16x32_bf16 v[164:167], v[80:83], v[20:23], v[164:167]
    v_add_f32 v250, v98, v114
    v_add_f32 v251, v99, v115
    v_mfma_f32_16x16x32_bf16 v[180:183], v[60:63], v[20:23], v[180:183]
    v_sub_f32 v112, v96, v112
    v_sub_f32 v113, v97, v113
    v_mfma_f32_16x16x32_bf16 v[184:187], v[64:67], v[20:23], v[184:187]
    v_sub_f32 v114, v98, v114
    v_sub_f32 v115, v99, v115
    v_mfma_f32_16x16x32_bf16 v[188:191], v[68:71], v[20:23], v[188:191]
    ds_read_b128 v[20:23], v2 offset:8192
    s_waitcnt lgkmcnt(3)
    v_mfma_f32_16x16x32_bf16 v[156:159], v[84:87], v[8:11], v[156:159]
    ds_read_b32 v0, v2 offset:35296
    v_add_f32 v96, v100, v116
    v_mfma_f32_16x16x32_bf16 v[160:163], v[88:91], v[8:11], v[160:163]
    v_add_f32 v97, v101, v117
    v_add_f32 v98, v102, v118
    v_mfma_f32_16x16x32_bf16 v[164:167], v[92:95], v[8:11], v[164:167]
    v_add_f32 v99, v103, v119
    v_sub_f32 v116, v100, v116
    v_mfma_f32_16x16x32_bf16 v[180:183], v[72:75], v[8:11], v[180:183]
    v_sub_f32 v117, v101, v117
    v_sub_f32 v118, v102, v118
    v_mfma_f32_16x16x32_bf16 v[184:187], v[76:79], v[8:11], v[184:187]
    v_sub_f32 v119, v103, v119
    v_add_f32 v100, v104, v132
    v_mfma_f32_16x16x32_bf16 v[188:191], v[80:83], v[8:11], v[188:191]
    v_add_f32 v101, v105, v133
    v_add_f32 v102, v106, v134
    v_mfma_f32_16x16x32_bf16 v[204:207], v[60:63], v[8:11], v[204:207]
    s_waitcnt lgkmcnt(0)
    v_readfirstlane_b32 s47, v0
    v_mfma_f32_16x16x32_bf16 v[208:211], v[64:67], v[8:11], v[208:211]
    s_cmp_eq_u32 s47, 4
    s_cbranch_scc0 L_CKnrdy8_spin
L_CKnrdy8:
    v_mfma_f32_16x16x32_bf16 v[212:215], v[68:71], v[8:11], v[212:215]
    ds_read_b128 v[8:11], v2 offset:12288
    v_mfma_f32_16x16x32_bf16 v[180:183], v[84:87], v[12:15], v[180:183]
    v_add_f32 v103, v107, v135
    v_sub_f32 v132, v104, v132
    v_mfma_f32_16x16x32_bf16 v[184:187], v[88:91], v[12:15], v[184:187]
    v_sub_f32 v133, v105, v133
    v_sub_f32 v134, v106, v134
    v_mfma_f32_16x16x32_bf16 v[188:191], v[92:95], v[12:15], v[188:191]
    v_sub_f32 v135, v107, v135
    v_add_f32 v104, v120, v136
    v_mfma_f32_16x16x32_bf16 v[204:207], v[72:75], v[12:15], v[204:207]
    v_add_f32 v105, v121, v137
    v_add_f32 v106, v122, v138
    v_mfma_f32_16x16x32_bf16 v[208:211], v[76:79], v[12:15], v[208:211]
    s_mov_b32 s53, 552960
    v_add_f32 v107, v123, v139
    v_mfma_f32_16x16x32_bf16 v[212:215], v[80:83], v[12:15], v[212:215]
    v_sub_f32 v136, v120, v136
    v_sub_f32 v137, v121, v137
    v_mfma_f32_16x16x32_bf16 v[228:231], v[60:63], v[12:15], v[228:231]
    buffer_load_dwordx4 v[60:63], v7, s[16:19], s53 offen offset:0 sc1
    v_sub_f32 v138, v122, v138
    v_mfma_f32_16x16x32_bf16 v[232:235], v[64:67], v[12:15], v[232:235]
    v_sub_f32 v139, v123, v139
    v_add_f32 v120, v124, v140
    v_add_f32 v121, v125, v141
    v_add_f32 v122, v126, v142
    v_mfma_f32_16x16x32_bf16 v[236:239], v[68:71], v[12:15], v[236:239]
    ds_read_b128 v[12:15], v2 offset:13312
    v_add_f32 v123, v127, v143
    v_mfma_f32_16x16x32_bf16 v[204:207], v[84:87], v[16:19], v[204:207]
    buffer_load_dwordx4 v[64:67], v253, s[16:19], s53 offen offset:0 sc1
    v_sub_f32 v140, v124, v140
    v_mfma_f32_16x16x32_bf16 v[208:211], v[88:91], v[16:19], v[208:211]
    v_sub_f32 v141, v125, v141
    v_sub_f32 v142, v126, v142
    v_mfma_f32_16x16x32_bf16 v[212:215], v[92:95], v[16:19], v[212:215]
    buffer_load_dwordx4 v[68:71], v254, s[16:19], s53 offen offset:0 sc1
    v_sub_f32 v143, v127, v143
    v_add_f32 v124, v128, v156
    v_add_f32 v125, v129, v157
    v_add_f32 v126, v130, v158
    v_mfma_f32_16x16x32_bf16 v[228:231], v[72:75], v[16:19], v[228:231]
    v_add_f32 v127, v131, v159
    v_sub_f32 v156, v128, v156
    v_sub_f32 v157, v129, v157
    v_mfma_f32_16x16x32_bf16 v[232:235], v[76:79], v[16:19], v[232:235]
    v_sub_f32 v158, v130, v158
    v_sub_f32 v159, v131, v159
    v_add_f32 v128, v144, v160
    v_add_f32 v129, v145, v161
    v_add_f32 v130, v146, v162
    v_mfma_f32_16x16x32_bf16 v[236:239], v[80:83], v[16:19], v[236:239]
    ds_read_b128 v[16:19], v2 offset:14336
    v_mfma_f32_16x16x32_bf16 v[228:231], v[84:87], v[20:23], v[228:231]
    ds_write_b32 v255, v252 offset:368
    buffer_load_dwordx4 v[72:75], v7, s[16:19], s53 offen offset:1024 sc1
    v_mfma_f32_16x16x32_bf16 v[232:235], v[88:91], v[20:23], v[232:235]
    v_add_f32 v131, v147, v163
    v_sub_f32 v160, v144, v160
    v_mfma_f32_16x16x32_bf16 v[236:239], v[92:95], v[20:23], v[236:239]
    ds_read_b128 v[20:23], v2 offset:15360
    s_waitcnt vmcnt(10) lgkmcnt(4)
    v_mfma_f32_16x16x32_bf16 v[224:227], v[24:27], v[8:11], v[224:227]
    buffer_load_dwordx4 v[76:79], v253, s[16:19], s53 offen offset:1024 sc1
    v_sub_f32 v161, v145, v161
    v_mfma_f32_16x16x32_bf16 v[248:251], v[28:31], v[8:11], v[248:251]
    v_sub_f32 v162, v146, v162
    v_sub_f32 v163, v147, v163
    v_add_f32 v144, v148, v164
    v_add_f32 v145, v149, v165
    v_add_f32 v146, v150, v166
    v_mfma_f32_16x16x32_bf16 v[96:99], v[32:35], v[8:11], v[96:99]
    ds_read_b128 v[8:11], v2 offset:16384
    v_add_f32 v147, v151, v167
    s_waitcnt vmcnt(8) lgkmcnt(4)
    v_mfma_f32_16x16x32_bf16 v[224:227], v[36:39], v[12:15], v[224:227]
    buffer_load_dwordx4 v[80:83], v254, s[16:19], s53 offen offset:1024 sc1
    v_sub_f32 v164, v148, v164
    v_mfma_f32_16x16x32_bf16 v[248:251], v[40:43], v[12:15], v[248:251]
    v_sub_f32 v165, v149, v165
    v_sub_f32 v166, v150, v166
    v_mfma_f32_16x16x32_bf16 v[96:99], v[44:47], v[12:15], v[96:99]
    buffer_load_dwordx4 v[84:87], v7, s[16:19], s53 offen offset:2048 sc1
    v_sub_f32 v167, v151, v167
    v_add_f32 v148, v152, v180
    v_add_f32 v149, v153, v181
    v_add_f32 v150, v154, v182
    v_mfma_f32_16x16x32_bf16 v[100:103], v[24:27], v[12:15], v[100:103]
    v_add_f32 v151, v155, v183
    v_sub_f32 v180, v152, v180
    v_mfma_f32_16x16x32_bf16 v[104:107], v[28:31], v[12:15], v[104:107]
    buffer_load_dwordx4 v[88:91], v253, s[16:19], s53 offen offset:2048 sc1
    v_sub_f32 v181, v153, v181
    v_mfma_f32_16x16x32_bf16 v[120:123], v[32:35], v[12:15], v[120:123]
    ds_read_b128 v[12:15], v2 offset:17408
    s_waitcnt vmcnt(8) lgkmcnt(4)
    v_mfma_f32_16x16x32_bf16 v[224:227], v[48:51], v[16:19], v[224:227]
    v_sub_f32 v182, v154, v182
    v_sub_f32 v183, v155, v183
    v_add_f32 v152, v168, v184
    v_mfma_f32_16x16x32_bf16 v[248:251], v[52:55], v[16:19], v[248:251]
    buffer_load_dwordx4 v[92:95], v254, s[16:19], s53 offen offset:2048 sc1
    v_add_f32 v153, v169, v185
    v_mfma_f32_16x16x32_bf16 v[96:99], v[56:59], v[16:19], v[96:99]
    v_add_f32 v154, v170, v186
    v_add_f32 v155, v171, v187
    v_mfma_f32_16x16x32_bf16 v[100:103], v[36:39], v[16:19], v[100:103]
    v_sub_f32 v184, v168, v184
    v_sub_f32 v185, v169, v185
    v_mfma_f32_16x16x32_bf16 v[104:107], v[40:43], v[16:19], v[104:107]
    v_sub_f32 v186, v170, v186
    v_sub_f32 v187, v171, v187
    v_add_f32 v168, v172, v188
    v_add_f32 v169, v173, v189
    v_mfma_f32_16x16x32_bf16 v[120:123], v[44:47], v[16:19], v[120:123]
    v_add_f32 v170, v174, v190
    v_add_f32 v171, v175, v191
    v_mfma_f32_16x16x32_bf16 v[124:127], v[24:27], v[16:19], v[124:127]
    v_sub_f32 v188, v172, v188
    v_sub_f32 v189, v173, v189
    v_mfma_f32_16x16x32_bf16 v[128:131], v[28:31], v[16:19], v[128:131]
    v_sub_f32 v190, v174, v190
    v_sub_f32 v191, v175, v191
    v_mfma_f32_16x16x32_bf16 v[144:147], v[32:35], v[16:19], v[144:147]
    ds_read_b128 v[16:19], v2 offset:18432
    s_waitcnt lgkmcnt(3)
    v_mfma_f32_16x16x32_bf16 v[100:103], v[48:51], v[20:23], v[100:103]
    v_add_f32 v172, v176, v204
    v_add_f32 v173, v177, v205
    v_mfma_f32_16x16x32_bf16 v[104:107], v[52:55], v[20:23], v[104:107]
    v_add_f32 v174, v178, v206
    v_add_f32 v175, v179, v207
    v_mfma_f32_16x16x32_bf16 v[120:123], v[56:59], v[20:23], v[120:123]
    v_sub_f32 v204, v176, v204
    v_sub_f32 v205, v177, v205
    v_mfma_f32_16x16x32_bf16 v[124:127], v[36:39], v[20:23], v[124:127]
    v_sub_f32 v206, v178, v206
    v_sub_f32 v207, v179, v207
    v_mfma_f32_16x16x32_bf16 v[128:131], v[40:43], v[20:23], v[128:131]
    v_add_f32 v176, v192, v208
    v_add_f32 v177, v193, v209
    v_mfma_f32_16x16x32_bf16 v[144:147], v[44:47], v[20:23], v[144:147]
    v_add_f32 v178, v194, v210
    v_add_f32 v179, v195, v211
    v_mfma_f32_16x16x32_bf16 v[148:151], v[24:27], v[20:23], v[148:151]
    v_sub_f32 v208, v192, v208
    v_sub_f32 v209, v193, v209
    v_mfma_f32_16x16x32_bf16 v[152:155], v[28:31], v[20:23], v[152:155]
    v_sub_f32 v210, v194, v210
    v_sub_f32 v211, v195, v211
    v_add_f32 v192, v196, v212
    v_add_f32 v193, v197, v213
    v_mfma_f32_16x16x32_bf16 v[168:171], v[32:35], v[20:23], v[168:171]
    ds_read_b128 v[20:23], v2 offset:19456
    s_waitcnt lgkmcnt(3)
    v_mfma_f32_16x16x32_bf16 v[124:127], v[48:51], v[8:11], v[124:127]
    v_add_f32 v194, v198, v214
    v_add_f32 v195, v199, v215
    v_mfma_f32_16x16x32_bf16 v[128:131], v[52:55], v[8:11], v[128:131]
    v_sub_f32 v212, v196, v212
    v_sub_f32 v213, v197, v213
    v_mfma_f32_16x16x32_bf16 v[144:147], v[56:59], v[8:11], v[144:147]
    v_sub_f32 v214, v198, v214
    v_sub_f32 v215, v199, v215
    v_mfma_f32_16x16x32_bf16 v[148:151], v[36:39], v[8:11], v[148:151]
    v_add_f32 v196, v200, v228
    v_add_f32 v197, v201, v229
    v_mfma_f32_16x16x32_bf16 v[152:155], v[40:43], v[8:11], v[152:155]
    v_add_f32 v198, v202, v230
    v_add_f32 v199, v203, v231
    v_mfma_f32_16x16x32_bf16 v[168:171], v[44:47], v[8:11], v[168:171]
    v_sub_f32 v228, v200, v228
    v_sub_f32 v229, v201, v229
    v_mfma_f32_16x16x32_bf16 v[172:175], v[24:27], v[8:11], v[172:175]
    v_sub_f32 v230, v202, v230
    v_sub_f32 v231, v203, v231
    v_add_f32 v200, v216, v232
    v_add_f32 v201, v217, v233
    v_mfma_f32_16x16x32_bf16 v[176:179], v[28:31], v[8:11], v[176:179]
    v_add_f32 v202, v218, v234
    v_add_f32 v203, v219, v235
    v_mfma_f32_16x16x32_bf16 v[192:195], v[32:35], v[8:11], v[192:195]
    ds_read_b128 v[8:11], v2 offset:23552
    s_waitcnt lgkmcnt(3)
    v_mfma_f32_16x16x32_bf16 v[148:151], v[48:51], v[12:15], v[148:151]
    v_sub_f32 v232, v216, v232
    v_sub_f32 v233, v217, v233
    v_mfma_f32_16x16x32_bf16 v[152:155], v[52:55], v[12:15], v[152:155]
    v_sub_f32 v234, v218, v234
    v_sub_f32 v235, v219, v235
    v_add_f32 v216, v220, v236
    v_mfma_f32_16x16x32_bf16 v[168:171], v[56:59], v[12:15], v[168:171]
    v_add_f32 v217, v221, v237
    v_add_f32 v218, v222, v238
    v_mfma_f32_16x16x32_bf16 v[172:175], v[36:39], v[12:15], v[172:175]
    v_add_f32 v219, v223, v239
    v_sub_f32 v236, v220, v236
    v_mfma_f32_16x16x32_bf16 v[176:179], v[40:43], v[12:15], v[176:179]
    s_mov_b32 s53, 589824
    v_sub_f32 v237, v221, v237
    v_mfma_f32_16x16x32_bf16 v[192:195], v[44:47], v[12:15], v[192:195]
    v_sub_f32 v238, v222, v238
    v_sub_f32 v239, v223, v239
    v_mfma_f32_16x16x32_bf16 v[196:199], v[24:27], v[12:15], v[196:199]
    buffer_load_dwordx4 v[24:27], v7, s[16:19], s53 offen offset:0 sc1
    v_mfma_f32_16x16x32_bf16 v[200:203], v[28:31], v[12:15], v[200:203]
    v_mfma_f32_16x16x32_bf16 v[216:219], v[32:35], v[12:15], v[216:219]
    ds_read_b128 v[12:15], v2 offset:24576
    s_waitcnt lgkmcnt(3)
    v_mfma_f32_16x16x32_bf16 v[172:175], v[48:51], v[16:19], v[172:175]
    buffer_load_dwordx4 v[28:31], v253, s[16:19], s53 offen offset:0 sc1
    v_mfma_f32_16x16x32_bf16 v[176:179], v[52:55], v[16:19], v[176:179]
    v_mfma_f32_16x16x32_bf16 v[192:195], v[56:59], v[16:19], v[192:195]
    buffer_load_dwordx4 v[32:35], v254, s[16:19], s53 offen offset:0 sc1
    v_mfma_f32_16x16x32_bf16 v[196:199], v[36:39], v[16:19], v[196:199]
    v_mfma_f32_16x16x32_bf16 v[200:203], v[40:43], v[16:19], v[200:203]
    v_mfma_f32_16x16x32_bf16 v[216:219], v[44:47], v[16:19], v[216:219]
    ds_read_b128 v[16:19], v2 offset:25600
    s_waitcnt lgkmcnt(3)
    v_mfma_f32_16x16x32_bf16 v[196:199], v[48:51], v[20:23], v[196:199]
    buffer_load_dwordx4 v[36:39], v7, s[16:19], s53 offen offset:1024 sc1
    v_mfma_f32_16x16x32_bf16 v[200:203], v[52:55], v[20:23], v[200:203]
    v_mfma_f32_16x16x32_bf16 v[216:219], v[56:59], v[20:23], v[216:219]
    ds_read_b128 v[20:23], v2 offset:26624
    s_waitcnt vmcnt(10) lgkmcnt(3)
    v_mfma_f32_16x16x32_bf16 v[224:227], v[60:63], v[8:11], v[224:227]
    buffer_load_dwordx4 v[40:43], v253, s[16:19], s53 offen offset:1024 sc1
    v_mfma_f32_16x16x32_bf16 v[248:251], v[64:67], v[8:11], v[248:251]
    v_mfma_f32_16x16x32_bf16 v[96:99], v[68:71], v[8:11], v[96:99]
    ds_read_b128 v[8:11], v2 offset:27648
    s_waitcnt vmcnt(8) lgkmcnt(3)
    v_mfma_f32_16x16x32_bf16 v[224:227], v[72:75], v[12:15], v[224:227]
    buffer_load_dwordx4 v[44:47], v254, s[16:19], s53 offen offset:1024 sc1
    v_mfma_f32_16x16x32_bf16 v[248:251], v[76:79], v[12:15], v[248:251]
    v_mfma_f32_16x16x32_bf16 v[96:99], v[80:83], v[12:15], v[96:99]
    buffer_load_dwordx4 v[48:51], v7, s[16:19], s53 offen offset:2048 sc1
    v_mfma_f32_16x16x32_bf16 v[100:103], v[60:63], v[12:15], v[100:103]
    v_mfma_f32_16x16x32_bf16 v[104:107], v[64:67], v[12:15], v[104:107]
    buffer_load_dwordx4 v[52:55], v253, s[16:19], s53 offen offset:2048 sc1
    v_mfma_f32_16x16x32_bf16 v[120:123], v[68:71], v[12:15], v[120:123]
    ds_read_b128 v[12:15], v2 offset:28672
    s_waitcnt vmcnt(8) lgkmcnt(3)
    v_mfma_f32_16x16x32_bf16 v[224:227], v[84:87], v[16:19], v[224:227]
    v_mfma_f32_16x16x32_bf16 v[248:251], v[88:91], v[16:19], v[248:251]
    buffer_load_dwordx4 v[56:59], v254, s[16:19], s53 offen offset:2048 sc1
    v_mfma_f32_16x16x32_bf16 v[96:99], v[92:95], v[16:19], v[96:99]
    v_mfma_f32_16x16x32_bf16 v[100:103], v[72:75], v[16:19], v[100:103]
    v_mfma_f32_16x16x32_bf16 v[104:107], v[76:79], v[16:19], v[104:107]
    v_mfma_f32_16x16x32_bf16 v[120:123], v[80:83], v[16:19], v[120:123]
    v_mfma_f32_16x16x32_bf16 v[124:127], v[60:63], v[16:19], v[124:127]
    v_mfma_f32_16x16x32_bf16 v[128:131], v[64:67], v[16:19], v[128:131]
    v_mfma_f32_16x16x32_bf16 v[144:147], v[68:71], v[16:19], v[144:147]
    ds_read_b128 v[16:19], v2 offset:29696
    s_waitcnt lgkmcnt(3)
    v_mfma_f32_16x16x32_bf16 v[100:103], v[84:87], v[20:23], v[100:103]
    v_mfma_f32_16x16x32_bf16 v[104:107], v[88:91], v[20:23], v[104:107]
    v_mfma_f32_16x16x32_bf16 v[120:123], v[92:95], v[20:23], v[120:123]
    v_mfma_f32_16x16x32_bf16 v[124:127], v[72:75], v[20:23], v[124:127]
    v_mfma_f32_16x16x32_bf16 v[128:131], v[76:79], v[20:23], v[128:131]
    v_mfma_f32_16x16x32_bf16 v[144:147], v[80:83], v[20:23], v[144:147]
    v_mfma_f32_16x16x32_bf16 v[148:151], v[60:63], v[20:23], v[148:151]
    v_mfma_f32_16x16x32_bf16 v[152:155], v[64:67], v[20:23], v[152:155]
    v_mfma_f32_16x16x32_bf16 v[168:171], v[68:71], v[20:23], v[168:171]
    ds_read_b128 v[20:23], v2 offset:30720
    s_waitcnt lgkmcnt(3)
    v_mfma_f32_16x16x32_bf16 v[124:127], v[84:87], v[8:11], v[124:127]
    ds_read_b32 v0, v2 offset:35300
    v_mfma_f32_16x16x32_bf16 v[128:131], v[88:91], v[8:11], v[128:131]
    v_mfma_f32_16x16x32_bf16 v[144:147], v[92:95], v[8:11], v[144:147]
    v_mfma_f32_16x16x32_bf16 v[148:151], v[72:75], v[8:11], v[148:151]
    v_mfma_f32_16x16x32_bf16 v[152:155], v[76:79], v[8:11], v[152:155]
    v_mfma_f32_16x16x32_bf16 v[168:171], v[80:83], v[8:11], v[168:171]
    v_mfma_f32_16x16x32_bf16 v[172:175], v[60:63], v[8:11], v[172:175]
    s_waitcnt lgkmcnt(0)
    v_readfirstlane_b32 s47, v0
    v_mfma_f32_16x16x32_bf16 v[176:179], v[64:67], v[8:11], v[176:179]
    s_cmp_eq_u32 s47, 4
    s_cbranch_scc0 L_CKnrdy9_spin
L_CKnrdy9:
    v_mfma_f32_16x16x32_bf16 v[192:195], v[68:71], v[8:11], v[192:195]
    ds_read_b128 v[8:11], v1 offset:0
    v_mfma_f32_16x16x32_bf16 v[148:151], v[84:87], v[12:15], v[148:151]
    v_mfma_f32_16x16x32_bf16 v[152:155], v[88:91], v[12:15], v[152:155]
    v_mfma_f32_16x16x32_bf16 v[168:171], v[92:95], v[12:15], v[168:171]
    v_mfma_f32_16x16x32_bf16 v[172:175], v[72:75], v[12:15], v[172:175]
    v_mfma_f32_16x16x32_bf16 v[176:179], v[76:79], v[12:15], v[176:179]
    s_mov_b32 s53, 626688
    v_mfma_f32_16x16x32_bf16 v[192:195], v[80:83], v[12:15], v[192:195]
    v_mfma_f32_16x16x32_bf16 v[196:199], v[60:63], v[12:15], v[196:199]
    buffer_load_dwordx4 v[60:63], v7, s[16:19], s53 offen offset:0 sc1
    v_mfma_f32_16x16x32_bf16 v[200:203], v[64:67], v[12:15], v[200:203]
    v_mfma_f32_16x16x32_bf16 v[216:219], v[68:71], v[12:15], v[216:219]
    ds_read_b128 v[12:15], v1 offset:1024
    v_mfma_f32_16x16x32_bf16 v[172:175], v[84:87], v[16:19], v[172:175]
    buffer_load_dwordx4 v[64:67], v253, s[16:19], s53 offen offset:0 sc1
    v_mfma_f32_16x16x32_bf16 v[176:179], v[88:91], v[16:19], v[176:179]
    v_mfma_f32_16x16x32_bf16 v[192:195], v[92:95], v[16:19], v[192:195]
    buffer_load_dwordx4 v[68:71], v254, s[16:19], s53 offen offset:0 sc1
    v_mfma_f32_16x16x32_bf16 v[196:199], v[72:75], v[16:19], v[196:199]
    v_mfma_f32_16x16x32_bf16 v[200:203], v[76:79], v[16:19], v[200:203]
    v_mfma_f32_16x16x32_bf16 v[216:219], v[80:83], v[16:19], v[216:219]
    ds_read_b128 v[16:19], v1 offset:2048
    v_mfma_f32_16x16x32_bf16 v[196:199], v[84:87], v[20:23], v[196:199]
    ds_write_b32 v255, v252 offset:384
    buffer_load_dwordx4 v[72:75], v7, s[16:19], s53 offen offset:1024 sc1
    v_mfma_f32_16x16x32_bf16 v[200:203], v[88:91], v[20:23], v[200:203]
    v_mfma_f32_16x16x32_bf16 v[216:219], v[92:95], v[20:23], v[216:219]
    ds_read_b128 v[20:23], v1 offset:3072
    s_waitcnt vmcnt(10) lgkmcnt(4)
    v_mfma_f32_16x16x32_bf16 v[224:227], v[24:27], v[8:11], v[224:227]
    buffer_load_dwordx4 v[76:79], v253, s[16:19], s53 offen offset:1024 sc1
    v_mfma_f32_16x16x32_bf16 v[248:251], v[28:31], v[8:11], v[248:251]
    v_mfma_f32_16x16x32_bf16 v[96:99], v[32:35], v[8:11], v[96:99]
    ds_read_b128 v[8:11], v1 offset:4096
    s_waitcnt vmcnt(8) lgkmcnt(4)
    v_mfma_f32_16x16x32_bf16 v[224:227], v[36:39], v[12:15], v[224:227]
    buffer_load_dwordx4 v[80:83], v254, s[16:19], s53 offen offset:1024 sc1
    v_mfma_f32_16x16x32_bf16 v[248:251], v[40:43], v[12:15], v[248:251]
    v_mfma_f32_16x16x32_bf16 v[96:99], v[44:47], v[12:15], v[96:99]
    buffer_load_dwordx4 v[84:87], v7, s[16:19], s53 offen offset:2048 sc1
    v_mfma_f32_16x16x32_bf16 v[100:103], v[24:27], v[12:15], v[100:103]
    v_mfma_f32_16x16x32_bf16 v[104:107], v[28:31], v[12:15], v[104:107]
    buffer_load_dwordx4 v[88:91], v253, s[16:19], s53 offen offset:2048 sc1
    v_mfma_f32_16x16x32_bf16 v[120:123], v[32:35], v[12:15], v[120:123]
    ds_read_b128 v[12:15], v1 offset:5120
    s_waitcnt vmcnt(8) lgkmcnt(4)
    v_mfma_f32_16x16x32_bf16 v[224:227], v[48:51], v[16:19], v[224:227]
    v_mfma_f32_16x16x32_bf16 v[248:251], v[52:55], v[16:19], v[248:251]
    buffer_load_dwordx4 v[92:95], v254, s[16:19], s53 offen offset:2048 sc1
    v_mfma_f32_16x16x32_bf16 v[96:99], v[56:59], v[16:19], v[96:99]
    v_mfma_f32_16x16x32_bf16 v[100:103], v[36:39], v[16:19], v[100:103]
    v_mfma_f32_16x16x32_bf16 v[104:107], v[40:43], v[16:19], v[104:107]
    v_mfma_f32_16x16x32_bf16 v[120:123], v[44:47], v[16:19], v[120:123]
    v_mfma_f32_16x16x32_bf16 v[124:127], v[24:27], v[16:19], v[124:127]
    v_mfma_f32_16x16x32_bf16 v[128:131], v[28:31], v[16:19], v[128:131]
    v_mfma_f32_16x16x32_bf16 v[144:147], v[32:35], v[16:19], v[144:147]
    ds_read_b128 v[16:19], v1 offset:6144
    s_waitcnt lgkmcnt(3)
    v_mfma_f32_16x16x32_bf16 v[100:103], v[48:51], v[20:23], v[100:103]
    v_mfma_f32_16x16x32_bf16 v[104:107], v[52:55], v[20:23], v[104:107]
    v_mfma_f32_16x16x32_bf16 v[120:123], v[56:59], v[20:23], v[120:123]
    v_mfma_f32_16x16x32_bf16 v[124:127], v[36:39], v[20:23], v[124:127]
    v_mfma_f32_16x16x32_bf16 v[128:131], v[40:43], v[20:23], v[128:131]
    v_mfma_f32_16x16x32_bf16 v[144:147], v[44:47], v[20:23], v[144:147]
    v_mfma_f32_16x16x32_bf16 v[148:151], v[24:27], v[20:23], v[148:151]
    v_mfma_f32_16x16x32_bf16 v[152:155], v[28:31], v[20:23], v[152:155]
    v_mfma_f32_16x16x32_bf16 v[168:171], v[32:35], v[20:23], v[168:171]
    ds_read_b128 v[20:23], v1 offset:7168
    s_waitcnt lgkmcnt(3)
    v_mfma_f32_16x16x32_bf16 v[124:127], v[48:51], v[8:11], v[124:127]
    v_mfma_f32_16x16x32_bf16 v[128:131], v[52:55], v[8:11], v[128:131]
    v_mfma_f32_16x16x32_bf16 v[144:147], v[56:59], v[8:11], v[144:147]
    v_mfma_f32_16x16x32_bf16 v[148:151], v[36:39], v[8:11], v[148:151]
    v_mfma_f32_16x16x32_bf16 v[152:155], v[40:43], v[8:11], v[152:155]
    v_mfma_f32_16x16x32_bf16 v[168:171], v[44:47], v[8:11], v[168:171]
    v_mfma_f32_16x16x32_bf16 v[172:175], v[24:27], v[8:11], v[172:175]
    v_mfma_f32_16x16x32_bf16 v[176:179], v[28:31], v[8:11], v[176:179]
    v_mfma_f32_16x16x32_bf16 v[192:195], v[32:35], v[8:11], v[192:195]
    ds_read_b128 v[8:11], v1 offset:11264
    s_waitcnt lgkmcnt(3)
    v_mfma_f32_16x16x32_bf16 v[148:151], v[48:51], v[12:15], v[148:151]
    v_mfma_f32_16x16x32_bf16 v[152:155], v[52:55], v[12:15], v[152:155]
    v_mfma_f32_16x16x32_bf16 v[168:171], v[56:59], v[12:15], v[168:171]
    v_mfma_f32_16x16x32_bf16 v[172:175], v[36:39], v[12:15], v[172:175]
    v_mfma_f32_16x16x32_bf16 v[176:179], v[40:43], v[12:15], v[176:179]
    s_mov_b32 s53, 737280
    v_mfma_f32_16x16x32_bf16 v[192:195], v[44:47], v[12:15], v[192:195]
    v_mfma_f32_16x16x32_bf16 v[196:199], v[24:27], v[12:15], v[196:199]
    buffer_load_dwordx4 v[24:27], v7, s[16:19], s53 offen offset:0 sc1
    v_mfma_f32_16x16x32_bf16 v[200:203], v[28:31], v[12:15], v[200:203]
    v_mfma_f32_16x16x32_bf16 v[216:219], v[32:35], v[12:15], v[216:219]
    ds_read_b128 v[12:15], v1 offset:12288
    s_waitcnt lgkmcnt(3)
    v_mfma_f32_16x16x32_bf16 v[172:175], v[48:51], v[16:19], v[172:175]
    buffer_load_dwordx4 v[28:31], v253, s[16:19], s53 offen offset:0 sc1
    v_mfma_f32_16x16x32_bf16 v[176:179], v[52:55], v[16:19], v[176:179]
    v_mfma_f32_16x16x32_bf16 v[192:195], v[56:59], v[16:19], v[192:195]
    buffer_load_dwordx4 v[32:35], v254, s[16:19], s53 offen offset:0 sc1
    v_mfma_f32_16x16x32_bf16 v[196:199], v[36:39], v[16:19], v[196:199]
    v_mfma_f32_16x16x32_bf16 v[200:203], v[40:43], v[16:19], v[200:203]
    v_mfma_f32_16x16x32_bf16 v[216:219], v[44:47], v[16:19], v[216:219]
    ds_read_b128 v[16:19], v1 offset:13312
    s_waitcnt lgkmcnt(3)
    v_mfma_f32_16x16x32_bf16 v[196:199], v[48:51], v[20:23], v[196:199]
    buffer_load_dwordx4 v[36:39], v7, s[16:19], s53 offen offset:1024 sc1
    v_mfma_f32_16x16x32_bf16 v[200:203], v[52:55], v[20:23], v[200:203]
    v_mfma_f32_16x16x32_bf16 v[216:219], v[56:59], v[20:23], v[216:219]
    ds_read_b128 v[20:23], v1 offset:14336
    s_waitcnt vmcnt(10) lgkmcnt(3)
    v_mfma_f32_16x16x32_bf16 v[224:227], v[60:63], v[8:11], v[224:227]
    buffer_load_dwordx4 v[40:43], v253, s[16:19], s53 offen offset:1024 sc1
    v_mfma_f32_16x16x32_bf16 v[248:251], v[64:67], v[8:11], v[248:251]
    v_mfma_f32_16x16x32_bf16 v[96:99], v[68:71], v[8:11], v[96:99]
    ds_read_b128 v[8:11], v1 offset:15360
    s_waitcnt vmcnt(8) lgkmcnt(3)
    v_mfma_f32_16x16x32_bf16 v[224:227], v[72:75], v[12:15], v[224:227]
    buffer_load_dwordx4 v[44:47], v254, s[16:19], s53 offen offset:1024 sc1
    v_mfma_f32_16x16x32_bf16 v[248:251], v[76:79], v[12:15], v[248:251]
    v_mfma_f32_16x16x32_bf16 v[96:99], v[80:83], v[12:15], v[96:99]
    buffer_load_dwordx4 v[48:51], v7, s[16:19], s53 offen offset:2048 sc1
    v_mfma_f32_16x16x32_bf16 v[100:103], v[60:63], v[12:15], v[100:103]
    v_mfma_f32_16x16x32_bf16 v[104:107], v[64:67], v[12:15], v[104:107]
    buffer_load_dwordx4 v[52:55], v253, s[16:19], s53 offen offset:2048 sc1
    v_mfma_f32_16x16x32_bf16 v[120:123], v[68:71], v[12:15], v[120:123]
    ds_read_b128 v[12:15], v1 offset:16384
    s_waitcnt vmcnt(8) lgkmcnt(3)
    v_mfma_f32_16x16x32_bf16 v[224:227], v[84:87], v[16:19], v[224:227]
    v_mfma_f32_16x16x32_bf16 v[248:251], v[88:91], v[16:19], v[248:251]
    buffer_load_dwordx4 v[56:59], v254, s[16:19], s53 offen offset:2048 sc1
    v_mfma_f32_16x16x32_bf16 v[96:99], v[92:95], v[16:19], v[96:99]
    v_mfma_f32_16x16x32_bf16 v[100:103], v[72:75], v[16:19], v[100:103]
    v_mfma_f32_16x16x32_bf16 v[104:107], v[76:79], v[16:19], v[104:107]
    v_mfma_f32_16x16x32_bf16 v[120:123], v[80:83], v[16:19], v[120:123]
    v_mfma_f32_16x16x32_bf16 v[124:127], v[60:63], v[16:19], v[124:127]
    v_mfma_f32_16x16x32_bf16 v[128:131], v[64:67], v[16:19], v[128:131]
    v_cvt_pk_bf16_f32 v224, v224, v225
    v_cvt_pk_bf16_f32 v225, v226, v227
    v_mfma_f32_16x16x32_bf16 v[144:147], v[68:71], v[16:19], v[144:147]
    ds_read_b128 v[16:19], v1 offset:17408
    s_waitcnt lgkmcnt(3)
    v_mfma_f32_16x16x32_bf16 v[100:103], v[84:87], v[20:23], v[100:103]
    ds_write_b64 v4, v[224:225] offset:0
    v_mfma_f32_16x16x32_bf16 v[104:107], v[88:91], v[20:23], v[104:107]
    v_cvt_pk_bf16_f32 v248, v248, v249
    v_cvt_pk_bf16_f32 v249, v250, v251
    v_mfma_f32_16x16x32_bf16 v[120:123], v[92:95], v[20:23], v[120:123]
    ds_write_b64 v5, v[248:249] offset:0
    v_mfma_f32_16x16x32_bf16 v[124:127], v[72:75], v[20:23], v[124:127]
    v_cvt_pk_bf16_f32 v96, v96, v97
    v_cvt_pk_bf16_f32 v97, v98, v99
    v_mfma_f32_16x16x32_bf16 v[128:131], v[76:79], v[20:23], v[128:131]
    ds_write_b64 v6, v[96:97] offset:0
    v_mfma_f32_16x16x32_bf16 v[144:147], v[80:83], v[20:23], v[144:147]
    ds_write_b32 v255, v252 offset:0
    v_cvt_pk_bf16_f32 v100, v100, v101
    v_mfma_f32_16x16x32_bf16 v[148:151], v[60:63], v[20:23], v[148:151]
    v_cvt_pk_bf16_f32 v101, v102, v103
    v_mfma_f32_16x16x32_bf16 v[152:155], v[64:67], v[20:23], v[152:155]
    ds_write_b64 v4, v[100:101] offset:6400
    v_mfma_f32_16x16x32_bf16 v[168:171], v[68:71], v[20:23], v[168:171]
    ds_read_b128 v[20:23], v1 offset:18432
    s_waitcnt lgkmcnt(8)
    v_mfma_f32_16x16x32_bf16 v[124:127], v[84:87], v[8:11], v[124:127]
    ds_read_b32 v0, v2 offset:35304
    v_cvt_pk_bf16_f32 v104, v104, v105
    v_mfma_f32_16x16x32_bf16 v[128:131], v[88:91], v[8:11], v[128:131]
    v_cvt_pk_bf16_f32 v105, v106, v107
    v_mfma_f32_16x16x32_bf16 v[144:147], v[92:95], v[8:11], v[144:147]
    ds_write_b64 v5, v[104:105] offset:6400
    v_mfma_f32_16x16x32_bf16 v[148:151], v[72:75], v[8:11], v[148:151]
    v_cvt_pk_bf16_f32 v120, v120, v121
    v_cvt_pk_bf16_f32 v121, v122, v123
    v_mfma_f32_16x16x32_bf16 v[152:155], v[76:79], v[8:11], v[152:155]
    ds_write_b64 v6, v[120:121] offset:6400
    v_mfma_f32_16x16x32_bf16 v[168:171], v[80:83], v[8:11], v[168:171]
    ds_write_b32 v255, v252 offset:16
    v_cvt_pk_bf16_f32 v124, v124, v125
    v_mfma_f32_16x16x32_bf16 v[172:175], v[60:63], v[8:11], v[172:175]
    s_waitcnt lgkmcnt(3)
    v_readfirstlane_b32 s47, v0
    v_mfma_f32_16x16x32_bf16 v[176:179], v[64:67], v[8:11], v[176:179]
    s_cmp_eq_u32 s47, 4
    s_cbranch_scc0 L_CKnrdy10_spin
L_CKnrdy10:
    v_mfma_f32_16x16x32_bf16 v[192:195], v[68:71], v[8:11], v[192:195]
    ds_read_b128 v[8:11], v1 offset:22528
    v_mfma_f32_16x16x32_bf16 v[148:151], v[84:87], v[12:15], v[148:151]
    v_cvt_pk_bf16_f32 v125, v126, v127
    v_mfma_f32_16x16x32_bf16 v[152:155], v[88:91], v[12:15], v[152:155]
    ds_write_b64 v4, v[124:125] offset:12800
    v_mfma_f32_16x16x32_bf16 v[168:171], v[92:95], v[12:15], v[168:171]
    v_cvt_pk_bf16_f32 v128, v128, v129
    v_cvt_pk_bf16_f32 v129, v130, v131
    v_mfma_f32_16x16x32_bf16 v[172:175], v[72:75], v[12:15], v[172:175]
    ds_write_b64 v5, v[128:129] offset:12800
    v_mfma_f32_16x16x32_bf16 v[176:179], v[76:79], v[12:15], v[176:179]
    s_mov_b32 s53, 774144
    v_cvt_pk_bf16_f32 v144, v144, v145
    v_mfma_f32_16x16x32_bf16 v[192:195], v[80:83], v[12:15], v[192:195]
    v_cvt_pk_bf16_f32 v145, v146, v147
    v_mfma_f32_16x16x32_bf16 v[196:199], v[60:63], v[12:15], v[196:199]
    buffer_load_dwordx4 v[60:63], v7, s[16:19], s53 offen offset:0 sc1
    v_mfma_f32_16x16x32_bf16 v[200:203], v[64:67], v[12:15], v[200:203]
    ds_write_b64 v6, v[144:145] offset:12800
    v_mfma_f32_16x16x32_bf16 v[216:219], v[68:71], v[12:15], v[216:219]
    ds_read_b128 v[12:15], v1 offset:23552
    v_mfma_f32_16x16x32_bf16 v[172:175], v[84:87], v[16:19], v[172:175]
    buffer_load_dwordx4 v[64:67], v253, s[16:19], s53 offen offset:0 sc1
    ds_write_b32 v255, v252 offset:32
    v_mfma_f32_16x16x32_bf16 v[176:179], v[88:91], v[16:19], v[176:179]
    v_cvt_pk_bf16_f32 v148, v148, v149
    v_cvt_pk_bf16_f32 v149, v150, v151
    v_mfma_f32_16x16x32_bf16 v[192:195], v[92:95], v[16:19], v[192:195]
    buffer_load_dwordx4 v[68:71], v254, s[16:19], s53 offen offset:0 sc1
    v_mfma_f32_16x16x32_bf16 v[196:199], v[72:75], v[16:19], v[196:199]
    ds_write_b64 v4, v[148:149] offset:19200
    v_mfma_f32_16x16x32_bf16 v[200:203], v[76:79], v[16:19], v[200:203]
    v_cvt_pk_bf16_f32 v152, v152, v153
    v_cvt_pk_bf16_f32 v153, v154, v155
    v_mfma_f32_16x16x32_bf16 v[216:219], v[80:83], v[16:19], v[216:219]
    ds_read_b128 v[16:19], v1 offset:24576
    v_mfma_f32_16x16x32_bf16 v[196:199], v[84:87], v[20:23], v[196:199]
    buffer_load_dwordx4 v[72:75], v7, s[16:19], s53 offen offset:1024 sc1
    v_mfma_f32_16x16x32_bf16 v[200:203], v[88:91], v[20:23], v[200:203]
    ds_write_b64 v5, v[152:153] offset:19200
    v_mfma_f32_16x16x32_bf16 v[216:219], v[92:95], v[20:23], v[216:219]
    ds_read_b128 v[20:23], v1 offset:25600
    s_waitcnt vmcnt(10) lgkmcnt(9)
    v_mfma_f32_16x16x32_bf16 v[108:111], v[24:27], v[8:11], v[108:111]
    buffer_load_dwordx4 v[76:79], v253, s[16:19], s53 offen offset:1024 sc1
    v_cvt_pk_bf16_f32 v168, v168, v169
    v_mfma_f32_16x16x32_bf16 v[112:115], v[28:31], v[8:11], v[112:115]
    v_cvt_pk_bf16_f32 v169, v170, v171
    v_mfma_f32_16x16x32_bf16 v[116:119], v[32:35], v[8:11], v[116:119]
    ds_read_b128 v[8:11], v1 offset:26624
    s_waitcnt vmcnt(8) lgkmcnt(6)
    v_mfma_f32_16x16x32_bf16 v[108:111], v[36:39], v[12:15], v[108:111]
    buffer_load_dwordx4 v[80:83], v254, s[16:19], s53 offen offset:1024 sc1
    v_mfma_f32_16x16x32_bf16 v[112:115], v[40:43], v[12:15], v[112:115]
    ds_write_b64 v6, v[168:169] offset:19200
    v_mfma_f32_16x16x32_bf16 v[116:119], v[44:47], v[12:15], v[116:119]
    buffer_load_dwordx4 v[84:87], v7, s[16:19], s53 offen offset:2048 sc1
    ds_write_b32 v255, v252 offset:48
    v_mfma_f32_16x16x32_bf16 v[132:135], v[24:27], v[12:15], v[132:135]
    v_cvt_pk_bf16_f32 v172, v172, v173
    v_cvt_pk_bf16_f32 v173, v174, v175
    v_mfma_f32_16x16x32_bf16 v[136:139], v[28:31], v[12:15], v[136:139]
    buffer_load_dwordx4 v[88:91], v253, s[16:19], s53 offen offset:2048 sc1
    v_mfma_f32_16x16x32_bf16 v[140:143], v[32:35], v[12:15], v[140:143]
    ds_read_b128 v[12:15], v1 offset:27648
    s_waitcnt vmcnt(8) lgkmcnt(6)
    v_mfma_f32_16x16x32_bf16 v[108:111], v[48:51], v[16:19], v[108:111]
    ds_write_b64 v4, v[172:173] offset:25600
    v_mfma_f32_16x16x32_bf16 v[112:115], v[52:55], v[16:19], v[112:115]
    buffer_load_dwordx4 v[92:95], v254, s[16:19], s53 offen offset:2048 sc1
    v_cvt_pk_bf16_f32 v176, v176, v177
    v_mfma_f32_16x16x32_bf16 v[116:119], v[56:59], v[16:19], v[116:119]
    v_cvt_pk_bf16_f32 v177, v178, v179
    v_mfma_f32_16x16x32_bf16 v[132:135], v[36:39], v[16:19], v[132:135]
    ds_write_b64 v5, v[176:177] offset:25600
    v_mfma_f32_16x16x32_bf16 v[136:139], v[40:43], v[16:19], v[136:139]
    v_cvt_pk_bf16_f32 v192, v192, v193
    v_cvt_pk_bf16_f32 v193, v194, v195
    v_mfma_f32_16x16x32_bf16 v[140:143], v[44:47], v[16:19], v[140:143]
    ds_write_b64 v6, v[192:193] offset:25600
    v_mfma_f32_16x16x32_bf16 v[156:159], v[24:27], v[16:19], v[156:159]
    ds_write_b32 v255, v252 offset:64
    v_cvt_pk_bf16_f32 v196, v196, v197
    v_mfma_f32_16x16x32_bf16 v[160:163], v[28:31], v[16:19], v[160:163]
    v_cvt_pk_bf16_f32 v197, v198, v199
    v_mfma_f32_16x16x32_bf16 v[164:167], v[32:35], v[16:19], v[164:167]
    ds_read_b128 v[16:19], v1 offset:28672
    s_waitcnt lgkmcnt(9)
    v_mfma_f32_16x16x32_bf16 v[132:135], v[48:51], v[20:23], v[132:135]
    ds_write_b64 v4, v[196:197] offset:32000
    v_mfma_f32_16x16x32_bf16 v[136:139], v[52:55], v[20:23], v[136:139]
    v_cvt_pk_bf16_f32 v200, v200, v201
    v_cvt_pk_bf16_f32 v201, v202, v203
    v_mfma_f32_16x16x32_bf16 v[140:143], v[56:59], v[20:23], v[140:143]
    ds_write_b64 v5, v[200:201] offset:32000
    v_mfma_f32_16x16x32_bf16 v[156:159], v[36:39], v[20:23], v[156:159]
    v_cvt_pk_bf16_f32 v216, v216, v217
    v_cvt_pk_bf16_f32 v217, v218, v219
    v_mfma_f32_16x16x32_bf16 v[160:163], v[40:43], v[20:23], v[160:163]
    ds_write_b64 v6, v[216:217] offset:32000
    v_mfma_f32_16x16x32_bf16 v[164:167], v[44:47], v[20:23], v[164:167]
    ds_write_b32 v255, v252 offset:80
    v_add_u32 v4, 38400, v4
    v_mfma_f32_16x16x32_bf16 v[180:183], v[24:27], v[20:23], v[180:183]
    v_add_u32 v5, 38400, v5
    v_add_u32 v6, 38400, v6
    v_mfma_f32_16x16x32_bf16 v[184:187], v[28:31], v[20:23], v[184:187]
    v_mfma_f32_16x16x32_bf16 v[188:191], v[32:35], v[20:23], v[188:191]
    ds_read_b128 v[20:23], v1 offset:29696
    s_waitcnt lgkmcnt(13)
    v_mfma_f32_16x16x32_bf16 v[156:159], v[48:51], v[8:11], v[156:159]
    v_mfma_f32_16x16x32_bf16 v[160:163], v[52:55], v[8:11], v[160:163]
    v_mfma_f32_16x16x32_bf16 v[164:167], v[56:59], v[8:11], v[164:167]
    v_mfma_f32_16x16x32_bf16 v[180:183], v[36:39], v[8:11], v[180:183]
    v_mfma_f32_16x16x32_bf16 v[184:187], v[40:43], v[8:11], v[184:187]
    v_mfma_f32_16x16x32_bf16 v[188:191], v[44:47], v[8:11], v[188:191]
    v_mfma_f32_16x16x32_bf16 v[204:207], v[24:27], v[8:11], v[204:207]
    v_mfma_f32_16x16x32_bf16 v[208:211], v[28:31], v[8:11], v[208:211]
    v_mfma_f32_16x16x32_bf16 v[212:215], v[32:35], v[8:11], v[212:215]
    ds_read_b128 v[8:11], v2 offset:1024
    s_waitcnt lgkmcnt(11)
    v_mfma_f32_16x16x32_bf16 v[180:183], v[48:51], v[12:15], v[180:183]
    v_mfma_f32_16x16x32_bf16 v[184:187], v[52:55], v[12:15], v[184:187]
    v_mfma_f32_16x16x32_bf16 v[188:191], v[56:59], v[12:15], v[188:191]
    v_mfma_f32_16x16x32_bf16 v[204:207], v[36:39], v[12:15], v[204:207]
    v_mfma_f32_16x16x32_bf16 v[208:211], v[40:43], v[12:15], v[208:211]
    s_mov_b32 s53, 811008
    v_mfma_f32_16x16x32_bf16 v[212:215], v[44:47], v[12:15], v[212:215]
    v_mfma_f32_16x16x32_bf16 v[228:231], v[24:27], v[12:15], v[228:231]
    buffer_load_dwordx4 v[24:27], v7, s[16:19], s53 offen offset:0 sc1
    v_mfma_f32_16x16x32_bf16 v[232:235], v[28:31], v[12:15], v[232:235]
    v_mfma_f32_16x16x32_bf16 v[236:239], v[32:35], v[12:15], v[236:239]
    ds_read_b128 v[12:15], v2 offset:2048
    s_waitcnt lgkmcnt(7)
    v_mfma_f32_16x16x32_bf16 v[204:207], v[48:51], v[16:19], v[204:207]
    buffer_load_dwordx4 v[28:31], v253, s[16:19], s53 offen offset:0 sc1
    v_mfma_f32_16x16x32_bf16 v[208:211], v[52:55], v[16:19], v[208:211]
    v_mfma_f32_16x16x32_bf16 v[212:215], v[56:59], v[16:19], v[212:215]
    buffer_load_dwordx4 v[32:35], v254, s[16:19], s53 offen offset:0 sc1
    v_mfma_f32_16x16x32_bf16 v[228:231], v[36:39], v[16:19], v[228:231]
    v_mfma_f32_16x16x32_bf16 v[232:235], v[40:43], v[16:19], v[232:235]
    v_mfma_f32_16x16x32_bf16 v[236:239], v[44:47], v[16:19], v[236:239]
    ds_read_b128 v[16:19], v2 offset:3072
    s_waitcnt lgkmcnt(3)
    v_mfma_f32_16x16x32_bf16 v[228:231], v[48:51], v[20:23], v[228:231]
    buffer_load_dwordx4 v[36:39], v7, s[16:19], s53 offen offset:1024 sc1
    v_mfma_f32_16x16x32_bf16 v[232:235], v[52:55], v[20:23], v[232:235]
    v_mfma_f32_16x16x32_bf16 v[236:239], v[56:59], v[20:23], v[236:239]
    ds_read_b128 v[20:23], v2 offset:4096
    s_waitcnt vmcnt(10) lgkmcnt(3)
    v_mfma_f32_16x16x32_bf16 v[108:111], v[60:63], v[8:11], v[108:111]
    buffer_load_dwordx4 v[40:43], v253, s[16:19], s53 offen offset:1024 sc1
    v_mfma_f32_16x16x32_bf16 v[112:115], v[64:67], v[8:11], v[112:115]
    v_mfma_f32_16x16x32_bf16 v[116:119], v[68:71], v[8:11], v[116:119]
    ds_read_b128 v[8:11], v2 offset:5120
    s_waitcnt vmcnt(8) lgkmcnt(3)
    v_mfma_f32_16x16x32_bf16 v[108:111], v[72:75], v[12:15], v[108:111]
    buffer_load_dwordx4 v[44:47], v254, s[16:19], s53 offen offset:1024 sc1
    v_mfma_f32_16x16x32_bf16 v[112:115], v[76:79], v[12:15], v[112:115]
    v_mfma_f32_16x16x32_bf16 v[116:119], v[80:83], v[12:15], v[116:119]
    buffer_load_dwordx4 v[48:51], v7, s[16:19], s53 offen offset:2048 sc1
    v_mfma_f32_16x16x32_bf16 v[132:135], v[60:63], v[12:15], v[132:135]
    v_mfma_f32_16x16x32_bf16 v[136:139], v[64:67], v[12:15], v[136:139]
    buffer_load_dwordx4 v[52:55], v253, s[16:19], s53 offen offset:2048 sc1
    v_mfma_f32_16x16x32_bf16 v[140:143], v[68:71], v[12:15], v[140:143]
    ds_read_b128 v[12:15], v2 offset:6144
    s_waitcnt vmcnt(8) lgkmcnt(3)
    v_mfma_f32_16x16x32_bf16 v[108:111], v[84:87], v[16:19], v[108:111]
    v_mfma_f32_16x16x32_bf16 v[112:115], v[88:91], v[16:19], v[112:115]
    buffer_load_dwordx4 v[56:59], v254, s[16:19], s53 offen offset:2048 sc1
    v_mfma_f32_16x16x32_bf16 v[116:119], v[92:95], v[16:19], v[116:119]
    v_mfma_f32_16x16x32_bf16 v[132:135], v[72:75], v[16:19], v[132:135]
    v_mfma_f32_16x16x32_bf16 v[136:139], v[76:79], v[16:19], v[136:139]
    v_mfma_f32_16x16x32_bf16 v[140:143], v[80:83], v[16:19], v[140:143]
    v_mfma_f32_16x16x32_bf16 v[156:159], v[60:63], v[16:19], v[156:159]
    v_mfma_f32_16x16x32_bf16 v[160:163], v[64:67], v[16:19], v[160:163]
    v_mfma_f32_16x16x32_bf16 v[164:167], v[68:71], v[16:19], v[164:167]
    ds_read_b128 v[16:19], v2 offset:7168
    s_waitcnt lgkmcnt(3)
    v_mfma_f32_16x16x32_bf16 v[132:135], v[84:87], v[20:23], v[132:135]
    v_mfma_f32_16x16x32_bf16 v[136:139], v[88:91], v[20:23], v[136:139]
    v_mfma_f32_16x16x32_bf16 v[140:143], v[92:95], v[20:23], v[140:143]
    v_mfma_f32_16x16x32_bf16 v[156:159], v[72:75], v[20:23], v[156:159]
    v_mfma_f32_16x16x32_bf16 v[160:163], v[76:79], v[20:23], v[160:163]
    v_mfma_f32_16x16x32_bf16 v[164:167], v[80:83], v[20:23], v[164:167]
    v_mfma_f32_16x16x32_bf16 v[180:183], v[60:63], v[20:23], v[180:183]
    v_mfma_f32_16x16x32_bf16 v[184:187], v[64:67], v[20:23], v[184:187]
    v_mfma_f32_16x16x32_bf16 v[188:191], v[68:71], v[20:23], v[188:191]
    ds_read_b128 v[20:23], v2 offset:8192
    s_waitcnt lgkmcnt(3)
    v_mfma_f32_16x16x32_bf16 v[156:159], v[84:87], v[8:11], v[156:159]
    ds_read_b32 v0, v2 offset:35308
    v_mfma_f32_16x16x32_bf16 v[160:163], v[88:91], v[8:11], v[160:163]
    v_mfma_f32_16x16x32_bf16 v[164:167], v[92:95], v[8:11], v[164:167]
    v_mfma_f32_16x16x32_bf16 v[180:183], v[72:75], v[8:11], v[180:183]
    v_mfma_f32_16x16x32_bf16 v[184:187], v[76:79], v[8:11], v[184:187]
    v_mfma_f32_16x16x32_bf16 v[188:191], v[80:83], v[8:11], v[188:191]
    v_mfma_f32_16x16x32_bf16 v[204:207], v[60:63], v[8:11], v[204:207]
    s_waitcnt lgkmcnt(0)
    v_readfirstlane_b32 s47, v0
    v_mfma_f32_16x16x32_bf16 v[208:211], v[64:67], v[8:11], v[208:211]
    s_cmp_eq_u32 s47, 4
    s_cbranch_scc0 L_CKnrdy11_spin
L_CKnrdy11:
    v_mfma_f32_16x16x32_bf16 v[212:215], v[68:71], v[8:11], v[212:215]
    ds_read_b128 v[8:11], v2 offset:12288
    v_mfma_f32_16x16x32_bf16 v[180:183], v[84:87], v[12:15], v[180:183]
    v_mfma_f32_16x16x32_bf16 v[184:187], v[88:91], v[12:15], v[184:187]
    v_mfma_f32_16x16x32_bf16 v[188:191], v[92:95], v[12:15], v[188:191]
    v_mfma_f32_16x16x32_bf16 v[204:207], v[72:75], v[12:15], v[204:207]
    v_mfma_f32_16x16x32_bf16 v[208:211], v[76:79], v[12:15], v[208:211]
    s_mov_b32 s53, 847872
    v_mfma_f32_16x16x32_bf16 v[212:215], v[80:83], v[12:15], v[212:215]
    v_mfma_f32_16x16x32_bf16 v[228:231], v[60:63], v[12:15], v[228:231]
    buffer_load_dwordx4 v[60:63], v7, s[16:19], s53 offen offset:0 sc1
    v_mfma_f32_16x16x32_bf16 v[232:235], v[64:67], v[12:15], v[232:235]
    v_mfma_f32_16x16x32_bf16 v[236:239], v[68:71], v[12:15], v[236:239]
    ds_read_b128 v[12:15], v2 offset:13312
    v_mfma_f32_16x16x32_bf16 v[204:207], v[84:87], v[16:19], v[204:207]
    buffer_load_dwordx4 v[64:67], v253, s[16:19], s53 offen offset:0 sc1
    v_mfma_f32_16x16x32_bf16 v[208:211], v[88:91], v[16:19], v[208:211]
    buffer_load_dwordx4 v[68:71], v254, s[16:19], s53 offen offset:0 sc1
    v_mfma_f32_16x16x32_bf16 v[212:215], v[92:95], v[16:19], v[212:215]
    v_mfma_f32_16x16x32_bf16 v[228:231], v[72:75], v[16:19], v[228:231]
    buffer_load_dwordx4 v[72:75], v7, s[16:19], s53 offen offset:1024 sc1
    v_mfma_f32_16x16x32_bf16 v[232:235], v[76:79], v[16:19], v[232:235]
    v_mfma_f32_16x16x32_bf16 v[236:239], v[80:83], v[16:19], v[236:239]
    ds_read_b128 v[16:19], v2 offset:14336
    v_mfma_f32_16x16x32_bf16 v[228:231], v[84:87], v[20:23], v[228:231]
    buffer_load_dwordx4 v[76:79], v253, s[16:19], s53 offen offset:1024 sc1
    v_mfma_f32_16x16x32_bf16 v[232:235], v[88:91], v[20:23], v[232:235]
    buffer_load_dwordx4 v[80:83], v254, s[16:19], s53 offen offset:1024 sc1
    v_mfma_f32_16x16x32_bf16 v[236:239], v[92:95], v[20:23], v[236:239]
    ds_read_b128 v[20:23], v2 offset:23552
    s_waitcnt vmcnt(12) lgkmcnt(3)
    v_mfma_f32_16x16x32_bf16 v[108:111], v[24:27], v[8:11], v[108:111]
    buffer_load_dwordx4 v[84:87], v7, s[16:19], s53 offen offset:2048 sc1
    v_mfma_f32_16x16x32_bf16 v[112:115], v[28:31], v[8:11], v[112:115]
    v_mfma_f32_16x16x32_bf16 v[116:119], v[32:35], v[8:11], v[116:119]
    ds_read_b128 v[8:11], v2 offset:15360
    s_waitcnt vmcnt(10) lgkmcnt(3)
    v_mfma_f32_16x16x32_bf16 v[108:111], v[36:39], v[12:15], v[108:111]
    buffer_load_dwordx4 v[88:91], v253, s[16:19], s53 offen offset:2048 sc1
    v_mfma_f32_16x16x32_bf16 v[112:115], v[40:43], v[12:15], v[112:115]
    buffer_load_dwordx4 v[92:95], v254, s[16:19], s53 offen offset:2048 sc1
    v_mfma_f32_16x16x32_bf16 v[116:119], v[44:47], v[12:15], v[116:119]
    ds_write_b32 v255, v252 offset:224
    v_mfma_f32_16x16x32_bf16 v[132:135], v[24:27], v[12:15], v[132:135]
    v_mfma_f32_16x16x32_bf16 v[136:139], v[28:31], v[12:15], v[136:139]
    v_mfma_f32_16x16x32_bf16 v[140:143], v[32:35], v[12:15], v[140:143]
    ds_read_b128 v[12:15], v2 offset:24576
    s_waitcnt vmcnt(9) lgkmcnt(4)
    v_mfma_f32_16x16x32_bf16 v[108:111], v[48:51], v[16:19], v[108:111]
    v_mfma_f32_16x16x32_bf16 v[112:115], v[52:55], v[16:19], v[112:115]
    v_mfma_f32_16x16x32_bf16 v[116:119], v[56:59], v[16:19], v[116:119]
    v_mfma_f32_16x16x32_bf16 v[132:135], v[36:39], v[16:19], v[132:135]
    v_mfma_f32_16x16x32_bf16 v[136:139], v[40:43], v[16:19], v[136:139]
    v_mfma_f32_16x16x32_bf16 v[140:143], v[44:47], v[16:19], v[140:143]
    v_mfma_f32_16x16x32_bf16 v[156:159], v[24:27], v[16:19], v[156:159]
    v_mfma_f32_16x16x32_bf16 v[160:163], v[28:31], v[16:19], v[160:163]
    v_mfma_f32_16x16x32_bf16 v[164:167], v[32:35], v[16:19], v[164:167]
    ds_read_b128 v[16:19], v2 offset:25600
    s_waitcnt vmcnt(6) lgkmcnt(4)
    v_mfma_f32_16x16x32_bf16 v[108:111], v[60:63], v[20:23], v[108:111]
    v_mfma_f32_16x16x32_bf16 v[112:115], v[64:67], v[20:23], v[112:115]
    v_mfma_f32_16x16x32_bf16 v[116:119], v[68:71], v[20:23], v[116:119]
    ds_read_b128 v[20:23], v2 offset:26624
    s_waitcnt lgkmcnt(4)
    v_mfma_f32_16x16x32_bf16 v[132:135], v[48:51], v[8:11], v[132:135]
    v_mfma_f32_16x16x32_bf16 v[136:139], v[52:55], v[8:11], v[136:139]
    v_mfma_f32_16x16x32_bf16 v[140:143], v[56:59], v[8:11], v[140:143]
    v_mfma_f32_16x16x32_bf16 v[156:159], v[36:39], v[8:11], v[156:159]
    v_mfma_f32_16x16x32_bf16 v[160:163], v[40:43], v[8:11], v[160:163]
    v_mfma_f32_16x16x32_bf16 v[164:167], v[44:47], v[8:11], v[164:167]
    v_mfma_f32_16x16x32_bf16 v[180:183], v[24:27], v[8:11], v[180:183]
    v_mfma_f32_16x16x32_bf16 v[184:187], v[28:31], v[8:11], v[184:187]
    v_mfma_f32_16x16x32_bf16 v[188:191], v[32:35], v[8:11], v[188:191]
    ds_read_b128 v[8:11], v2 offset:16384
    s_waitcnt vmcnt(3) lgkmcnt(3)
    v_mfma_f32_16x16x32_bf16 v[108:111], v[72:75], v[12:15], v[108:111]
    v_mfma_f32_16x16x32_bf16 v[112:115], v[76:79], v[12:15], v[112:115]
    v_mfma_f32_16x16x32_bf16 v[116:119], v[80:83], v[12:15], v[116:119]
    v_mfma_f32_16x16x32_bf16 v[132:135], v[60:63], v[12:15], v[132:135]
    v_mfma_f32_16x16x32_bf16 v[136:139], v[64:67], v[12:15], v[136:139]
    v_mfma_f32_16x16x32_bf16 v[140:143], v[68:71], v[12:15], v[140:143]
    ds_read_b128 v[12:15], v2 offset:27648
    s_waitcnt vmcnt(0) lgkmcnt(3)
    v_mfma_f32_16x16x32_bf16 v[108:111], v[84:87], v[16:19], v[108:111]
    v_mfma_f32_16x16x32_bf16 v[112:115], v[88:91], v[16:19], v[112:115]
    v_mfma_f32_16x16x32_bf16 v[116:119], v[92:95], v[16:19], v[116:119]
    v_mfma_f32_16x16x32_bf16 v[132:135], v[72:75], v[16:19], v[132:135]
    v_mfma_f32_16x16x32_bf16 v[136:139], v[76:79], v[16:19], v[136:139]
    v_mfma_f32_16x16x32_bf16 v[140:143], v[80:83], v[16:19], v[140:143]
    v_mfma_f32_16x16x32_bf16 v[156:159], v[60:63], v[16:19], v[156:159]
    v_mfma_f32_16x16x32_bf16 v[160:163], v[64:67], v[16:19], v[160:163]
    v_mfma_f32_16x16x32_bf16 v[164:167], v[68:71], v[16:19], v[164:167]
    ds_read_b128 v[16:19], v2 offset:17408
    s_waitcnt lgkmcnt(3)
    v_mfma_f32_16x16x32_bf16 v[132:135], v[84:87], v[20:23], v[132:135]
    v_cvt_pk_bf16_f32 v108, v108, v109
    v_cvt_pk_bf16_f32 v109, v110, v111
    v_mfma_f32_16x16x32_bf16 v[136:139], v[88:91], v[20:23], v[136:139]
    ds_write_b64 v4, v[108:109] offset:0
    v_mfma_f32_16x16x32_bf16 v[140:143], v[92:95], v[20:23], v[140:143]
    v_cvt_pk_bf16_f32 v112, v112, v113
    v_cvt_pk_bf16_f32 v113, v114, v115
    v_mfma_f32_16x16x32_bf16 v[156:159], v[72:75], v[20:23], v[156:159]
    ds_write_b64 v5, v[112:113] offset:0
    v_mfma_f32_16x16x32_bf16 v[160:163], v[76:79], v[20:23], v[160:163]
    v_cvt_pk_bf16_f32 v116, v116, v117
    v_cvt_pk_bf16_f32 v117, v118, v119
    v_mfma_f32_16x16x32_bf16 v[164:167], v[80:83], v[20:23], v[164:167]
    ds_write_b64 v6, v[116:117] offset:0
    v_mfma_f32_16x16x32_bf16 v[180:183], v[60:63], v[20:23], v[180:183]
    ds_write_b32 v255, v252 offset:96
    v_cvt_pk_bf16_f32 v132, v132, v133
    v_mfma_f32_16x16x32_bf16 v[184:187], v[64:67], v[20:23], v[184:187]
    v_cvt_pk_bf16_f32 v133, v134, v135
    v_mfma_f32_16x16x32_bf16 v[188:191], v[68:71], v[20:23], v[188:191]
    ds_read_b128 v[20:23], v2 offset:28672
    s_waitcnt lgkmcnt(7)
    v_mfma_f32_16x16x32_bf16 v[156:159], v[48:51], v[8:11], v[156:159]
    ds_write_b64 v4, v[132:133] offset:6400
    v_mfma_f32_16x16x32_bf16 v[160:163], v[52:55], v[8:11], v[160:163]
    v_cvt_pk_bf16_f32 v136, v136, v137
    v_cvt_pk_bf16_f32 v137, v138, v139
    v_mfma_f32_16x16x32_bf16 v[164:167], v[56:59], v[8:11], v[164:167]
    ds_write_b64 v5, v[136:137] offset:6400
    v_mfma_f32_16x16x32_bf16 v[180:183], v[36:39], v[8:11], v[180:183]
    v_cvt_pk_bf16_f32 v140, v140, v141
    v_cvt_pk_bf16_f32 v141, v142, v143
    v_mfma_f32_16x16x32_bf16 v[184:187], v[40:43], v[8:11], v[184:187]
    ds_write_b64 v6, v[140:141] offset:6400
    v_mfma_f32_16x16x32_bf16 v[188:191], v[44:47], v[8:11], v[188:191]
    ds_write_b32 v255, v252 offset:112
    v_mfma_f32_16x16x32_bf16 v[204:207], v[24:27], v[8:11], v[204:207]
    v_mfma_f32_16x16x32_bf16 v[208:211], v[28:31], v[8:11], v[208:211]
    v_mfma_f32_16x16x32_bf16 v[212:215], v[32:35], v[8:11], v[212:215]
    ds_read_b128 v[8:11], v2 offset:18432
    s_waitcnt lgkmcnt(11)
    v_mfma_f32_16x16x32_bf16 v[156:159], v[84:87], v[12:15], v[156:159]
    v_mfma_f32_16x16x32_bf16 v[160:163], v[88:91], v[12:15], v[160:163]
    v_mfma_f32_16x16x32_bf16 v[164:167], v[92:95], v[12:15], v[164:167]
    v_mfma_f32_16x16x32_bf16 v[180:183], v[72:75], v[12:15], v[180:183]
    v_mfma_f32_16x16x32_bf16 v[184:187], v[76:79], v[12:15], v[184:187]
    v_mfma_f32_16x16x32_bf16 v[188:191], v[80:83], v[12:15], v[188:191]
    v_mfma_f32_16x16x32_bf16 v[204:207], v[60:63], v[12:15], v[204:207]
    v_mfma_f32_16x16x32_bf16 v[208:211], v[64:67], v[12:15], v[208:211]
    v_mfma_f32_16x16x32_bf16 v[212:215], v[68:71], v[12:15], v[212:215]
    ds_read_b128 v[12:15], v2 offset:29696
    s_waitcnt lgkmcnt(11)
    v_mfma_f32_16x16x32_bf16 v[180:183], v[48:51], v[16:19], v[180:183]
    v_cvt_pk_bf16_f32 v156, v156, v157
    v_cvt_pk_bf16_f32 v157, v158, v159
    v_mfma_f32_16x16x32_bf16 v[184:187], v[52:55], v[16:19], v[184:187]
    ds_write_b64 v4, v[156:157] offset:12800
    v_mfma_f32_16x16x32_bf16 v[188:191], v[56:59], v[16:19], v[188:191]
    v_cvt_pk_bf16_f32 v160, v160, v161
    v_cvt_pk_bf16_f32 v161, v162, v163
    v_mfma_f32_16x16x32_bf16 v[204:207], v[36:39], v[16:19], v[204:207]
    ds_write_b64 v5, v[160:161] offset:12800
    v_mfma_f32_16x16x32_bf16 v[208:211], v[40:43], v[16:19], v[208:211]
    v_cvt_pk_bf16_f32 v164, v164, v165
    v_cvt_pk_bf16_f32 v165, v166, v167
    v_mfma_f32_16x16x32_bf16 v[212:215], v[44:47], v[16:19], v[212:215]
    ds_write_b64 v6, v[164:165] offset:12800
    v_mfma_f32_16x16x32_bf16 v[228:231], v[24:27], v[16:19], v[228:231]
    ds_write_b32 v255, v252 offset:128
    v_mfma_f32_16x16x32_bf16 v[232:235], v[28:31], v[16:19], v[232:235]
    v_mfma_f32_16x16x32_bf16 v[236:239], v[32:35], v[16:19], v[236:239]
    ds_read_b128 v[16:19], v2 offset:19456
    s_waitcnt lgkmcnt(11)
    v_mfma_f32_16x16x32_bf16 v[180:183], v[84:87], v[20:23], v[180:183]
    v_mfma_f32_16x16x32_bf16 v[184:187], v[88:91], v[20:23], v[184:187]
    v_mfma_f32_16x16x32_bf16 v[188:191], v[92:95], v[20:23], v[188:191]
    v_mfma_f32_16x16x32_bf16 v[204:207], v[72:75], v[20:23], v[204:207]
    v_mfma_f32_16x16x32_bf16 v[208:211], v[76:79], v[20:23], v[208:211]
    v_mfma_f32_16x16x32_bf16 v[212:215], v[80:83], v[20:23], v[212:215]
    v_mfma_f32_16x16x32_bf16 v[228:231], v[60:63], v[20:23], v[228:231]
    v_mfma_f32_16x16x32_bf16 v[232:235], v[64:67], v[20:23], v[232:235]
    v_mfma_f32_16x16x32_bf16 v[236:239], v[68:71], v[20:23], v[236:239]
    ds_read_b128 v[20:23], v2 offset:30720
    s_waitcnt lgkmcnt(7)
    v_mfma_f32_16x16x32_bf16 v[204:207], v[48:51], v[8:11], v[204:207]
    v_cvt_pk_bf16_f32 v180, v180, v181
    v_cvt_pk_bf16_f32 v181, v182, v183
    v_mfma_f32_16x16x32_bf16 v[208:211], v[52:55], v[8:11], v[208:211]
    ds_write_b64 v4, v[180:181] offset:19200
    v_mfma_f32_16x16x32_bf16 v[212:215], v[56:59], v[8:11], v[212:215]
    v_cvt_pk_bf16_f32 v184, v184, v185
    v_cvt_pk_bf16_f32 v185, v186, v187
    v_mfma_f32_16x16x32_bf16 v[228:231], v[36:39], v[8:11], v[228:231]
    ds_write_b64 v5, v[184:185] offset:19200
    v_mfma_f32_16x16x32_bf16 v[232:235], v[40:43], v[8:11], v[232:235]
    v_cvt_pk_bf16_f32 v188, v188, v189
    v_cvt_pk_bf16_f32 v189, v190, v191
    v_mfma_f32_16x16x32_bf16 v[236:239], v[44:47], v[8:11], v[236:239]
    s_waitcnt lgkmcnt(8)
    v_mfma_f32_16x16x32_bf16 v[204:207], v[84:87], v[12:15], v[204:207]
    ds_write_b64 v6, v[188:189] offset:19200
    v_mfma_f32_16x16x32_bf16 v[208:211], v[88:91], v[12:15], v[208:211]
    ds_write_b32 v255, v252 offset:144
    v_mfma_f32_16x16x32_bf16 v[212:215], v[92:95], v[12:15], v[212:215]
    v_mfma_f32_16x16x32_bf16 v[228:231], v[72:75], v[12:15], v[228:231]
    v_mfma_f32_16x16x32_bf16 v[232:235], v[76:79], v[12:15], v[232:235]
    v_mfma_f32_16x16x32_bf16 v[236:239], v[80:83], v[12:15], v[236:239]
    s_waitcnt lgkmcnt(5)
    v_mfma_f32_16x16x32_bf16 v[228:231], v[48:51], v[16:19], v[228:231]
    v_cvt_pk_bf16_f32 v204, v204, v205
    v_cvt_pk_bf16_f32 v205, v206, v207
    v_mfma_f32_16x16x32_bf16 v[232:235], v[52:55], v[16:19], v[232:235]
    ds_write_b64 v4, v[204:205] offset:25600
    v_mfma_f32_16x16x32_bf16 v[236:239], v[56:59], v[16:19], v[236:239]
    v_cvt_pk_bf16_f32 v208, v208, v209
    s_waitcnt lgkmcnt(5)
    v_mfma_f32_16x16x32_bf16 v[228:231], v[84:87], v[20:23], v[228:231]
    v_cvt_pk_bf16_f32 v209, v210, v211
    v_mfma_f32_16x16x32_bf16 v[232:235], v[88:91], v[20:23], v[232:235]
    ds_write_b64 v5, v[208:209] offset:25600
    v_mfma_f32_16x16x32_bf16 v[236:239], v[92:95], v[20:23], v[236:239]
    v_cvt_pk_bf16_f32 v212, v212, v213
    v_cvt_pk_bf16_f32 v213, v214, v215
    ds_write_b64 v6, v[212:213] offset:25600
    ds_write_b32 v255, v252 offset:160
    s_nop 3
    v_cvt_pk_bf16_f32 v228, v228, v229
    v_cvt_pk_bf16_f32 v229, v230, v231
    v_cvt_pk_bf16_f32 v232, v232, v233
    v_cvt_pk_bf16_f32 v233, v234, v235
    v_cvt_pk_bf16_f32 v236, v236, v237
    v_cvt_pk_bf16_f32 v237, v238, v239
    ds_write_b64 v4, v[228:229] offset:32000
    ds_write_b64 v5, v[232:233] offset:32000
    ds_write_b64 v6, v[236:237] offset:32000
    ds_write_b32 v255, v252 offset:176
    s_endpgm
L_CKnrdy0_spin:
    ds_read_b32 v0, v2 offset:35264
    s_waitcnt lgkmcnt(0)
    v_readfirstlane_b32 s47, v0
    s_cmp_eq_u32 s47, 4
    s_cbranch_scc0 L_CKnrdy0_spin
    s_branch L_CKnrdy0
L_CKnrdy1_spin:
    ds_read_b32 v0, v2 offset:35268
    s_waitcnt lgkmcnt(0)
    v_readfirstlane_b32 s47, v0
    s_cmp_eq_u32 s47, 4
    s_cbranch_scc0 L_CKnrdy1_spin
    s_branch L_CKnrdy1
L_CKnuflag_spin:
    ds_read_b32 v0, v2 offset:35056
    s_waitcnt lgkmcnt(0)
    v_readfirstlane_b32 s47, v0
    s_cmp_eq_u32 s47, 1
    s_cbranch_scc0 L_CKnuflag_spin
    s_branch L_CKnuflag
L_CKnrdy2_spin:
    ds_read_b32 v0, v2 offset:35272
    s_waitcnt lgkmcnt(0)
    v_readfirstlane_b32 s47, v0
    s_cmp_eq_u32 s47, 4
    s_cbranch_scc0 L_CKnrdy2_spin
    s_branch L_CKnrdy2
L_CKnrdy3_spin:
    ds_read_b32 v0, v2 offset:35276
    s_waitcnt lgkmcnt(0)
    v_readfirstlane_b32 s47, v0
    s_cmp_eq_u32 s47, 4
    s_cbranch_scc0 L_CKnrdy3_spin
    s_branch L_CKnrdy3
L_CKnrdy4_spin:
    ds_read_b32 v0, v2 offset:35280
    s_waitcnt lgkmcnt(0)
    v_readfirstlane_b32 s47, v0
    s_cmp_eq_u32 s47, 4
    s_cbranch_scc0 L_CKnrdy4_spin
    s_branch L_CKnrdy4
L_CKnrdy5_spin:
    ds_read_b32 v0, v2 offset:35284
    s_waitcnt lgkmcnt(0)
    v_readfirstlane_b32 s47, v0
    s_cmp_eq_u32 s47, 4
    s_cbranch_scc0 L_CKnrdy5_spin
    s_branch L_CKnrdy5
L_CKnrdy6_spin:
    ds_read_b32 v0, v2 offset:35288
    s_waitcnt lgkmcnt(0)
    v_readfirstlane_b32 s47, v0
    s_cmp_eq_u32 s47, 4
    s_cbranch_scc0 L_CKnrdy6_spin
    s_branch L_CKnrdy6
L_CKnrdy7_spin:
    ds_read_b32 v0, v2 offset:35292
    s_waitcnt lgkmcnt(0)
    v_readfirstlane_b32 s47, v0
    s_cmp_eq_u32 s47, 4
    s_cbranch_scc0 L_CKnrdy7_spin
    s_branch L_CKnrdy7
L_CKnrdy8_spin:
    ds_read_b32 v0, v2 offset:35296
    s_waitcnt lgkmcnt(0)
    v_readfirstlane_b32 s47, v0
    s_cmp_eq_u32 s47, 4
    s_cbranch_scc0 L_CKnrdy8_spin
    s_branch L_CKnrdy8
L_CKnrdy9_spin:
    ds_read_b32 v0, v2 offset:35300
    s_waitcnt lgkmcnt(0)
    v_readfirstlane_b32 s47, v0
    s_cmp_eq_u32 s47, 4
    s_cbranch_scc0 L_CKnrdy9_spin
    s_branch L_CKnrdy9
L_CKnrdy10_spin:
    ds_read_b32 v0, v2 offset:35304
    s_waitcnt lgkmcnt(0)
    v_readfirstlane_b32 s47, v0
    s_cmp_eq_u32 s47, 4
    s_cbranch_scc0 L_CKnrdy10_spin
    s_branch L_CKnrdy10
L_CKnrdy11_spin:
    ds_read_b32 v0, v2 offset:35308
    s_waitcnt lgkmcnt(0)
    v_readfirstlane_b32 s47, v0
    s_cmp_eq_u32 s47, 4
    s_cbranch_scc0 L_CKnrdy11_spin
    s_branch L_CKnrdy11
L_END:
    s_endpgm
.section .rodata,"a"
.p2align 6
.amdhsa_kernel standalone__standard_2d_1d_3d_conv__vision_kernel
  .amdhsa_next_free_vgpr 256
  .amdhsa_next_free_sgpr 102
  .amdhsa_accum_offset 256
  .amdhsa_group_segment_fixed_size 0
  .amdhsa_kernarg_size 48
  .amdhsa_user_sgpr_count 2
  .amdhsa_user_sgpr_kernarg_segment_ptr 1
  .amdhsa_system_sgpr_workgroup_id_x 1
  .amdhsa_ieee_mode 0
  .amdhsa_float_denorm_mode_32 1
.end_amdhsa_kernel
```
